```python
import torch

def _softmax(x, axis=-1):
    return torch.softmax(x, dim=axis)

def _gelu(x):
    return torch.nn.functional.gelu(x, approximate='tanh')

def _silu(x):
    return torch.nn.functional.silu(x)

def _sigmoid(x):
    return torch.sigmoid(x)

def _layernorm(x, axis=-1, eps=1e-05):
    m = x.mean(dim=axis, keepdim=True)
    v = x.var(dim=axis, keepdim=True, unbiased=False)
    return (x - m) / torch.sqrt(v + eps)

def _scatter_add(tgt, idx, src, axis=0):
    return tgt.clone().index_add_(axis, idx, src)

def _segment_sum(src, seg, n):
    out = torch.zeros((n,) + src.shape[1:], dtype=src.dtype)
    return out.index_add_(0, seg, src)

def _pad(x, pw):
    flat = tuple((v for pair in reversed(pw) for v in pair))
    return torch.nn.functional.pad(x, flat)
kernel_name = 'concat_heads__memory_aug_recurrent_mem_tr__memory_aug_recurrent_mem_tr__prompt'

def setup_inputs():

    _w = lambda a: (lambda t: t.to(torch.bfloat16) if t.is_floating_point() else t)(torch.as_tensor(a))

    def _A_setup():
        B, S, Dm = (1, 2048, 512)
        H, Dh = (32, 128)
        M, seg = (8, 32)
        seg = min(seg, S)
        S = S // seg * seg
        return {'x': _w((lambda *s: torch.randn(*s, dtype=torch.bfloat16) * 0.05)(B, S, Dm)), 'mem0': _w((lambda *s: torch.randn(*s, dtype=torch.bfloat16) * 0.4)(B, M, Dm)), 'Wq': _w((lambda *s: torch.randn(*s, dtype=torch.bfloat16) * 6.4)(Dm, H, Dh) * Dm ** (-0.5)), 'Wk': _w((lambda *s: torch.randn(*s, dtype=torch.bfloat16) * 6.4)(Dm, H, Dh) * Dm ** (-0.5)), 'Wv': _w((lambda *s: torch.randn(*s, dtype=torch.bfloat16) * 0.4)(Dm, H, Dh) * Dm ** (-0.5)), 'Wo': _w((lambda *s: torch.randn(*s, dtype=torch.bfloat16) * 0.4)(H, Dh, Dm) * (H * Dh) ** (-0.5)), 'seg_len': seg}
    _A_in = _A_setup()

    def _B_setup():
        B, S, Dm = (1, 2048, 512)
        H, Dh = (32, 128)
        M, seg = (8, 32)
        seg = min(seg, S)
        S = S // seg * seg
        return {'x': _w((lambda *s: torch.randn(*s, dtype=torch.bfloat16) * 0.05)(B, S, Dm)), 'mem0': _w((lambda *s: torch.randn(*s, dtype=torch.bfloat16) * 0.4)(B, M, Dm)), 'Wq': _w((lambda *s: torch.randn(*s, dtype=torch.bfloat16) * 6.4)(Dm, H, Dh) * Dm ** (-0.5)), 'Wk': _w((lambda *s: torch.randn(*s, dtype=torch.bfloat16) * 6.4)(Dm, H, Dh) * Dm ** (-0.5)), 'Wv': _w((lambda *s: torch.randn(*s, dtype=torch.bfloat16) * 0.4)(Dm, H, Dh) * Dm ** (-0.5)), 'Wo': _w((lambda *s: torch.randn(*s, dtype=torch.bfloat16) * 0.4)(H, Dh, Dm) * (H * Dh) ** (-0.5)), 'seg_len': seg}
    _B_in = _B_setup()
    return {'A_x': _A_in['x'], 'A_mem0': _A_in['mem0'], 'A_Wq': _A_in['Wq'], 'A_Wk': _A_in['Wk'], 'A_Wv': _A_in['Wv'], 'A_Wo': _A_in['Wo'], 'A_seg_len': _A_in['seg_len'], 'B_x': _B_in['x'], 'B_mem0': _B_in['mem0'], 'B_Wq': _B_in['Wq'], 'B_Wk': _B_in['Wk'], 'B_Wv': _B_in['Wv'], 'B_Wo': _B_in['Wo'], 'B_seg_len': _B_in['seg_len']}

def reference(A_x, A_mem0, A_Wq, A_Wk, A_Wv, A_Wo, A_seg_len, B_x, B_mem0, B_Wq, B_Wk, B_Wv, B_Wo, B_seg_len):

    def _A_ref(x, mem0, Wq, Wk, Wv, Wo, seg_len):
        B, S, Dm = x.shape
        H, Dh = (Wq.shape[1], Wq.shape[2])
        M = mem0.shape[1]
        scale = Dh ** (-0.5)
        n_seg = S // seg_len
        L = M + seg_len
        idx = torch.arange(L)
        mask = (idx[:, None] < M) | (idx[:, None] >= idx[None, :])
        mem = mem0
        outs = []
        for s in range(n_seg):
            xs = x[:, s * seg_len:(s + 1) * seg_len, :].clone()
            h = torch.concatenate([mem, xs], axis=1)
            q = torch.einsum('btd,dhe->bhte', h, Wq)
            k = torch.einsum('btd,dhe->bhte', h, Wk)
            v = torch.einsum('btd,dhe->bhte', h, Wv)
            scores = torch.einsum('bhqe,bhke->bhqk', q, k) * scale
            scores = torch.where(mask[None, None], scores, -1000000000.0)
            p = _softmax(scores, axis=-1)
            o = torch.einsum('bhqk,bhke->bhqe', p, v)
            o = torch.einsum('bhte,hed->btd', o, Wo)
            mem = o[:, :M, :].clone()
            outs.append(o[:, M:, :])
        return torch.concatenate(outs, axis=1)

    def _B_ref(x, mem0, Wq, Wk, Wv, Wo, seg_len):
        B, S, Dm = x.shape
        H, Dh = (Wq.shape[1], Wq.shape[2])
        M = mem0.shape[1]
        scale = Dh ** (-0.5)
        n_seg = S // seg_len
        L = M + seg_len
        idx = torch.arange(L)
        mask = (idx[:, None] < M) | (idx[:, None] >= idx[None, :])
        mem = mem0
        outs = []
        for s in range(n_seg):
            xs = x[:, s * seg_len:(s + 1) * seg_len, :].clone()
            h = torch.concatenate([mem, xs], axis=1)
            q = torch.einsum('btd,dhe->bhte', h, Wq)
            k = torch.einsum('btd,dhe->bhte', h, Wk)
            v = torch.einsum('btd,dhe->bhte', h, Wv)
            scores = torch.einsum('bhqe,bhke->bhqk', q, k) * scale
            scores = torch.where(mask[None, None], scores, -1000000000.0)
            p = _softmax(scores, axis=-1)
            o = torch.einsum('bhqk,bhke->bhqe', p, v)
            o = torch.einsum('bhte,hed->btd', o, Wo)
            mem = o[:, :M, :].clone()
            outs.append(o[:, M:, :])
        return torch.concatenate(outs, axis=1)
    a = _A_ref(A_x, A_mem0, A_Wq, A_Wk, A_Wv, A_Wo, A_seg_len)
    b = _B_ref(B_x, B_mem0, B_Wq, B_Wk, B_Wv, B_Wo, B_seg_len)
    return torch.concatenate([a, b], axis=-1)
```

```asm
; @launch grid=(256,1,1) block=(256,1,1) lds=163840
.amdgcn_target "amdgcn-amd-amdhsa--gfx950"
.text
.globl concat_heads__memory_aug_recurrent_mem_tr__memory_aug_recurrent_mem_tr__prompt_kernel
.p2align 8
.type concat_heads__memory_aug_recurrent_mem_tr__memory_aug_recurrent_mem_tr__prompt_kernel,@function
concat_heads__memory_aug_recurrent_mem_tr__memory_aug_recurrent_mem_tr__prompt_kernel:
    s_cmp_ge_u32 s2, 256
    s_cbranch_scc1 L_end2
    s_load_dwordx4 s[4:7], s[0:1], 0
    s_load_dwordx4 s[8:11], s[0:1], 16
    s_load_dwordx4 s[12:15], s[0:1], 32
    s_load_dwordx2 s[32:33], s[0:1], 56
    s_load_dwordx4 s[36:39], s[0:1], 64
    s_load_dwordx4 s[40:43], s[0:1], 80
    s_load_dwordx2 s[44:45], s[0:1], 96
    s_load_dwordx4 s[16:19], s[0:1], 112
    s_load_dwordx2 s[20:21], s[0:1], 128
    s_getreg_b32 s22, hwreg(HW_REG_XCC_ID)
    s_and_b32 s22, s22, 7
    s_lshl_b32 s22, s22, 2
    s_lshr_b32 s22, 0x76541032, s22
    s_and_b32 s22, s22, 7
    v_lshrrev_b32 v1, 6, v0
    v_and_b32 v0, 63, v0
    v_readfirstlane_b32 s23, v1
    s_mov_b32 s27, 2000000
    s_mov_b32 s3, 0
    s_waitcnt lgkmcnt(0)
    s_cmp_eq_u32 s23, 0
    s_cbranch_scc0 L_noticket
    s_mov_b64 exec, 1
    s_lshl_b32 s58, s22, 5
    v_mov_b32 v1, s58
    v_mov_b32 v2, 1
    global_atomic_add v3, v1, v2, s[18:19] sc0
    s_mov_b64 exec, -1
L_noticket:
    s_waitcnt vmcnt(0)
L_tk2:
    s_cmp_eq_u32 s23, 0
    s_cbranch_scc0 L_tk3
    s_mov_b64 exec, 1
    v_mov_b32 v1, 0
    ds_write_b32 v1, v3
    s_waitcnt lgkmcnt(0)
    s_mov_b64 exec, -1
L_tk3:
    s_barrier
    v_mov_b32 v1, 0
    ds_read_b32 v3, v1
    s_waitcnt lgkmcnt(0)
    v_readfirstlane_b32 s24, v3
    s_barrier
L_role:
    s_cmp_ge_u32 s24, 32
    s_cbranch_scc1 L_norole
    s_cmp_ge_u32 s22, 2
    s_cbranch_scc1 L_worker
    s_mov_b32 s25, s22
    s_cmp_eq_u32 s25, 1
    s_cselect_b64 s[4:5], s[32:33], s[4:5]
    s_cselect_b64 s[6:7], s[36:37], s[6:7]
    s_cselect_b64 s[8:9], s[38:39], s[8:9]
    s_cselect_b64 s[10:11], s[40:41], s[10:11]
    s_cselect_b64 s[12:13], s[42:43], s[12:13]
    s_cselect_b64 s[14:15], s[44:45], s[14:15]
    s_lshl_b32 s58, s25, 26
    s_add_u32 s20, s20, s58
    s_addc_u32 s21, s21, 0
    s_cmp_eq_u32 s3, 1
    s_cbranch_scc1 L_chain_safe
    v_and_b32 v1, 15, v0
    v_lshrrev_b32 v2, 4, v0
    v_lshlrev_b32 v2, 10, v2
    v_and_b32 v8, 16, v0
    v_lshl_add_u32 v2, v1, 4, v2
    s_lshl_b32 s58, s24, 17
    s_lshl_b32 s59, s23, 8
    s_add_u32 s58, s58, s59
    v_add_u32 v4, s58, v2
    s_mul_i32 s72, s23, 36864
    s_add_u32 s72, s72, 16384
    s_mov_b32 s88, s14
    s_and_b32 s89, s15, 0xffff
    s_mov_b32 s90, 4194304
    s_mov_b32 s91, 0x20000
    s_mov_b32 s60, 0
    s_add_u32 m0, s72, 0
    s_add_u32 s61, s60, 0
    buffer_load_dwordx4 v4, s[88:91], s61 offen  lds
    s_add_u32 m0, s72, 1024
    s_add_u32 s61, s60, 4096
    buffer_load_dwordx4 v4, s[88:91], s61 offen  lds
    s_add_u32 m0, s72, 2048
    s_add_u32 s61, s60, 8192
    buffer_load_dwordx4 v4, s[88:91], s61 offen  lds
    s_add_u32 m0, s72, 3072
    s_add_u32 s61, s60, 12288
    buffer_load_dwordx4 v4, s[88:91], s61 offen  lds
    s_mov_b32 s60, 0
    s_add_u32 m0, s72, 4096
    s_add_u32 s61, s60, 16384
    buffer_load_dwordx4 v4, s[88:91], s61 offen  lds
    s_add_u32 m0, s72, 5120
    s_add_u32 s61, s60, 20480
    buffer_load_dwordx4 v4, s[88:91], s61 offen  lds
    s_add_u32 m0, s72, 6144
    s_add_u32 s61, s60, 24576
    buffer_load_dwordx4 v4, s[88:91], s61 offen  lds
    s_add_u32 m0, s72, 7168
    s_add_u32 s61, s60, 28672
    buffer_load_dwordx4 v4, s[88:91], s61 offen  lds
    s_mov_b32 s60, 32768
    s_add_u32 m0, s72, 8192
    s_add_u32 s61, s60, 0
    buffer_load_dwordx4 v4, s[88:91], s61 offen  lds
    s_add_u32 m0, s72, 9216
    s_add_u32 s61, s60, 4096
    buffer_load_dwordx4 v4, s[88:91], s61 offen  lds
    s_add_u32 m0, s72, 10240
    s_add_u32 s61, s60, 8192
    buffer_load_dwordx4 v4, s[88:91], s61 offen  lds
    s_add_u32 m0, s72, 11264
    s_add_u32 s61, s60, 12288
    buffer_load_dwordx4 v4, s[88:91], s61 offen  lds
    s_mov_b32 s60, 32768
    s_add_u32 m0, s72, 12288
    s_add_u32 s61, s60, 16384
    buffer_load_dwordx4 v4, s[88:91], s61 offen  lds
    s_add_u32 m0, s72, 13312
    s_add_u32 s61, s60, 20480
    buffer_load_dwordx4 v4, s[88:91], s61 offen  lds
    s_add_u32 m0, s72, 14336
    s_add_u32 s61, s60, 24576
    buffer_load_dwordx4 v4, s[88:91], s61 offen  lds
    s_add_u32 m0, s72, 15360
    s_add_u32 s61, s60, 28672
    buffer_load_dwordx4 v4, s[88:91], s61 offen  lds
L_ch_c0:
L_ch_c1:
    s_mov_b32 s67, s23
    v_and_b32 v61, 15, v0
    v_lshrrev_b32 v62, 4, v0
    v_lshlrev_b32 v105, 4, v0
    s_mov_b32 s48, 0xcccccccc
    s_mov_b32 s49, 0xcccccccc
    s_mov_b32 s98, 0x3e0293ee
    s_mov_b32 s68, 0x05040100
    s_mov_b32 s69, 0x07060302
    s_mov_b32 s70, 4290838464
    s_mov_b32 s71, 0xffc00000
    s_mov_b32 s99, 0x3e0293ee
    v_mov_b32 v124, s70
    v_mov_b32 v125, s70
    v_mov_b32 v126, s70
    v_mov_b32 v127, s70
    v_mov_b32 v64, 0xeeee
    v_mov_b32 v65, 0x4444
    v_cndmask_b32 v104, v65, v64, s[48:49]
    v_and_b32 v63, 1, v61
    v_lshlrev_b32 v63, 4, v63
    v_mov_b32 v64, 0x3f80
    v_lshlrev_b32 v64, v63, v64
    v_lshrrev_b32 v65, 2, v61
    v_cmp_eq_u32 vcc, v65, v62
    s_nop 1
    v_cndmask_b32 v64, 0, v64, vcc
    v_mov_b32 v65, 0
    v_cndmask_b32 v106, v65, v64, s[48:49]
    v_cndmask_b32 v107, v64, v65, s[48:49]
    v_lshrrev_b32 v63, 2, v61
    v_and_b32 v63, 1, v63
    v_lshlrev_b32 v63, 4, v63
    v_mov_b32 v64, 0x3f80
    v_lshlrev_b32 v64, v63, v64
    v_and_b32 v65, 11, v61
    v_cmp_eq_u32 vcc, 0, v65
    s_nop 1
    v_cndmask_b32 v108, 0, v64, vcc
    v_cmp_eq_u32 vcc, 1, v65
    s_nop 1
    v_cndmask_b32 v109, 0, v64, vcc
    v_cmp_eq_u32 vcc, 8, v65
    s_nop 1
    v_cndmask_b32 v110, 0, v64, vcc
    v_cmp_eq_u32 vcc, 9, v65
    s_nop 1
    v_cndmask_b32 v111, 0, v64, vcc
    v_lshrrev_b32 v63, 1, v62
    v_lshlrev_b32 v63, 13, v63
    v_and_b32 v64, 1, v62
    v_lshl_add_u32 v63, v64, 11, v63
    v_lshl_add_u32 v63, v61, 2, v63
    s_lshl_b32 s58, s23, 16
    s_lshl_b32 s59, s24, 6
    s_add_u32 s58, s58, s59
    v_add_u32 v112, s58, v63
    s_lshl_b32 s58, s23, 9
    v_lshrrev_b32 v63, 1, v62
    v_lshlrev_b32 v63, 8, v63
    v_or_b32 v63, s58, v63
    v_xor_b32 v112, v112, v63
    s_mov_b32 s50, 0
    s_mov_b32 s51, 16384
    s_mov_b32 s52, 32768
    s_mov_b32 s53, 49152
    s_mov_b32 s54, 4096
    s_mov_b32 s55, 20480
    s_mov_b32 s56, 36864
    s_mov_b32 s57, 53248
    v_and_b32 v63, 2, v0
    v_lshlrev_b32 v63, 4, v63
    v_and_b32 v64, 1, v62
    v_lshl_add_u32 v63, v64, 4, v63
    v_and_b32 v64, 1, v0
    v_lshl_add_u32 v63, v64, 3, v63
    v_lshrrev_b32 v64, 1, v62
    v_lshl_add_u32 v63, v64, 2, v63
    s_lshr_b32 s32, s23, 1
    s_lshr_b32 s60, s24, 1
    s_and_b32 s60, s60, 3
    s_lshl_b32 s58, s32, 2
    s_add_u32 s60, s60, s58
    s_and_b32 s61, s24, 1
    s_lshl_b32 s61, s61, 1
    s_and_b32 s58, s23, 1
    s_add_u32 s61, s61, s58
    s_lshl_b32 s58, s60, 10
    s_lshr_b32 s59, s24, 3
    s_lshl_b32 s59, s59, 8
    s_add_u32 s58, s58, s59
    s_lshl_b32 s59, s61, 6
    s_add_u32 s58, s58, s59
    v_add_u32 v113, s58, v63
    v_and_b32 v63, 1, v62
    v_lshlrev_b32 v63, 10, v63
    v_lshrrev_b32 v64, 1, v62
    v_lshl_add_u32 v63, v64, 2, v63
    v_and_b32 v64, 3, v0
    v_lshl_add_u32 v63, v64, 3, v63
    s_lshl_b32 s58, s61, 11
    s_lshr_b32 s59, s24, 3
    s_lshl_b32 s59, s59, 8
    s_add_u32 s58, s58, s59
    s_lshl_b32 s59, s60, 5
    s_add_u32 s58, s58, s59
    v_add_u32 v70, s58, v63
    s_lshl_b32 s58, s67, 11
    v_add_u32 v114, s58, v105
    v_xor_b32 v115, 0x800, v114
    v_xor_b32 v116, 0x1000, v114
    v_xor_b32 v117, 0x1800, v114
    s_mul_i32 s58, s23, 36864
    s_add_u32 s58, s58, 16384
    v_add_u32 v118, s58, v105
    s_lshl_b32 s58, s23, 2
    v_add_u32 v119, s58, v105
    s_lshl_b32 s60, s24, 2
    s_add_u32 s60, s60, s23
    s_lshl_b32 s65, s60, 11
    s_add_u32 s65, s65, 60817408
    s_lshl_b32 s66, s67, 10
    s_add_u32 s66, s66, 61343744
    s_lshl_b32 s58, s60, 12
    s_add_u32 s42, s20, s58
    s_addc_u32 s43, s21, 0
    s_lshl_b32 s58, s60, 10
    s_add_u32 s58, s58, 50331648
    s_add_u32 s44, s20, s58
    s_addc_u32 s45, s21, 0
    v_and_b32 v63, 3, v0
    v_lshlrev_b32 v63, 7, v63
    v_and_b32 v64, 4, v0
    v_lshl_add_u32 v122, v64, 12, v63
    s_lshl_b32 s58, s24, 9
    s_add_u32 s58, s58, 61865984
    s_add_u32 s96, s20, s58
    s_addc_u32 s97, s21, 0
    s_lshl_b32 s58, s23, 7
    s_add_u32 s58, s58, 32768
    s_add_u32 s4, s96, s58
    s_addc_u32 s5, s97, 0
    v_mov_b32 v64, 0
    s_mov_b64 exec, 1
    global_store_dword v105, v64, s[4:5] sc1
    s_mov_b64 exec, -1
    s_mov_b32 s62, 0
    s_mov_b32 s63, 0
    s_add_u32 s58, s62, 60817408
    s_add_u32 s28, s20, s58
    s_addc_u32 s29, s21, 0
    s_add_u32 s58, s65, s62
    s_add_u32 s34, s20, s58
    s_addc_u32 s35, s21, 0
    s_add_u32 s58, s63, 61341696
    s_add_u32 s36, s20, s58
    s_addc_u32 s37, s21, 0
    s_xor_b32 s58, s63, 0x2000
    s_add_u32 s58, s58, 61341696
    s_add_u32 s38, s20, s58
    s_addc_u32 s39, s21, 0
    s_add_u32 s58, s66, s63
    s_add_u32 s40, s20, s58
    s_addc_u32 s41, s21, 0
    global_store_dwordx4 v105, v[124:127], s[34:35]
    global_store_dwordx4 v105, v[124:127], s[34:35] offset:1024
    s_add_u32 s46, s34, 0x40000
    s_addc_u32 s47, s35, 0
    global_store_dwordx4 v105, v[124:127], s[46:47]
    global_store_dwordx4 v105, v[124:127], s[46:47] offset:1024
    global_store_dword v113, v124, s[38:39]
    global_store_dword v113, v124, s[36:37]
    global_load_dword v123, v70, s[6:7]
    s_mov_b32 s60, 65536
    s_add_u32 m0, s72, 16384
    s_add_u32 s61, s60, 0
    buffer_load_dwordx4 v4, s[88:91], s61 offen  lds
    s_add_u32 m0, s72, 17408
    s_add_u32 s61, s60, 4096
    buffer_load_dwordx4 v4, s[88:91], s61 offen  lds
    s_add_u32 m0, s72, 18432
    s_add_u32 s61, s60, 8192
    buffer_load_dwordx4 v4, s[88:91], s61 offen  lds
    s_add_u32 m0, s72, 19456
    s_add_u32 s61, s60, 12288
    buffer_load_dwordx4 v4, s[88:91], s61 offen  lds
    s_mov_b32 s60, 65536
    s_add_u32 m0, s72, 20480
    s_add_u32 s61, s60, 16384
    buffer_load_dwordx4 v4, s[88:91], s61 offen  lds
    s_add_u32 m0, s72, 21504
    s_add_u32 s61, s60, 20480
    buffer_load_dwordx4 v4, s[88:91], s61 offen  lds
    s_add_u32 m0, s72, 22528
    s_add_u32 s61, s60, 24576
    buffer_load_dwordx4 v4, s[88:91], s61 offen  lds
    s_add_u32 m0, s72, 23552
    s_add_u32 s61, s60, 28672
    buffer_load_dwordx4 v4, s[88:91], s61 offen  lds
    s_mov_b32 s60, 98304
    s_add_u32 m0, s72, 24576
    s_add_u32 s61, s60, 0
    buffer_load_dwordx4 v4, s[88:91], s61 offen  lds
    s_add_u32 m0, s72, 25600
    s_add_u32 s61, s60, 4096
    buffer_load_dwordx4 v4, s[88:91], s61 offen  lds
    s_add_u32 m0, s72, 26624
    s_add_u32 s61, s60, 8192
    buffer_load_dwordx4 v4, s[88:91], s61 offen  lds
    s_add_u32 m0, s72, 27648
    s_add_u32 s61, s60, 12288
    buffer_load_dwordx4 v4, s[88:91], s61 offen  lds
    s_mov_b32 s60, 98304
    s_add_u32 m0, s72, 28672
    s_add_u32 s61, s60, 16384
    buffer_load_dwordx4 v4, s[88:91], s61 offen  lds
    s_add_u32 m0, s72, 29696
    s_add_u32 s61, s60, 20480
    buffer_load_dwordx4 v4, s[88:91], s61 offen  lds
    s_add_u32 m0, s72, 30720
    s_add_u32 s61, s60, 24576
    buffer_load_dwordx4 v4, s[88:91], s61 offen  lds
    s_add_u32 m0, s72, 31744
    s_add_u32 s61, s60, 28672
    buffer_load_dwordx4 v4, s[88:91], s61 offen  lds
    v_lshrrev_b32 v2, 5, v0
    v_lshlrev_b32 v2, 16, v2
    v_lshl_add_u32 v2, v8, 9, v2
    v_lshrrev_b32 v9, 2, v0
    v_and_b32 v9, 12, v9
    v_xor_b32 v9, v9, v1
    v_lshl_add_u32 v2, v9, 4, v2
    s_lshr_b32 s58, s23, 1
    s_lshl_b32 s58, s58, 21
    s_and_b32 s59, s23, 1
    s_lshl_b32 s59, s59, 14
    s_add_u32 s58, s58, s59
    s_lshl_b32 s59, s24, 8
    s_add_u32 s58, s58, s59
    v_add_u32 v3, s58, v2
    v_lshrrev_b32 v2, 2, v0
    v_lshlrev_b32 v2, 8, v2
    v_and_b32 v1, 3, v0
    v_lshl_add_u32 v2, v1, 3, v2
    v_lshlrev_b32 v9, 3, v1
    v_and_b32 v10, 4, v0
    v_lshl_add_u32 v9, v10, 6, v9
    v_and_b32 v10, 8, v0
    v_lshl_add_u32 v9, v10, 2, v9
    v_and_b32 v10, 16, v0
    v_lshl_add_u32 v9, v10, 8, v9
    v_and_b32 v10, 32, v0
    v_lshl_add_u32 v9, v10, 5, v9
    v_add_u32 v5, s72, v9
    v_and_b32 v9, 12, v0
    v_lshlrev_b32 v9, 4, v9
    s_lshl_b32 s58, s23, 6
    v_xor_b32 v9, s58, v9
    v_add_u32 v2, v2, v9
    v_add_u32 v6, 16384, v2
    v_add_u32 v7, 73728, v6
    s_mov_b32 s76, s8
    s_and_b32 s77, s9, 0xffff
    s_mov_b32 s78, 4194304
    s_mov_b32 s79, 0x20000
    s_mov_b32 s80, s10
    s_and_b32 s81, s11, 0xffff
    s_mov_b32 s82, 4194304
    s_mov_b32 s83, 0x20000
    s_mov_b32 s84, s12
    s_and_b32 s85, s13, 0xffff
    s_mov_b32 s86, 4194304
    s_mov_b32 s87, 0x20000
    s_waitcnt vmcnt(16) lgkmcnt(0)
    s_barrier
    s_cmp_eq_u32 s23, 0
    s_cbranch_scc0 L_ch_noarr
    s_mov_b64 exec, 1
    s_lshl_b32 s58, s3, 5
    s_add_u32 s58, s58, 208
    v_mov_b32 v1, s58
    v_mov_b32 v2, 1
    global_atomic_add v1, v2, s[18:19]
    s_mov_b64 exec, -1
L_ch_noarr:
    s_add_u32 m0, s72, 32768
    s_mov_b32 s61, 0
    buffer_load_dwordx4 v3, s[80:83], s61 offen  lds
    s_add_u32 m0, s72, 33792
    s_mov_b32 s61, 32768
    buffer_load_dwordx4 v3, s[80:83], s61 offen  lds
    s_add_u32 m0, s72, 34816
    s_mov_b32 s61, 1048576
    buffer_load_dwordx4 v3, s[80:83], s61 offen  lds
    s_add_u32 m0, s72, 35840
    s_mov_b32 s61, 1081344
    buffer_load_dwordx4 v3, s[80:83], s61 offen  lds
    s_cmp_eq_u32 s67, 0
    s_cbranch_scc0 L_ch_wv1
    ds_read_b64_tr_b16 a[16:17], v5 offset:0
    ds_read_b64_tr_b16 a[18:19], v5 offset:512
    ds_read_b64_tr_b16 a[20:21], v5 offset:2048
    ds_read_b64_tr_b16 a[22:23], v5 offset:2560
    ds_read_b64_tr_b16 a[24:25], v5 offset:64
    ds_read_b64_tr_b16 a[26:27], v5 offset:576
    ds_read_b64_tr_b16 a[28:29], v5 offset:2112
    ds_read_b64_tr_b16 a[30:31], v5 offset:2624
    s_waitcnt lgkmcnt(0)
    ds_read_b64_tr_b16 a[48:49], v5 offset:128
    ds_read_b64_tr_b16 a[50:51], v5 offset:640
    ds_read_b64_tr_b16 a[52:53], v5 offset:2176
    ds_read_b64_tr_b16 a[54:55], v5 offset:2688
    ds_read_b64_tr_b16 a[56:57], v5 offset:192
    ds_read_b64_tr_b16 a[58:59], v5 offset:704
    ds_read_b64_tr_b16 a[60:61], v5 offset:2240
    ds_read_b64_tr_b16 a[62:63], v5 offset:2752
    s_waitcnt lgkmcnt(0)
    s_add_u32 m0, s72, 0
    s_mov_b32 s61, 131072
    buffer_load_dwordx4 v3, s[80:83], s61 offen  lds
    s_add_u32 m0, s72, 1024
    s_mov_b32 s61, 163840
    buffer_load_dwordx4 v3, s[80:83], s61 offen  lds
    s_add_u32 m0, s72, 2048
    s_mov_b32 s61, 1179648
    buffer_load_dwordx4 v3, s[80:83], s61 offen  lds
    s_add_u32 m0, s72, 3072
    s_mov_b32 s61, 1212416
    buffer_load_dwordx4 v3, s[80:83], s61 offen  lds
    s_add_u32 m0, s72, 4096
    s_mov_b32 s61, 262144
    buffer_load_dwordx4 v3, s[80:83], s61 offen  lds
    s_add_u32 m0, s72, 5120
    s_mov_b32 s61, 294912
    buffer_load_dwordx4 v3, s[80:83], s61 offen  lds
    s_add_u32 m0, s72, 6144
    s_mov_b32 s61, 1310720
    buffer_load_dwordx4 v3, s[80:83], s61 offen  lds
    s_add_u32 m0, s72, 7168
    s_mov_b32 s61, 1343488
    buffer_load_dwordx4 v3, s[80:83], s61 offen  lds
    ds_read_b64_tr_b16 v[128:129], v5 offset:8192
    ds_read_b64_tr_b16 v[130:131], v5 offset:8704
    ds_read_b64_tr_b16 v[132:133], v5 offset:10240
    ds_read_b64_tr_b16 v[134:135], v5 offset:10752
    ds_read_b64_tr_b16 v[152:153], v5 offset:8256
    ds_read_b64_tr_b16 v[154:155], v5 offset:8768
    ds_read_b64_tr_b16 v[156:157], v5 offset:10304
    ds_read_b64_tr_b16 v[158:159], v5 offset:10816
    s_waitcnt lgkmcnt(0)
    ds_read_b64_tr_b16 v[176:177], v5 offset:8320
    ds_read_b64_tr_b16 v[178:179], v5 offset:8832
    ds_read_b64_tr_b16 v[180:181], v5 offset:10368
    ds_read_b64_tr_b16 v[182:183], v5 offset:10880
    ds_read_b64_tr_b16 v[200:201], v5 offset:8384
    ds_read_b64_tr_b16 v[202:203], v5 offset:8896
    ds_read_b64_tr_b16 v[204:205], v5 offset:10432
    ds_read_b64_tr_b16 v[206:207], v5 offset:10944
    s_waitcnt lgkmcnt(0)
    s_add_u32 m0, s72, 8192
    s_mov_b32 s61, 393216
    buffer_load_dwordx4 v3, s[80:83], s61 offen  lds
    s_add_u32 m0, s72, 9216
    s_mov_b32 s61, 425984
    buffer_load_dwordx4 v3, s[80:83], s61 offen  lds
    s_add_u32 m0, s72, 10240
    s_mov_b32 s61, 1441792
    buffer_load_dwordx4 v3, s[80:83], s61 offen  lds
    s_add_u32 m0, s72, 11264
    s_mov_b32 s61, 1474560
    buffer_load_dwordx4 v3, s[80:83], s61 offen  lds
    s_waitcnt vmcnt(24)
    ds_read_b64_tr_b16 v[136:137], v5 offset:16384
    ds_read_b64_tr_b16 v[138:139], v5 offset:16896
    ds_read_b64_tr_b16 v[140:141], v5 offset:18432
    ds_read_b64_tr_b16 v[142:143], v5 offset:18944
    ds_read_b64_tr_b16 v[160:161], v5 offset:16448
    ds_read_b64_tr_b16 v[162:163], v5 offset:16960
    ds_read_b64_tr_b16 v[164:165], v5 offset:18496
    ds_read_b64_tr_b16 v[166:167], v5 offset:19008
    s_waitcnt lgkmcnt(0)
    ds_read_b64_tr_b16 v[184:185], v5 offset:16512
    ds_read_b64_tr_b16 v[186:187], v5 offset:17024
    ds_read_b64_tr_b16 v[188:189], v5 offset:18560
    ds_read_b64_tr_b16 v[190:191], v5 offset:19072
    ds_read_b64_tr_b16 a[80:81], v5 offset:16576
    ds_read_b64_tr_b16 a[82:83], v5 offset:17088
    ds_read_b64_tr_b16 a[84:85], v5 offset:18624
    ds_read_b64_tr_b16 a[86:87], v5 offset:19136
    s_waitcnt lgkmcnt(0)
    s_waitcnt vmcnt(16)
    ds_read_b64_tr_b16 v[144:145], v5 offset:24576
    ds_read_b64_tr_b16 v[146:147], v5 offset:25088
    ds_read_b64_tr_b16 v[148:149], v5 offset:26624
    ds_read_b64_tr_b16 v[150:151], v5 offset:27136
    ds_read_b64_tr_b16 v[168:169], v5 offset:24640
    ds_read_b64_tr_b16 v[170:171], v5 offset:25152
    ds_read_b64_tr_b16 v[172:173], v5 offset:26688
    ds_read_b64_tr_b16 v[174:175], v5 offset:27200
    s_waitcnt lgkmcnt(0)
    ds_read_b64_tr_b16 v[192:193], v5 offset:24704
    ds_read_b64_tr_b16 v[194:195], v5 offset:25216
    ds_read_b64_tr_b16 v[196:197], v5 offset:26752
    ds_read_b64_tr_b16 v[198:199], v5 offset:27264
    ds_read_b64_tr_b16 a[88:89], v5 offset:24768
    ds_read_b64_tr_b16 a[90:91], v5 offset:25280
    ds_read_b64_tr_b16 a[92:93], v5 offset:26816
    ds_read_b64_tr_b16 a[94:95], v5 offset:27328
    s_waitcnt lgkmcnt(0)
    v_add_u32 v4, 36864, v6
    v_add_u32 v5, 36864, v7
    s_waitcnt vmcnt(12)
    s_barrier
    ds_read_b64_tr_b16 v[8:9], v6 offset:32768
    ds_read_b64_tr_b16 v[10:11], v4 offset:32768
    ds_read_b64_tr_b16 v[12:13], v7 offset:32768
    ds_read_b64_tr_b16 v[14:15], v5 offset:32768
    ds_read_b64_tr_b16 v[16:17], v6 offset:32800
    ds_read_b64_tr_b16 v[18:19], v4 offset:32800
    ds_read_b64_tr_b16 v[20:21], v7 offset:32800
    ds_read_b64_tr_b16 v[22:23], v5 offset:32800
    ds_write_b128 v118, a[48:51] offset:28672
    ds_write_b128 v118, a[52:55] offset:29696
    ds_write_b128 v118, a[56:59] offset:30720
    ds_write_b128 v118, a[60:63] offset:31744
    s_add_u32 m0, s72, 20480
    s_mov_b32 s61, 524288
    buffer_load_dwordx4 v3, s[80:83], s61 offen  lds
    s_add_u32 m0, s72, 21504
    s_mov_b32 s61, 557056
    buffer_load_dwordx4 v3, s[80:83], s61 offen  lds
    s_add_u32 m0, s72, 22528
    s_mov_b32 s61, 1572864
    buffer_load_dwordx4 v3, s[80:83], s61 offen  lds
    s_add_u32 m0, s72, 23552
    s_mov_b32 s61, 1605632
    buffer_load_dwordx4 v3, s[80:83], s61 offen  lds
    s_waitcnt lgkmcnt(0)
    s_waitcnt vmcnt(12)
    s_barrier
    ds_read_b64_tr_b16 v[24:25], v6 offset:0
    ds_read_b64_tr_b16 v[26:27], v4 offset:0
    ds_read_b64_tr_b16 v[28:29], v7 offset:0
    ds_read_b64_tr_b16 v[30:31], v5 offset:0
    ds_read_b64_tr_b16 v[32:33], v6 offset:32
    ds_read_b64_tr_b16 v[34:35], v4 offset:32
    ds_read_b64_tr_b16 v[36:37], v7 offset:32
    ds_read_b64_tr_b16 v[38:39], v5 offset:32
    ds_write_b128 v118, a[80:83] offset:32768
    ds_write_b128 v118, a[84:87] offset:33792
    ds_write_b128 v118, a[88:91] offset:34816
    ds_write_b128 v118, a[92:95] offset:35840
    s_add_u32 m0, s72, 16384
    s_mov_b32 s61, 655360
    buffer_load_dwordx4 v3, s[80:83], s61 offen  lds
    s_add_u32 m0, s72, 17408
    s_mov_b32 s61, 688128
    buffer_load_dwordx4 v3, s[80:83], s61 offen  lds
    s_add_u32 m0, s72, 18432
    s_mov_b32 s61, 1703936
    buffer_load_dwordx4 v3, s[80:83], s61 offen  lds
    s_add_u32 m0, s72, 19456
    s_mov_b32 s61, 1736704
    buffer_load_dwordx4 v3, s[80:83], s61 offen  lds
    s_waitcnt lgkmcnt(0)
    s_waitcnt vmcnt(12)
    s_barrier
    ds_read_b64_tr_b16 v[208:209], v6 offset:4096
    ds_read_b64_tr_b16 v[210:211], v4 offset:4096
    ds_read_b64_tr_b16 v[212:213], v7 offset:4096
    ds_read_b64_tr_b16 v[214:215], v5 offset:4096
    ds_read_b64_tr_b16 v[216:217], v6 offset:4128
    ds_read_b64_tr_b16 v[218:219], v4 offset:4128
    ds_read_b64_tr_b16 v[220:221], v7 offset:4128
    ds_read_b64_tr_b16 v[222:223], v5 offset:4128
    ds_write_b128 v118, a[16:19] offset:24576
    ds_write_b128 v118, a[20:23] offset:25600
    ds_write_b128 v118, a[24:27] offset:26624
    ds_write_b128 v118, a[28:31] offset:27648
    s_add_u32 m0, s72, 12288
    s_mov_b32 s61, 786432
    buffer_load_dwordx4 v3, s[80:83], s61 offen  lds
    s_add_u32 m0, s72, 13312
    s_mov_b32 s61, 819200
    buffer_load_dwordx4 v3, s[80:83], s61 offen  lds
    s_add_u32 m0, s72, 14336
    s_mov_b32 s61, 1835008
    buffer_load_dwordx4 v3, s[80:83], s61 offen  lds
    s_add_u32 m0, s72, 15360
    s_mov_b32 s61, 1867776
    buffer_load_dwordx4 v3, s[80:83], s61 offen  lds
    s_waitcnt lgkmcnt(0)
    s_waitcnt vmcnt(12)
    s_barrier
    ds_read_b64_tr_b16 v[240:241], v6 offset:8192
    ds_read_b64_tr_b16 v[242:243], v4 offset:8192
    ds_read_b64_tr_b16 v[244:245], v7 offset:8192
    ds_read_b64_tr_b16 v[246:247], v5 offset:8192
    ds_read_b64_tr_b16 v[248:249], v6 offset:8224
    ds_read_b64_tr_b16 v[250:251], v4 offset:8224
    ds_read_b64_tr_b16 v[252:253], v7 offset:8224
    ds_read_b64_tr_b16 v[254:255], v5 offset:8224
    s_add_u32 m0, s72, 4096
    s_mov_b32 s61, 917504
    buffer_load_dwordx4 v3, s[80:83], s61 offen  lds
    s_add_u32 m0, s72, 5120
    s_mov_b32 s61, 950272
    buffer_load_dwordx4 v3, s[80:83], s61 offen  lds
    s_add_u32 m0, s72, 6144
    s_mov_b32 s61, 1966080
    buffer_load_dwordx4 v3, s[80:83], s61 offen  lds
    s_add_u32 m0, s72, 7168
    s_mov_b32 s61, 1998848
    buffer_load_dwordx4 v3, s[80:83], s61 offen  lds
    s_waitcnt lgkmcnt(0)
    s_waitcnt vmcnt(12)
    s_barrier
    ds_read_b64_tr_b16 v[40:41], v6 offset:20480
    ds_read_b64_tr_b16 v[42:43], v4 offset:20480
    ds_read_b64_tr_b16 v[44:45], v7 offset:20480
    ds_read_b64_tr_b16 v[46:47], v5 offset:20480
    ds_read_b64_tr_b16 v[48:49], v6 offset:20512
    ds_read_b64_tr_b16 v[50:51], v4 offset:20512
    ds_read_b64_tr_b16 v[52:53], v7 offset:20512
    ds_read_b64_tr_b16 v[54:55], v5 offset:20512
    s_add_u32 m0, s72, 8192
    s_mov_b32 s61, 0
    buffer_load_dwordx4 v3, s[84:87], s61 offen  lds
    s_add_u32 m0, s72, 9216
    s_mov_b32 s61, 32768
    buffer_load_dwordx4 v3, s[84:87], s61 offen  lds
    s_add_u32 m0, s72, 10240
    s_mov_b32 s61, 1048576
    buffer_load_dwordx4 v3, s[84:87], s61 offen  lds
    s_add_u32 m0, s72, 11264
    s_mov_b32 s61, 1081344
    buffer_load_dwordx4 v3, s[84:87], s61 offen  lds
    s_waitcnt lgkmcnt(0)
    s_waitcnt vmcnt(12)
    s_barrier
    ds_read_b64_tr_b16 v[56:57], v6 offset:16384
    ds_read_b64_tr_b16 v[58:59], v4 offset:16384
    ds_read_b64_tr_b16 v[60:61], v7 offset:16384
    ds_read_b64_tr_b16 v[62:63], v5 offset:16384
    ds_read_b64_tr_b16 v[64:65], v6 offset:16416
    ds_read_b64_tr_b16 v[66:67], v4 offset:16416
    ds_read_b64_tr_b16 v[68:69], v7 offset:16416
    ds_read_b64_tr_b16 v[70:71], v5 offset:16416
    s_add_u32 m0, s72, 20480
    s_mov_b32 s61, 131072
    buffer_load_dwordx4 v3, s[84:87], s61 offen  lds
    s_add_u32 m0, s72, 21504
    s_mov_b32 s61, 163840
    buffer_load_dwordx4 v3, s[84:87], s61 offen  lds
    s_add_u32 m0, s72, 22528
    s_mov_b32 s61, 1179648
    buffer_load_dwordx4 v3, s[84:87], s61 offen  lds
    s_add_u32 m0, s72, 23552
    s_mov_b32 s61, 1212416
    buffer_load_dwordx4 v3, s[84:87], s61 offen  lds
    s_waitcnt lgkmcnt(0)
    s_waitcnt vmcnt(12)
    s_barrier
    ds_read_b64_tr_b16 v[224:225], v6 offset:12288
    ds_read_b64_tr_b16 v[226:227], v4 offset:12288
    ds_read_b64_tr_b16 v[228:229], v7 offset:12288
    ds_read_b64_tr_b16 v[230:231], v5 offset:12288
    ds_read_b64_tr_b16 v[232:233], v6 offset:12320
    ds_read_b64_tr_b16 v[234:235], v4 offset:12320
    ds_read_b64_tr_b16 v[236:237], v7 offset:12320
    ds_read_b64_tr_b16 v[238:239], v5 offset:12320
    s_add_u32 m0, s72, 16384
    s_mov_b32 s61, 262144
    buffer_load_dwordx4 v3, s[84:87], s61 offen  lds
    s_add_u32 m0, s72, 17408
    s_mov_b32 s61, 294912
    buffer_load_dwordx4 v3, s[84:87], s61 offen  lds
    s_add_u32 m0, s72, 18432
    s_mov_b32 s61, 1310720
    buffer_load_dwordx4 v3, s[84:87], s61 offen  lds
    s_add_u32 m0, s72, 19456
    s_mov_b32 s61, 1343488
    buffer_load_dwordx4 v3, s[84:87], s61 offen  lds
    s_waitcnt lgkmcnt(0)
    s_waitcnt vmcnt(12)
    s_barrier
    ds_read_b64_tr_b16 a[224:225], v6 offset:4096
    ds_read_b64_tr_b16 a[226:227], v4 offset:4096
    ds_read_b64_tr_b16 a[228:229], v7 offset:4096
    ds_read_b64_tr_b16 a[230:231], v5 offset:4096
    ds_read_b64_tr_b16 a[232:233], v6 offset:4128
    ds_read_b64_tr_b16 a[234:235], v4 offset:4128
    ds_read_b64_tr_b16 a[236:237], v7 offset:4128
    ds_read_b64_tr_b16 a[238:239], v5 offset:4128
    s_add_u32 m0, s72, 12288
    s_mov_b32 s61, 393216
    buffer_load_dwordx4 v3, s[84:87], s61 offen  lds
    s_add_u32 m0, s72, 13312
    s_mov_b32 s61, 425984
    buffer_load_dwordx4 v3, s[84:87], s61 offen  lds
    s_add_u32 m0, s72, 14336
    s_mov_b32 s61, 1441792
    buffer_load_dwordx4 v3, s[84:87], s61 offen  lds
    s_add_u32 m0, s72, 15360
    s_mov_b32 s61, 1474560
    buffer_load_dwordx4 v3, s[84:87], s61 offen  lds
    s_waitcnt lgkmcnt(0)
    s_waitcnt vmcnt(12)
    s_barrier
    ds_read_b64_tr_b16 a[128:129], v6 offset:8192
    ds_read_b64_tr_b16 a[130:131], v4 offset:8192
    ds_read_b64_tr_b16 a[132:133], v7 offset:8192
    ds_read_b64_tr_b16 a[134:135], v5 offset:8192
    ds_read_b64_tr_b16 a[136:137], v6 offset:8224
    ds_read_b64_tr_b16 a[138:139], v4 offset:8224
    ds_read_b64_tr_b16 a[140:141], v7 offset:8224
    ds_read_b64_tr_b16 a[142:143], v5 offset:8224
    ds_write_b128 v118, v[8:11] offset:0
    ds_write_b128 v118, v[12:15] offset:1024
    ds_write_b128 v118, v[16:19] offset:2048
    ds_write_b128 v118, v[20:23] offset:3072
    s_add_u32 m0, s72, 4096
    s_mov_b32 s61, 524288
    buffer_load_dwordx4 v3, s[84:87], s61 offen  lds
    s_add_u32 m0, s72, 5120
    s_mov_b32 s61, 557056
    buffer_load_dwordx4 v3, s[84:87], s61 offen  lds
    s_add_u32 m0, s72, 6144
    s_mov_b32 s61, 1572864
    buffer_load_dwordx4 v3, s[84:87], s61 offen  lds
    s_add_u32 m0, s72, 7168
    s_mov_b32 s61, 1605632
    buffer_load_dwordx4 v3, s[84:87], s61 offen  lds
    s_waitcnt lgkmcnt(0)
    s_waitcnt vmcnt(12)
    s_barrier
    ds_read_b64_tr_b16 a[160:161], v6 offset:20480
    ds_read_b64_tr_b16 a[162:163], v4 offset:20480
    ds_read_b64_tr_b16 a[164:165], v7 offset:20480
    ds_read_b64_tr_b16 a[166:167], v5 offset:20480
    ds_read_b64_tr_b16 a[168:169], v6 offset:20512
    ds_read_b64_tr_b16 a[170:171], v4 offset:20512
    ds_read_b64_tr_b16 a[172:173], v7 offset:20512
    ds_read_b64_tr_b16 a[174:175], v5 offset:20512
    s_add_u32 m0, s72, 8192
    s_mov_b32 s61, 655360
    buffer_load_dwordx4 v3, s[84:87], s61 offen  lds
    s_add_u32 m0, s72, 9216
    s_mov_b32 s61, 688128
    buffer_load_dwordx4 v3, s[84:87], s61 offen  lds
    s_add_u32 m0, s72, 10240
    s_mov_b32 s61, 1703936
    buffer_load_dwordx4 v3, s[84:87], s61 offen  lds
    s_add_u32 m0, s72, 11264
    s_mov_b32 s61, 1736704
    buffer_load_dwordx4 v3, s[84:87], s61 offen  lds
    s_waitcnt lgkmcnt(0)
    s_waitcnt vmcnt(12)
    s_barrier
    ds_read_b64_tr_b16 a[192:193], v6 offset:16384
    ds_read_b64_tr_b16 a[194:195], v4 offset:16384
    ds_read_b64_tr_b16 a[196:197], v7 offset:16384
    ds_read_b64_tr_b16 a[198:199], v5 offset:16384
    ds_read_b64_tr_b16 a[200:201], v6 offset:16416
    ds_read_b64_tr_b16 a[202:203], v4 offset:16416
    ds_read_b64_tr_b16 a[204:205], v7 offset:16416
    ds_read_b64_tr_b16 a[206:207], v5 offset:16416
    s_add_u32 m0, s72, 20480
    s_mov_b32 s61, 786432
    buffer_load_dwordx4 v3, s[84:87], s61 offen  lds
    s_add_u32 m0, s72, 21504
    s_mov_b32 s61, 819200
    buffer_load_dwordx4 v3, s[84:87], s61 offen  lds
    s_add_u32 m0, s72, 22528
    s_mov_b32 s61, 1835008
    buffer_load_dwordx4 v3, s[84:87], s61 offen  lds
    s_add_u32 m0, s72, 23552
    s_mov_b32 s61, 1867776
    buffer_load_dwordx4 v3, s[84:87], s61 offen  lds
    s_waitcnt lgkmcnt(0)
    s_waitcnt vmcnt(12)
    s_barrier
    ds_read_b64_tr_b16 a[208:209], v6 offset:12288
    ds_read_b64_tr_b16 a[210:211], v4 offset:12288
    ds_read_b64_tr_b16 a[212:213], v7 offset:12288
    ds_read_b64_tr_b16 a[214:215], v5 offset:12288
    ds_read_b64_tr_b16 a[216:217], v6 offset:12320
    ds_read_b64_tr_b16 a[218:219], v4 offset:12320
    ds_read_b64_tr_b16 a[220:221], v7 offset:12320
    ds_read_b64_tr_b16 a[222:223], v5 offset:12320
    s_add_u32 m0, s72, 16384
    s_mov_b32 s61, 917504
    buffer_load_dwordx4 v3, s[84:87], s61 offen  lds
    s_add_u32 m0, s72, 17408
    s_mov_b32 s61, 950272
    buffer_load_dwordx4 v3, s[84:87], s61 offen  lds
    s_add_u32 m0, s72, 18432
    s_mov_b32 s61, 1966080
    buffer_load_dwordx4 v3, s[84:87], s61 offen  lds
    s_add_u32 m0, s72, 19456
    s_mov_b32 s61, 1998848
    buffer_load_dwordx4 v3, s[84:87], s61 offen  lds
    s_waitcnt lgkmcnt(0)
    s_waitcnt vmcnt(12)
    s_barrier
    ds_read_b64_tr_b16 a[144:145], v6 offset:4096
    ds_read_b64_tr_b16 a[146:147], v4 offset:4096
    ds_read_b64_tr_b16 a[148:149], v7 offset:4096
    ds_read_b64_tr_b16 a[150:151], v5 offset:4096
    ds_read_b64_tr_b16 a[152:153], v6 offset:4128
    ds_read_b64_tr_b16 a[154:155], v4 offset:4128
    ds_read_b64_tr_b16 a[156:157], v7 offset:4128
    ds_read_b64_tr_b16 a[158:159], v5 offset:4128
    s_add_u32 m0, s72, 12288
    s_mov_b32 s61, 0
    buffer_load_dwordx4 v3, s[76:79], s61 offen  lds
    s_add_u32 m0, s72, 13312
    s_mov_b32 s61, 32768
    buffer_load_dwordx4 v3, s[76:79], s61 offen  lds
    s_add_u32 m0, s72, 14336
    s_mov_b32 s61, 1048576
    buffer_load_dwordx4 v3, s[76:79], s61 offen  lds
    s_add_u32 m0, s72, 15360
    s_mov_b32 s61, 1081344
    buffer_load_dwordx4 v3, s[76:79], s61 offen  lds
    s_waitcnt lgkmcnt(0)
    s_waitcnt vmcnt(12)
    s_barrier
    ds_read_b64_tr_b16 a[176:177], v6 offset:8192
    ds_read_b64_tr_b16 a[178:179], v4 offset:8192
    ds_read_b64_tr_b16 a[180:181], v7 offset:8192
    ds_read_b64_tr_b16 a[182:183], v5 offset:8192
    ds_read_b64_tr_b16 a[184:185], v6 offset:8224
    ds_read_b64_tr_b16 a[186:187], v4 offset:8224
    ds_read_b64_tr_b16 a[188:189], v7 offset:8224
    ds_read_b64_tr_b16 a[190:191], v5 offset:8224
    s_add_u32 m0, s72, 4096
    s_mov_b32 s61, 131072
    buffer_load_dwordx4 v3, s[76:79], s61 offen  lds
    s_add_u32 m0, s72, 5120
    s_mov_b32 s61, 163840
    buffer_load_dwordx4 v3, s[76:79], s61 offen  lds
    s_add_u32 m0, s72, 6144
    s_mov_b32 s61, 1179648
    buffer_load_dwordx4 v3, s[76:79], s61 offen  lds
    s_add_u32 m0, s72, 7168
    s_mov_b32 s61, 1212416
    buffer_load_dwordx4 v3, s[76:79], s61 offen  lds
    s_waitcnt lgkmcnt(0)
    s_waitcnt vmcnt(12)
    s_barrier
    ds_read_b64_tr_b16 v[72:73], v6 offset:20480
    ds_read_b64_tr_b16 v[74:75], v4 offset:20480
    ds_read_b64_tr_b16 v[76:77], v7 offset:20480
    ds_read_b64_tr_b16 v[78:79], v5 offset:20480
    ds_read_b64_tr_b16 v[80:81], v6 offset:20512
    ds_read_b64_tr_b16 v[82:83], v4 offset:20512
    ds_read_b64_tr_b16 v[84:85], v7 offset:20512
    ds_read_b64_tr_b16 v[86:87], v5 offset:20512
    s_add_u32 m0, s72, 8192
    s_mov_b32 s61, 262144
    buffer_load_dwordx4 v3, s[76:79], s61 offen  lds
    s_add_u32 m0, s72, 9216
    s_mov_b32 s61, 294912
    buffer_load_dwordx4 v3, s[76:79], s61 offen  lds
    s_add_u32 m0, s72, 10240
    s_mov_b32 s61, 1310720
    buffer_load_dwordx4 v3, s[76:79], s61 offen  lds
    s_add_u32 m0, s72, 11264
    s_mov_b32 s61, 1343488
    buffer_load_dwordx4 v3, s[76:79], s61 offen  lds
    global_store_dword v113, v123, s[36:37]
    v_mbcnt_lo_u32_b32 v1, -1, 0
    v_and_b32 v1, 15, v1
    v_lshlrev_b32 v1, 4, v1
    global_load_dword v2, v1, s[18:19] sc1
    s_waitcnt lgkmcnt(0)
    s_waitcnt vmcnt(14)
    s_barrier
    ds_read_b64_tr_b16 v[88:89], v6 offset:16384
    ds_read_b64_tr_b16 v[90:91], v4 offset:16384
    ds_read_b64_tr_b16 v[92:93], v7 offset:16384
    ds_read_b64_tr_b16 v[94:95], v5 offset:16384
    ds_read_b64_tr_b16 v[96:97], v6 offset:16416
    ds_read_b64_tr_b16 v[98:99], v4 offset:16416
    ds_read_b64_tr_b16 v[100:101], v7 offset:16416
    ds_read_b64_tr_b16 v[102:103], v5 offset:16416
    s_add_u32 m0, s72, 20480
    s_mov_b32 s61, 393216
    buffer_load_dwordx4 v3, s[76:79], s61 offen  lds
    s_add_u32 m0, s72, 21504
    s_mov_b32 s61, 425984
    buffer_load_dwordx4 v3, s[76:79], s61 offen  lds
    s_add_u32 m0, s72, 22528
    s_mov_b32 s61, 1441792
    buffer_load_dwordx4 v3, s[76:79], s61 offen  lds
    s_add_u32 m0, s72, 23552
    s_mov_b32 s61, 1474560
    buffer_load_dwordx4 v3, s[76:79], s61 offen  lds
    s_waitcnt lgkmcnt(0)
    s_waitcnt vmcnt(14)
    s_barrier
    ds_read_b64_tr_b16 a[0:1], v6 offset:12288
    ds_read_b64_tr_b16 a[2:3], v4 offset:12288
    ds_read_b64_tr_b16 a[4:5], v7 offset:12288
    ds_read_b64_tr_b16 a[6:7], v5 offset:12288
    ds_read_b64_tr_b16 a[8:9], v6 offset:12320
    ds_read_b64_tr_b16 a[10:11], v4 offset:12320
    ds_read_b64_tr_b16 a[12:13], v7 offset:12320
    ds_read_b64_tr_b16 a[14:15], v5 offset:12320
    s_add_u32 m0, s72, 16384
    s_mov_b32 s61, 524288
    buffer_load_dwordx4 v3, s[76:79], s61 offen  lds
    s_add_u32 m0, s72, 17408
    s_mov_b32 s61, 557056
    buffer_load_dwordx4 v3, s[76:79], s61 offen  lds
    s_add_u32 m0, s72, 18432
    s_mov_b32 s61, 1572864
    buffer_load_dwordx4 v3, s[76:79], s61 offen  lds
    s_add_u32 m0, s72, 19456
    s_mov_b32 s61, 1605632
    buffer_load_dwordx4 v3, s[76:79], s61 offen  lds
    s_waitcnt lgkmcnt(0)
    s_waitcnt vmcnt(14)
    s_barrier
    ds_read_b64_tr_b16 a[32:33], v6 offset:4096
    ds_read_b64_tr_b16 a[34:35], v4 offset:4096
    ds_read_b64_tr_b16 a[36:37], v7 offset:4096
    ds_read_b64_tr_b16 a[38:39], v5 offset:4096
    ds_read_b64_tr_b16 a[40:41], v6 offset:4128
    ds_read_b64_tr_b16 a[42:43], v4 offset:4128
    ds_read_b64_tr_b16 a[44:45], v7 offset:4128
    ds_read_b64_tr_b16 a[46:47], v5 offset:4128
    s_add_u32 m0, s72, 12288
    s_mov_b32 s61, 655360
    buffer_load_dwordx4 v3, s[76:79], s61 offen  lds
    s_add_u32 m0, s72, 13312
    s_mov_b32 s61, 688128
    buffer_load_dwordx4 v3, s[76:79], s61 offen  lds
    s_add_u32 m0, s72, 14336
    s_mov_b32 s61, 1703936
    buffer_load_dwordx4 v3, s[76:79], s61 offen  lds
    s_add_u32 m0, s72, 15360
    s_mov_b32 s61, 1736704
    buffer_load_dwordx4 v3, s[76:79], s61 offen  lds
    s_waitcnt lgkmcnt(0)
    s_waitcnt vmcnt(14)
    s_barrier
    ds_read_b64_tr_b16 a[64:65], v6 offset:8192
    ds_read_b64_tr_b16 a[66:67], v4 offset:8192
    ds_read_b64_tr_b16 a[68:69], v7 offset:8192
    ds_read_b64_tr_b16 a[70:71], v5 offset:8192
    ds_read_b64_tr_b16 a[72:73], v6 offset:8224
    ds_read_b64_tr_b16 a[74:75], v4 offset:8224
    ds_read_b64_tr_b16 a[76:77], v7 offset:8224
    ds_read_b64_tr_b16 a[78:79], v5 offset:8224
    s_add_u32 m0, s72, 4096
    s_mov_b32 s61, 786432
    buffer_load_dwordx4 v3, s[76:79], s61 offen  lds
    s_add_u32 m0, s72, 5120
    s_mov_b32 s61, 819200
    buffer_load_dwordx4 v3, s[76:79], s61 offen  lds
    s_add_u32 m0, s72, 6144
    s_mov_b32 s61, 1835008
    buffer_load_dwordx4 v3, s[76:79], s61 offen  lds
    s_add_u32 m0, s72, 7168
    s_mov_b32 s61, 1867776
    buffer_load_dwordx4 v3, s[76:79], s61 offen  lds
    s_waitcnt lgkmcnt(0)
    s_waitcnt vmcnt(12)
    s_barrier
    ds_read_b64_tr_b16 a[96:97], v6 offset:20480
    ds_read_b64_tr_b16 a[98:99], v4 offset:20480
    ds_read_b64_tr_b16 a[100:101], v7 offset:20480
    ds_read_b64_tr_b16 a[102:103], v5 offset:20480
    ds_read_b64_tr_b16 a[104:105], v6 offset:20512
    ds_read_b64_tr_b16 a[106:107], v4 offset:20512
    ds_read_b64_tr_b16 a[108:109], v7 offset:20512
    ds_read_b64_tr_b16 a[110:111], v5 offset:20512
    s_add_u32 m0, s72, 8192
    s_mov_b32 s61, 917504
    buffer_load_dwordx4 v3, s[76:79], s61 offen  lds
    s_add_u32 m0, s72, 9216
    s_mov_b32 s61, 950272
    buffer_load_dwordx4 v3, s[76:79], s61 offen  lds
    s_add_u32 m0, s72, 10240
    s_mov_b32 s61, 1966080
    buffer_load_dwordx4 v3, s[76:79], s61 offen  lds
    s_add_u32 m0, s72, 11264
    s_mov_b32 s61, 1998848
    buffer_load_dwordx4 v3, s[76:79], s61 offen  lds
    s_waitcnt lgkmcnt(0)
    s_waitcnt vmcnt(12)
    s_barrier
    ds_read_b64_tr_b16 a[16:17], v6 offset:16384
    ds_read_b64_tr_b16 a[18:19], v4 offset:16384
    ds_read_b64_tr_b16 a[20:21], v7 offset:16384
    ds_read_b64_tr_b16 a[22:23], v5 offset:16384
    ds_read_b64_tr_b16 a[24:25], v6 offset:16416
    ds_read_b64_tr_b16 a[26:27], v4 offset:16416
    ds_read_b64_tr_b16 a[28:29], v7 offset:16416
    ds_read_b64_tr_b16 a[30:31], v5 offset:16416
    ds_write_b128 v118, v[88:91] offset:20480
    ds_write_b128 v118, v[92:95] offset:21504
    ds_write_b128 v118, v[96:99] offset:22528
    ds_write_b128 v118, v[100:103] offset:23552
    global_load_dword v123, v122, s[96:97] sc1
    s_waitcnt lgkmcnt(0)
    s_waitcnt vmcnt(9)
    s_barrier
    ds_read_b64_tr_b16 a[48:49], v6 offset:12288
    ds_read_b64_tr_b16 a[50:51], v4 offset:12288
    ds_read_b64_tr_b16 a[52:53], v7 offset:12288
    ds_read_b64_tr_b16 a[54:55], v5 offset:12288
    ds_read_b64_tr_b16 a[56:57], v6 offset:12320
    ds_read_b64_tr_b16 a[58:59], v4 offset:12320
    ds_read_b64_tr_b16 a[60:61], v7 offset:12320
    ds_read_b64_tr_b16 a[62:63], v5 offset:12320
    ds_write_b128 v118, v[72:75] offset:16384
    ds_write_b128 v118, v[76:79] offset:17408
    ds_write_b128 v118, v[80:83] offset:18432
    ds_write_b128 v118, v[84:87] offset:19456
    s_waitcnt lgkmcnt(0)
    s_waitcnt vmcnt(5)
    s_barrier
    ds_read_b64_tr_b16 a[80:81], v6 offset:4096
    ds_read_b64_tr_b16 a[82:83], v4 offset:4096
    ds_read_b64_tr_b16 a[84:85], v7 offset:4096
    ds_read_b64_tr_b16 a[86:87], v5 offset:4096
    ds_read_b64_tr_b16 a[88:89], v6 offset:4128
    ds_read_b64_tr_b16 a[90:91], v4 offset:4128
    ds_read_b64_tr_b16 a[92:93], v7 offset:4128
    ds_read_b64_tr_b16 a[94:95], v5 offset:4128
    ds_write_b128 v118, v[56:59] offset:12288
    ds_write_b128 v118, v[60:63] offset:13312
    ds_write_b128 v118, v[64:67] offset:14336
    ds_write_b128 v118, v[68:71] offset:15360
    s_waitcnt lgkmcnt(0)
    s_waitcnt vmcnt(1)
    s_barrier
    ds_read_b64_tr_b16 a[112:113], v6 offset:8192
    ds_read_b64_tr_b16 a[114:115], v4 offset:8192
    ds_read_b64_tr_b16 a[116:117], v7 offset:8192
    ds_read_b64_tr_b16 a[118:119], v5 offset:8192
    ds_read_b64_tr_b16 a[120:121], v6 offset:8224
    ds_read_b64_tr_b16 a[122:123], v4 offset:8224
    ds_read_b64_tr_b16 a[124:125], v7 offset:8224
    ds_read_b64_tr_b16 a[126:127], v5 offset:8224
    ds_write_b128 v118, v[24:27] offset:4096
    ds_write_b128 v118, v[28:31] offset:5120
    ds_write_b128 v118, v[32:35] offset:6144
    ds_write_b128 v118, v[36:39] offset:7168
    s_waitcnt vmcnt(0)
    global_load_dwordx4 a[240:243], v105, s[42:43] offset:0 sc1
    global_load_dwordx4 a[244:247], v105, s[42:43] offset:1024 sc1
    global_load_dwordx4 a[248:251], v105, s[42:43] offset:2048 sc1
    global_load_dwordx4 a[252:255], v105, s[42:43] offset:3072 sc1
    s_waitcnt lgkmcnt(0)
    s_barrier
    ds_write_b128 v118, v[40:43] offset:8192
    ds_write_b128 v118, v[44:47] offset:9216
    ds_write_b128 v118, v[48:51] offset:10240
    ds_write_b128 v118, v[52:55] offset:11264
    s_branch L_ch_wdone
L_ch_wv1:
    s_cmp_eq_u32 s67, 1
    s_cbranch_scc0 L_ch_wv2
    ds_read_b64_tr_b16 v[128:129], v5 offset:0
    ds_read_b64_tr_b16 v[130:131], v5 offset:512
    ds_read_b64_tr_b16 v[132:133], v5 offset:2048
    ds_read_b64_tr_b16 v[134:135], v5 offset:2560
    ds_read_b64_tr_b16 v[152:153], v5 offset:64
    ds_read_b64_tr_b16 v[154:155], v5 offset:576
    ds_read_b64_tr_b16 v[156:157], v5 offset:2112
    ds_read_b64_tr_b16 v[158:159], v5 offset:2624
    s_waitcnt lgkmcnt(0)
    ds_read_b64_tr_b16 v[176:177], v5 offset:128
    ds_read_b64_tr_b16 v[178:179], v5 offset:640
    ds_read_b64_tr_b16 v[180:181], v5 offset:2176
    ds_read_b64_tr_b16 v[182:183], v5 offset:2688
    ds_read_b64_tr_b16 v[200:201], v5 offset:192
    ds_read_b64_tr_b16 v[202:203], v5 offset:704
    ds_read_b64_tr_b16 v[204:205], v5 offset:2240
    ds_read_b64_tr_b16 v[206:207], v5 offset:2752
    s_waitcnt lgkmcnt(0)
    s_add_u32 m0, s72, 0
    s_mov_b32 s61, 131072
    buffer_load_dwordx4 v3, s[80:83], s61 offen  lds
    s_add_u32 m0, s72, 1024
    s_mov_b32 s61, 163840
    buffer_load_dwordx4 v3, s[80:83], s61 offen  lds
    s_add_u32 m0, s72, 2048
    s_mov_b32 s61, 1179648
    buffer_load_dwordx4 v3, s[80:83], s61 offen  lds
    s_add_u32 m0, s72, 3072
    s_mov_b32 s61, 1212416
    buffer_load_dwordx4 v3, s[80:83], s61 offen  lds
    s_add_u32 m0, s72, 4096
    s_mov_b32 s61, 262144
    buffer_load_dwordx4 v3, s[80:83], s61 offen  lds
    s_add_u32 m0, s72, 5120
    s_mov_b32 s61, 294912
    buffer_load_dwordx4 v3, s[80:83], s61 offen  lds
    s_add_u32 m0, s72, 6144
    s_mov_b32 s61, 1310720
    buffer_load_dwordx4 v3, s[80:83], s61 offen  lds
    s_add_u32 m0, s72, 7168
    s_mov_b32 s61, 1343488
    buffer_load_dwordx4 v3, s[80:83], s61 offen  lds
    ds_read_b64_tr_b16 a[16:17], v5 offset:8192
    ds_read_b64_tr_b16 a[18:19], v5 offset:8704
    ds_read_b64_tr_b16 a[20:21], v5 offset:10240
    ds_read_b64_tr_b16 a[22:23], v5 offset:10752
    ds_read_b64_tr_b16 a[24:25], v5 offset:8256
    ds_read_b64_tr_b16 a[26:27], v5 offset:8768
    ds_read_b64_tr_b16 a[28:29], v5 offset:10304
    ds_read_b64_tr_b16 a[30:31], v5 offset:10816
    s_waitcnt lgkmcnt(0)
    ds_read_b64_tr_b16 a[48:49], v5 offset:8320
    ds_read_b64_tr_b16 a[50:51], v5 offset:8832
    ds_read_b64_tr_b16 a[52:53], v5 offset:10368
    ds_read_b64_tr_b16 a[54:55], v5 offset:10880
    ds_read_b64_tr_b16 a[56:57], v5 offset:8384
    ds_read_b64_tr_b16 a[58:59], v5 offset:8896
    ds_read_b64_tr_b16 a[60:61], v5 offset:10432
    ds_read_b64_tr_b16 a[62:63], v5 offset:10944
    s_waitcnt lgkmcnt(0)
    s_add_u32 m0, s72, 8192
    s_mov_b32 s61, 393216
    buffer_load_dwordx4 v3, s[80:83], s61 offen  lds
    s_add_u32 m0, s72, 9216
    s_mov_b32 s61, 425984
    buffer_load_dwordx4 v3, s[80:83], s61 offen  lds
    s_add_u32 m0, s72, 10240
    s_mov_b32 s61, 1441792
    buffer_load_dwordx4 v3, s[80:83], s61 offen  lds
    s_add_u32 m0, s72, 11264
    s_mov_b32 s61, 1474560
    buffer_load_dwordx4 v3, s[80:83], s61 offen  lds
    s_waitcnt vmcnt(24)
    ds_read_b64_tr_b16 v[144:145], v5 offset:16384
    ds_read_b64_tr_b16 v[146:147], v5 offset:16896
    ds_read_b64_tr_b16 v[148:149], v5 offset:18432
    ds_read_b64_tr_b16 v[150:151], v5 offset:18944
    ds_read_b64_tr_b16 v[168:169], v5 offset:16448
    ds_read_b64_tr_b16 v[170:171], v5 offset:16960
    ds_read_b64_tr_b16 v[172:173], v5 offset:18496
    ds_read_b64_tr_b16 v[174:175], v5 offset:19008
    s_waitcnt lgkmcnt(0)
    ds_read_b64_tr_b16 v[192:193], v5 offset:16512
    ds_read_b64_tr_b16 v[194:195], v5 offset:17024
    ds_read_b64_tr_b16 v[196:197], v5 offset:18560
    ds_read_b64_tr_b16 v[198:199], v5 offset:19072
    ds_read_b64_tr_b16 a[88:89], v5 offset:16576
    ds_read_b64_tr_b16 a[90:91], v5 offset:17088
    ds_read_b64_tr_b16 a[92:93], v5 offset:18624
    ds_read_b64_tr_b16 a[94:95], v5 offset:19136
    s_waitcnt lgkmcnt(0)
    s_waitcnt vmcnt(16)
    ds_read_b64_tr_b16 v[136:137], v5 offset:24576
    ds_read_b64_tr_b16 v[138:139], v5 offset:25088
    ds_read_b64_tr_b16 v[140:141], v5 offset:26624
    ds_read_b64_tr_b16 v[142:143], v5 offset:27136
    ds_read_b64_tr_b16 v[160:161], v5 offset:24640
    ds_read_b64_tr_b16 v[162:163], v5 offset:25152
    ds_read_b64_tr_b16 v[164:165], v5 offset:26688
    ds_read_b64_tr_b16 v[166:167], v5 offset:27200
    s_waitcnt lgkmcnt(0)
    ds_read_b64_tr_b16 v[184:185], v5 offset:24704
    ds_read_b64_tr_b16 v[186:187], v5 offset:25216
    ds_read_b64_tr_b16 v[188:189], v5 offset:26752
    ds_read_b64_tr_b16 v[190:191], v5 offset:27264
    ds_read_b64_tr_b16 a[80:81], v5 offset:24768
    ds_read_b64_tr_b16 a[82:83], v5 offset:25280
    ds_read_b64_tr_b16 a[84:85], v5 offset:26816
    ds_read_b64_tr_b16 a[86:87], v5 offset:27328
    s_waitcnt lgkmcnt(0)
    v_add_u32 v4, 36864, v6
    v_add_u32 v5, 36864, v7
    s_waitcnt vmcnt(12)
    s_barrier
    ds_read_b64_tr_b16 v[24:25], v6 offset:32768
    ds_read_b64_tr_b16 v[26:27], v4 offset:32768
    ds_read_b64_tr_b16 v[28:29], v7 offset:32768
    ds_read_b64_tr_b16 v[30:31], v5 offset:32768
    ds_read_b64_tr_b16 v[32:33], v6 offset:32800
    ds_read_b64_tr_b16 v[34:35], v4 offset:32800
    ds_read_b64_tr_b16 v[36:37], v7 offset:32800
    ds_read_b64_tr_b16 v[38:39], v5 offset:32800
    ds_write_b128 v118, a[48:51] offset:28672
    ds_write_b128 v118, a[52:55] offset:29696
    ds_write_b128 v118, a[56:59] offset:30720
    ds_write_b128 v118, a[60:63] offset:31744
    s_add_u32 m0, s72, 20480
    s_mov_b32 s61, 524288
    buffer_load_dwordx4 v3, s[80:83], s61 offen  lds
    s_add_u32 m0, s72, 21504
    s_mov_b32 s61, 557056
    buffer_load_dwordx4 v3, s[80:83], s61 offen  lds
    s_add_u32 m0, s72, 22528
    s_mov_b32 s61, 1572864
    buffer_load_dwordx4 v3, s[80:83], s61 offen  lds
    s_add_u32 m0, s72, 23552
    s_mov_b32 s61, 1605632
    buffer_load_dwordx4 v3, s[80:83], s61 offen  lds
    s_waitcnt lgkmcnt(0)
    s_waitcnt vmcnt(12)
    s_barrier
    ds_read_b64_tr_b16 v[8:9], v6 offset:0
    ds_read_b64_tr_b16 v[10:11], v4 offset:0
    ds_read_b64_tr_b16 v[12:13], v7 offset:0
    ds_read_b64_tr_b16 v[14:15], v5 offset:0
    ds_read_b64_tr_b16 v[16:17], v6 offset:32
    ds_read_b64_tr_b16 v[18:19], v4 offset:32
    ds_read_b64_tr_b16 v[20:21], v7 offset:32
    ds_read_b64_tr_b16 v[22:23], v5 offset:32
    ds_write_b128 v118, a[80:83] offset:32768
    ds_write_b128 v118, a[84:87] offset:33792
    ds_write_b128 v118, a[88:91] offset:34816
    ds_write_b128 v118, a[92:95] offset:35840
    s_add_u32 m0, s72, 16384
    s_mov_b32 s61, 655360
    buffer_load_dwordx4 v3, s[80:83], s61 offen  lds
    s_add_u32 m0, s72, 17408
    s_mov_b32 s61, 688128
    buffer_load_dwordx4 v3, s[80:83], s61 offen  lds
    s_add_u32 m0, s72, 18432
    s_mov_b32 s61, 1703936
    buffer_load_dwordx4 v3, s[80:83], s61 offen  lds
    s_add_u32 m0, s72, 19456
    s_mov_b32 s61, 1736704
    buffer_load_dwordx4 v3, s[80:83], s61 offen  lds
    s_waitcnt lgkmcnt(0)
    s_waitcnt vmcnt(12)
    s_barrier
    ds_read_b64_tr_b16 v[240:241], v6 offset:4096
    ds_read_b64_tr_b16 v[242:243], v4 offset:4096
    ds_read_b64_tr_b16 v[244:245], v7 offset:4096
    ds_read_b64_tr_b16 v[246:247], v5 offset:4096
    ds_read_b64_tr_b16 v[248:249], v6 offset:4128
    ds_read_b64_tr_b16 v[250:251], v4 offset:4128
    ds_read_b64_tr_b16 v[252:253], v7 offset:4128
    ds_read_b64_tr_b16 v[254:255], v5 offset:4128
    ds_write_b128 v118, a[16:19] offset:24576
    ds_write_b128 v118, a[20:23] offset:25600
    ds_write_b128 v118, a[24:27] offset:26624
    ds_write_b128 v118, a[28:31] offset:27648
    s_add_u32 m0, s72, 12288
    s_mov_b32 s61, 786432
    buffer_load_dwordx4 v3, s[80:83], s61 offen  lds
    s_add_u32 m0, s72, 13312
    s_mov_b32 s61, 819200
    buffer_load_dwordx4 v3, s[80:83], s61 offen  lds
    s_add_u32 m0, s72, 14336
    s_mov_b32 s61, 1835008
    buffer_load_dwordx4 v3, s[80:83], s61 offen  lds
    s_add_u32 m0, s72, 15360
    s_mov_b32 s61, 1867776
    buffer_load_dwordx4 v3, s[80:83], s61 offen  lds
    s_waitcnt lgkmcnt(0)
    s_waitcnt vmcnt(12)
    s_barrier
    ds_read_b64_tr_b16 v[208:209], v6 offset:8192
    ds_read_b64_tr_b16 v[210:211], v4 offset:8192
    ds_read_b64_tr_b16 v[212:213], v7 offset:8192
    ds_read_b64_tr_b16 v[214:215], v5 offset:8192
    ds_read_b64_tr_b16 v[216:217], v6 offset:8224
    ds_read_b64_tr_b16 v[218:219], v4 offset:8224
    ds_read_b64_tr_b16 v[220:221], v7 offset:8224
    ds_read_b64_tr_b16 v[222:223], v5 offset:8224
    s_add_u32 m0, s72, 4096
    s_mov_b32 s61, 917504
    buffer_load_dwordx4 v3, s[80:83], s61 offen  lds
    s_add_u32 m0, s72, 5120
    s_mov_b32 s61, 950272
    buffer_load_dwordx4 v3, s[80:83], s61 offen  lds
    s_add_u32 m0, s72, 6144
    s_mov_b32 s61, 1966080
    buffer_load_dwordx4 v3, s[80:83], s61 offen  lds
    s_add_u32 m0, s72, 7168
    s_mov_b32 s61, 1998848
    buffer_load_dwordx4 v3, s[80:83], s61 offen  lds
    s_waitcnt lgkmcnt(0)
    s_waitcnt vmcnt(12)
    s_barrier
    ds_read_b64_tr_b16 v[56:57], v6 offset:20480
    ds_read_b64_tr_b16 v[58:59], v4 offset:20480
    ds_read_b64_tr_b16 v[60:61], v7 offset:20480
    ds_read_b64_tr_b16 v[62:63], v5 offset:20480
    ds_read_b64_tr_b16 v[64:65], v6 offset:20512
    ds_read_b64_tr_b16 v[66:67], v4 offset:20512
    ds_read_b64_tr_b16 v[68:69], v7 offset:20512
    ds_read_b64_tr_b16 v[70:71], v5 offset:20512
    s_add_u32 m0, s72, 8192
    s_mov_b32 s61, 0
    buffer_load_dwordx4 v3, s[84:87], s61 offen  lds
    s_add_u32 m0, s72, 9216
    s_mov_b32 s61, 32768
    buffer_load_dwordx4 v3, s[84:87], s61 offen  lds
    s_add_u32 m0, s72, 10240
    s_mov_b32 s61, 1048576
    buffer_load_dwordx4 v3, s[84:87], s61 offen  lds
    s_add_u32 m0, s72, 11264
    s_mov_b32 s61, 1081344
    buffer_load_dwordx4 v3, s[84:87], s61 offen  lds
    s_waitcnt lgkmcnt(0)
    s_waitcnt vmcnt(12)
    s_barrier
    ds_read_b64_tr_b16 v[40:41], v6 offset:16384
    ds_read_b64_tr_b16 v[42:43], v4 offset:16384
    ds_read_b64_tr_b16 v[44:45], v7 offset:16384
    ds_read_b64_tr_b16 v[46:47], v5 offset:16384
    ds_read_b64_tr_b16 v[48:49], v6 offset:16416
    ds_read_b64_tr_b16 v[50:51], v4 offset:16416
    ds_read_b64_tr_b16 v[52:53], v7 offset:16416
    ds_read_b64_tr_b16 v[54:55], v5 offset:16416
    s_add_u32 m0, s72, 20480
    s_mov_b32 s61, 131072
    buffer_load_dwordx4 v3, s[84:87], s61 offen  lds
    s_add_u32 m0, s72, 21504
    s_mov_b32 s61, 163840
    buffer_load_dwordx4 v3, s[84:87], s61 offen  lds
    s_add_u32 m0, s72, 22528
    s_mov_b32 s61, 1179648
    buffer_load_dwordx4 v3, s[84:87], s61 offen  lds
    s_add_u32 m0, s72, 23552
    s_mov_b32 s61, 1212416
    buffer_load_dwordx4 v3, s[84:87], s61 offen  lds
    s_waitcnt lgkmcnt(0)
    s_waitcnt vmcnt(12)
    s_barrier
    ds_read_b64_tr_b16 a[224:225], v6 offset:12288
    ds_read_b64_tr_b16 a[226:227], v4 offset:12288
    ds_read_b64_tr_b16 a[228:229], v7 offset:12288
    ds_read_b64_tr_b16 a[230:231], v5 offset:12288
    ds_read_b64_tr_b16 a[232:233], v6 offset:12320
    ds_read_b64_tr_b16 a[234:235], v4 offset:12320
    ds_read_b64_tr_b16 a[236:237], v7 offset:12320
    ds_read_b64_tr_b16 a[238:239], v5 offset:12320
    s_add_u32 m0, s72, 16384
    s_mov_b32 s61, 262144
    buffer_load_dwordx4 v3, s[84:87], s61 offen  lds
    s_add_u32 m0, s72, 17408
    s_mov_b32 s61, 294912
    buffer_load_dwordx4 v3, s[84:87], s61 offen  lds
    s_add_u32 m0, s72, 18432
    s_mov_b32 s61, 1310720
    buffer_load_dwordx4 v3, s[84:87], s61 offen  lds
    s_add_u32 m0, s72, 19456
    s_mov_b32 s61, 1343488
    buffer_load_dwordx4 v3, s[84:87], s61 offen  lds
    s_waitcnt lgkmcnt(0)
    s_waitcnt vmcnt(12)
    s_barrier
    ds_read_b64_tr_b16 v[224:225], v6 offset:4096
    ds_read_b64_tr_b16 v[226:227], v4 offset:4096
    ds_read_b64_tr_b16 v[228:229], v7 offset:4096
    ds_read_b64_tr_b16 v[230:231], v5 offset:4096
    ds_read_b64_tr_b16 v[232:233], v6 offset:4128
    ds_read_b64_tr_b16 v[234:235], v4 offset:4128
    ds_read_b64_tr_b16 v[236:237], v7 offset:4128
    ds_read_b64_tr_b16 v[238:239], v5 offset:4128
    s_add_u32 m0, s72, 12288
    s_mov_b32 s61, 393216
    buffer_load_dwordx4 v3, s[84:87], s61 offen  lds
    s_add_u32 m0, s72, 13312
    s_mov_b32 s61, 425984
    buffer_load_dwordx4 v3, s[84:87], s61 offen  lds
    s_add_u32 m0, s72, 14336
    s_mov_b32 s61, 1441792
    buffer_load_dwordx4 v3, s[84:87], s61 offen  lds
    s_add_u32 m0, s72, 15360
    s_mov_b32 s61, 1474560
    buffer_load_dwordx4 v3, s[84:87], s61 offen  lds
    s_waitcnt lgkmcnt(0)
    s_waitcnt vmcnt(12)
    s_barrier
    ds_read_b64_tr_b16 a[160:161], v6 offset:8192
    ds_read_b64_tr_b16 a[162:163], v4 offset:8192
    ds_read_b64_tr_b16 a[164:165], v7 offset:8192
    ds_read_b64_tr_b16 a[166:167], v5 offset:8192
    ds_read_b64_tr_b16 a[168:169], v6 offset:8224
    ds_read_b64_tr_b16 a[170:171], v4 offset:8224
    ds_read_b64_tr_b16 a[172:173], v7 offset:8224
    ds_read_b64_tr_b16 a[174:175], v5 offset:8224
    ds_write_b128 v118, v[8:11] offset:0
    ds_write_b128 v118, v[12:15] offset:1024
    ds_write_b128 v118, v[16:19] offset:2048
    ds_write_b128 v118, v[20:23] offset:3072
    s_add_u32 m0, s72, 4096
    s_mov_b32 s61, 524288
    buffer_load_dwordx4 v3, s[84:87], s61 offen  lds
    s_add_u32 m0, s72, 5120
    s_mov_b32 s61, 557056
    buffer_load_dwordx4 v3, s[84:87], s61 offen  lds
    s_add_u32 m0, s72, 6144
    s_mov_b32 s61, 1572864
    buffer_load_dwordx4 v3, s[84:87], s61 offen  lds
    s_add_u32 m0, s72, 7168
    s_mov_b32 s61, 1605632
    buffer_load_dwordx4 v3, s[84:87], s61 offen  lds
    s_waitcnt lgkmcnt(0)
    s_waitcnt vmcnt(12)
    s_barrier
    ds_read_b64_tr_b16 a[128:129], v6 offset:20480
    ds_read_b64_tr_b16 a[130:131], v4 offset:20480
    ds_read_b64_tr_b16 a[132:133], v7 offset:20480
    ds_read_b64_tr_b16 a[134:135], v5 offset:20480
    ds_read_b64_tr_b16 a[136:137], v6 offset:20512
    ds_read_b64_tr_b16 a[138:139], v4 offset:20512
    ds_read_b64_tr_b16 a[140:141], v7 offset:20512
    ds_read_b64_tr_b16 a[142:143], v5 offset:20512
    s_add_u32 m0, s72, 8192
    s_mov_b32 s61, 655360
    buffer_load_dwordx4 v3, s[84:87], s61 offen  lds
    s_add_u32 m0, s72, 9216
    s_mov_b32 s61, 688128
    buffer_load_dwordx4 v3, s[84:87], s61 offen  lds
    s_add_u32 m0, s72, 10240
    s_mov_b32 s61, 1703936
    buffer_load_dwordx4 v3, s[84:87], s61 offen  lds
    s_add_u32 m0, s72, 11264
    s_mov_b32 s61, 1736704
    buffer_load_dwordx4 v3, s[84:87], s61 offen  lds
    s_waitcnt lgkmcnt(0)
    s_waitcnt vmcnt(12)
    s_barrier
    ds_read_b64_tr_b16 a[208:209], v6 offset:16384
    ds_read_b64_tr_b16 a[210:211], v4 offset:16384
    ds_read_b64_tr_b16 a[212:213], v7 offset:16384
    ds_read_b64_tr_b16 a[214:215], v5 offset:16384
    ds_read_b64_tr_b16 a[216:217], v6 offset:16416
    ds_read_b64_tr_b16 a[218:219], v4 offset:16416
    ds_read_b64_tr_b16 a[220:221], v7 offset:16416
    ds_read_b64_tr_b16 a[222:223], v5 offset:16416
    s_add_u32 m0, s72, 20480
    s_mov_b32 s61, 786432
    buffer_load_dwordx4 v3, s[84:87], s61 offen  lds
    s_add_u32 m0, s72, 21504
    s_mov_b32 s61, 819200
    buffer_load_dwordx4 v3, s[84:87], s61 offen  lds
    s_add_u32 m0, s72, 22528
    s_mov_b32 s61, 1835008
    buffer_load_dwordx4 v3, s[84:87], s61 offen  lds
    s_add_u32 m0, s72, 23552
    s_mov_b32 s61, 1867776
    buffer_load_dwordx4 v3, s[84:87], s61 offen  lds
    s_waitcnt lgkmcnt(0)
    s_waitcnt vmcnt(12)
    s_barrier
    ds_read_b64_tr_b16 a[192:193], v6 offset:12288
    ds_read_b64_tr_b16 a[194:195], v4 offset:12288
    ds_read_b64_tr_b16 a[196:197], v7 offset:12288
    ds_read_b64_tr_b16 a[198:199], v5 offset:12288
    ds_read_b64_tr_b16 a[200:201], v6 offset:12320
    ds_read_b64_tr_b16 a[202:203], v4 offset:12320
    ds_read_b64_tr_b16 a[204:205], v7 offset:12320
    ds_read_b64_tr_b16 a[206:207], v5 offset:12320
    s_add_u32 m0, s72, 16384
    s_mov_b32 s61, 917504
    buffer_load_dwordx4 v3, s[84:87], s61 offen  lds
    s_add_u32 m0, s72, 17408
    s_mov_b32 s61, 950272
    buffer_load_dwordx4 v3, s[84:87], s61 offen  lds
    s_add_u32 m0, s72, 18432
    s_mov_b32 s61, 1966080
    buffer_load_dwordx4 v3, s[84:87], s61 offen  lds
    s_add_u32 m0, s72, 19456
    s_mov_b32 s61, 1998848
    buffer_load_dwordx4 v3, s[84:87], s61 offen  lds
    s_waitcnt lgkmcnt(0)
    s_waitcnt vmcnt(12)
    s_barrier
    ds_read_b64_tr_b16 a[176:177], v6 offset:4096
    ds_read_b64_tr_b16 a[178:179], v4 offset:4096
    ds_read_b64_tr_b16 a[180:181], v7 offset:4096
    ds_read_b64_tr_b16 a[182:183], v5 offset:4096
    ds_read_b64_tr_b16 a[184:185], v6 offset:4128
    ds_read_b64_tr_b16 a[186:187], v4 offset:4128
    ds_read_b64_tr_b16 a[188:189], v7 offset:4128
    ds_read_b64_tr_b16 a[190:191], v5 offset:4128
    s_add_u32 m0, s72, 12288
    s_mov_b32 s61, 0
    buffer_load_dwordx4 v3, s[76:79], s61 offen  lds
    s_add_u32 m0, s72, 13312
    s_mov_b32 s61, 32768
    buffer_load_dwordx4 v3, s[76:79], s61 offen  lds
    s_add_u32 m0, s72, 14336
    s_mov_b32 s61, 1048576
    buffer_load_dwordx4 v3, s[76:79], s61 offen  lds
    s_add_u32 m0, s72, 15360
    s_mov_b32 s61, 1081344
    buffer_load_dwordx4 v3, s[76:79], s61 offen  lds
    s_waitcnt lgkmcnt(0)
    s_waitcnt vmcnt(12)
    s_barrier
    ds_read_b64_tr_b16 a[144:145], v6 offset:8192
    ds_read_b64_tr_b16 a[146:147], v4 offset:8192
    ds_read_b64_tr_b16 a[148:149], v7 offset:8192
    ds_read_b64_tr_b16 a[150:151], v5 offset:8192
    ds_read_b64_tr_b16 a[152:153], v6 offset:8224
    ds_read_b64_tr_b16 a[154:155], v4 offset:8224
    ds_read_b64_tr_b16 a[156:157], v7 offset:8224
    ds_read_b64_tr_b16 a[158:159], v5 offset:8224
    s_add_u32 m0, s72, 4096
    s_mov_b32 s61, 131072
    buffer_load_dwordx4 v3, s[76:79], s61 offen  lds
    s_add_u32 m0, s72, 5120
    s_mov_b32 s61, 163840
    buffer_load_dwordx4 v3, s[76:79], s61 offen  lds
    s_add_u32 m0, s72, 6144
    s_mov_b32 s61, 1179648
    buffer_load_dwordx4 v3, s[76:79], s61 offen  lds
    s_add_u32 m0, s72, 7168
    s_mov_b32 s61, 1212416
    buffer_load_dwordx4 v3, s[76:79], s61 offen  lds
    s_waitcnt lgkmcnt(0)
    s_waitcnt vmcnt(12)
    s_barrier
    ds_read_b64_tr_b16 v[88:89], v6 offset:20480
    ds_read_b64_tr_b16 v[90:91], v4 offset:20480
    ds_read_b64_tr_b16 v[92:93], v7 offset:20480
    ds_read_b64_tr_b16 v[94:95], v5 offset:20480
    ds_read_b64_tr_b16 v[96:97], v6 offset:20512
    ds_read_b64_tr_b16 v[98:99], v4 offset:20512
    ds_read_b64_tr_b16 v[100:101], v7 offset:20512
    ds_read_b64_tr_b16 v[102:103], v5 offset:20512
    s_add_u32 m0, s72, 8192
    s_mov_b32 s61, 262144
    buffer_load_dwordx4 v3, s[76:79], s61 offen  lds
    s_add_u32 m0, s72, 9216
    s_mov_b32 s61, 294912
    buffer_load_dwordx4 v3, s[76:79], s61 offen  lds
    s_add_u32 m0, s72, 10240
    s_mov_b32 s61, 1310720
    buffer_load_dwordx4 v3, s[76:79], s61 offen  lds
    s_add_u32 m0, s72, 11264
    s_mov_b32 s61, 1343488
    buffer_load_dwordx4 v3, s[76:79], s61 offen  lds
    global_store_dword v113, v123, s[36:37]
    v_mbcnt_lo_u32_b32 v1, -1, 0
    v_and_b32 v1, 15, v1
    v_lshlrev_b32 v1, 4, v1
    global_load_dword v2, v1, s[18:19] sc1
    s_waitcnt lgkmcnt(0)
    s_waitcnt vmcnt(14)
    s_barrier
    ds_read_b64_tr_b16 v[72:73], v6 offset:16384
    ds_read_b64_tr_b16 v[74:75], v4 offset:16384
    ds_read_b64_tr_b16 v[76:77], v7 offset:16384
    ds_read_b64_tr_b16 v[78:79], v5 offset:16384
    ds_read_b64_tr_b16 v[80:81], v6 offset:16416
    ds_read_b64_tr_b16 v[82:83], v4 offset:16416
    ds_read_b64_tr_b16 v[84:85], v7 offset:16416
    ds_read_b64_tr_b16 v[86:87], v5 offset:16416
    s_add_u32 m0, s72, 20480
    s_mov_b32 s61, 393216
    buffer_load_dwordx4 v3, s[76:79], s61 offen  lds
    s_add_u32 m0, s72, 21504
    s_mov_b32 s61, 425984
    buffer_load_dwordx4 v3, s[76:79], s61 offen  lds
    s_add_u32 m0, s72, 22528
    s_mov_b32 s61, 1441792
    buffer_load_dwordx4 v3, s[76:79], s61 offen  lds
    s_add_u32 m0, s72, 23552
    s_mov_b32 s61, 1474560
    buffer_load_dwordx4 v3, s[76:79], s61 offen  lds
    s_waitcnt lgkmcnt(0)
    s_waitcnt vmcnt(14)
    s_barrier
    ds_read_b64_tr_b16 a[32:33], v6 offset:12288
    ds_read_b64_tr_b16 a[34:35], v4 offset:12288
    ds_read_b64_tr_b16 a[36:37], v7 offset:12288
    ds_read_b64_tr_b16 a[38:39], v5 offset:12288
    ds_read_b64_tr_b16 a[40:41], v6 offset:12320
    ds_read_b64_tr_b16 a[42:43], v4 offset:12320
    ds_read_b64_tr_b16 a[44:45], v7 offset:12320
    ds_read_b64_tr_b16 a[46:47], v5 offset:12320
    s_add_u32 m0, s72, 16384
    s_mov_b32 s61, 524288
    buffer_load_dwordx4 v3, s[76:79], s61 offen  lds
    s_add_u32 m0, s72, 17408
    s_mov_b32 s61, 557056
    buffer_load_dwordx4 v3, s[76:79], s61 offen  lds
    s_add_u32 m0, s72, 18432
    s_mov_b32 s61, 1572864
    buffer_load_dwordx4 v3, s[76:79], s61 offen  lds
    s_add_u32 m0, s72, 19456
    s_mov_b32 s61, 1605632
    buffer_load_dwordx4 v3, s[76:79], s61 offen  lds
    s_waitcnt lgkmcnt(0)
    s_waitcnt vmcnt(14)
    s_barrier
    ds_read_b64_tr_b16 a[0:1], v6 offset:4096
    ds_read_b64_tr_b16 a[2:3], v4 offset:4096
    ds_read_b64_tr_b16 a[4:5], v7 offset:4096
    ds_read_b64_tr_b16 a[6:7], v5 offset:4096
    ds_read_b64_tr_b16 a[8:9], v6 offset:4128
    ds_read_b64_tr_b16 a[10:11], v4 offset:4128
    ds_read_b64_tr_b16 a[12:13], v7 offset:4128
    ds_read_b64_tr_b16 a[14:15], v5 offset:4128
    s_add_u32 m0, s72, 12288
    s_mov_b32 s61, 655360
    buffer_load_dwordx4 v3, s[76:79], s61 offen  lds
    s_add_u32 m0, s72, 13312
    s_mov_b32 s61, 688128
    buffer_load_dwordx4 v3, s[76:79], s61 offen  lds
    s_add_u32 m0, s72, 14336
    s_mov_b32 s61, 1703936
    buffer_load_dwordx4 v3, s[76:79], s61 offen  lds
    s_add_u32 m0, s72, 15360
    s_mov_b32 s61, 1736704
    buffer_load_dwordx4 v3, s[76:79], s61 offen  lds
    s_waitcnt lgkmcnt(0)
    s_waitcnt vmcnt(14)
    s_barrier
    ds_read_b64_tr_b16 a[96:97], v6 offset:8192
    ds_read_b64_tr_b16 a[98:99], v4 offset:8192
    ds_read_b64_tr_b16 a[100:101], v7 offset:8192
    ds_read_b64_tr_b16 a[102:103], v5 offset:8192
    ds_read_b64_tr_b16 a[104:105], v6 offset:8224
    ds_read_b64_tr_b16 a[106:107], v4 offset:8224
    ds_read_b64_tr_b16 a[108:109], v7 offset:8224
    ds_read_b64_tr_b16 a[110:111], v5 offset:8224
    s_add_u32 m0, s72, 4096
    s_mov_b32 s61, 786432
    buffer_load_dwordx4 v3, s[76:79], s61 offen  lds
    s_add_u32 m0, s72, 5120
    s_mov_b32 s61, 819200
    buffer_load_dwordx4 v3, s[76:79], s61 offen  lds
    s_add_u32 m0, s72, 6144
    s_mov_b32 s61, 1835008
    buffer_load_dwordx4 v3, s[76:79], s61 offen  lds
    s_add_u32 m0, s72, 7168
    s_mov_b32 s61, 1867776
    buffer_load_dwordx4 v3, s[76:79], s61 offen  lds
    s_waitcnt lgkmcnt(0)
    s_waitcnt vmcnt(12)
    s_barrier
    ds_read_b64_tr_b16 a[64:65], v6 offset:20480
    ds_read_b64_tr_b16 a[66:67], v4 offset:20480
    ds_read_b64_tr_b16 a[68:69], v7 offset:20480
    ds_read_b64_tr_b16 a[70:71], v5 offset:20480
    ds_read_b64_tr_b16 a[72:73], v6 offset:20512
    ds_read_b64_tr_b16 a[74:75], v4 offset:20512
    ds_read_b64_tr_b16 a[76:77], v7 offset:20512
    ds_read_b64_tr_b16 a[78:79], v5 offset:20512
    s_add_u32 m0, s72, 8192
    s_mov_b32 s61, 917504
    buffer_load_dwordx4 v3, s[76:79], s61 offen  lds
    s_add_u32 m0, s72, 9216
    s_mov_b32 s61, 950272
    buffer_load_dwordx4 v3, s[76:79], s61 offen  lds
    s_add_u32 m0, s72, 10240
    s_mov_b32 s61, 1966080
    buffer_load_dwordx4 v3, s[76:79], s61 offen  lds
    s_add_u32 m0, s72, 11264
    s_mov_b32 s61, 1998848
    buffer_load_dwordx4 v3, s[76:79], s61 offen  lds
    s_waitcnt lgkmcnt(0)
    s_waitcnt vmcnt(12)
    s_barrier
    ds_read_b64_tr_b16 a[48:49], v6 offset:16384
    ds_read_b64_tr_b16 a[50:51], v4 offset:16384
    ds_read_b64_tr_b16 a[52:53], v7 offset:16384
    ds_read_b64_tr_b16 a[54:55], v5 offset:16384
    ds_read_b64_tr_b16 a[56:57], v6 offset:16416
    ds_read_b64_tr_b16 a[58:59], v4 offset:16416
    ds_read_b64_tr_b16 a[60:61], v7 offset:16416
    ds_read_b64_tr_b16 a[62:63], v5 offset:16416
    ds_write_b128 v118, v[88:91] offset:20480
    ds_write_b128 v118, v[92:95] offset:21504
    ds_write_b128 v118, v[96:99] offset:22528
    ds_write_b128 v118, v[100:103] offset:23552
    global_load_dword v123, v122, s[96:97] sc1
    s_waitcnt lgkmcnt(0)
    s_waitcnt vmcnt(9)
    s_barrier
    ds_read_b64_tr_b16 a[16:17], v6 offset:12288
    ds_read_b64_tr_b16 a[18:19], v4 offset:12288
    ds_read_b64_tr_b16 a[20:21], v7 offset:12288
    ds_read_b64_tr_b16 a[22:23], v5 offset:12288
    ds_read_b64_tr_b16 a[24:25], v6 offset:12320
    ds_read_b64_tr_b16 a[26:27], v4 offset:12320
    ds_read_b64_tr_b16 a[28:29], v7 offset:12320
    ds_read_b64_tr_b16 a[30:31], v5 offset:12320
    ds_write_b128 v118, v[72:75] offset:16384
    ds_write_b128 v118, v[76:79] offset:17408
    ds_write_b128 v118, v[80:83] offset:18432
    ds_write_b128 v118, v[84:87] offset:19456
    s_waitcnt lgkmcnt(0)
    s_waitcnt vmcnt(5)
    s_barrier
    ds_read_b64_tr_b16 a[112:113], v6 offset:4096
    ds_read_b64_tr_b16 a[114:115], v4 offset:4096
    ds_read_b64_tr_b16 a[116:117], v7 offset:4096
    ds_read_b64_tr_b16 a[118:119], v5 offset:4096
    ds_read_b64_tr_b16 a[120:121], v6 offset:4128
    ds_read_b64_tr_b16 a[122:123], v4 offset:4128
    ds_read_b64_tr_b16 a[124:125], v7 offset:4128
    ds_read_b64_tr_b16 a[126:127], v5 offset:4128
    ds_write_b128 v118, v[56:59] offset:12288
    ds_write_b128 v118, v[60:63] offset:13312
    ds_write_b128 v118, v[64:67] offset:14336
    ds_write_b128 v118, v[68:71] offset:15360
    s_waitcnt lgkmcnt(0)
    s_waitcnt vmcnt(1)
    s_barrier
    ds_read_b64_tr_b16 a[80:81], v6 offset:8192
    ds_read_b64_tr_b16 a[82:83], v4 offset:8192
    ds_read_b64_tr_b16 a[84:85], v7 offset:8192
    ds_read_b64_tr_b16 a[86:87], v5 offset:8192
    ds_read_b64_tr_b16 a[88:89], v6 offset:8224
    ds_read_b64_tr_b16 a[90:91], v4 offset:8224
    ds_read_b64_tr_b16 a[92:93], v7 offset:8224
    ds_read_b64_tr_b16 a[94:95], v5 offset:8224
    ds_write_b128 v118, v[24:27] offset:4096
    ds_write_b128 v118, v[28:31] offset:5120
    ds_write_b128 v118, v[32:35] offset:6144
    ds_write_b128 v118, v[36:39] offset:7168
    s_waitcnt vmcnt(0)
    global_load_dwordx4 a[240:243], v105, s[42:43] offset:0 sc1
    global_load_dwordx4 a[244:247], v105, s[42:43] offset:1024 sc1
    global_load_dwordx4 a[248:251], v105, s[42:43] offset:2048 sc1
    global_load_dwordx4 a[252:255], v105, s[42:43] offset:3072 sc1
    s_waitcnt lgkmcnt(0)
    s_barrier
    ds_write_b128 v118, v[40:43] offset:8192
    ds_write_b128 v118, v[44:47] offset:9216
    ds_write_b128 v118, v[48:51] offset:10240
    ds_write_b128 v118, v[52:55] offset:11264
    s_branch L_ch_wdone
L_ch_wv2:
    s_cmp_eq_u32 s67, 2
    s_cbranch_scc0 L_ch_wv3
    ds_read_b64_tr_b16 v[136:137], v5 offset:0
    ds_read_b64_tr_b16 v[138:139], v5 offset:512
    ds_read_b64_tr_b16 v[140:141], v5 offset:2048
    ds_read_b64_tr_b16 v[142:143], v5 offset:2560
    ds_read_b64_tr_b16 v[160:161], v5 offset:64
    ds_read_b64_tr_b16 v[162:163], v5 offset:576
    ds_read_b64_tr_b16 v[164:165], v5 offset:2112
    ds_read_b64_tr_b16 v[166:167], v5 offset:2624
    s_waitcnt lgkmcnt(0)
    ds_read_b64_tr_b16 v[184:185], v5 offset:128
    ds_read_b64_tr_b16 v[186:187], v5 offset:640
    ds_read_b64_tr_b16 v[188:189], v5 offset:2176
    ds_read_b64_tr_b16 v[190:191], v5 offset:2688
    ds_read_b64_tr_b16 a[80:81], v5 offset:192
    ds_read_b64_tr_b16 a[82:83], v5 offset:704
    ds_read_b64_tr_b16 a[84:85], v5 offset:2240
    ds_read_b64_tr_b16 a[86:87], v5 offset:2752
    s_waitcnt lgkmcnt(0)
    s_add_u32 m0, s72, 0
    s_mov_b32 s61, 131072
    buffer_load_dwordx4 v3, s[80:83], s61 offen  lds
    s_add_u32 m0, s72, 1024
    s_mov_b32 s61, 163840
    buffer_load_dwordx4 v3, s[80:83], s61 offen  lds
    s_add_u32 m0, s72, 2048
    s_mov_b32 s61, 1179648
    buffer_load_dwordx4 v3, s[80:83], s61 offen  lds
    s_add_u32 m0, s72, 3072
    s_mov_b32 s61, 1212416
    buffer_load_dwordx4 v3, s[80:83], s61 offen  lds
    s_add_u32 m0, s72, 4096
    s_mov_b32 s61, 262144
    buffer_load_dwordx4 v3, s[80:83], s61 offen  lds
    s_add_u32 m0, s72, 5120
    s_mov_b32 s61, 294912
    buffer_load_dwordx4 v3, s[80:83], s61 offen  lds
    s_add_u32 m0, s72, 6144
    s_mov_b32 s61, 1310720
    buffer_load_dwordx4 v3, s[80:83], s61 offen  lds
    s_add_u32 m0, s72, 7168
    s_mov_b32 s61, 1343488
    buffer_load_dwordx4 v3, s[80:83], s61 offen  lds
    ds_read_b64_tr_b16 v[144:145], v5 offset:8192
    ds_read_b64_tr_b16 v[146:147], v5 offset:8704
    ds_read_b64_tr_b16 v[148:149], v5 offset:10240
    ds_read_b64_tr_b16 v[150:151], v5 offset:10752
    ds_read_b64_tr_b16 v[168:169], v5 offset:8256
    ds_read_b64_tr_b16 v[170:171], v5 offset:8768
    ds_read_b64_tr_b16 v[172:173], v5 offset:10304
    ds_read_b64_tr_b16 v[174:175], v5 offset:10816
    s_waitcnt lgkmcnt(0)
    ds_read_b64_tr_b16 v[192:193], v5 offset:8320
    ds_read_b64_tr_b16 v[194:195], v5 offset:8832
    ds_read_b64_tr_b16 v[196:197], v5 offset:10368
    ds_read_b64_tr_b16 v[198:199], v5 offset:10880
    ds_read_b64_tr_b16 a[88:89], v5 offset:8384
    ds_read_b64_tr_b16 a[90:91], v5 offset:8896
    ds_read_b64_tr_b16 a[92:93], v5 offset:10432
    ds_read_b64_tr_b16 a[94:95], v5 offset:10944
    s_waitcnt lgkmcnt(0)
    s_add_u32 m0, s72, 8192
    s_mov_b32 s61, 393216
    buffer_load_dwordx4 v3, s[80:83], s61 offen  lds
    s_add_u32 m0, s72, 9216
    s_mov_b32 s61, 425984
    buffer_load_dwordx4 v3, s[80:83], s61 offen  lds
    s_add_u32 m0, s72, 10240
    s_mov_b32 s61, 1441792
    buffer_load_dwordx4 v3, s[80:83], s61 offen  lds
    s_add_u32 m0, s72, 11264
    s_mov_b32 s61, 1474560
    buffer_load_dwordx4 v3, s[80:83], s61 offen  lds
    s_waitcnt vmcnt(24)
    ds_read_b64_tr_b16 a[16:17], v5 offset:16384
    ds_read_b64_tr_b16 a[18:19], v5 offset:16896
    ds_read_b64_tr_b16 a[20:21], v5 offset:18432
    ds_read_b64_tr_b16 a[22:23], v5 offset:18944
    ds_read_b64_tr_b16 a[24:25], v5 offset:16448
    ds_read_b64_tr_b16 a[26:27], v5 offset:16960
    ds_read_b64_tr_b16 a[28:29], v5 offset:18496
    ds_read_b64_tr_b16 a[30:31], v5 offset:19008
    s_waitcnt lgkmcnt(0)
    ds_read_b64_tr_b16 a[48:49], v5 offset:16512
    ds_read_b64_tr_b16 a[50:51], v5 offset:17024
    ds_read_b64_tr_b16 a[52:53], v5 offset:18560
    ds_read_b64_tr_b16 a[54:55], v5 offset:19072
    ds_read_b64_tr_b16 a[56:57], v5 offset:16576
    ds_read_b64_tr_b16 a[58:59], v5 offset:17088
    ds_read_b64_tr_b16 a[60:61], v5 offset:18624
    ds_read_b64_tr_b16 a[62:63], v5 offset:19136
    s_waitcnt lgkmcnt(0)
    s_waitcnt vmcnt(16)
    ds_read_b64_tr_b16 v[128:129], v5 offset:24576
    ds_read_b64_tr_b16 v[130:131], v5 offset:25088
    ds_read_b64_tr_b16 v[132:133], v5 offset:26624
    ds_read_b64_tr_b16 v[134:135], v5 offset:27136
    ds_read_b64_tr_b16 v[152:153], v5 offset:24640
    ds_read_b64_tr_b16 v[154:155], v5 offset:25152
    ds_read_b64_tr_b16 v[156:157], v5 offset:26688
    ds_read_b64_tr_b16 v[158:159], v5 offset:27200
    s_waitcnt lgkmcnt(0)
    ds_read_b64_tr_b16 v[176:177], v5 offset:24704
    ds_read_b64_tr_b16 v[178:179], v5 offset:25216
    ds_read_b64_tr_b16 v[180:181], v5 offset:26752
    ds_read_b64_tr_b16 v[182:183], v5 offset:27264
    ds_read_b64_tr_b16 v[200:201], v5 offset:24768
    ds_read_b64_tr_b16 v[202:203], v5 offset:25280
    ds_read_b64_tr_b16 v[204:205], v5 offset:26816
    ds_read_b64_tr_b16 v[206:207], v5 offset:27328
    s_waitcnt lgkmcnt(0)
    v_add_u32 v4, 36864, v6
    v_add_u32 v5, 36864, v7
    s_waitcnt vmcnt(12)
    s_barrier
    ds_read_b64_tr_b16 v[208:209], v6 offset:32768
    ds_read_b64_tr_b16 v[210:211], v4 offset:32768
    ds_read_b64_tr_b16 v[212:213], v7 offset:32768
    ds_read_b64_tr_b16 v[214:215], v5 offset:32768
    ds_read_b64_tr_b16 v[216:217], v6 offset:32800
    ds_read_b64_tr_b16 v[218:219], v4 offset:32800
    ds_read_b64_tr_b16 v[220:221], v7 offset:32800
    ds_read_b64_tr_b16 v[222:223], v5 offset:32800
    ds_write_b128 v118, a[48:51] offset:28672
    ds_write_b128 v118, a[52:55] offset:29696
    ds_write_b128 v118, a[56:59] offset:30720
    ds_write_b128 v118, a[60:63] offset:31744
    s_add_u32 m0, s72, 20480
    s_mov_b32 s61, 524288
    buffer_load_dwordx4 v3, s[80:83], s61 offen  lds
    s_add_u32 m0, s72, 21504
    s_mov_b32 s61, 557056
    buffer_load_dwordx4 v3, s[80:83], s61 offen  lds
    s_add_u32 m0, s72, 22528
    s_mov_b32 s61, 1572864
    buffer_load_dwordx4 v3, s[80:83], s61 offen  lds
    s_add_u32 m0, s72, 23552
    s_mov_b32 s61, 1605632
    buffer_load_dwordx4 v3, s[80:83], s61 offen  lds
    s_waitcnt lgkmcnt(0)
    s_waitcnt vmcnt(12)
    s_barrier
    ds_read_b64_tr_b16 v[240:241], v6 offset:0
    ds_read_b64_tr_b16 v[242:243], v4 offset:0
    ds_read_b64_tr_b16 v[244:245], v7 offset:0
    ds_read_b64_tr_b16 v[246:247], v5 offset:0
    ds_read_b64_tr_b16 v[248:249], v6 offset:32
    ds_read_b64_tr_b16 v[250:251], v4 offset:32
    ds_read_b64_tr_b16 v[252:253], v7 offset:32
    ds_read_b64_tr_b16 v[254:255], v5 offset:32
    ds_write_b128 v118, a[80:83] offset:32768
    ds_write_b128 v118, a[84:87] offset:33792
    ds_write_b128 v118, a[88:91] offset:34816
    ds_write_b128 v118, a[92:95] offset:35840
    s_add_u32 m0, s72, 16384
    s_mov_b32 s61, 655360
    buffer_load_dwordx4 v3, s[80:83], s61 offen  lds
    s_add_u32 m0, s72, 17408
    s_mov_b32 s61, 688128
    buffer_load_dwordx4 v3, s[80:83], s61 offen  lds
    s_add_u32 m0, s72, 18432
    s_mov_b32 s61, 1703936
    buffer_load_dwordx4 v3, s[80:83], s61 offen  lds
    s_add_u32 m0, s72, 19456
    s_mov_b32 s61, 1736704
    buffer_load_dwordx4 v3, s[80:83], s61 offen  lds
    s_waitcnt lgkmcnt(0)
    s_waitcnt vmcnt(12)
    s_barrier
    ds_read_b64_tr_b16 v[8:9], v6 offset:4096
    ds_read_b64_tr_b16 v[10:11], v4 offset:4096
    ds_read_b64_tr_b16 v[12:13], v7 offset:4096
    ds_read_b64_tr_b16 v[14:15], v5 offset:4096
    ds_read_b64_tr_b16 v[16:17], v6 offset:4128
    ds_read_b64_tr_b16 v[18:19], v4 offset:4128
    ds_read_b64_tr_b16 v[20:21], v7 offset:4128
    ds_read_b64_tr_b16 v[22:23], v5 offset:4128
    ds_write_b128 v118, a[16:19] offset:24576
    ds_write_b128 v118, a[20:23] offset:25600
    ds_write_b128 v118, a[24:27] offset:26624
    ds_write_b128 v118, a[28:31] offset:27648
    s_add_u32 m0, s72, 12288
    s_mov_b32 s61, 786432
    buffer_load_dwordx4 v3, s[80:83], s61 offen  lds
    s_add_u32 m0, s72, 13312
    s_mov_b32 s61, 819200
    buffer_load_dwordx4 v3, s[80:83], s61 offen  lds
    s_add_u32 m0, s72, 14336
    s_mov_b32 s61, 1835008
    buffer_load_dwordx4 v3, s[80:83], s61 offen  lds
    s_add_u32 m0, s72, 15360
    s_mov_b32 s61, 1867776
    buffer_load_dwordx4 v3, s[80:83], s61 offen  lds
    s_waitcnt lgkmcnt(0)
    s_waitcnt vmcnt(12)
    s_barrier
    ds_read_b64_tr_b16 v[24:25], v6 offset:8192
    ds_read_b64_tr_b16 v[26:27], v4 offset:8192
    ds_read_b64_tr_b16 v[28:29], v7 offset:8192
    ds_read_b64_tr_b16 v[30:31], v5 offset:8192
    ds_read_b64_tr_b16 v[32:33], v6 offset:8224
    ds_read_b64_tr_b16 v[34:35], v4 offset:8224
    ds_read_b64_tr_b16 v[36:37], v7 offset:8224
    ds_read_b64_tr_b16 v[38:39], v5 offset:8224
    s_add_u32 m0, s72, 4096
    s_mov_b32 s61, 917504
    buffer_load_dwordx4 v3, s[80:83], s61 offen  lds
    s_add_u32 m0, s72, 5120
    s_mov_b32 s61, 950272
    buffer_load_dwordx4 v3, s[80:83], s61 offen  lds
    s_add_u32 m0, s72, 6144
    s_mov_b32 s61, 1966080
    buffer_load_dwordx4 v3, s[80:83], s61 offen  lds
    s_add_u32 m0, s72, 7168
    s_mov_b32 s61, 1998848
    buffer_load_dwordx4 v3, s[80:83], s61 offen  lds
    s_waitcnt lgkmcnt(0)
    s_waitcnt vmcnt(12)
    s_barrier
    ds_read_b64_tr_b16 v[224:225], v6 offset:20480
    ds_read_b64_tr_b16 v[226:227], v4 offset:20480
    ds_read_b64_tr_b16 v[228:229], v7 offset:20480
    ds_read_b64_tr_b16 v[230:231], v5 offset:20480
    ds_read_b64_tr_b16 v[232:233], v6 offset:20512
    ds_read_b64_tr_b16 v[234:235], v4 offset:20512
    ds_read_b64_tr_b16 v[236:237], v7 offset:20512
    ds_read_b64_tr_b16 v[238:239], v5 offset:20512
    s_add_u32 m0, s72, 8192
    s_mov_b32 s61, 0
    buffer_load_dwordx4 v3, s[84:87], s61 offen  lds
    s_add_u32 m0, s72, 9216
    s_mov_b32 s61, 32768
    buffer_load_dwordx4 v3, s[84:87], s61 offen  lds
    s_add_u32 m0, s72, 10240
    s_mov_b32 s61, 1048576
    buffer_load_dwordx4 v3, s[84:87], s61 offen  lds
    s_add_u32 m0, s72, 11264
    s_mov_b32 s61, 1081344
    buffer_load_dwordx4 v3, s[84:87], s61 offen  lds
    s_waitcnt lgkmcnt(0)
    s_waitcnt vmcnt(12)
    s_barrier
    ds_read_b64_tr_b16 a[224:225], v6 offset:16384
    ds_read_b64_tr_b16 a[226:227], v4 offset:16384
    ds_read_b64_tr_b16 a[228:229], v7 offset:16384
    ds_read_b64_tr_b16 a[230:231], v5 offset:16384
    ds_read_b64_tr_b16 a[232:233], v6 offset:16416
    ds_read_b64_tr_b16 a[234:235], v4 offset:16416
    ds_read_b64_tr_b16 a[236:237], v7 offset:16416
    ds_read_b64_tr_b16 a[238:239], v5 offset:16416
    s_add_u32 m0, s72, 20480
    s_mov_b32 s61, 131072
    buffer_load_dwordx4 v3, s[84:87], s61 offen  lds
    s_add_u32 m0, s72, 21504
    s_mov_b32 s61, 163840
    buffer_load_dwordx4 v3, s[84:87], s61 offen  lds
    s_add_u32 m0, s72, 22528
    s_mov_b32 s61, 1179648
    buffer_load_dwordx4 v3, s[84:87], s61 offen  lds
    s_add_u32 m0, s72, 23552
    s_mov_b32 s61, 1212416
    buffer_load_dwordx4 v3, s[84:87], s61 offen  lds
    s_waitcnt lgkmcnt(0)
    s_waitcnt vmcnt(12)
    s_barrier
    ds_read_b64_tr_b16 v[40:41], v6 offset:12288
    ds_read_b64_tr_b16 v[42:43], v4 offset:12288
    ds_read_b64_tr_b16 v[44:45], v7 offset:12288
    ds_read_b64_tr_b16 v[46:47], v5 offset:12288
    ds_read_b64_tr_b16 v[48:49], v6 offset:12320
    ds_read_b64_tr_b16 v[50:51], v4 offset:12320
    ds_read_b64_tr_b16 v[52:53], v7 offset:12320
    ds_read_b64_tr_b16 v[54:55], v5 offset:12320
    s_add_u32 m0, s72, 16384
    s_mov_b32 s61, 262144
    buffer_load_dwordx4 v3, s[84:87], s61 offen  lds
    s_add_u32 m0, s72, 17408
    s_mov_b32 s61, 294912
    buffer_load_dwordx4 v3, s[84:87], s61 offen  lds
    s_add_u32 m0, s72, 18432
    s_mov_b32 s61, 1310720
    buffer_load_dwordx4 v3, s[84:87], s61 offen  lds
    s_add_u32 m0, s72, 19456
    s_mov_b32 s61, 1343488
    buffer_load_dwordx4 v3, s[84:87], s61 offen  lds
    s_waitcnt lgkmcnt(0)
    s_waitcnt vmcnt(12)
    s_barrier
    ds_read_b64_tr_b16 v[56:57], v6 offset:4096
    ds_read_b64_tr_b16 v[58:59], v4 offset:4096
    ds_read_b64_tr_b16 v[60:61], v7 offset:4096
    ds_read_b64_tr_b16 v[62:63], v5 offset:4096
    ds_read_b64_tr_b16 v[64:65], v6 offset:4128
    ds_read_b64_tr_b16 v[66:67], v4 offset:4128
    ds_read_b64_tr_b16 v[68:69], v7 offset:4128
    ds_read_b64_tr_b16 v[70:71], v5 offset:4128
    s_add_u32 m0, s72, 12288
    s_mov_b32 s61, 393216
    buffer_load_dwordx4 v3, s[84:87], s61 offen  lds
    s_add_u32 m0, s72, 13312
    s_mov_b32 s61, 425984
    buffer_load_dwordx4 v3, s[84:87], s61 offen  lds
    s_add_u32 m0, s72, 14336
    s_mov_b32 s61, 1441792
    buffer_load_dwordx4 v3, s[84:87], s61 offen  lds
    s_add_u32 m0, s72, 15360
    s_mov_b32 s61, 1474560
    buffer_load_dwordx4 v3, s[84:87], s61 offen  lds
    s_waitcnt lgkmcnt(0)
    s_waitcnt vmcnt(12)
    s_barrier
    ds_read_b64_tr_b16 a[192:193], v6 offset:8192
    ds_read_b64_tr_b16 a[194:195], v4 offset:8192
    ds_read_b64_tr_b16 a[196:197], v7 offset:8192
    ds_read_b64_tr_b16 a[198:199], v5 offset:8192
    ds_read_b64_tr_b16 a[200:201], v6 offset:8224
    ds_read_b64_tr_b16 a[202:203], v4 offset:8224
    ds_read_b64_tr_b16 a[204:205], v7 offset:8224
    ds_read_b64_tr_b16 a[206:207], v5 offset:8224
    ds_write_b128 v118, v[8:11] offset:0
    ds_write_b128 v118, v[12:15] offset:1024
    ds_write_b128 v118, v[16:19] offset:2048
    ds_write_b128 v118, v[20:23] offset:3072
    s_add_u32 m0, s72, 4096
    s_mov_b32 s61, 524288
    buffer_load_dwordx4 v3, s[84:87], s61 offen  lds
    s_add_u32 m0, s72, 5120
    s_mov_b32 s61, 557056
    buffer_load_dwordx4 v3, s[84:87], s61 offen  lds
    s_add_u32 m0, s72, 6144
    s_mov_b32 s61, 1572864
    buffer_load_dwordx4 v3, s[84:87], s61 offen  lds
    s_add_u32 m0, s72, 7168
    s_mov_b32 s61, 1605632
    buffer_load_dwordx4 v3, s[84:87], s61 offen  lds
    s_waitcnt lgkmcnt(0)
    s_waitcnt vmcnt(12)
    s_barrier
    ds_read_b64_tr_b16 a[208:209], v6 offset:20480
    ds_read_b64_tr_b16 a[210:211], v4 offset:20480
    ds_read_b64_tr_b16 a[212:213], v7 offset:20480
    ds_read_b64_tr_b16 a[214:215], v5 offset:20480
    ds_read_b64_tr_b16 a[216:217], v6 offset:20512
    ds_read_b64_tr_b16 a[218:219], v4 offset:20512
    ds_read_b64_tr_b16 a[220:221], v7 offset:20512
    ds_read_b64_tr_b16 a[222:223], v5 offset:20512
    s_add_u32 m0, s72, 8192
    s_mov_b32 s61, 655360
    buffer_load_dwordx4 v3, s[84:87], s61 offen  lds
    s_add_u32 m0, s72, 9216
    s_mov_b32 s61, 688128
    buffer_load_dwordx4 v3, s[84:87], s61 offen  lds
    s_add_u32 m0, s72, 10240
    s_mov_b32 s61, 1703936
    buffer_load_dwordx4 v3, s[84:87], s61 offen  lds
    s_add_u32 m0, s72, 11264
    s_mov_b32 s61, 1736704
    buffer_load_dwordx4 v3, s[84:87], s61 offen  lds
    s_waitcnt lgkmcnt(0)
    s_waitcnt vmcnt(12)
    s_barrier
    ds_read_b64_tr_b16 a[128:129], v6 offset:16384
    ds_read_b64_tr_b16 a[130:131], v4 offset:16384
    ds_read_b64_tr_b16 a[132:133], v7 offset:16384
    ds_read_b64_tr_b16 a[134:135], v5 offset:16384
    ds_read_b64_tr_b16 a[136:137], v6 offset:16416
    ds_read_b64_tr_b16 a[138:139], v4 offset:16416
    ds_read_b64_tr_b16 a[140:141], v7 offset:16416
    ds_read_b64_tr_b16 a[142:143], v5 offset:16416
    s_add_u32 m0, s72, 20480
    s_mov_b32 s61, 786432
    buffer_load_dwordx4 v3, s[84:87], s61 offen  lds
    s_add_u32 m0, s72, 21504
    s_mov_b32 s61, 819200
    buffer_load_dwordx4 v3, s[84:87], s61 offen  lds
    s_add_u32 m0, s72, 22528
    s_mov_b32 s61, 1835008
    buffer_load_dwordx4 v3, s[84:87], s61 offen  lds
    s_add_u32 m0, s72, 23552
    s_mov_b32 s61, 1867776
    buffer_load_dwordx4 v3, s[84:87], s61 offen  lds
    s_waitcnt lgkmcnt(0)
    s_waitcnt vmcnt(12)
    s_barrier
    ds_read_b64_tr_b16 a[160:161], v6 offset:12288
    ds_read_b64_tr_b16 a[162:163], v4 offset:12288
    ds_read_b64_tr_b16 a[164:165], v7 offset:12288
    ds_read_b64_tr_b16 a[166:167], v5 offset:12288
    ds_read_b64_tr_b16 a[168:169], v6 offset:12320
    ds_read_b64_tr_b16 a[170:171], v4 offset:12320
    ds_read_b64_tr_b16 a[172:173], v7 offset:12320
    ds_read_b64_tr_b16 a[174:175], v5 offset:12320
    s_add_u32 m0, s72, 16384
    s_mov_b32 s61, 917504
    buffer_load_dwordx4 v3, s[84:87], s61 offen  lds
    s_add_u32 m0, s72, 17408
    s_mov_b32 s61, 950272
    buffer_load_dwordx4 v3, s[84:87], s61 offen  lds
    s_add_u32 m0, s72, 18432
    s_mov_b32 s61, 1966080
    buffer_load_dwordx4 v3, s[84:87], s61 offen  lds
    s_add_u32 m0, s72, 19456
    s_mov_b32 s61, 1998848
    buffer_load_dwordx4 v3, s[84:87], s61 offen  lds
    s_waitcnt lgkmcnt(0)
    s_waitcnt vmcnt(12)
    s_barrier
    ds_read_b64_tr_b16 v[72:73], v6 offset:4096
    ds_read_b64_tr_b16 v[74:75], v4 offset:4096
    ds_read_b64_tr_b16 v[76:77], v7 offset:4096
    ds_read_b64_tr_b16 v[78:79], v5 offset:4096
    ds_read_b64_tr_b16 v[80:81], v6 offset:4128
    ds_read_b64_tr_b16 v[82:83], v4 offset:4128
    ds_read_b64_tr_b16 v[84:85], v7 offset:4128
    ds_read_b64_tr_b16 v[86:87], v5 offset:4128
    s_add_u32 m0, s72, 12288
    s_mov_b32 s61, 0
    buffer_load_dwordx4 v3, s[76:79], s61 offen  lds
    s_add_u32 m0, s72, 13312
    s_mov_b32 s61, 32768
    buffer_load_dwordx4 v3, s[76:79], s61 offen  lds
    s_add_u32 m0, s72, 14336
    s_mov_b32 s61, 1048576
    buffer_load_dwordx4 v3, s[76:79], s61 offen  lds
    s_add_u32 m0, s72, 15360
    s_mov_b32 s61, 1081344
    buffer_load_dwordx4 v3, s[76:79], s61 offen  lds
    s_waitcnt lgkmcnt(0)
    s_waitcnt vmcnt(12)
    s_barrier
    ds_read_b64_tr_b16 v[88:89], v6 offset:8192
    ds_read_b64_tr_b16 v[90:91], v4 offset:8192
    ds_read_b64_tr_b16 v[92:93], v7 offset:8192
    ds_read_b64_tr_b16 v[94:95], v5 offset:8192
    ds_read_b64_tr_b16 v[96:97], v6 offset:8224
    ds_read_b64_tr_b16 v[98:99], v4 offset:8224
    ds_read_b64_tr_b16 v[100:101], v7 offset:8224
    ds_read_b64_tr_b16 v[102:103], v5 offset:8224
    s_add_u32 m0, s72, 4096
    s_mov_b32 s61, 131072
    buffer_load_dwordx4 v3, s[76:79], s61 offen  lds
    s_add_u32 m0, s72, 5120
    s_mov_b32 s61, 163840
    buffer_load_dwordx4 v3, s[76:79], s61 offen  lds
    s_add_u32 m0, s72, 6144
    s_mov_b32 s61, 1179648
    buffer_load_dwordx4 v3, s[76:79], s61 offen  lds
    s_add_u32 m0, s72, 7168
    s_mov_b32 s61, 1212416
    buffer_load_dwordx4 v3, s[76:79], s61 offen  lds
    s_waitcnt lgkmcnt(0)
    s_waitcnt vmcnt(12)
    s_barrier
    ds_read_b64_tr_b16 a[144:145], v6 offset:20480
    ds_read_b64_tr_b16 a[146:147], v4 offset:20480
    ds_read_b64_tr_b16 a[148:149], v7 offset:20480
    ds_read_b64_tr_b16 a[150:151], v5 offset:20480
    ds_read_b64_tr_b16 a[152:153], v6 offset:20512
    ds_read_b64_tr_b16 a[154:155], v4 offset:20512
    ds_read_b64_tr_b16 a[156:157], v7 offset:20512
    ds_read_b64_tr_b16 a[158:159], v5 offset:20512
    s_add_u32 m0, s72, 8192
    s_mov_b32 s61, 262144
    buffer_load_dwordx4 v3, s[76:79], s61 offen  lds
    s_add_u32 m0, s72, 9216
    s_mov_b32 s61, 294912
    buffer_load_dwordx4 v3, s[76:79], s61 offen  lds
    s_add_u32 m0, s72, 10240
    s_mov_b32 s61, 1310720
    buffer_load_dwordx4 v3, s[76:79], s61 offen  lds
    s_add_u32 m0, s72, 11264
    s_mov_b32 s61, 1343488
    buffer_load_dwordx4 v3, s[76:79], s61 offen  lds
    global_store_dword v113, v123, s[36:37]
    v_mbcnt_lo_u32_b32 v1, -1, 0
    v_and_b32 v1, 15, v1
    v_lshlrev_b32 v1, 4, v1
    global_load_dword v2, v1, s[18:19] sc1
    s_waitcnt lgkmcnt(0)
    s_waitcnt vmcnt(14)
    s_barrier
    ds_read_b64_tr_b16 a[176:177], v6 offset:16384
    ds_read_b64_tr_b16 a[178:179], v4 offset:16384
    ds_read_b64_tr_b16 a[180:181], v7 offset:16384
    ds_read_b64_tr_b16 a[182:183], v5 offset:16384
    ds_read_b64_tr_b16 a[184:185], v6 offset:16416
    ds_read_b64_tr_b16 a[186:187], v4 offset:16416
    ds_read_b64_tr_b16 a[188:189], v7 offset:16416
    ds_read_b64_tr_b16 a[190:191], v5 offset:16416
    s_add_u32 m0, s72, 20480
    s_mov_b32 s61, 393216
    buffer_load_dwordx4 v3, s[76:79], s61 offen  lds
    s_add_u32 m0, s72, 21504
    s_mov_b32 s61, 425984
    buffer_load_dwordx4 v3, s[76:79], s61 offen  lds
    s_add_u32 m0, s72, 22528
    s_mov_b32 s61, 1441792
    buffer_load_dwordx4 v3, s[76:79], s61 offen  lds
    s_add_u32 m0, s72, 23552
    s_mov_b32 s61, 1474560
    buffer_load_dwordx4 v3, s[76:79], s61 offen  lds
    s_waitcnt lgkmcnt(0)
    s_waitcnt vmcnt(14)
    s_barrier
    ds_read_b64_tr_b16 a[64:65], v6 offset:12288
    ds_read_b64_tr_b16 a[66:67], v4 offset:12288
    ds_read_b64_tr_b16 a[68:69], v7 offset:12288
    ds_read_b64_tr_b16 a[70:71], v5 offset:12288
    ds_read_b64_tr_b16 a[72:73], v6 offset:12320
    ds_read_b64_tr_b16 a[74:75], v4 offset:12320
    ds_read_b64_tr_b16 a[76:77], v7 offset:12320
    ds_read_b64_tr_b16 a[78:79], v5 offset:12320
    s_add_u32 m0, s72, 16384
    s_mov_b32 s61, 524288
    buffer_load_dwordx4 v3, s[76:79], s61 offen  lds
    s_add_u32 m0, s72, 17408
    s_mov_b32 s61, 557056
    buffer_load_dwordx4 v3, s[76:79], s61 offen  lds
    s_add_u32 m0, s72, 18432
    s_mov_b32 s61, 1572864
    buffer_load_dwordx4 v3, s[76:79], s61 offen  lds
    s_add_u32 m0, s72, 19456
    s_mov_b32 s61, 1605632
    buffer_load_dwordx4 v3, s[76:79], s61 offen  lds
    s_waitcnt lgkmcnt(0)
    s_waitcnt vmcnt(14)
    s_barrier
    ds_read_b64_tr_b16 a[96:97], v6 offset:4096
    ds_read_b64_tr_b16 a[98:99], v4 offset:4096
    ds_read_b64_tr_b16 a[100:101], v7 offset:4096
    ds_read_b64_tr_b16 a[102:103], v5 offset:4096
    ds_read_b64_tr_b16 a[104:105], v6 offset:4128
    ds_read_b64_tr_b16 a[106:107], v4 offset:4128
    ds_read_b64_tr_b16 a[108:109], v7 offset:4128
    ds_read_b64_tr_b16 a[110:111], v5 offset:4128
    s_add_u32 m0, s72, 12288
    s_mov_b32 s61, 655360
    buffer_load_dwordx4 v3, s[76:79], s61 offen  lds
    s_add_u32 m0, s72, 13312
    s_mov_b32 s61, 688128
    buffer_load_dwordx4 v3, s[76:79], s61 offen  lds
    s_add_u32 m0, s72, 14336
    s_mov_b32 s61, 1703936
    buffer_load_dwordx4 v3, s[76:79], s61 offen  lds
    s_add_u32 m0, s72, 15360
    s_mov_b32 s61, 1736704
    buffer_load_dwordx4 v3, s[76:79], s61 offen  lds
    s_waitcnt lgkmcnt(0)
    s_waitcnt vmcnt(14)
    s_barrier
    ds_read_b64_tr_b16 a[0:1], v6 offset:8192
    ds_read_b64_tr_b16 a[2:3], v4 offset:8192
    ds_read_b64_tr_b16 a[4:5], v7 offset:8192
    ds_read_b64_tr_b16 a[6:7], v5 offset:8192
    ds_read_b64_tr_b16 a[8:9], v6 offset:8224
    ds_read_b64_tr_b16 a[10:11], v4 offset:8224
    ds_read_b64_tr_b16 a[12:13], v7 offset:8224
    ds_read_b64_tr_b16 a[14:15], v5 offset:8224
    s_add_u32 m0, s72, 4096
    s_mov_b32 s61, 786432
    buffer_load_dwordx4 v3, s[76:79], s61 offen  lds
    s_add_u32 m0, s72, 5120
    s_mov_b32 s61, 819200
    buffer_load_dwordx4 v3, s[76:79], s61 offen  lds
    s_add_u32 m0, s72, 6144
    s_mov_b32 s61, 1835008
    buffer_load_dwordx4 v3, s[76:79], s61 offen  lds
    s_add_u32 m0, s72, 7168
    s_mov_b32 s61, 1867776
    buffer_load_dwordx4 v3, s[76:79], s61 offen  lds
    s_waitcnt lgkmcnt(0)
    s_waitcnt vmcnt(12)
    s_barrier
    ds_read_b64_tr_b16 a[32:33], v6 offset:20480
    ds_read_b64_tr_b16 a[34:35], v4 offset:20480
    ds_read_b64_tr_b16 a[36:37], v7 offset:20480
    ds_read_b64_tr_b16 a[38:39], v5 offset:20480
    ds_read_b64_tr_b16 a[40:41], v6 offset:20512
    ds_read_b64_tr_b16 a[42:43], v4 offset:20512
    ds_read_b64_tr_b16 a[44:45], v7 offset:20512
    ds_read_b64_tr_b16 a[46:47], v5 offset:20512
    s_add_u32 m0, s72, 8192
    s_mov_b32 s61, 917504
    buffer_load_dwordx4 v3, s[76:79], s61 offen  lds
    s_add_u32 m0, s72, 9216
    s_mov_b32 s61, 950272
    buffer_load_dwordx4 v3, s[76:79], s61 offen  lds
    s_add_u32 m0, s72, 10240
    s_mov_b32 s61, 1966080
    buffer_load_dwordx4 v3, s[76:79], s61 offen  lds
    s_add_u32 m0, s72, 11264
    s_mov_b32 s61, 1998848
    buffer_load_dwordx4 v3, s[76:79], s61 offen  lds
    s_waitcnt lgkmcnt(0)
    s_waitcnt vmcnt(12)
    s_barrier
    ds_read_b64_tr_b16 a[80:81], v6 offset:16384
    ds_read_b64_tr_b16 a[82:83], v4 offset:16384
    ds_read_b64_tr_b16 a[84:85], v7 offset:16384
    ds_read_b64_tr_b16 a[86:87], v5 offset:16384
    ds_read_b64_tr_b16 a[88:89], v6 offset:16416
    ds_read_b64_tr_b16 a[90:91], v4 offset:16416
    ds_read_b64_tr_b16 a[92:93], v7 offset:16416
    ds_read_b64_tr_b16 a[94:95], v5 offset:16416
    ds_write_b128 v118, v[88:91] offset:20480
    ds_write_b128 v118, v[92:95] offset:21504
    ds_write_b128 v118, v[96:99] offset:22528
    ds_write_b128 v118, v[100:103] offset:23552
    global_load_dword v123, v122, s[96:97] sc1
    s_waitcnt lgkmcnt(0)
    s_waitcnt vmcnt(9)
    s_barrier
    ds_read_b64_tr_b16 a[112:113], v6 offset:12288
    ds_read_b64_tr_b16 a[114:115], v4 offset:12288
    ds_read_b64_tr_b16 a[116:117], v7 offset:12288
    ds_read_b64_tr_b16 a[118:119], v5 offset:12288
    ds_read_b64_tr_b16 a[120:121], v6 offset:12320
    ds_read_b64_tr_b16 a[122:123], v4 offset:12320
    ds_read_b64_tr_b16 a[124:125], v7 offset:12320
    ds_read_b64_tr_b16 a[126:127], v5 offset:12320
    ds_write_b128 v118, v[72:75] offset:16384
    ds_write_b128 v118, v[76:79] offset:17408
    ds_write_b128 v118, v[80:83] offset:18432
    ds_write_b128 v118, v[84:87] offset:19456
    s_waitcnt lgkmcnt(0)
    s_waitcnt vmcnt(5)
    s_barrier
    ds_read_b64_tr_b16 a[16:17], v6 offset:4096
    ds_read_b64_tr_b16 a[18:19], v4 offset:4096
    ds_read_b64_tr_b16 a[20:21], v7 offset:4096
    ds_read_b64_tr_b16 a[22:23], v5 offset:4096
    ds_read_b64_tr_b16 a[24:25], v6 offset:4128
    ds_read_b64_tr_b16 a[26:27], v4 offset:4128
    ds_read_b64_tr_b16 a[28:29], v7 offset:4128
    ds_read_b64_tr_b16 a[30:31], v5 offset:4128
    ds_write_b128 v118, v[56:59] offset:12288
    ds_write_b128 v118, v[60:63] offset:13312
    ds_write_b128 v118, v[64:67] offset:14336
    ds_write_b128 v118, v[68:71] offset:15360
    s_waitcnt lgkmcnt(0)
    s_waitcnt vmcnt(1)
    s_barrier
    ds_read_b64_tr_b16 a[48:49], v6 offset:8192
    ds_read_b64_tr_b16 a[50:51], v4 offset:8192
    ds_read_b64_tr_b16 a[52:53], v7 offset:8192
    ds_read_b64_tr_b16 a[54:55], v5 offset:8192
    ds_read_b64_tr_b16 a[56:57], v6 offset:8224
    ds_read_b64_tr_b16 a[58:59], v4 offset:8224
    ds_read_b64_tr_b16 a[60:61], v7 offset:8224
    ds_read_b64_tr_b16 a[62:63], v5 offset:8224
    ds_write_b128 v118, v[24:27] offset:4096
    ds_write_b128 v118, v[28:31] offset:5120
    ds_write_b128 v118, v[32:35] offset:6144
    ds_write_b128 v118, v[36:39] offset:7168
    s_waitcnt vmcnt(0)
    global_load_dwordx4 a[240:243], v105, s[42:43] offset:0 sc1
    global_load_dwordx4 a[244:247], v105, s[42:43] offset:1024 sc1
    global_load_dwordx4 a[248:251], v105, s[42:43] offset:2048 sc1
    global_load_dwordx4 a[252:255], v105, s[42:43] offset:3072 sc1
    s_waitcnt lgkmcnt(0)
    s_barrier
    ds_write_b128 v118, v[40:43] offset:8192
    ds_write_b128 v118, v[44:47] offset:9216
    ds_write_b128 v118, v[48:51] offset:10240
    ds_write_b128 v118, v[52:55] offset:11264
    s_branch L_ch_wdone
L_ch_wv3:
    ds_read_b64_tr_b16 v[144:145], v5 offset:0
    ds_read_b64_tr_b16 v[146:147], v5 offset:512
    ds_read_b64_tr_b16 v[148:149], v5 offset:2048
    ds_read_b64_tr_b16 v[150:151], v5 offset:2560
    ds_read_b64_tr_b16 v[168:169], v5 offset:64
    ds_read_b64_tr_b16 v[170:171], v5 offset:576
    ds_read_b64_tr_b16 v[172:173], v5 offset:2112
    ds_read_b64_tr_b16 v[174:175], v5 offset:2624
    s_waitcnt lgkmcnt(0)
    ds_read_b64_tr_b16 v[192:193], v5 offset:128
    ds_read_b64_tr_b16 v[194:195], v5 offset:640
    ds_read_b64_tr_b16 v[196:197], v5 offset:2176
    ds_read_b64_tr_b16 v[198:199], v5 offset:2688
    ds_read_b64_tr_b16 a[88:89], v5 offset:192
    ds_read_b64_tr_b16 a[90:91], v5 offset:704
    ds_read_b64_tr_b16 a[92:93], v5 offset:2240
    ds_read_b64_tr_b16 a[94:95], v5 offset:2752
    s_waitcnt lgkmcnt(0)
    s_add_u32 m0, s72, 0
    s_mov_b32 s61, 131072
    buffer_load_dwordx4 v3, s[80:83], s61 offen  lds
    s_add_u32 m0, s72, 1024
    s_mov_b32 s61, 163840
    buffer_load_dwordx4 v3, s[80:83], s61 offen  lds
    s_add_u32 m0, s72, 2048
    s_mov_b32 s61, 1179648
    buffer_load_dwordx4 v3, s[80:83], s61 offen  lds
    s_add_u32 m0, s72, 3072
    s_mov_b32 s61, 1212416
    buffer_load_dwordx4 v3, s[80:83], s61 offen  lds
    s_add_u32 m0, s72, 4096
    s_mov_b32 s61, 262144
    buffer_load_dwordx4 v3, s[80:83], s61 offen  lds
    s_add_u32 m0, s72, 5120
    s_mov_b32 s61, 294912
    buffer_load_dwordx4 v3, s[80:83], s61 offen  lds
    s_add_u32 m0, s72, 6144
    s_mov_b32 s61, 1310720
    buffer_load_dwordx4 v3, s[80:83], s61 offen  lds
    s_add_u32 m0, s72, 7168
    s_mov_b32 s61, 1343488
    buffer_load_dwordx4 v3, s[80:83], s61 offen  lds
    ds_read_b64_tr_b16 v[136:137], v5 offset:8192
    ds_read_b64_tr_b16 v[138:139], v5 offset:8704
    ds_read_b64_tr_b16 v[140:141], v5 offset:10240
    ds_read_b64_tr_b16 v[142:143], v5 offset:10752
    ds_read_b64_tr_b16 v[160:161], v5 offset:8256
    ds_read_b64_tr_b16 v[162:163], v5 offset:8768
    ds_read_b64_tr_b16 v[164:165], v5 offset:10304
    ds_read_b64_tr_b16 v[166:167], v5 offset:10816
    s_waitcnt lgkmcnt(0)
    ds_read_b64_tr_b16 v[184:185], v5 offset:8320
    ds_read_b64_tr_b16 v[186:187], v5 offset:8832
    ds_read_b64_tr_b16 v[188:189], v5 offset:10368
    ds_read_b64_tr_b16 v[190:191], v5 offset:10880
    ds_read_b64_tr_b16 a[80:81], v5 offset:8384
    ds_read_b64_tr_b16 a[82:83], v5 offset:8896
    ds_read_b64_tr_b16 a[84:85], v5 offset:10432
    ds_read_b64_tr_b16 a[86:87], v5 offset:10944
    s_waitcnt lgkmcnt(0)
    s_add_u32 m0, s72, 8192
    s_mov_b32 s61, 393216
    buffer_load_dwordx4 v3, s[80:83], s61 offen  lds
    s_add_u32 m0, s72, 9216
    s_mov_b32 s61, 425984
    buffer_load_dwordx4 v3, s[80:83], s61 offen  lds
    s_add_u32 m0, s72, 10240
    s_mov_b32 s61, 1441792
    buffer_load_dwordx4 v3, s[80:83], s61 offen  lds
    s_add_u32 m0, s72, 11264
    s_mov_b32 s61, 1474560
    buffer_load_dwordx4 v3, s[80:83], s61 offen  lds
    s_waitcnt vmcnt(24)
    ds_read_b64_tr_b16 v[128:129], v5 offset:16384
    ds_read_b64_tr_b16 v[130:131], v5 offset:16896
    ds_read_b64_tr_b16 v[132:133], v5 offset:18432
    ds_read_b64_tr_b16 v[134:135], v5 offset:18944
    ds_read_b64_tr_b16 v[152:153], v5 offset:16448
    ds_read_b64_tr_b16 v[154:155], v5 offset:16960
    ds_read_b64_tr_b16 v[156:157], v5 offset:18496
    ds_read_b64_tr_b16 v[158:159], v5 offset:19008
    s_waitcnt lgkmcnt(0)
    ds_read_b64_tr_b16 v[176:177], v5 offset:16512
    ds_read_b64_tr_b16 v[178:179], v5 offset:17024
    ds_read_b64_tr_b16 v[180:181], v5 offset:18560
    ds_read_b64_tr_b16 v[182:183], v5 offset:19072
    ds_read_b64_tr_b16 v[200:201], v5 offset:16576
    ds_read_b64_tr_b16 v[202:203], v5 offset:17088
    ds_read_b64_tr_b16 v[204:205], v5 offset:18624
    ds_read_b64_tr_b16 v[206:207], v5 offset:19136
    s_waitcnt lgkmcnt(0)
    s_waitcnt vmcnt(16)
    ds_read_b64_tr_b16 a[16:17], v5 offset:24576
    ds_read_b64_tr_b16 a[18:19], v5 offset:25088
    ds_read_b64_tr_b16 a[20:21], v5 offset:26624
    ds_read_b64_tr_b16 a[22:23], v5 offset:27136
    ds_read_b64_tr_b16 a[24:25], v5 offset:24640
    ds_read_b64_tr_b16 a[26:27], v5 offset:25152
    ds_read_b64_tr_b16 a[28:29], v5 offset:26688
    ds_read_b64_tr_b16 a[30:31], v5 offset:27200
    s_waitcnt lgkmcnt(0)
    ds_read_b64_tr_b16 a[48:49], v5 offset:24704
    ds_read_b64_tr_b16 a[50:51], v5 offset:25216
    ds_read_b64_tr_b16 a[52:53], v5 offset:26752
    ds_read_b64_tr_b16 a[54:55], v5 offset:27264
    ds_read_b64_tr_b16 a[56:57], v5 offset:24768
    ds_read_b64_tr_b16 a[58:59], v5 offset:25280
    ds_read_b64_tr_b16 a[60:61], v5 offset:26816
    ds_read_b64_tr_b16 a[62:63], v5 offset:27328
    s_waitcnt lgkmcnt(0)
    v_add_u32 v4, 36864, v6
    v_add_u32 v5, 36864, v7
    s_waitcnt vmcnt(12)
    s_barrier
    ds_read_b64_tr_b16 v[240:241], v6 offset:32768
    ds_read_b64_tr_b16 v[242:243], v4 offset:32768
    ds_read_b64_tr_b16 v[244:245], v7 offset:32768
    ds_read_b64_tr_b16 v[246:247], v5 offset:32768
    ds_read_b64_tr_b16 v[248:249], v6 offset:32800
    ds_read_b64_tr_b16 v[250:251], v4 offset:32800
    ds_read_b64_tr_b16 v[252:253], v7 offset:32800
    ds_read_b64_tr_b16 v[254:255], v5 offset:32800
    ds_write_b128 v118, a[48:51] offset:28672
    ds_write_b128 v118, a[52:55] offset:29696
    ds_write_b128 v118, a[56:59] offset:30720
    ds_write_b128 v118, a[60:63] offset:31744
    s_add_u32 m0, s72, 20480
    s_mov_b32 s61, 524288
    buffer_load_dwordx4 v3, s[80:83], s61 offen  lds
    s_add_u32 m0, s72, 21504
    s_mov_b32 s61, 557056
    buffer_load_dwordx4 v3, s[80:83], s61 offen  lds
    s_add_u32 m0, s72, 22528
    s_mov_b32 s61, 1572864
    buffer_load_dwordx4 v3, s[80:83], s61 offen  lds
    s_add_u32 m0, s72, 23552
    s_mov_b32 s61, 1605632
    buffer_load_dwordx4 v3, s[80:83], s61 offen  lds
    s_waitcnt lgkmcnt(0)
    s_waitcnt vmcnt(12)
    s_barrier
    ds_read_b64_tr_b16 v[208:209], v6 offset:0
    ds_read_b64_tr_b16 v[210:211], v4 offset:0
    ds_read_b64_tr_b16 v[212:213], v7 offset:0
    ds_read_b64_tr_b16 v[214:215], v5 offset:0
    ds_read_b64_tr_b16 v[216:217], v6 offset:32
    ds_read_b64_tr_b16 v[218:219], v4 offset:32
    ds_read_b64_tr_b16 v[220:221], v7 offset:32
    ds_read_b64_tr_b16 v[222:223], v5 offset:32
    ds_write_b128 v118, a[80:83] offset:32768
    ds_write_b128 v118, a[84:87] offset:33792
    ds_write_b128 v118, a[88:91] offset:34816
    ds_write_b128 v118, a[92:95] offset:35840
    s_add_u32 m0, s72, 16384
    s_mov_b32 s61, 655360
    buffer_load_dwordx4 v3, s[80:83], s61 offen  lds
    s_add_u32 m0, s72, 17408
    s_mov_b32 s61, 688128
    buffer_load_dwordx4 v3, s[80:83], s61 offen  lds
    s_add_u32 m0, s72, 18432
    s_mov_b32 s61, 1703936
    buffer_load_dwordx4 v3, s[80:83], s61 offen  lds
    s_add_u32 m0, s72, 19456
    s_mov_b32 s61, 1736704
    buffer_load_dwordx4 v3, s[80:83], s61 offen  lds
    s_waitcnt lgkmcnt(0)
    s_waitcnt vmcnt(12)
    s_barrier
    ds_read_b64_tr_b16 v[24:25], v6 offset:4096
    ds_read_b64_tr_b16 v[26:27], v4 offset:4096
    ds_read_b64_tr_b16 v[28:29], v7 offset:4096
    ds_read_b64_tr_b16 v[30:31], v5 offset:4096
    ds_read_b64_tr_b16 v[32:33], v6 offset:4128
    ds_read_b64_tr_b16 v[34:35], v4 offset:4128
    ds_read_b64_tr_b16 v[36:37], v7 offset:4128
    ds_read_b64_tr_b16 v[38:39], v5 offset:4128
    ds_write_b128 v118, a[16:19] offset:24576
    ds_write_b128 v118, a[20:23] offset:25600
    ds_write_b128 v118, a[24:27] offset:26624
    ds_write_b128 v118, a[28:31] offset:27648
    s_add_u32 m0, s72, 12288
    s_mov_b32 s61, 786432
    buffer_load_dwordx4 v3, s[80:83], s61 offen  lds
    s_add_u32 m0, s72, 13312
    s_mov_b32 s61, 819200
    buffer_load_dwordx4 v3, s[80:83], s61 offen  lds
    s_add_u32 m0, s72, 14336
    s_mov_b32 s61, 1835008
    buffer_load_dwordx4 v3, s[80:83], s61 offen  lds
    s_add_u32 m0, s72, 15360
    s_mov_b32 s61, 1867776
    buffer_load_dwordx4 v3, s[80:83], s61 offen  lds
    s_waitcnt lgkmcnt(0)
    s_waitcnt vmcnt(12)
    s_barrier
    ds_read_b64_tr_b16 v[8:9], v6 offset:8192
    ds_read_b64_tr_b16 v[10:11], v4 offset:8192
    ds_read_b64_tr_b16 v[12:13], v7 offset:8192
    ds_read_b64_tr_b16 v[14:15], v5 offset:8192
    ds_read_b64_tr_b16 v[16:17], v6 offset:8224
    ds_read_b64_tr_b16 v[18:19], v4 offset:8224
    ds_read_b64_tr_b16 v[20:21], v7 offset:8224
    ds_read_b64_tr_b16 v[22:23], v5 offset:8224
    s_add_u32 m0, s72, 4096
    s_mov_b32 s61, 917504
    buffer_load_dwordx4 v3, s[80:83], s61 offen  lds
    s_add_u32 m0, s72, 5120
    s_mov_b32 s61, 950272
    buffer_load_dwordx4 v3, s[80:83], s61 offen  lds
    s_add_u32 m0, s72, 6144
    s_mov_b32 s61, 1966080
    buffer_load_dwordx4 v3, s[80:83], s61 offen  lds
    s_add_u32 m0, s72, 7168
    s_mov_b32 s61, 1998848
    buffer_load_dwordx4 v3, s[80:83], s61 offen  lds
    s_waitcnt lgkmcnt(0)
    s_waitcnt vmcnt(12)
    s_barrier
    ds_read_b64_tr_b16 a[224:225], v6 offset:20480
    ds_read_b64_tr_b16 a[226:227], v4 offset:20480
    ds_read_b64_tr_b16 a[228:229], v7 offset:20480
    ds_read_b64_tr_b16 a[230:231], v5 offset:20480
    ds_read_b64_tr_b16 a[232:233], v6 offset:20512
    ds_read_b64_tr_b16 a[234:235], v4 offset:20512
    ds_read_b64_tr_b16 a[236:237], v7 offset:20512
    ds_read_b64_tr_b16 a[238:239], v5 offset:20512
    s_add_u32 m0, s72, 8192
    s_mov_b32 s61, 0
    buffer_load_dwordx4 v3, s[84:87], s61 offen  lds
    s_add_u32 m0, s72, 9216
    s_mov_b32 s61, 32768
    buffer_load_dwordx4 v3, s[84:87], s61 offen  lds
    s_add_u32 m0, s72, 10240
    s_mov_b32 s61, 1048576
    buffer_load_dwordx4 v3, s[84:87], s61 offen  lds
    s_add_u32 m0, s72, 11264
    s_mov_b32 s61, 1081344
    buffer_load_dwordx4 v3, s[84:87], s61 offen  lds
    s_waitcnt lgkmcnt(0)
    s_waitcnt vmcnt(12)
    s_barrier
    ds_read_b64_tr_b16 v[224:225], v6 offset:16384
    ds_read_b64_tr_b16 v[226:227], v4 offset:16384
    ds_read_b64_tr_b16 v[228:229], v7 offset:16384
    ds_read_b64_tr_b16 v[230:231], v5 offset:16384
    ds_read_b64_tr_b16 v[232:233], v6 offset:16416
    ds_read_b64_tr_b16 v[234:235], v4 offset:16416
    ds_read_b64_tr_b16 v[236:237], v7 offset:16416
    ds_read_b64_tr_b16 v[238:239], v5 offset:16416
    s_add_u32 m0, s72, 20480
    s_mov_b32 s61, 131072
    buffer_load_dwordx4 v3, s[84:87], s61 offen  lds
    s_add_u32 m0, s72, 21504
    s_mov_b32 s61, 163840
    buffer_load_dwordx4 v3, s[84:87], s61 offen  lds
    s_add_u32 m0, s72, 22528
    s_mov_b32 s61, 1179648
    buffer_load_dwordx4 v3, s[84:87], s61 offen  lds
    s_add_u32 m0, s72, 23552
    s_mov_b32 s61, 1212416
    buffer_load_dwordx4 v3, s[84:87], s61 offen  lds
    s_waitcnt lgkmcnt(0)
    s_waitcnt vmcnt(12)
    s_barrier
    ds_read_b64_tr_b16 v[56:57], v6 offset:12288
    ds_read_b64_tr_b16 v[58:59], v4 offset:12288
    ds_read_b64_tr_b16 v[60:61], v7 offset:12288
    ds_read_b64_tr_b16 v[62:63], v5 offset:12288
    ds_read_b64_tr_b16 v[64:65], v6 offset:12320
    ds_read_b64_tr_b16 v[66:67], v4 offset:12320
    ds_read_b64_tr_b16 v[68:69], v7 offset:12320
    ds_read_b64_tr_b16 v[70:71], v5 offset:12320
    s_add_u32 m0, s72, 16384
    s_mov_b32 s61, 262144
    buffer_load_dwordx4 v3, s[84:87], s61 offen  lds
    s_add_u32 m0, s72, 17408
    s_mov_b32 s61, 294912
    buffer_load_dwordx4 v3, s[84:87], s61 offen  lds
    s_add_u32 m0, s72, 18432
    s_mov_b32 s61, 1310720
    buffer_load_dwordx4 v3, s[84:87], s61 offen  lds
    s_add_u32 m0, s72, 19456
    s_mov_b32 s61, 1343488
    buffer_load_dwordx4 v3, s[84:87], s61 offen  lds
    s_waitcnt lgkmcnt(0)
    s_waitcnt vmcnt(12)
    s_barrier
    ds_read_b64_tr_b16 v[40:41], v6 offset:4096
    ds_read_b64_tr_b16 v[42:43], v4 offset:4096
    ds_read_b64_tr_b16 v[44:45], v7 offset:4096
    ds_read_b64_tr_b16 v[46:47], v5 offset:4096
    ds_read_b64_tr_b16 v[48:49], v6 offset:4128
    ds_read_b64_tr_b16 v[50:51], v4 offset:4128
    ds_read_b64_tr_b16 v[52:53], v7 offset:4128
    ds_read_b64_tr_b16 v[54:55], v5 offset:4128
    s_add_u32 m0, s72, 12288
    s_mov_b32 s61, 393216
    buffer_load_dwordx4 v3, s[84:87], s61 offen  lds
    s_add_u32 m0, s72, 13312
    s_mov_b32 s61, 425984
    buffer_load_dwordx4 v3, s[84:87], s61 offen  lds
    s_add_u32 m0, s72, 14336
    s_mov_b32 s61, 1441792
    buffer_load_dwordx4 v3, s[84:87], s61 offen  lds
    s_add_u32 m0, s72, 15360
    s_mov_b32 s61, 1474560
    buffer_load_dwordx4 v3, s[84:87], s61 offen  lds
    s_waitcnt lgkmcnt(0)
    s_waitcnt vmcnt(12)
    s_barrier
    ds_read_b64_tr_b16 a[208:209], v6 offset:8192
    ds_read_b64_tr_b16 a[210:211], v4 offset:8192
    ds_read_b64_tr_b16 a[212:213], v7 offset:8192
    ds_read_b64_tr_b16 a[214:215], v5 offset:8192
    ds_read_b64_tr_b16 a[216:217], v6 offset:8224
    ds_read_b64_tr_b16 a[218:219], v4 offset:8224
    ds_read_b64_tr_b16 a[220:221], v7 offset:8224
    ds_read_b64_tr_b16 a[222:223], v5 offset:8224
    ds_write_b128 v118, v[8:11] offset:0
    ds_write_b128 v118, v[12:15] offset:1024
    ds_write_b128 v118, v[16:19] offset:2048
    ds_write_b128 v118, v[20:23] offset:3072
    s_add_u32 m0, s72, 4096
    s_mov_b32 s61, 524288
    buffer_load_dwordx4 v3, s[84:87], s61 offen  lds
    s_add_u32 m0, s72, 5120
    s_mov_b32 s61, 557056
    buffer_load_dwordx4 v3, s[84:87], s61 offen  lds
    s_add_u32 m0, s72, 6144
    s_mov_b32 s61, 1572864
    buffer_load_dwordx4 v3, s[84:87], s61 offen  lds
    s_add_u32 m0, s72, 7168
    s_mov_b32 s61, 1605632
    buffer_load_dwordx4 v3, s[84:87], s61 offen  lds
    s_waitcnt lgkmcnt(0)
    s_waitcnt vmcnt(12)
    s_barrier
    ds_read_b64_tr_b16 a[192:193], v6 offset:20480
    ds_read_b64_tr_b16 a[194:195], v4 offset:20480
    ds_read_b64_tr_b16 a[196:197], v7 offset:20480
    ds_read_b64_tr_b16 a[198:199], v5 offset:20480
    ds_read_b64_tr_b16 a[200:201], v6 offset:20512
    ds_read_b64_tr_b16 a[202:203], v4 offset:20512
    ds_read_b64_tr_b16 a[204:205], v7 offset:20512
    ds_read_b64_tr_b16 a[206:207], v5 offset:20512
    s_add_u32 m0, s72, 8192
    s_mov_b32 s61, 655360
    buffer_load_dwordx4 v3, s[84:87], s61 offen  lds
    s_add_u32 m0, s72, 9216
    s_mov_b32 s61, 688128
    buffer_load_dwordx4 v3, s[84:87], s61 offen  lds
    s_add_u32 m0, s72, 10240
    s_mov_b32 s61, 1703936
    buffer_load_dwordx4 v3, s[84:87], s61 offen  lds
    s_add_u32 m0, s72, 11264
    s_mov_b32 s61, 1736704
    buffer_load_dwordx4 v3, s[84:87], s61 offen  lds
    s_waitcnt lgkmcnt(0)
    s_waitcnt vmcnt(12)
    s_barrier
    ds_read_b64_tr_b16 a[160:161], v6 offset:16384
    ds_read_b64_tr_b16 a[162:163], v4 offset:16384
    ds_read_b64_tr_b16 a[164:165], v7 offset:16384
    ds_read_b64_tr_b16 a[166:167], v5 offset:16384
    ds_read_b64_tr_b16 a[168:169], v6 offset:16416
    ds_read_b64_tr_b16 a[170:171], v4 offset:16416
    ds_read_b64_tr_b16 a[172:173], v7 offset:16416
    ds_read_b64_tr_b16 a[174:175], v5 offset:16416
    s_add_u32 m0, s72, 20480
    s_mov_b32 s61, 786432
    buffer_load_dwordx4 v3, s[84:87], s61 offen  lds
    s_add_u32 m0, s72, 21504
    s_mov_b32 s61, 819200
    buffer_load_dwordx4 v3, s[84:87], s61 offen  lds
    s_add_u32 m0, s72, 22528
    s_mov_b32 s61, 1835008
    buffer_load_dwordx4 v3, s[84:87], s61 offen  lds
    s_add_u32 m0, s72, 23552
    s_mov_b32 s61, 1867776
    buffer_load_dwordx4 v3, s[84:87], s61 offen  lds
    s_waitcnt lgkmcnt(0)
    s_waitcnt vmcnt(12)
    s_barrier
    ds_read_b64_tr_b16 a[128:129], v6 offset:12288
    ds_read_b64_tr_b16 a[130:131], v4 offset:12288
    ds_read_b64_tr_b16 a[132:133], v7 offset:12288
    ds_read_b64_tr_b16 a[134:135], v5 offset:12288
    ds_read_b64_tr_b16 a[136:137], v6 offset:12320
    ds_read_b64_tr_b16 a[138:139], v4 offset:12320
    ds_read_b64_tr_b16 a[140:141], v7 offset:12320
    ds_read_b64_tr_b16 a[142:143], v5 offset:12320
    s_add_u32 m0, s72, 16384
    s_mov_b32 s61, 917504
    buffer_load_dwordx4 v3, s[84:87], s61 offen  lds
    s_add_u32 m0, s72, 17408
    s_mov_b32 s61, 950272
    buffer_load_dwordx4 v3, s[84:87], s61 offen  lds
    s_add_u32 m0, s72, 18432
    s_mov_b32 s61, 1966080
    buffer_load_dwordx4 v3, s[84:87], s61 offen  lds
    s_add_u32 m0, s72, 19456
    s_mov_b32 s61, 1998848
    buffer_load_dwordx4 v3, s[84:87], s61 offen  lds
    s_waitcnt lgkmcnt(0)
    s_waitcnt vmcnt(12)
    s_barrier
    ds_read_b64_tr_b16 v[88:89], v6 offset:4096
    ds_read_b64_tr_b16 v[90:91], v4 offset:4096
    ds_read_b64_tr_b16 v[92:93], v7 offset:4096
    ds_read_b64_tr_b16 v[94:95], v5 offset:4096
    ds_read_b64_tr_b16 v[96:97], v6 offset:4128
    ds_read_b64_tr_b16 v[98:99], v4 offset:4128
    ds_read_b64_tr_b16 v[100:101], v7 offset:4128
    ds_read_b64_tr_b16 v[102:103], v5 offset:4128
    s_add_u32 m0, s72, 12288
    s_mov_b32 s61, 0
    buffer_load_dwordx4 v3, s[76:79], s61 offen  lds
    s_add_u32 m0, s72, 13312
    s_mov_b32 s61, 32768
    buffer_load_dwordx4 v3, s[76:79], s61 offen  lds
    s_add_u32 m0, s72, 14336
    s_mov_b32 s61, 1048576
    buffer_load_dwordx4 v3, s[76:79], s61 offen  lds
    s_add_u32 m0, s72, 15360
    s_mov_b32 s61, 1081344
    buffer_load_dwordx4 v3, s[76:79], s61 offen  lds
    s_waitcnt lgkmcnt(0)
    s_waitcnt vmcnt(12)
    s_barrier
    ds_read_b64_tr_b16 v[72:73], v6 offset:8192
    ds_read_b64_tr_b16 v[74:75], v4 offset:8192
    ds_read_b64_tr_b16 v[76:77], v7 offset:8192
    ds_read_b64_tr_b16 v[78:79], v5 offset:8192
    ds_read_b64_tr_b16 v[80:81], v6 offset:8224
    ds_read_b64_tr_b16 v[82:83], v4 offset:8224
    ds_read_b64_tr_b16 v[84:85], v7 offset:8224
    ds_read_b64_tr_b16 v[86:87], v5 offset:8224
    s_add_u32 m0, s72, 4096
    s_mov_b32 s61, 131072
    buffer_load_dwordx4 v3, s[76:79], s61 offen  lds
    s_add_u32 m0, s72, 5120
    s_mov_b32 s61, 163840
    buffer_load_dwordx4 v3, s[76:79], s61 offen  lds
    s_add_u32 m0, s72, 6144
    s_mov_b32 s61, 1179648
    buffer_load_dwordx4 v3, s[76:79], s61 offen  lds
    s_add_u32 m0, s72, 7168
    s_mov_b32 s61, 1212416
    buffer_load_dwordx4 v3, s[76:79], s61 offen  lds
    s_waitcnt lgkmcnt(0)
    s_waitcnt vmcnt(12)
    s_barrier
    ds_read_b64_tr_b16 a[176:177], v6 offset:20480
    ds_read_b64_tr_b16 a[178:179], v4 offset:20480
    ds_read_b64_tr_b16 a[180:181], v7 offset:20480
    ds_read_b64_tr_b16 a[182:183], v5 offset:20480
    ds_read_b64_tr_b16 a[184:185], v6 offset:20512
    ds_read_b64_tr_b16 a[186:187], v4 offset:20512
    ds_read_b64_tr_b16 a[188:189], v7 offset:20512
    ds_read_b64_tr_b16 a[190:191], v5 offset:20512
    s_add_u32 m0, s72, 8192
    s_mov_b32 s61, 262144
    buffer_load_dwordx4 v3, s[76:79], s61 offen  lds
    s_add_u32 m0, s72, 9216
    s_mov_b32 s61, 294912
    buffer_load_dwordx4 v3, s[76:79], s61 offen  lds
    s_add_u32 m0, s72, 10240
    s_mov_b32 s61, 1310720
    buffer_load_dwordx4 v3, s[76:79], s61 offen  lds
    s_add_u32 m0, s72, 11264
    s_mov_b32 s61, 1343488
    buffer_load_dwordx4 v3, s[76:79], s61 offen  lds
    global_store_dword v113, v123, s[36:37]
    v_mbcnt_lo_u32_b32 v1, -1, 0
    v_and_b32 v1, 15, v1
    v_lshlrev_b32 v1, 4, v1
    global_load_dword v2, v1, s[18:19] sc1
    s_waitcnt lgkmcnt(0)
    s_waitcnt vmcnt(14)
    s_barrier
    ds_read_b64_tr_b16 a[144:145], v6 offset:16384
    ds_read_b64_tr_b16 a[146:147], v4 offset:16384
    ds_read_b64_tr_b16 a[148:149], v7 offset:16384
    ds_read_b64_tr_b16 a[150:151], v5 offset:16384
    ds_read_b64_tr_b16 a[152:153], v6 offset:16416
    ds_read_b64_tr_b16 a[154:155], v4 offset:16416
    ds_read_b64_tr_b16 a[156:157], v7 offset:16416
    ds_read_b64_tr_b16 a[158:159], v5 offset:16416
    s_add_u32 m0, s72, 20480
    s_mov_b32 s61, 393216
    buffer_load_dwordx4 v3, s[76:79], s61 offen  lds
    s_add_u32 m0, s72, 21504
    s_mov_b32 s61, 425984
    buffer_load_dwordx4 v3, s[76:79], s61 offen  lds
    s_add_u32 m0, s72, 22528
    s_mov_b32 s61, 1441792
    buffer_load_dwordx4 v3, s[76:79], s61 offen  lds
    s_add_u32 m0, s72, 23552
    s_mov_b32 s61, 1474560
    buffer_load_dwordx4 v3, s[76:79], s61 offen  lds
    s_waitcnt lgkmcnt(0)
    s_waitcnt vmcnt(14)
    s_barrier
    ds_read_b64_tr_b16 a[96:97], v6 offset:12288
    ds_read_b64_tr_b16 a[98:99], v4 offset:12288
    ds_read_b64_tr_b16 a[100:101], v7 offset:12288
    ds_read_b64_tr_b16 a[102:103], v5 offset:12288
    ds_read_b64_tr_b16 a[104:105], v6 offset:12320
    ds_read_b64_tr_b16 a[106:107], v4 offset:12320
    ds_read_b64_tr_b16 a[108:109], v7 offset:12320
    ds_read_b64_tr_b16 a[110:111], v5 offset:12320
    s_add_u32 m0, s72, 16384
    s_mov_b32 s61, 524288
    buffer_load_dwordx4 v3, s[76:79], s61 offen  lds
    s_add_u32 m0, s72, 17408
    s_mov_b32 s61, 557056
    buffer_load_dwordx4 v3, s[76:79], s61 offen  lds
    s_add_u32 m0, s72, 18432
    s_mov_b32 s61, 1572864
    buffer_load_dwordx4 v3, s[76:79], s61 offen  lds
    s_add_u32 m0, s72, 19456
    s_mov_b32 s61, 1605632
    buffer_load_dwordx4 v3, s[76:79], s61 offen  lds
    s_waitcnt lgkmcnt(0)
    s_waitcnt vmcnt(14)
    s_barrier
    ds_read_b64_tr_b16 a[64:65], v6 offset:4096
    ds_read_b64_tr_b16 a[66:67], v4 offset:4096
    ds_read_b64_tr_b16 a[68:69], v7 offset:4096
    ds_read_b64_tr_b16 a[70:71], v5 offset:4096
    ds_read_b64_tr_b16 a[72:73], v6 offset:4128
    ds_read_b64_tr_b16 a[74:75], v4 offset:4128
    ds_read_b64_tr_b16 a[76:77], v7 offset:4128
    ds_read_b64_tr_b16 a[78:79], v5 offset:4128
    s_add_u32 m0, s72, 12288
    s_mov_b32 s61, 655360
    buffer_load_dwordx4 v3, s[76:79], s61 offen  lds
    s_add_u32 m0, s72, 13312
    s_mov_b32 s61, 688128
    buffer_load_dwordx4 v3, s[76:79], s61 offen  lds
    s_add_u32 m0, s72, 14336
    s_mov_b32 s61, 1703936
    buffer_load_dwordx4 v3, s[76:79], s61 offen  lds
    s_add_u32 m0, s72, 15360
    s_mov_b32 s61, 1736704
    buffer_load_dwordx4 v3, s[76:79], s61 offen  lds
    s_waitcnt lgkmcnt(0)
    s_waitcnt vmcnt(14)
    s_barrier
    ds_read_b64_tr_b16 a[32:33], v6 offset:8192
    ds_read_b64_tr_b16 a[34:35], v4 offset:8192
    ds_read_b64_tr_b16 a[36:37], v7 offset:8192
    ds_read_b64_tr_b16 a[38:39], v5 offset:8192
    ds_read_b64_tr_b16 a[40:41], v6 offset:8224
    ds_read_b64_tr_b16 a[42:43], v4 offset:8224
    ds_read_b64_tr_b16 a[44:45], v7 offset:8224
    ds_read_b64_tr_b16 a[46:47], v5 offset:8224
    s_add_u32 m0, s72, 4096
    s_mov_b32 s61, 786432
    buffer_load_dwordx4 v3, s[76:79], s61 offen  lds
    s_add_u32 m0, s72, 5120
    s_mov_b32 s61, 819200
    buffer_load_dwordx4 v3, s[76:79], s61 offen  lds
    s_add_u32 m0, s72, 6144
    s_mov_b32 s61, 1835008
    buffer_load_dwordx4 v3, s[76:79], s61 offen  lds
    s_add_u32 m0, s72, 7168
    s_mov_b32 s61, 1867776
    buffer_load_dwordx4 v3, s[76:79], s61 offen  lds
    s_waitcnt lgkmcnt(0)
    s_waitcnt vmcnt(12)
    s_barrier
    ds_read_b64_tr_b16 a[0:1], v6 offset:20480
    ds_read_b64_tr_b16 a[2:3], v4 offset:20480
    ds_read_b64_tr_b16 a[4:5], v7 offset:20480
    ds_read_b64_tr_b16 a[6:7], v5 offset:20480
    ds_read_b64_tr_b16 a[8:9], v6 offset:20512
    ds_read_b64_tr_b16 a[10:11], v4 offset:20512
    ds_read_b64_tr_b16 a[12:13], v7 offset:20512
    ds_read_b64_tr_b16 a[14:15], v5 offset:20512
    s_add_u32 m0, s72, 8192
    s_mov_b32 s61, 917504
    buffer_load_dwordx4 v3, s[76:79], s61 offen  lds
    s_add_u32 m0, s72, 9216
    s_mov_b32 s61, 950272
    buffer_load_dwordx4 v3, s[76:79], s61 offen  lds
    s_add_u32 m0, s72, 10240
    s_mov_b32 s61, 1966080
    buffer_load_dwordx4 v3, s[76:79], s61 offen  lds
    s_add_u32 m0, s72, 11264
    s_mov_b32 s61, 1998848
    buffer_load_dwordx4 v3, s[76:79], s61 offen  lds
    s_waitcnt lgkmcnt(0)
    s_waitcnt vmcnt(12)
    s_barrier
    ds_read_b64_tr_b16 a[112:113], v6 offset:16384
    ds_read_b64_tr_b16 a[114:115], v4 offset:16384
    ds_read_b64_tr_b16 a[116:117], v7 offset:16384
    ds_read_b64_tr_b16 a[118:119], v5 offset:16384
    ds_read_b64_tr_b16 a[120:121], v6 offset:16416
    ds_read_b64_tr_b16 a[122:123], v4 offset:16416
    ds_read_b64_tr_b16 a[124:125], v7 offset:16416
    ds_read_b64_tr_b16 a[126:127], v5 offset:16416
    ds_write_b128 v118, v[88:91] offset:20480
    ds_write_b128 v118, v[92:95] offset:21504
    ds_write_b128 v118, v[96:99] offset:22528
    ds_write_b128 v118, v[100:103] offset:23552
    global_load_dword v123, v122, s[96:97] sc1
    s_waitcnt lgkmcnt(0)
    s_waitcnt vmcnt(9)
    s_barrier
    ds_read_b64_tr_b16 a[80:81], v6 offset:12288
    ds_read_b64_tr_b16 a[82:83], v4 offset:12288
    ds_read_b64_tr_b16 a[84:85], v7 offset:12288
    ds_read_b64_tr_b16 a[86:87], v5 offset:12288
    ds_read_b64_tr_b16 a[88:89], v6 offset:12320
    ds_read_b64_tr_b16 a[90:91], v4 offset:12320
    ds_read_b64_tr_b16 a[92:93], v7 offset:12320
    ds_read_b64_tr_b16 a[94:95], v5 offset:12320
    ds_write_b128 v118, v[72:75] offset:16384
    ds_write_b128 v118, v[76:79] offset:17408
    ds_write_b128 v118, v[80:83] offset:18432
    ds_write_b128 v118, v[84:87] offset:19456
    s_waitcnt lgkmcnt(0)
    s_waitcnt vmcnt(5)
    s_barrier
    ds_read_b64_tr_b16 a[48:49], v6 offset:4096
    ds_read_b64_tr_b16 a[50:51], v4 offset:4096
    ds_read_b64_tr_b16 a[52:53], v7 offset:4096
    ds_read_b64_tr_b16 a[54:55], v5 offset:4096
    ds_read_b64_tr_b16 a[56:57], v6 offset:4128
    ds_read_b64_tr_b16 a[58:59], v4 offset:4128
    ds_read_b64_tr_b16 a[60:61], v7 offset:4128
    ds_read_b64_tr_b16 a[62:63], v5 offset:4128
    ds_write_b128 v118, v[56:59] offset:12288
    ds_write_b128 v118, v[60:63] offset:13312
    ds_write_b128 v118, v[64:67] offset:14336
    ds_write_b128 v118, v[68:71] offset:15360
    s_waitcnt lgkmcnt(0)
    s_waitcnt vmcnt(1)
    s_barrier
    ds_read_b64_tr_b16 a[16:17], v6 offset:8192
    ds_read_b64_tr_b16 a[18:19], v4 offset:8192
    ds_read_b64_tr_b16 a[20:21], v7 offset:8192
    ds_read_b64_tr_b16 a[22:23], v5 offset:8192
    ds_read_b64_tr_b16 a[24:25], v6 offset:8224
    ds_read_b64_tr_b16 a[26:27], v4 offset:8224
    ds_read_b64_tr_b16 a[28:29], v7 offset:8224
    ds_read_b64_tr_b16 a[30:31], v5 offset:8224
    ds_write_b128 v118, v[24:27] offset:4096
    ds_write_b128 v118, v[28:31] offset:5120
    ds_write_b128 v118, v[32:35] offset:6144
    ds_write_b128 v118, v[36:39] offset:7168
    s_waitcnt vmcnt(0)
    global_load_dwordx4 a[240:243], v105, s[42:43] offset:0 sc1
    global_load_dwordx4 a[244:247], v105, s[42:43] offset:1024 sc1
    global_load_dwordx4 a[248:251], v105, s[42:43] offset:2048 sc1
    global_load_dwordx4 a[252:255], v105, s[42:43] offset:3072 sc1
    s_waitcnt lgkmcnt(0)
    s_barrier
    ds_write_b128 v118, v[40:43] offset:8192
    ds_write_b128 v118, v[44:47] offset:9216
    ds_write_b128 v118, v[48:51] offset:10240
    ds_write_b128 v118, v[52:55] offset:11264
L_ch_wdone:
    s_mov_b32 s26, 0
    s_lshl_b32 s59, s3, 1
    s_add_u32 s59, s59, 13
    v_readlane_b32 s60, v2, s59
    s_lshl_b32 s59, s3, 1
    s_add_u32 s59, s59, 13
    s_branch L_ch_w0
L_ch_wa:
    global_load_dword v2, v1, s[18:19] sc1
    s_waitcnt vmcnt(0)
L_ch_w0:
    v_readlane_b32 s58, v2, s59
    s_cmp_ge_u32 s58, 256
    s_cbranch_scc1 L_ch_wb
    s_sleep 16
    s_sub_u32 s27, s27, 1
    s_cbranch_scc0 L_ch_wa
    s_branch L_end
L_ch_wb:
    s_cmp_eq_u32 s3, 1
    s_cbranch_scc1 L_ch_wc
    v_cmp_ne_u32 vcc, 32, v2
    s_and_b32 s58, vcc_lo, 0x5555
    s_cbranch_scc0 L_ch_wc
    global_load_dword v2, v1, s[18:19] sc1
    s_waitcnt vmcnt(0)
    v_cmp_ne_u32 vcc, 32, v2
    s_and_b32 s58, vcc_lo, 0x5555
    s_cbranch_scc1 L_safe
L_ch_wc:
    s_mov_b32 s59, 1
    v_cmp_ge_u32 vcc, s59, v123
    s_cmp_ge_u32 s60, 256
    s_cbranch_scc0 L_ch_fl0
    s_cbranch_vccz L_ch_kvok
L_ch_fl0:
    global_load_dword v123, v122, s[96:97] sc1
    s_waitcnt vmcnt(0)
    v_cmp_ge_u32 vcc, s59, v123
    s_cbranch_vccz L_ch_fl0ok
    s_sleep 1
    s_sub_u32 s27, s27, 1
    s_cbranch_scc0 L_ch_fl0
    s_branch L_end
L_ch_fl0ok:
    global_load_dwordx4 a[240:243], v105, s[42:43] offset:0 sc1
    global_load_dwordx4 a[244:247], v105, s[42:43] offset:1024 sc1
    global_load_dwordx4 a[248:251], v105, s[42:43] offset:2048 sc1
    global_load_dwordx4 a[252:255], v105, s[42:43] offset:3072 sc1
L_ch_kvok:
    s_add_u32 s42, s42, 524288
    s_addc_u32 s43, s43, 0
    s_waitcnt lgkmcnt(0)
    s_mov_b32 s30, 0x40000
    s_mov_b32 s31, 0x20000
    s_mov_b32 s12, 0x3f803f80
    s_mov_b32 s13, 0x3f803f80
    s_add_u32 s62, s28, 0x40000
    s_addc_u32 s63, s29, 0
    s_xor_b64 s[62:63], s[62:63], s[28:29]
    s_xor_b64 s[6:7], s[34:35], s[46:47]
    s_xor_b64 s[16:17], s[36:37], s[38:39]
    s_add_u32 s68, s40, 0x2000
    s_addc_u32 s69, s41, 0
    s_xor_b64 s[68:69], s[68:69], s[40:41]
    s_xor_b64 s[28:29], s[28:29], s[62:63]
    s_mov_b64 s[34:35], s[46:47]
    s_sub_u32 s44, s44, 131072
    s_subb_u32 s45, s45, 0
    s_mov_b32 s8, s4
    s_mov_b32 s9, s5
    s_cmp_eq_u32 s23, 0
    s_cselect_b32 s10, 4, 0
    s_mov_b32 s11, 0x20000
    v_mov_b64 v[64:65], 0
    v_mov_b64 v[66:67], 0
    v_mov_b64 v[68:69], 0
    v_mov_b64 v[70:71], 0
    v_mov_b64 v[72:73], 0
    v_mov_b64 v[74:75], 0
    v_mov_b64 v[76:77], 0
    v_mov_b64 v[78:79], 0
    v_mov_b64 v[80:81], 0
    v_mov_b64 v[82:83], 0
    v_mov_b64 v[84:85], 0
    v_mov_b64 v[86:87], 0
    ds_read_b128 v[32:35], v118 offset:0
    ds_read_b128 v[36:39], v118 offset:1024
    ds_read_b128 v[40:43], v118 offset:2048
    ds_read_b128 v[44:47], v118 offset:3072
    ds_read_b128 v[48:51], v118 offset:4096
    ds_read_b128 v[52:55], v118 offset:5120
    ds_read_b128 v[56:59], v118 offset:6144
    ds_read_b128 v[60:63], v118 offset:7168
    global_load_dwordx4 v[0:3], v105, s[40:41] offset:-2048 sc1
    v_mov_b32 v121, 1
    s_mov_b64 s[14:15], -1
    s_waitcnt vmcnt(0) lgkmcnt(0)
    v_accvgpr_read_b32 v88, a240
    v_accvgpr_read_b32 v89, a241
    v_accvgpr_read_b32 v90, a242
    v_accvgpr_read_b32 v91, a243
    v_accvgpr_read_b32 v92, a244
    v_accvgpr_read_b32 v93, a245
    v_accvgpr_read_b32 v94, a246
    v_accvgpr_read_b32 v95, a247
    v_accvgpr_read_b32 v100, a252
    v_accvgpr_read_b32 v101, a253
    v_accvgpr_read_b32 v102, a254
    v_accvgpr_read_b32 v103, a255
    s_branch L_ch_chk
.p2align 6
    s_nop 0
L_ch_mefail:
    s_mov_b64 exec, vcc
L_ch_mestart:
    global_load_dwordx4 v[0:3], v105, s[40:41] offset:-2048 sc1
    s_mov_b64 exec, -1
L_ch_mewait:
    v_max3_u32 v28, v0, v1, v2
    v_max_u32 v28, v28, v3
    v_cmp_le_u32 vcc, s71, v28
    s_cbranch_vccz L_ch_go
    s_sub_u32 s27, s27, 1
    s_cbranch_scc1 L_end
L_ch_chk:
    v_max3_u32 v28, v0, v1, v2
    v_max_u32 v28, v28, v3
    v_cmp_le_u32 vcc, s71, v28
    s_cbranch_vccnz L_ch_mefail
L_ch_go:
    ds_write_b128 v114, v[0:3] offset:0
    v_smfmac_f32_16x16x64_bf16 v[64:67], v[0:3], a[0:7], v104
    global_store_dword v113, v124, s[38:39]
    v_smfmac_f32_16x16x64_bf16 v[68:71], v[0:3], a[8:15], v104
    global_load_dwordx4 v[4:7], v105, s[40:41] offset:2048 sc1
    v_smfmac_f32_16x16x64_bf16 v[72:75], v[0:3], v[32:39], v104
    v_smfmac_f32_16x16x64_bf16 v[76:79], v[0:3], v[40:47], v104
    s_waitcnt lgkmcnt(0)
    s_barrier
    ds_read_b128 v[8:11], v115 offset:0
    v_smfmac_f32_16x16x64_bf16 v[80:83], v[0:3], a[128:135], v104
    ds_read_b128 v[16:19], v116 offset:0
    v_smfmac_f32_16x16x64_bf16 v[84:87], v[0:3], a[136:143], v104
    ds_read_b128 v[24:27], v117 offset:0
    s_waitcnt lgkmcnt(2)
    v_smfmac_f32_16x16x64_bf16 v[64:67], v[8:11], a[32:39], v104
    ds_read_b128 v[32:35], v118 offset:8192
    v_smfmac_f32_16x16x64_bf16 v[68:71], v[8:11], a[40:47], v104
    ds_read_b128 v[36:39], v118 offset:9216
    v_smfmac_f32_16x16x64_bf16 v[72:75], v[8:11], v[48:55], v104
    ds_read_b128 v[40:43], v118 offset:10240
    v_smfmac_f32_16x16x64_bf16 v[76:79], v[8:11], v[56:63], v104
    ds_read_b128 v[44:47], v118 offset:11264
    s_waitcnt lgkmcnt(4)
    v_smfmac_f32_16x16x64_bf16 v[64:67], v[16:19], a[64:71], v104
    global_load_dwordx4 v[4:7], v105, s[40:41] offset:2048 sc1
    v_smfmac_f32_16x16x64_bf16 v[68:71], v[16:19], a[72:79], v104
    ds_read_b128 v[48:51], v118 offset:12288
    v_smfmac_f32_16x16x64_bf16 v[72:75], v[16:19], v[208:215], v104
    ds_read_b128 v[52:55], v118 offset:13312
    v_smfmac_f32_16x16x64_bf16 v[76:79], v[16:19], v[216:223], v104
    global_load_dwordx4 a[240:243], v105, s[42:43] offset:0 sc1
    v_smfmac_f32_16x16x64_bf16 v[64:67], v[24:27], a[96:103], v104
    ds_read_b128 v[56:59], v118 offset:14336
    v_smfmac_f32_16x16x64_bf16 v[68:71], v[24:27], a[104:111], v104
    s_waitcnt vmcnt(2)
    v_max3_u32 v28, v4, v5, v6
    v_smfmac_f32_16x16x64_bf16 v[72:75], v[24:27], v[240:247], v104
    v_max_u32 v28, v28, v7
    ds_write_b128 v114, v[4:7] offset:1024
    v_smfmac_f32_16x16x64_bf16 v[76:79], v[24:27], v[248:255], v104
    global_store_dwordx4 v105, v[96:99], s[44:45] sc1
    global_load_dwordx4 a[244:247], v105, s[42:43] offset:1024 sc1
    v_cmp_le_u32 vcc, s71, v28
    v_smfmac_f32_16x16x64_bf16 v[80:83], v[8:11], a[160:167], v104
    buffer_store_dword v121, v105, s[8:11], 0 offen sc1
    v_accvgpr_read_b32 v96, a248
    v_smfmac_f32_16x16x64_bf16 v[84:87], v[8:11], a[168:175], v104
    s_cbranch_vccnz L_ch_mlfail2
L_ch_mlok:
    s_waitcnt lgkmcnt(0)
    s_barrier
    ds_read_b128 v[12:15], v115 offset:1024
    v_smfmac_f32_16x16x64_bf16 v[64:67], v[4:7], a[16:23], v104
    ds_read_b128 v[20:23], v116 offset:1024
    v_accvgpr_read_b32 v97, a249
    v_smfmac_f32_16x16x64_bf16 v[68:71], v[4:7], a[24:31], v104
    ds_read_b128 v[28:31], v117 offset:1024
    v_accvgpr_read_b32 v98, a250
    v_smfmac_f32_16x16x64_bf16 v[72:75], v[4:7], v[32:39], v104
    global_load_dwordx4 a[252:255], v105, s[42:43] offset:3072 sc1
    v_accvgpr_read_b32 v99, a251
    v_smfmac_f32_16x16x64_bf16 v[76:79], v[4:7], v[40:47], v104
    ds_read_b128 v[60:63], v118 offset:15360
    s_waitcnt lgkmcnt(3)
    v_smfmac_f32_16x16x64_bf16 v[64:67], v[12:15], a[48:55], v104
    ds_read_b128 v[32:35], v118 offset:16384
    v_smfmac_f32_16x16x64_bf16 v[72:75], v[12:15], v[48:55], v104
    global_load_dwordx4 a[248:251], v105, s[42:43] offset:2048 sc1
    s_waitcnt lgkmcnt(2)
    v_smfmac_f32_16x16x64_bf16 v[64:67], v[20:23], a[80:87], v104
    ds_read_b128 v[36:39], v118 offset:17408
    v_mov_b32 v1, 0
    v_smfmac_f32_16x16x64_bf16 v[72:75], v[20:23], v[224:231], v104
    ds_read_b128 v[40:43], v118 offset:18432
    v_mov_b32 v2, 0
    v_smfmac_f32_16x16x64_bf16 v[64:67], v[28:31], a[112:119], v104
    ds_read_b128 v[44:47], v118 offset:19456
    v_mov_b64 v[8:9], s[12:13]
    v_smfmac_f32_16x16x64_bf16 v[72:75], v[28:31], a[224:231], v104
    ds_read_b128 v[48:51], v118 offset:20480
    v_mov_b64 v[10:11], s[12:13]
    v_smfmac_f32_16x16x64_bf16 v[68:71], v[12:15], a[56:63], v104
    ds_read_b128 v[52:55], v118 offset:21504
    v_add_f32 v64, v64, v66
    s_waitcnt lgkmcnt(6)
    v_smfmac_f32_16x16x64_bf16 v[76:79], v[12:15], v[56:63], v104
    ds_read_b128 v[56:59], v118 offset:22528
    v_add_f32 v65, v65, v67
    v_smfmac_f32_16x16x64_bf16 v[68:71], v[20:23], a[88:95], v104
    ds_read_b128 v[60:63], v118 offset:23552
    v_cvt_pk_bf16_f32 v66, v64, v65
    v_smfmac_f32_16x16x64_bf16 v[68:71], v[28:31], a[120:127], v104
    v_add_f32 v72, v72, v74
    v_smfmac_f32_16x16x64_bf16 v[76:79], v[20:23], v[232:239], v104
    s_mov_b64 vcc, s[48:49]
    v_add_f32 v73, v73, v75
    v_smfmac_f32_16x16x64_bf16 v[76:79], v[28:31], a[232:239], v104
    v_cvt_pk_bf16_f32 v67, v72, v73
    v_add_f32 v68, v68, v70
    v_add_f32 v69, v69, v71
    v_mfma_f32_16x16x16_bf16 v[72:75], v[66:67], v[106:107], 0
    v_cvt_pk_bf16_f32 v70, v68, v69
    s_nop 0
    v_add_f32 v76, v76, v78
    v_add_f32 v77, v77, v79
    v_cvt_pk_bf16_f32 v71, v76, v77
    s_xor_b64 s[36:37], s[36:37], s[16:17]
    s_xor_b64 s[38:39], s[38:39], s[16:17]
    v_mfma_f32_16x16x16_bf16 v[76:79], v[70:71], v[106:107], 0
    global_store_dwordx4 v105, v[124:127], s[34:35] offset:1024
    v_cvt_pk_bf16_f32 v64, v72, v73
    v_cvt_pk_bf16_f32 v65, v74, v75
    s_nop 4
    v_cvt_pk_bf16_f32 v66, v76, v77
    v_cvt_pk_bf16_f32 v67, v78, v79
    s_xor_b64 s[40:41], s[40:41], s[68:69]
    s_xor_b64 s[28:29], s[28:29], s[62:63]
    v_mfma_f32_16x16x32_bf16 v[72:75], v[88:91], v[64:67], 0
    s_mov_b64 exec, s[14:15]
    global_load_dword v123, v122, s[96:97] sc1
    s_mov_b64 exec, -1
    v_mfma_f32_16x16x32_bf16 v[76:79], v[92:95], v[64:67], 0
    s_add_u32 s42, s42, 524288
    s_addc_u32 s43, s43, 0
    v_mfma_f32_16x16x32_bf16 v[68:71], v[64:67], v[64:67], 0
    s_add_u32 s44, s44, 131072
    s_addc_u32 s45, s45, 0
    s_nop 1
    v_cndmask_b32_dpp v72, v76, v72, vcc quad_perm:[2,3,2,3] row_mask:0xf bank_mask:0xf
    v_cndmask_b32_dpp v73, v77, v73, vcc quad_perm:[2,3,2,3] row_mask:0xf bank_mask:0xf
    v_cndmask_b32_dpp v74, v78, v74, vcc quad_perm:[2,3,2,3] row_mask:0xf bank_mask:0xf
    v_cndmask_b32_dpp v75, v79, v75, vcc quad_perm:[2,3,2,3] row_mask:0xf bank_mask:0xf
    v_cndmask_b32_dpp v68, v69, v68, vcc quad_perm:[2,3,2,3] row_mask:0xf bank_mask:0xf
    ds_write_b128 v114, v[72:75] offset:8192
    ds_write_b32 v119, v68 offset:9216
    global_store_dwordx4 v105, v[124:127], s[34:35] offset:0
    s_waitcnt lgkmcnt(8)
    v_smfmac_f32_16x16x64_bf16 v[80:83], v[20:23], v[32:39], v104
    ds_read_b128 v[32:35], v118 offset:24576
    s_waitcnt lgkmcnt(7)
    v_smfmac_f32_16x16x64_bf16 v[84:87], v[20:23], v[40:47], v104
    v_mov_b64 v[20:21], 0
    s_waitcnt lgkmcnt(5)
    v_smfmac_f32_16x16x64_bf16 v[80:83], v[28:31], v[48:55], v104
    v_mov_b64 v[22:23], 0
    s_waitcnt vmcnt(9) lgkmcnt(1)
    s_barrier
    ds_read_b128 v[76:79], v115 offset:8192
    v_smfmac_f32_16x16x64_bf16 v[84:87], v[28:31], v[56:63], v104
    ds_read_b128 v[88:91], v116 offset:8192
    ds_read_b128 v[92:95], v117 offset:8192
    ds_read_b128 v[68:71], v105 offset:9216
    v_smfmac_f32_16x16x64_bf16 v[80:83], v[16:19], a[192:199], v104
    ds_read_b128 v[36:39], v118 offset:25600
    v_mov_b64 v[28:29], 0
    v_smfmac_f32_16x16x64_bf16 v[84:87], v[16:19], a[200:207], v104
    ds_read_b128 v[40:43], v118 offset:26624
    v_mov_b64 v[30:31], 0
    v_smfmac_f32_16x16x64_bf16 v[80:83], v[24:27], a[208:215], v104
    ds_read_b128 v[44:47], v118 offset:27648
    v_mov_b64 v[16:17], 0
    v_smfmac_f32_16x16x64_bf16 v[84:87], v[24:27], a[216:223], v104
    s_not_b64 vcc, vcc
    s_cmp_ge_u32 s26, 63
    v_mov_b64 v[18:19], 0
    v_smfmac_f32_16x16x64_bf16 v[80:83], v[4:7], a[144:151], v104
    s_cbranch_scc1 L_ch_done
    s_waitcnt lgkmcnt(6)
    v_add_f32 v72, v72, v76
    v_add_f32 v73, v73, v77
    v_add_f32 v74, v74, v78
    v_add_f32 v75, v75, v79
    s_waitcnt lgkmcnt(3)
    v_pk_add_f32 v[88:89], v[88:89], v[92:93]
    v_pk_add_f32 v[90:91], v[90:91], v[94:95]
    v_pk_add_f32 v[68:69], v[68:69], v[70:71]
    v_pk_add_f32 v[72:73], v[72:73], v[88:89]
    v_pk_add_f32 v[74:75], v[74:75], v[90:91]
    v_add_f32 v68, v68, v69
    v_max3_f32 v69, v72, v73, v74
    v_max3_f32 v69, v69, v75, v68
    v_smfmac_f32_16x16x64_bf16 v[84:87], v[4:7], a[152:159], v104
    ds_read_b128 v[48:51], v118 offset:28672
    v_max_f32_dpp v69, v69, v69 quad_perm:[2,3,0,1] row_mask:0xf bank_mask:0xf
    v_mov_b32 v70, v69
    v_smfmac_f32_16x16x64_bf16 v[80:83], v[12:15], a[176:183], v104
    ds_read_b128 v[52:55], v118 offset:29696
    v_permlane16_swap_b32 v69, v70
    v_max_f32 v69, v69, v70
    v_mov_b32 v70, v69
    v_smfmac_f32_16x16x64_bf16 v[84:87], v[12:15], a[184:191], v104
    ds_read_b128 v[56:59], v118 offset:30720
    v_permlane32_swap_b32 v69, v70
    v_max_f32 v70, v69, v70
    v_sub_f32 v68, v68, v70
    v_pk_add_f32 v[72:73], v[72:73], v[70:71] op_sel_hi:[1,0] neg_lo:[0,1] neg_hi:[0,1]
    v_pk_add_f32 v[74:75], v[74:75], v[70:71] op_sel_hi:[1,0] neg_lo:[0,1] neg_hi:[0,1]
    v_pk_mul_f32 v[72:73], v[72:73], s[98:99]
    v_pk_mul_f32 v[74:75], v[74:75], s[98:99]
    v_mul_f32 v68, s98, v68
    v_exp_f32 v72, v72
    v_exp_f32 v73, v73
    v_exp_f32 v74, v74
    v_cvt_pk_bf16_f32 v72, v72, v73
    v_exp_f32 v75, v75
    v_exp_f32 v68, v68
    v_cvt_pk_bf16_f32 v74, v74, v75
    v_mov_b32_dpp v88, v72 quad_perm:[2,3,2,3] row_mask:0xf bank_mask:0xf
    v_mov_b32_dpp v90, v72 quad_perm:[0,1,0,1] row_mask:0xf bank_mask:0xf
    v_mov_b32_dpp v89, v74 quad_perm:[2,3,2,3] row_mask:0xf bank_mask:0xf
    v_mov_b32_dpp v91, v74 quad_perm:[0,1,0,1] row_mask:0xf bank_mask:0xf
    v_mov_b32_dpp v69, v68 quad_perm:[2,3,2,3] row_mask:0xf bank_mask:0xf
    v_mov_b32_dpp v70, v68 quad_perm:[0,1,0,1] row_mask:0xf bank_mask:0xf
    v_mfma_f32_16x16x32_bf16 v[92:95], v[8:11], v[88:91], 0
    v_cvt_pk_bf16_f32 v0, v69, v70
    v_cvt_pk_bf16_f32 v3, v69, v70
    v_mfma_f32_16x16x32_bf16 v[76:79], v[100:103], v[88:91], 0
    v_add_f32 v80, v80, v82
    v_add_f32 v81, v81, v83
    v_mfma_f32_16x16x32_bf16 v[72:75], v[96:99], v[88:91], 0
    v_add_f32 v84, v84, v86
    v_add_f32 v85, v85, v87
    v_cvt_pk_bf16_f32 v82, v80, v81
    v_mfma_f32_16x16x16_bf16 v[92:95], v[8:9], v[0:1], v[92:95]
    v_cvt_pk_bf16_f32 v83, v84, v85
    ds_read_b128 v[60:63], v118 offset:31744
    s_nop 0
    v_mfma_f32_16x16x16_bf16 v[76:79], v[82:83], v[2:3], v[76:79]
    v_mov_b64 v[24:25], 0
    v_mov_b64 v[26:27], 0
    v_mfma_f32_16x16x16_bf16 v[72:75], v[82:83], v[0:1], v[72:75]
    v_rcp_f32 v68, v92
    s_waitcnt lgkmcnt(4)
    s_nop 0
    v_mul_f32 v76, v76, v68
    v_mul_f32 v77, v77, v68
    v_pk_mul_f32 v[78:79], v[78:79], v[68:69] op_sel_hi:[1,0]
    v_cvt_pk_bf16_f32 v86, v76, v77
    v_cvt_pk_bf16_f32 v87, v78, v79
    v_pk_mul_f32 v[72:73], v[72:73], v[68:69] op_sel_hi:[1,0]
    v_pk_mul_f32 v[74:75], v[74:75], v[68:69] op_sel_hi:[1,0]
    v_cvt_pk_bf16_f32 v84, v72, v73
    v_cvt_pk_bf16_f32 v85, v74, v75
    ds_write_b128 v114, v[84:87] offset:0
    s_nop 0
    v_smfmac_f32_16x16x64_bf16 v[20:23], v[84:87], v[32:39], v104
    s_add_u32 s26, s26, 1
    s_xor_b64 s[34:35], s[34:35], s[6:7]
    v_cndmask_b32 v96, v82, v64, vcc
    v_smfmac_f32_16x16x64_bf16 v[28:31], v[84:87], v[40:47], v104
    s_add_u32 s59, s26, 1
    s_min_u32 s59, s59, 63
    v_cndmask_b32 v97, v83, v65, vcc
    s_waitcnt lgkmcnt(0)
    s_barrier
    ds_read_b128 v[68:71], v115 offset:0
    v_smfmac_f32_16x16x64_bf16 v[16:19], v[84:87], v[48:55], v104
    ds_read_b128 v[72:75], v116 offset:0
    ds_read_b128 v[76:79], v117 offset:0
    s_cmp_eq_u32 s32, 1
    v_smfmac_f32_16x16x64_bf16 v[24:27], v[84:87], v[56:63], v104
    s_waitcnt lgkmcnt(2)
    v_smfmac_f32_16x16x64_bf16 v[20:23], v[68:71], v[128:135], v104
    s_waitcnt lgkmcnt(0)
    v_smfmac_f32_16x16x64_bf16 v[20:23], v[72:75], v[136:143], v104
    ds_read_b128 v[32:35], v118 offset:32768
    v_cndmask_b32_dpp v98, v82, v66, vcc quad_perm:[2,3,0,1] row_mask:0xf bank_mask:0xf
    v_smfmac_f32_16x16x64_bf16 v[20:23], v[76:79], v[144:151], v104
    ds_read_b128 v[36:39], v118 offset:33792
    v_cndmask_b32_dpp v99, v83, v67, vcc quad_perm:[2,3,0,1] row_mask:0xf bank_mask:0xf
    v_smfmac_f32_16x16x64_bf16 v[28:31], v[68:71], v[152:159], v104
    ds_read_b128 v[40:43], v118 offset:34816
    v_mov_b64 v[0:1], v[124:125]
    v_smfmac_f32_16x16x64_bf16 v[28:31], v[72:75], v[160:167], v104
    ds_read_b128 v[44:47], v118 offset:35840
    v_cvt_pk_bf16_f32 v20, v20, v21
    v_smfmac_f32_16x16x64_bf16 v[28:31], v[76:79], v[168:175], v104
    buffer_store_dword v20, v112, s[28:31], s50 offen
    v_cvt_pk_bf16_f32 v22, v22, v23
    v_smfmac_f32_16x16x64_bf16 v[16:19], v[68:71], v[176:183], v104
    buffer_store_dword v22, v112, s[28:31], s51 offen
    v_mov_b64 v[2:3], v[124:125]
    v_smfmac_f32_16x16x64_bf16 v[16:19], v[72:75], v[184:191], v104
    v_cvt_pk_bf16_f32 v28, v28, v29
    v_smfmac_f32_16x16x64_bf16 v[16:19], v[76:79], v[192:199], v104
    buffer_store_dword v28, v112, s[28:31], s52 offen
    v_cvt_pk_bf16_f32 v30, v30, v31
    v_smfmac_f32_16x16x64_bf16 v[24:27], v[68:71], v[200:207], v104
    buffer_store_dword v30, v112, s[28:31], s53 offen
    s_waitcnt lgkmcnt(0)
    v_smfmac_f32_16x16x64_bf16 v[24:27], v[72:75], v[32:39], v104
    v_cvt_pk_bf16_f32 v16, v16, v17
    v_smfmac_f32_16x16x64_bf16 v[24:27], v[76:79], v[40:47], v104
    buffer_store_dword v16, v112, s[28:31], s54 offen
    v_cvt_pk_bf16_f32 v18, v18, v19
    buffer_store_dword v18, v112, s[28:31], s55 offen
    s_nop 3
    v_cvt_pk_bf16_f32 v24, v24, v25
    v_cvt_pk_bf16_f32 v26, v26, v27
    buffer_store_dword v24, v112, s[28:31], s56 offen
    buffer_store_dword v26, v112, s[28:31], s57 offen
    s_cbranch_scc1 L_ch_late
    ds_read_b128 v[32:35], v118 offset:0
    v_mov_b64 v[64:65], 0
    ds_read_b128 v[36:39], v118 offset:1024
    v_mov_b64 v[66:67], 0
    ds_read_b128 v[40:43], v118 offset:2048
    v_mov_b64 v[68:69], 0
    ds_read_b128 v[44:47], v118 offset:3072
    v_mov_b64 v[70:71], 0
    s_waitcnt vmcnt(4)
    global_load_dwordx4 v[4:7], v105, s[34:35] sc1
    global_load_dwordx4 v[12:15], v105, s[34:35] offset:1024 sc1
    ds_read_b128 v[48:51], v118 offset:4096
    ds_read_b128 v[52:55], v118 offset:5120
    ds_read_b128 v[56:59], v118 offset:6144
    ds_read_b128 v[60:63], v118 offset:7168
    s_waitcnt vmcnt(1)
    v_mfma_f32_16x16x32_bf16 v[8:11], v[108:111], v[4:7], 0
    s_waitcnt vmcnt(0)
    v_mfma_f32_16x16x32_bf16 v[8:11], v[108:111], v[12:15], v[8:11]
    s_nop 7
    v_add_f32_dpp v8, v8, v8 row_ror:4 row_mask:0xf bank_mask:0xf
    v_add_f32_dpp v9, v9, v9 row_ror:4 row_mask:0xf bank_mask:0xf
    v_cmp_u_f32 vcc, v10, v10
    v_add_f32_dpp v8, v8, v8 row_ror:8 row_mask:0xf bank_mask:0xf
    v_add_f32_dpp v9, v9, v9 row_ror:8 row_mask:0xf bank_mask:0xf
    v_cvt_pk_bf16_f32 v8, v8, v9
    global_store_dword v113, v8, s[36:37]
    s_cbranch_vccnz L_ch_eret
L_ch_eok:
    s_waitcnt vmcnt(1)
    v_cmp_ge_u32 vcc, s59, v123
    v_accvgpr_read_b32 v88, a240
    v_accvgpr_read_b32 v89, a241
    v_accvgpr_read_b32 v90, a242
    v_accvgpr_read_b32 v91, a243
    v_accvgpr_read_b32 v92, a244
    v_accvgpr_read_b32 v93, a245
    v_accvgpr_read_b32 v94, a246
    v_accvgpr_read_b32 v95, a247
    v_accvgpr_read_b32 v100, a252
    v_accvgpr_read_b32 v101, a253
    v_accvgpr_read_b32 v102, a254
    v_accvgpr_read_b32 v103, a255
    s_cbranch_vccnz L_ch_fle
L_ch_floke:
    v_mov_b32 v121, s26
    s_add_u32 s59, s59, 4
    s_min_u32 s59, s59, 63
    v_cmp_ge_u32 vcc, s59, v123
    s_cmp_lg_u64 vcc, 0
    s_cselect_b64 s[14:15], -1, 0
    v_mov_b64 v[72:73], 0
    v_mov_b64 v[74:75], 0
    v_mov_b64 v[76:77], 0
    v_mov_b64 v[78:79], 0
    v_mov_b64 v[80:81], 0
    v_mov_b64 v[82:83], 0
    v_mov_b64 v[84:85], 0
    v_mov_b64 v[86:87], 0
    s_waitcnt lgkmcnt(0)
    s_branch L_ch_mestart
.p2align 5
L_ch_late:
    ds_read_b128 v[32:35], v118 offset:0
    v_mov_b64 v[64:65], 0
    ds_read_b128 v[36:39], v118 offset:1024
    v_mov_b64 v[66:67], 0
    ds_read_b128 v[40:43], v118 offset:2048
    v_mov_b64 v[68:69], 0
    ds_read_b128 v[44:47], v118 offset:3072
    v_mov_b64 v[70:71], 0
    ds_read_b128 v[48:51], v118 offset:4096
    v_mov_b64 v[72:73], 0
    ds_read_b128 v[52:55], v118 offset:5120
    v_mov_b64 v[74:75], 0
    ds_read_b128 v[56:59], v118 offset:6144
    v_mov_b64 v[76:77], 0
    ds_read_b128 v[60:63], v118 offset:7168
    v_mov_b64 v[78:79], 0
    v_mov_b64 v[80:81], 0
    v_mov_b64 v[82:83], 0
    v_mov_b64 v[84:85], 0
    v_mov_b64 v[86:87], 0
    s_waitcnt vmcnt(8)
    v_cmp_ge_u32 vcc, s59, v123
    v_accvgpr_read_b32 v88, a240
    v_accvgpr_read_b32 v89, a241
    v_accvgpr_read_b32 v90, a242
    v_accvgpr_read_b32 v91, a243
    v_accvgpr_read_b32 v92, a244
    v_accvgpr_read_b32 v93, a245
    v_accvgpr_read_b32 v94, a246
    v_accvgpr_read_b32 v95, a247
    v_accvgpr_read_b32 v100, a252
    v_accvgpr_read_b32 v101, a253
    v_accvgpr_read_b32 v102, a254
    v_accvgpr_read_b32 v103, a255
    s_cbranch_vccnz L_ch_fll
L_ch_flokl:
    v_mov_b32 v121, s26
    s_add_u32 s59, s59, 4
    s_min_u32 s59, s59, 63
    v_cmp_ge_u32 vcc, s59, v123
    s_cmp_lg_u64 vcc, 0
    s_cselect_b64 s[14:15], -1, 0
    s_waitcnt vmcnt(0)
    global_load_dwordx4 v[4:7], v105, s[34:35] sc1
    global_load_dwordx4 v[12:15], v105, s[34:35] offset:1024 sc1
    s_waitcnt vmcnt(1)
    v_mfma_f32_16x16x32_bf16 v[8:11], v[108:111], v[4:7], 0
    s_waitcnt vmcnt(0)
    v_mfma_f32_16x16x32_bf16 v[8:11], v[108:111], v[12:15], v[8:11]
    s_nop 7
    v_add_f32_dpp v8, v8, v8 row_ror:4 row_mask:0xf bank_mask:0xf
    v_add_f32_dpp v9, v9, v9 row_ror:4 row_mask:0xf bank_mask:0xf
    v_cmp_u_f32 vcc, v10, v10
    v_add_f32_dpp v8, v8, v8 row_ror:8 row_mask:0xf bank_mask:0xf
    v_add_f32_dpp v9, v9, v9 row_ror:8 row_mask:0xf bank_mask:0xf
    v_cvt_pk_bf16_f32 v8, v8, v9
    global_load_dwordx4 v[0:3], v105, s[40:41] offset:-2048 sc1
    global_store_dword v113, v8, s[36:37]
    s_cbranch_vccnz L_ch_lret
L_ch_lok:
    s_waitcnt lgkmcnt(0)
    s_branch L_ch_chk
L_ch_eret:
    global_load_dwordx4 v[4:7], v105, s[34:35] sc1
    global_load_dwordx4 v[12:15], v105, s[34:35] offset:1024 sc1
    s_waitcnt vmcnt(1)
    v_mfma_f32_16x16x32_bf16 v[8:11], v[108:111], v[4:7], 0
    s_waitcnt vmcnt(0)
    v_mfma_f32_16x16x32_bf16 v[8:11], v[108:111], v[12:15], v[8:11]
    s_nop 7
    v_add_f32_dpp v8, v8, v8 row_ror:4 row_mask:0xf bank_mask:0xf
    v_add_f32_dpp v9, v9, v9 row_ror:4 row_mask:0xf bank_mask:0xf
    v_cmp_u_f32 vcc, v10, v10
    v_add_f32_dpp v8, v8, v8 row_ror:8 row_mask:0xf bank_mask:0xf
    v_add_f32_dpp v9, v9, v9 row_ror:8 row_mask:0xf bank_mask:0xf
    v_cvt_pk_bf16_f32 v8, v8, v9
    global_store_dword v113, v8, s[36:37]
    s_cbranch_vccz L_ch_eok
    s_sub_u32 s27, s27, 1
    s_cbranch_scc0 L_ch_eret
    s_branch L_end
L_ch_lret:
    global_load_dwordx4 v[4:7], v105, s[34:35] sc1
    global_load_dwordx4 v[12:15], v105, s[34:35] offset:1024 sc1
    s_waitcnt vmcnt(1)
    v_mfma_f32_16x16x32_bf16 v[8:11], v[108:111], v[4:7], 0
    s_waitcnt vmcnt(0)
    v_mfma_f32_16x16x32_bf16 v[8:11], v[108:111], v[12:15], v[8:11]
    s_nop 7
    v_add_f32_dpp v8, v8, v8 row_ror:4 row_mask:0xf bank_mask:0xf
    v_add_f32_dpp v9, v9, v9 row_ror:4 row_mask:0xf bank_mask:0xf
    v_cmp_u_f32 vcc, v10, v10
    v_add_f32_dpp v8, v8, v8 row_ror:8 row_mask:0xf bank_mask:0xf
    v_add_f32_dpp v9, v9, v9 row_ror:8 row_mask:0xf bank_mask:0xf
    v_cvt_pk_bf16_f32 v8, v8, v9
    global_store_dword v113, v8, s[36:37]
    s_cbranch_vccz L_ch_lok
    s_sub_u32 s27, s27, 1
    s_cbranch_scc0 L_ch_lret
    s_branch L_end
L_ch_mlfail2:
    s_waitcnt vmcnt(4) lgkmcnt(0)
    v_max3_u32 v28, v4, v5, v6
    v_max_u32 v28, v28, v7
    v_cmp_le_u32 vcc, s71, v28
    ds_write_b128 v114, v[4:7] offset:1024
    s_cbranch_vccz L_ch_mlok
L_ch_mlfail:
    global_load_dwordx4 v[4:7], v105, s[40:41] offset:2048 sc1
    s_waitcnt vmcnt(0) lgkmcnt(0)
    v_max3_u32 v28, v4, v5, v6
    v_max_u32 v28, v28, v7
    v_cmp_le_u32 vcc, s71, v28
    ds_write_b128 v114, v[4:7] offset:1024
    s_cbranch_vccz L_ch_mlok
    s_sub_u32 s27, s27, 1
    s_cbranch_scc0 L_ch_mlfail
    s_branch L_end
L_ch_fle:
    global_load_dword v123, v122, s[96:97] sc1
    s_waitcnt vmcnt(0)
    v_cmp_ge_u32 vcc, s59, v123
    s_cbranch_vccz L_ch_floke
    s_sleep 1
    s_sub_u32 s27, s27, 1
    s_cbranch_scc0 L_ch_fle
    s_branch L_end
L_ch_fll:
    global_load_dword v123, v122, s[96:97] sc1
    s_waitcnt vmcnt(0)
    v_cmp_ge_u32 vcc, s59, v123
    s_cbranch_vccz L_ch_flokl
    s_sleep 1
    s_sub_u32 s27, s27, 1
    s_cbranch_scc0 L_ch_fll
    s_branch L_end
L_ch_done:
    v_smfmac_f32_16x16x64_bf16 v[84:87], v[4:7], a[152:159], v104
    v_smfmac_f32_16x16x64_bf16 v[80:83], v[12:15], a[176:183], v104
    v_smfmac_f32_16x16x64_bf16 v[84:87], v[12:15], a[184:191], v104
    s_nop 6
    v_pk_add_f32 v[80:81], v[80:81], v[82:83]
    v_pk_add_f32 v[84:85], v[84:85], v[86:87]
    v_cvt_pk_bf16_f32 v82, v80, v81
    v_cvt_pk_bf16_f32 v83, v84, v85
    v_cndmask_b32 v96, v82, v64, vcc
    v_cndmask_b32 v97, v83, v65, vcc
    v_cndmask_b32_dpp v98, v82, v66, vcc quad_perm:[2,3,0,1] row_mask:0xf bank_mask:0xf
    v_cndmask_b32_dpp v99, v83, v67, vcc quad_perm:[2,3,0,1] row_mask:0xf bank_mask:0xf
    global_store_dwordx4 v105, v[96:99], s[44:45] sc1
    s_waitcnt lgkmcnt(0)
    v_mov_b32 v29, 65
    s_waitcnt vmcnt(0)
    s_barrier
    s_mov_b64 exec, 1
    global_store_dword v105, v29, s[4:5] sc1
    s_mov_b64 exec, -1
    s_endpgm
L_ch_cend:
L_worker:
    s_cmp_ge_u32 s22, 5
    s_cselect_b32 s25, 1, 0
    s_cselect_b32 s59, 5, 2
    s_sub_u32 s22, s22, s59
    s_lshl_b32 s58, s22, 5
    s_add_u32 s58, s58, s24
    s_mul_i32 s24, s58, 0x5556
    s_lshr_b32 s24, s24, 16
    s_mul_i32 s59, s24, 3
    s_sub_u32 s22, s58, s59
    s_cmp_eq_u32 s25, 1
    s_cselect_b64 s[4:5], s[32:33], s[4:5]
    s_cselect_b64 s[6:7], s[36:37], s[6:7]
    s_cselect_b64 s[8:9], s[38:39], s[8:9]
    s_cselect_b64 s[10:11], s[40:41], s[10:11]
    s_cselect_b64 s[12:13], s[42:43], s[12:13]
    s_cselect_b64 s[14:15], s[44:45], s[14:15]
    s_lshl_b32 s58, s25, 26
    s_add_u32 s20, s20, s58
    s_addc_u32 s21, s21, 0
    s_cmp_eq_u32 s22, 1
    s_cbranch_scc1 L_vw
    s_cmp_eq_u32 s22, 2
    s_cbranch_scc1 L_qw
    v_lshlrev_b32 v240, 4, v0
    v_add_u32 v241, 0x10000, v240
    v_mov_b32 v246, 0
    s_mov_b32 s68, 0x05040100
    s_mov_b32 s69, 0x07060302
    s_mov_b32 s32, 0
    s_mov_b32 s33, 4096
    s_mov_b32 s34, 8192
    s_mov_b32 s35, 12288
    s_mov_b32 s36, 16384
    s_mov_b32 s37, 20480
    s_mov_b32 s38, 24576
    s_mov_b32 s39, 28672
    v_lshrrev_b32 v1, 5, v0
    v_lshlrev_b32 v1, 8, v1
    v_and_b32 v2, 8, v0
    v_lshl_add_u32 v2, v2, 7, v1
    v_and_b32 v3, 16, v0
    v_lshl_add_u32 v2, v3, 3, v2
    v_and_b32 v3, 7, v0
    v_lshl_add_u32 v242, v3, 4, v2
    v_and_b32 v3, 16, v0
    v_lshl_add_u32 v2, v3, 6, v1
    v_and_b32 v3, 15, v0
    v_lshl_add_u32 v2, v3, 4, v2
    v_add_u32 v243, 0x800, v2
L_k_c1:
    s_lshl_b32 s58, s24, 9
    s_lshl_b32 s59, s23, 7
    s_add_u32 s58, s58, s59
    s_add_u32 s58, s58, 61865984
    s_add_u32 s42, s20, s58
    s_addc_u32 s43, s21, 0
    v_mov_b32 v253, s23
    s_mov_b64 exec, 1
    global_store_dword v246, v253, s[42:43] sc1
    s_mov_b64 exec, -1
    s_mov_b32 s52, s4
    s_and_b32 s53, s5, 0xffff
    s_mov_b32 s54, 2097152
    s_mov_b32 s55, 0x20000
    s_lshl_b32 s60, s23, 15
    v_xor_b32 v128, 0, v240
    s_add_u32 m0, s60, 32768
    s_add_u32 s61, s60, 0
    buffer_load_dwordx4 v128, s[52:55], s61 offen  lds
    v_xor_b32 v129, 16, v240
    s_add_u32 m0, s60, 33792
    s_add_u32 s61, s60, 1024
    buffer_load_dwordx4 v129, s[52:55], s61 offen  lds
    v_xor_b32 v130, 32, v240
    s_add_u32 m0, s60, 34816
    s_add_u32 s61, s60, 2048
    buffer_load_dwordx4 v130, s[52:55], s61 offen  lds
    v_xor_b32 v131, 48, v240
    s_add_u32 m0, s60, 35840
    s_add_u32 s61, s60, 3072
    buffer_load_dwordx4 v131, s[52:55], s61 offen  lds
    v_xor_b32 v132, 64, v240
    s_add_u32 m0, s60, 36864
    s_add_u32 s61, s60, 4096
    buffer_load_dwordx4 v132, s[52:55], s61 offen  lds
    v_xor_b32 v133, 80, v240
    s_add_u32 m0, s60, 37888
    s_add_u32 s61, s60, 5120
    buffer_load_dwordx4 v133, s[52:55], s61 offen  lds
    v_xor_b32 v134, 96, v240
    s_add_u32 m0, s60, 38912
    s_add_u32 s61, s60, 6144
    buffer_load_dwordx4 v134, s[52:55], s61 offen  lds
    v_xor_b32 v135, 112, v240
    s_add_u32 m0, s60, 39936
    s_add_u32 s61, s60, 7168
    buffer_load_dwordx4 v135, s[52:55], s61 offen  lds
    v_xor_b32 v136, 128, v240
    s_add_u32 m0, s60, 40960
    s_add_u32 s61, s60, 8192
    buffer_load_dwordx4 v136, s[52:55], s61 offen  lds
    v_xor_b32 v137, 144, v240
    s_add_u32 m0, s60, 41984
    s_add_u32 s61, s60, 9216
    buffer_load_dwordx4 v137, s[52:55], s61 offen  lds
    v_xor_b32 v138, 160, v240
    s_add_u32 m0, s60, 43008
    s_add_u32 s61, s60, 10240
    buffer_load_dwordx4 v138, s[52:55], s61 offen  lds
    v_xor_b32 v139, 176, v240
    s_add_u32 m0, s60, 44032
    s_add_u32 s61, s60, 11264
    buffer_load_dwordx4 v139, s[52:55], s61 offen  lds
    v_xor_b32 v140, 192, v240
    s_add_u32 m0, s60, 45056
    s_add_u32 s61, s60, 12288
    buffer_load_dwordx4 v140, s[52:55], s61 offen  lds
    v_xor_b32 v141, 208, v240
    s_add_u32 m0, s60, 46080
    s_add_u32 s61, s60, 13312
    buffer_load_dwordx4 v141, s[52:55], s61 offen  lds
    v_xor_b32 v142, 224, v240
    s_add_u32 m0, s60, 47104
    s_add_u32 s61, s60, 14336
    buffer_load_dwordx4 v142, s[52:55], s61 offen  lds
    v_xor_b32 v143, 240, v240
    s_add_u32 m0, s60, 48128
    s_add_u32 s61, s60, 15360
    buffer_load_dwordx4 v143, s[52:55], s61 offen  lds
    s_nop 0
    s_add_u32 m0, s60, 49152
    s_add_u32 s61, s60, 16384
    buffer_load_dwordx4 v128, s[52:55], s61 offen  lds
    s_nop 0
    s_add_u32 m0, s60, 50176
    s_add_u32 s61, s60, 17408
    buffer_load_dwordx4 v129, s[52:55], s61 offen  lds
    s_nop 0
    s_add_u32 m0, s60, 51200
    s_add_u32 s61, s60, 18432
    buffer_load_dwordx4 v130, s[52:55], s61 offen  lds
    s_nop 0
    s_add_u32 m0, s60, 52224
    s_add_u32 s61, s60, 19456
    buffer_load_dwordx4 v131, s[52:55], s61 offen  lds
    s_nop 0
    s_add_u32 m0, s60, 53248
    s_add_u32 s61, s60, 20480
    buffer_load_dwordx4 v132, s[52:55], s61 offen  lds
    s_nop 0
    s_add_u32 m0, s60, 54272
    s_add_u32 s61, s60, 21504
    buffer_load_dwordx4 v133, s[52:55], s61 offen  lds
    s_nop 0
    s_add_u32 m0, s60, 55296
    s_add_u32 s61, s60, 22528
    buffer_load_dwordx4 v134, s[52:55], s61 offen  lds
    s_nop 0
    s_add_u32 m0, s60, 56320
    s_add_u32 s61, s60, 23552
    buffer_load_dwordx4 v135, s[52:55], s61 offen  lds
    s_nop 0
    s_add_u32 m0, s60, 57344
    s_add_u32 s61, s60, 24576
    buffer_load_dwordx4 v136, s[52:55], s61 offen  lds
    s_nop 0
    s_add_u32 m0, s60, 58368
    s_add_u32 s61, s60, 25600
    buffer_load_dwordx4 v137, s[52:55], s61 offen  lds
    s_nop 0
    s_add_u32 m0, s60, 59392
    s_add_u32 s61, s60, 26624
    buffer_load_dwordx4 v138, s[52:55], s61 offen  lds
    s_nop 0
    s_add_u32 m0, s60, 60416
    s_add_u32 s61, s60, 27648
    buffer_load_dwordx4 v139, s[52:55], s61 offen  lds
    s_nop 0
    s_add_u32 m0, s60, 61440
    s_add_u32 s61, s60, 28672
    buffer_load_dwordx4 v140, s[52:55], s61 offen  lds
    s_nop 0
    s_add_u32 m0, s60, 62464
    s_add_u32 s61, s60, 29696
    buffer_load_dwordx4 v141, s[52:55], s61 offen  lds
    s_nop 0
    s_add_u32 m0, s60, 63488
    s_add_u32 s61, s60, 30720
    buffer_load_dwordx4 v142, s[52:55], s61 offen  lds
    s_nop 0
    s_add_u32 m0, s60, 64512
    s_add_u32 s61, s60, 31744
    buffer_load_dwordx4 v143, s[52:55], s61 offen  lds
    v_mov_b32 v249, v0
    v_lshrrev_b32 v2, 4, v0
    v_lshlrev_b32 v3, 2, v2
    v_and_b32 v1, 15, v0
    v_xor_b32 v1, v1, v3
    v_lshlrev_b32 v3, 13, v2
    v_lshl_add_u32 v3, v1, 4, v3
    s_lshl_b32 s58, s23, 15
    s_lshl_b32 s59, s24, 8
    s_add_u32 s58, s58, s59
    v_add_u32 v248, s58, v3
    s_lshl_b32 s60, s23, 10
    v_lshrrev_b32 v1, 5, v0
    v_lshlrev_b32 v1, 11, v1
    v_and_b32 v2, 12, v0
    v_lshl_add_u32 v1, v2, 6, v1
    v_lshl_add_u32 v1, v2, 4, v1
    v_and_b32 v2, 1, v0
    v_lshl_add_u32 v1, v2, 3, v1
    v_and_b32 v2, 2, v0
    v_and_b32 v3, 16, v0
    v_lshl_add_u32 v1, v2, 4, v1
    v_add_u32 v1, v3, v1
    v_xor_b32 v232, 0, v1
    v_add_u32 v233, 0x10000, v232
    v_xor_b32 v234, 64, v1
    v_add_u32 v235, 0x10000, v234
    v_xor_b32 v236, 128, v1
    v_add_u32 v237, 0x10000, v236
    v_xor_b32 v238, 192, v1
    v_add_u32 v239, 0x10000, v238
    s_mov_b32 s28, s10
    s_and_b32 s29, s11, 0xffff
    s_mov_b32 s30, 4194304
    s_mov_b32 s31, 0x20000
    s_add_u32 m0, s60, 0
    s_mov_b32 s61, 0
    buffer_load_dwordx4 v248, s[28:31], s61 offen  lds
    s_add_u32 m0, s60, 4096
    s_mov_b32 s61, 131072
    buffer_load_dwordx4 v248, s[28:31], s61 offen  lds
    s_add_u32 m0, s60, 8192
    s_mov_b32 s61, 262144
    buffer_load_dwordx4 v248, s[28:31], s61 offen  lds
    s_add_u32 m0, s60, 12288
    s_mov_b32 s61, 393216
    buffer_load_dwordx4 v248, s[28:31], s61 offen  lds
    s_add_u32 m0, s60, 16384
    s_mov_b32 s61, 524288
    buffer_load_dwordx4 v248, s[28:31], s61 offen  lds
    s_add_u32 m0, s60, 20480
    s_mov_b32 s61, 655360
    buffer_load_dwordx4 v248, s[28:31], s61 offen  lds
    s_add_u32 m0, s60, 24576
    s_mov_b32 s61, 786432
    buffer_load_dwordx4 v248, s[28:31], s61 offen  lds
    s_add_u32 m0, s60, 28672
    s_mov_b32 s61, 917504
    buffer_load_dwordx4 v248, s[28:31], s61 offen  lds
    v_and_b32 v144, 31, v249
    v_lshlrev_b32 v145, 10, v144
    v_and_b32 v144, 15, v144
    v_lshrrev_b32 v146, 5, v249
    v_xor_b32 v144, v144, v146
    v_lshl_add_u32 v145, v144, 4, v145
    s_lshl_b32 s58, s23, 15
    s_add_u32 s58, s58, 0x8000
    v_add_u32 v145, s58, v145
    v_xor_b32 v128, 0, v145
    v_xor_b32 v129, 32, v145
    v_xor_b32 v130, 64, v145
    v_xor_b32 v131, 96, v145
    v_xor_b32 v132, 128, v145
    v_xor_b32 v133, 160, v145
    v_xor_b32 v134, 192, v145
    v_xor_b32 v135, 224, v145
    s_waitcnt vmcnt(8)
    ds_read_b128 v[0:3], v128 offset:0
    ds_read_b128 v[4:7], v129 offset:0
    ds_read_b128 v[8:11], v130 offset:0
    ds_read_b128 v[12:15], v131 offset:0
    ds_read_b128 v[16:19], v132 offset:0
    ds_read_b128 v[20:23], v133 offset:0
    ds_read_b128 v[24:27], v134 offset:0
    ds_read_b128 v[28:31], v135 offset:0
    s_waitcnt lgkmcnt(0)
    ds_read_b128 v[32:35], v128 offset:256
    ds_read_b128 v[36:39], v129 offset:256
    ds_read_b128 v[40:43], v130 offset:256
    ds_read_b128 v[44:47], v131 offset:256
    ds_read_b128 v[48:51], v132 offset:256
    ds_read_b128 v[52:55], v133 offset:256
    ds_read_b128 v[56:59], v134 offset:256
    ds_read_b128 v[60:63], v135 offset:256
    s_waitcnt lgkmcnt(0)
    ds_read_b128 v[64:67], v128 offset:512
    ds_read_b128 v[68:71], v129 offset:512
    ds_read_b128 v[72:75], v130 offset:512
    ds_read_b128 v[76:79], v131 offset:512
    ds_read_b128 v[80:83], v132 offset:512
    ds_read_b128 v[84:87], v133 offset:512
    ds_read_b128 v[88:91], v134 offset:512
    ds_read_b128 v[92:95], v135 offset:512
    s_waitcnt lgkmcnt(0)
    ds_read_b128 v[96:99], v128 offset:768
    ds_read_b128 v[100:103], v129 offset:768
    ds_read_b128 v[104:107], v130 offset:768
    ds_read_b128 v[108:111], v131 offset:768
    ds_read_b128 v[112:115], v132 offset:768
    ds_read_b128 v[116:119], v133 offset:768
    ds_read_b128 v[120:123], v134 offset:768
    ds_read_b128 v[124:127], v135 offset:768
    s_waitcnt lgkmcnt(0)
    s_waitcnt vmcnt(8) lgkmcnt(0)
    s_barrier
    s_cmp_eq_u32 s23, 0
    s_cbranch_scc0 L_k_noarr
    s_mov_b64 exec, 1
    s_lshl_b32 s58, s3, 5
    s_add_u32 s58, s58, 208
    v_mov_b32 v252, s58
    v_mov_b32 v253, 1
    global_atomic_add v252, v253, s[18:19]
    s_mov_b64 exec, -1
L_k_noarr:
    s_add_u32 m0, s60, 32768
    s_mov_b32 s61, 1048576
    buffer_load_dwordx4 v248, s[28:31], s61 offen  lds
    s_add_u32 m0, s60, 36864
    s_mov_b32 s61, 1179648
    buffer_load_dwordx4 v248, s[28:31], s61 offen  lds
    s_add_u32 m0, s60, 40960
    s_mov_b32 s61, 1310720
    buffer_load_dwordx4 v248, s[28:31], s61 offen  lds
    s_add_u32 m0, s60, 45056
    s_mov_b32 s61, 1441792
    buffer_load_dwordx4 v248, s[28:31], s61 offen  lds
    s_add_u32 m0, s60, 49152
    s_mov_b32 s61, 1572864
    buffer_load_dwordx4 v248, s[28:31], s61 offen  lds
    s_add_u32 m0, s60, 53248
    s_mov_b32 s61, 1703936
    buffer_load_dwordx4 v248, s[28:31], s61 offen  lds
    s_add_u32 m0, s60, 57344
    s_mov_b32 s61, 1835008
    buffer_load_dwordx4 v248, s[28:31], s61 offen  lds
    s_add_u32 m0, s60, 61440
    s_mov_b32 s61, 1966080
    buffer_load_dwordx4 v248, s[28:31], s61 offen  lds
    s_add_u32 m0, s60, 65536
    s_mov_b32 s61, 2097152
    buffer_load_dwordx4 v248, s[28:31], s61 offen  lds
    s_add_u32 m0, s60, 69632
    s_mov_b32 s61, 2228224
    buffer_load_dwordx4 v248, s[28:31], s61 offen  lds
    s_add_u32 m0, s60, 73728
    s_mov_b32 s61, 2359296
    buffer_load_dwordx4 v248, s[28:31], s61 offen  lds
    s_add_u32 m0, s60, 77824
    s_mov_b32 s61, 2490368
    buffer_load_dwordx4 v248, s[28:31], s61 offen  lds
    s_add_u32 m0, s60, 81920
    s_mov_b32 s61, 2621440
    buffer_load_dwordx4 v248, s[28:31], s61 offen  lds
    s_add_u32 m0, s60, 86016
    s_mov_b32 s61, 2752512
    buffer_load_dwordx4 v248, s[28:31], s61 offen  lds
    s_add_u32 m0, s60, 90112
    s_mov_b32 s61, 2883584
    buffer_load_dwordx4 v248, s[28:31], s61 offen  lds
    s_add_u32 m0, s60, 94208
    s_mov_b32 s61, 3014656
    buffer_load_dwordx4 v248, s[28:31], s61 offen  lds
    s_add_u32 m0, s60, 98304
    s_mov_b32 s61, 3145728
    buffer_load_dwordx4 v248, s[28:31], s61 offen  lds
    s_add_u32 m0, s60, 102400
    s_mov_b32 s61, 3276800
    buffer_load_dwordx4 v248, s[28:31], s61 offen  lds
    s_add_u32 m0, s60, 106496
    s_mov_b32 s61, 3407872
    buffer_load_dwordx4 v248, s[28:31], s61 offen  lds
    s_add_u32 m0, s60, 110592
    s_mov_b32 s61, 3538944
    buffer_load_dwordx4 v248, s[28:31], s61 offen  lds
    s_add_u32 m0, s60, 114688
    s_mov_b32 s61, 3670016
    buffer_load_dwordx4 v248, s[28:31], s61 offen  lds
    s_add_u32 m0, s60, 118784
    s_mov_b32 s61, 3801088
    buffer_load_dwordx4 v248, s[28:31], s61 offen  lds
    s_add_u32 m0, s60, 122880
    s_mov_b32 s61, 3932160
    buffer_load_dwordx4 v248, s[28:31], s61 offen  lds
    s_add_u32 m0, s60, 126976
    s_mov_b32 s61, 4063232
    buffer_load_dwordx4 v248, s[28:31], s61 offen  lds
    s_lshl_b32 s58, s23, 15
    s_add_u32 s58, s58, 58720256
    s_add_u32 s28, s20, s58
    s_addc_u32 s29, s21, 0
    s_mov_b32 s30, 0x8000
    s_mov_b32 s31, 0x20000
    s_add_u32 s28, s28, 131072
    s_addc_u32 s29, s29, 0
    s_lshl_b32 s58, s23, 19
    s_lshl_b32 s59, s24, 14
    s_add_u32 s58, s58, s59
    s_add_u32 s52, s20, s58
    s_addc_u32 s53, s21, 0
    s_mov_b32 s54, 0x4000
    s_mov_b32 s55, 0x20000
    s_mov_b32 s26, 0
    s_waitcnt vmcnt(0)
    s_barrier
    ds_read_b64_tr_b16 v[128:129], v232 offset:0
    ds_read_b64_tr_b16 v[130:131], v232 offset:1024
    ds_read_b64_tr_b16 v[132:133], v232 offset:4096
    ds_read_b64_tr_b16 v[134:135], v232 offset:5120
    ds_read_b64_tr_b16 v[136:137], v232 offset:8192
    ds_read_b64_tr_b16 v[138:139], v232 offset:9216
    ds_read_b64_tr_b16 v[140:141], v232 offset:12288
    ds_read_b64_tr_b16 v[142:143], v232 offset:13312
    ds_read_b64_tr_b16 v[144:145], v232 offset:16384
    ds_read_b64_tr_b16 v[146:147], v232 offset:17408
    ds_read_b64_tr_b16 v[148:149], v232 offset:20480
    ds_read_b64_tr_b16 v[150:151], v232 offset:21504
    s_lshl_b32 s56, s24, 1
    s_add_u32 s56, s56, s22
    v_lshrrev_b32 v224, 2, v249
    v_lshlrev_b32 v224, 10, v224
    v_and_b32 v225, 3, v249
    v_lshl_add_u32 v224, v225, 4, v224
    s_lshl_b32 s58, s23, 20
    s_and_b32 s59, s56, 15
    s_lshl_b32 s59, s59, 6
    s_add_u32 s58, s58, s59
    v_add_u32 v228, s58, v224
    v_lshlrev_b32 v226, 10, v249
    v_add_u32 v230, s58, v226
    s_lshl_b32 s57, s23, 13
    s_add_u32 s57, s57, 0x20000
    v_lshrrev_b32 v224, 5, v249
    v_lshlrev_b32 v224, 8, v224
    v_and_b32 v226, 12, v249
    v_lshl_add_u32 v224, v226, 4, v224
    v_and_b32 v226, 16, v249
    v_lshl_add_u32 v224, v226, 1, v224
    v_lshl_add_u32 v224, v225, 3, v224
    v_add_u32 v229, s57, v224
    s_mov_b32 s72, s14
    s_and_b32 s73, s15, 0xffff
    s_mov_b32 s74, 4194304
    s_mov_b32 s75, 0x20000
    s_mov_b32 s80, 0
    s_and_b32 s80, s80, 7
    s_lshl_b32 s80, s80, 13
    s_mov_b32 s81, 1
    s_and_b32 s81, s81, 7
    s_lshl_b32 s81, s81, 13
    s_mov_b32 s82, 2
    s_and_b32 s82, s82, 7
    s_lshl_b32 s82, s82, 13
    s_mov_b32 s83, 3
    s_and_b32 s83, s83, 7
    s_lshl_b32 s83, s83, 13
    s_mov_b32 s84, 4
    s_and_b32 s84, s84, 7
    s_lshl_b32 s84, s84, 13
    s_mov_b32 s85, 5
    s_and_b32 s85, s85, 7
    s_lshl_b32 s85, s85, 13
    s_mov_b32 s86, 6
    s_and_b32 s86, s86, 7
    s_lshl_b32 s86, s86, 13
    s_mov_b32 s87, 7
    s_and_b32 s87, s87, 7
    s_lshl_b32 s87, s87, 13
    s_lshl_b32 s58, s24, 9
    s_add_u32 s58, s58, 61898752
    s_add_u32 s50, s20, s58
    s_addc_u32 s51, s21, 0
    s_waitcnt vmcnt(0)
    ds_read_b64_tr_b16 v[152:153], v232 offset:24576
    ds_read_b64_tr_b16 v[154:155], v232 offset:25600
    s_waitcnt lgkmcnt(12)
    v_mfma_f32_32x32x16_bf16 v[160:175], v[128:131], v[0:3], 0
    ds_read_b64_tr_b16 v[156:157], v232 offset:28672
    ds_read_b64_tr_b16 v[158:159], v232 offset:29696
    s_waitcnt lgkmcnt(12)
    v_mfma_f32_32x32x16_bf16 v[160:175], v[132:135], v[4:7], v[160:175]
    ds_read_b64_tr_b16 v[128:129], v232 offset:32768
    ds_read_b64_tr_b16 v[130:131], v232 offset:33792
    s_waitcnt lgkmcnt(12)
    v_mfma_f32_32x32x16_bf16 v[160:175], v[136:139], v[8:11], v[160:175]
    ds_read_b64_tr_b16 v[132:133], v232 offset:36864
    ds_read_b64_tr_b16 v[134:135], v232 offset:37888
    s_waitcnt lgkmcnt(12)
    v_mfma_f32_32x32x16_bf16 v[160:175], v[140:143], v[12:15], v[160:175]
    ds_read_b64_tr_b16 v[136:137], v232 offset:40960
    ds_read_b64_tr_b16 v[138:139], v232 offset:41984
    s_waitcnt lgkmcnt(12)
    v_mfma_f32_32x32x16_bf16 v[160:175], v[144:147], v[16:19], v[160:175]
    ds_read_b64_tr_b16 v[140:141], v232 offset:45056
    ds_read_b64_tr_b16 v[142:143], v232 offset:46080
    s_waitcnt lgkmcnt(12)
    v_mfma_f32_32x32x16_bf16 v[160:175], v[148:151], v[20:23], v[160:175]
    ds_read_b64_tr_b16 v[144:145], v232 offset:49152
    ds_read_b64_tr_b16 v[146:147], v232 offset:50176
    s_waitcnt lgkmcnt(12)
    v_mfma_f32_32x32x16_bf16 v[160:175], v[152:155], v[24:27], v[160:175]
    ds_read_b64_tr_b16 v[148:149], v232 offset:53248
    ds_read_b64_tr_b16 v[150:151], v232 offset:54272
    s_waitcnt lgkmcnt(12)
    v_mfma_f32_32x32x16_bf16 v[160:175], v[156:159], v[28:31], v[160:175]
    ds_read_b64_tr_b16 v[152:153], v232 offset:57344
    ds_read_b64_tr_b16 v[154:155], v232 offset:58368
    s_waitcnt lgkmcnt(12)
    v_mfma_f32_32x32x16_bf16 v[160:175], v[128:131], v[32:35], v[160:175]
    ds_read_b64_tr_b16 v[156:157], v232 offset:61440
    ds_read_b64_tr_b16 v[158:159], v232 offset:62464
    s_waitcnt lgkmcnt(12)
    v_mfma_f32_32x32x16_bf16 v[160:175], v[132:135], v[36:39], v[160:175]
    ds_read_b64_tr_b16 v[128:129], v233 offset:0
    ds_read_b64_tr_b16 v[130:131], v233 offset:1024
    s_waitcnt lgkmcnt(12)
    v_mfma_f32_32x32x16_bf16 v[160:175], v[136:139], v[40:43], v[160:175]
    ds_read_b64_tr_b16 v[132:133], v233 offset:4096
    ds_read_b64_tr_b16 v[134:135], v233 offset:5120
    s_waitcnt lgkmcnt(12)
    v_mfma_f32_32x32x16_bf16 v[160:175], v[140:143], v[44:47], v[160:175]
    ds_read_b64_tr_b16 v[136:137], v233 offset:8192
    ds_read_b64_tr_b16 v[138:139], v233 offset:9216
    s_waitcnt lgkmcnt(12)
    v_mfma_f32_32x32x16_bf16 v[160:175], v[144:147], v[48:51], v[160:175]
    ds_read_b64_tr_b16 v[140:141], v233 offset:12288
    ds_read_b64_tr_b16 v[142:143], v233 offset:13312
    s_waitcnt lgkmcnt(12)
    v_mfma_f32_32x32x16_bf16 v[160:175], v[148:151], v[52:55], v[160:175]
    ds_read_b64_tr_b16 v[144:145], v233 offset:16384
    ds_read_b64_tr_b16 v[146:147], v233 offset:17408
    s_waitcnt lgkmcnt(12)
    v_mfma_f32_32x32x16_bf16 v[160:175], v[152:155], v[56:59], v[160:175]
    ds_read_b64_tr_b16 v[148:149], v233 offset:20480
    ds_read_b64_tr_b16 v[150:151], v233 offset:21504
    s_waitcnt lgkmcnt(12)
    v_mfma_f32_32x32x16_bf16 v[160:175], v[156:159], v[60:63], v[160:175]
    ds_read_b64_tr_b16 v[152:153], v233 offset:24576
    ds_read_b64_tr_b16 v[154:155], v233 offset:25600
    s_waitcnt lgkmcnt(12)
    v_mfma_f32_32x32x16_bf16 v[160:175], v[128:131], v[64:67], v[160:175]
    ds_read_b64_tr_b16 v[156:157], v233 offset:28672
    ds_read_b64_tr_b16 v[158:159], v233 offset:29696
    s_waitcnt lgkmcnt(12)
    v_mfma_f32_32x32x16_bf16 v[160:175], v[132:135], v[68:71], v[160:175]
    ds_read_b64_tr_b16 v[128:129], v233 offset:32768
    ds_read_b64_tr_b16 v[130:131], v233 offset:33792
    s_waitcnt lgkmcnt(12)
    v_mfma_f32_32x32x16_bf16 v[160:175], v[136:139], v[72:75], v[160:175]
    ds_read_b64_tr_b16 v[132:133], v233 offset:36864
    ds_read_b64_tr_b16 v[134:135], v233 offset:37888
    s_waitcnt lgkmcnt(12)
    v_mfma_f32_32x32x16_bf16 v[160:175], v[140:143], v[76:79], v[160:175]
    ds_read_b64_tr_b16 v[136:137], v233 offset:40960
    ds_read_b64_tr_b16 v[138:139], v233 offset:41984
    s_waitcnt lgkmcnt(12)
    v_mfma_f32_32x32x16_bf16 v[160:175], v[144:147], v[80:83], v[160:175]
    ds_read_b64_tr_b16 v[140:141], v233 offset:45056
    ds_read_b64_tr_b16 v[142:143], v233 offset:46080
    s_waitcnt lgkmcnt(12)
    v_mfma_f32_32x32x16_bf16 v[160:175], v[148:151], v[84:87], v[160:175]
    ds_read_b64_tr_b16 v[144:145], v233 offset:49152
    ds_read_b64_tr_b16 v[146:147], v233 offset:50176
    s_waitcnt lgkmcnt(12)
    v_mfma_f32_32x32x16_bf16 v[160:175], v[152:155], v[88:91], v[160:175]
    ds_read_b64_tr_b16 v[148:149], v233 offset:53248
    ds_read_b64_tr_b16 v[150:151], v233 offset:54272
    s_waitcnt lgkmcnt(12)
    v_mfma_f32_32x32x16_bf16 v[160:175], v[156:159], v[92:95], v[160:175]
    ds_read_b64_tr_b16 v[152:153], v233 offset:57344
    ds_read_b64_tr_b16 v[154:155], v233 offset:58368
    s_waitcnt lgkmcnt(12)
    v_mfma_f32_32x32x16_bf16 v[160:175], v[128:131], v[96:99], v[160:175]
    ds_read_b64_tr_b16 v[156:157], v233 offset:61440
    ds_read_b64_tr_b16 v[158:159], v233 offset:62464
    s_waitcnt lgkmcnt(12)
    v_mfma_f32_32x32x16_bf16 v[160:175], v[132:135], v[100:103], v[160:175]
    ds_read_b64_tr_b16 v[128:129], v234 offset:0
    ds_read_b64_tr_b16 v[130:131], v234 offset:1024
    s_waitcnt lgkmcnt(12)
    v_mfma_f32_32x32x16_bf16 v[160:175], v[136:139], v[104:107], v[160:175]
    ds_read_b64_tr_b16 v[132:133], v234 offset:4096
    ds_read_b64_tr_b16 v[134:135], v234 offset:5120
    s_waitcnt lgkmcnt(12)
    v_mfma_f32_32x32x16_bf16 v[160:175], v[140:143], v[108:111], v[160:175]
    ds_read_b64_tr_b16 v[136:137], v234 offset:8192
    ds_read_b64_tr_b16 v[138:139], v234 offset:9216
    s_waitcnt lgkmcnt(12)
    v_mfma_f32_32x32x16_bf16 v[160:175], v[144:147], v[112:115], v[160:175]
    ds_read_b64_tr_b16 v[140:141], v234 offset:12288
    ds_read_b64_tr_b16 v[142:143], v234 offset:13312
    s_waitcnt lgkmcnt(12)
    v_mfma_f32_32x32x16_bf16 v[160:175], v[148:151], v[116:119], v[160:175]
    ds_read_b64_tr_b16 v[144:145], v234 offset:16384
    ds_read_b64_tr_b16 v[146:147], v234 offset:17408
    s_waitcnt lgkmcnt(12)
    v_mfma_f32_32x32x16_bf16 v[160:175], v[152:155], v[120:123], v[160:175]
    ds_read_b64_tr_b16 v[148:149], v234 offset:20480
    ds_read_b64_tr_b16 v[150:151], v234 offset:21504
    s_waitcnt lgkmcnt(12)
    v_mfma_f32_32x32x16_bf16 v[160:175], v[156:159], v[124:127], v[160:175]
    ds_read_b64_tr_b16 v[152:153], v234 offset:24576
    ds_read_b64_tr_b16 v[154:155], v234 offset:25600
    s_waitcnt lgkmcnt(12)
    v_mfma_f32_32x32x16_bf16 v[176:191], v[128:131], v[0:3], 0
    ds_read_b64_tr_b16 v[156:157], v234 offset:28672
    ds_read_b64_tr_b16 v[158:159], v234 offset:29696
    s_waitcnt lgkmcnt(12)
    v_mfma_f32_32x32x16_bf16 v[176:191], v[132:135], v[4:7], v[176:191]
    ds_read_b64_tr_b16 v[128:129], v234 offset:32768
    ds_read_b64_tr_b16 v[130:131], v234 offset:33792
    s_waitcnt lgkmcnt(12)
    v_mfma_f32_32x32x16_bf16 v[176:191], v[136:139], v[8:11], v[176:191]
    ds_read_b64_tr_b16 v[132:133], v234 offset:36864
    ds_read_b64_tr_b16 v[134:135], v234 offset:37888
    s_waitcnt lgkmcnt(12)
    v_mfma_f32_32x32x16_bf16 v[176:191], v[140:143], v[12:15], v[176:191]
    v_cvt_pk_bf16_f32 v192, v160, v161
    v_cvt_pk_bf16_f32 v193, v162, v163
    ds_read_b64_tr_b16 v[136:137], v234 offset:40960
    ds_read_b64_tr_b16 v[138:139], v234 offset:41984
    s_waitcnt lgkmcnt(12)
    v_mfma_f32_32x32x16_bf16 v[176:191], v[144:147], v[16:19], v[176:191]
    v_cvt_pk_bf16_f32 v194, v164, v165
    v_cvt_pk_bf16_f32 v195, v166, v167
    ds_read_b64_tr_b16 v[140:141], v234 offset:45056
    ds_read_b64_tr_b16 v[142:143], v234 offset:46080
    s_waitcnt lgkmcnt(12)
    v_mfma_f32_32x32x16_bf16 v[176:191], v[148:151], v[20:23], v[176:191]
    v_cvt_pk_bf16_f32 v196, v168, v169
    v_cvt_pk_bf16_f32 v197, v170, v171
    ds_read_b64_tr_b16 v[144:145], v234 offset:49152
    ds_read_b64_tr_b16 v[146:147], v234 offset:50176
    s_waitcnt lgkmcnt(12)
    v_mfma_f32_32x32x16_bf16 v[176:191], v[152:155], v[24:27], v[176:191]
    v_cvt_pk_bf16_f32 v198, v172, v173
    v_cvt_pk_bf16_f32 v199, v174, v175
    buffer_store_dwordx4 v[192:195], v242, s[52:55], s32 offen offset:0 sc1
    ds_read_b64_tr_b16 v[148:149], v234 offset:53248
    ds_read_b64_tr_b16 v[150:151], v234 offset:54272
    s_waitcnt lgkmcnt(12)
    v_mfma_f32_32x32x16_bf16 v[176:191], v[156:159], v[28:31], v[176:191]
    ds_read_b64_tr_b16 v[152:153], v234 offset:57344
    ds_read_b64_tr_b16 v[154:155], v234 offset:58368
    s_waitcnt lgkmcnt(12)
    v_mfma_f32_32x32x16_bf16 v[176:191], v[128:131], v[32:35], v[176:191]
    ds_read_b64_tr_b16 v[156:157], v234 offset:61440
    ds_read_b64_tr_b16 v[158:159], v234 offset:62464
    s_waitcnt lgkmcnt(12)
    v_mfma_f32_32x32x16_bf16 v[176:191], v[132:135], v[36:39], v[176:191]
    buffer_store_dwordx4 v[196:199], v242, s[52:55], s32 offen offset:512 sc1
    ds_read_b64_tr_b16 v[128:129], v235 offset:0
    ds_read_b64_tr_b16 v[130:131], v235 offset:1024
    s_waitcnt lgkmcnt(12)
    v_mfma_f32_32x32x16_bf16 v[176:191], v[136:139], v[40:43], v[176:191]
    ds_read_b64_tr_b16 v[132:133], v235 offset:4096
    ds_read_b64_tr_b16 v[134:135], v235 offset:5120
    s_waitcnt lgkmcnt(12)
    v_mfma_f32_32x32x16_bf16 v[176:191], v[140:143], v[44:47], v[176:191]
    ds_read_b64_tr_b16 v[136:137], v235 offset:8192
    ds_read_b64_tr_b16 v[138:139], v235 offset:9216
    s_waitcnt lgkmcnt(12)
    v_mfma_f32_32x32x16_bf16 v[176:191], v[144:147], v[48:51], v[176:191]
    ds_read_b64_tr_b16 v[140:141], v235 offset:12288
    ds_read_b64_tr_b16 v[142:143], v235 offset:13312
    s_waitcnt lgkmcnt(12)
    v_mfma_f32_32x32x16_bf16 v[176:191], v[148:151], v[52:55], v[176:191]
    ds_read_b64_tr_b16 v[144:145], v235 offset:16384
    ds_read_b64_tr_b16 v[146:147], v235 offset:17408
    s_waitcnt lgkmcnt(12)
    v_mfma_f32_32x32x16_bf16 v[176:191], v[152:155], v[56:59], v[176:191]
    ds_read_b64_tr_b16 v[148:149], v235 offset:20480
    ds_read_b64_tr_b16 v[150:151], v235 offset:21504
    s_waitcnt lgkmcnt(12)
    v_mfma_f32_32x32x16_bf16 v[176:191], v[156:159], v[60:63], v[176:191]
    ds_read_b64_tr_b16 v[152:153], v235 offset:24576
    ds_read_b64_tr_b16 v[154:155], v235 offset:25600
    s_waitcnt lgkmcnt(12)
    v_mfma_f32_32x32x16_bf16 v[176:191], v[128:131], v[64:67], v[176:191]
    ds_read_b64_tr_b16 v[156:157], v235 offset:28672
    ds_read_b64_tr_b16 v[158:159], v235 offset:29696
    s_waitcnt lgkmcnt(12)
    v_mfma_f32_32x32x16_bf16 v[176:191], v[132:135], v[68:71], v[176:191]
    ds_read_b64_tr_b16 v[128:129], v235 offset:32768
    ds_read_b64_tr_b16 v[130:131], v235 offset:33792
    s_waitcnt lgkmcnt(12)
    v_mfma_f32_32x32x16_bf16 v[176:191], v[136:139], v[72:75], v[176:191]
    ds_read_b64_tr_b16 v[132:133], v235 offset:36864
    ds_read_b64_tr_b16 v[134:135], v235 offset:37888
    s_waitcnt lgkmcnt(12)
    v_mfma_f32_32x32x16_bf16 v[176:191], v[140:143], v[76:79], v[176:191]
    ds_read_b64_tr_b16 v[136:137], v235 offset:40960
    ds_read_b64_tr_b16 v[138:139], v235 offset:41984
    s_waitcnt lgkmcnt(12)
    v_mfma_f32_32x32x16_bf16 v[176:191], v[144:147], v[80:83], v[176:191]
    ds_read_b64_tr_b16 v[140:141], v235 offset:45056
    ds_read_b64_tr_b16 v[142:143], v235 offset:46080
    s_waitcnt lgkmcnt(12)
    v_mfma_f32_32x32x16_bf16 v[176:191], v[148:151], v[84:87], v[176:191]
    ds_read_b64_tr_b16 v[144:145], v235 offset:49152
    ds_read_b64_tr_b16 v[146:147], v235 offset:50176
    s_waitcnt lgkmcnt(12)
    v_mfma_f32_32x32x16_bf16 v[176:191], v[152:155], v[88:91], v[176:191]
    ds_read_b64_tr_b16 v[148:149], v235 offset:53248
    ds_read_b64_tr_b16 v[150:151], v235 offset:54272
    s_waitcnt lgkmcnt(12)
    v_mfma_f32_32x32x16_bf16 v[176:191], v[156:159], v[92:95], v[176:191]
    ds_read_b64_tr_b16 v[152:153], v235 offset:57344
    ds_read_b64_tr_b16 v[154:155], v235 offset:58368
    s_waitcnt lgkmcnt(12)
    v_mfma_f32_32x32x16_bf16 v[176:191], v[128:131], v[96:99], v[176:191]
    ds_read_b64_tr_b16 v[156:157], v235 offset:61440
    ds_read_b64_tr_b16 v[158:159], v235 offset:62464
    s_waitcnt lgkmcnt(12)
    v_mfma_f32_32x32x16_bf16 v[176:191], v[132:135], v[100:103], v[176:191]
    ds_read_b64_tr_b16 v[128:129], v236 offset:0
    ds_read_b64_tr_b16 v[130:131], v236 offset:1024
    s_waitcnt lgkmcnt(12)
    v_mfma_f32_32x32x16_bf16 v[176:191], v[136:139], v[104:107], v[176:191]
    ds_read_b64_tr_b16 v[132:133], v236 offset:4096
    ds_read_b64_tr_b16 v[134:135], v236 offset:5120
    s_waitcnt lgkmcnt(12)
    v_mfma_f32_32x32x16_bf16 v[176:191], v[140:143], v[108:111], v[176:191]
    ds_read_b64_tr_b16 v[136:137], v236 offset:8192
    ds_read_b64_tr_b16 v[138:139], v236 offset:9216
    s_waitcnt lgkmcnt(12)
    v_mfma_f32_32x32x16_bf16 v[176:191], v[144:147], v[112:115], v[176:191]
    ds_read_b64_tr_b16 v[140:141], v236 offset:12288
    ds_read_b64_tr_b16 v[142:143], v236 offset:13312
    s_waitcnt lgkmcnt(12)
    v_mfma_f32_32x32x16_bf16 v[176:191], v[148:151], v[116:119], v[176:191]
    ds_read_b64_tr_b16 v[144:145], v236 offset:16384
    ds_read_b64_tr_b16 v[146:147], v236 offset:17408
    s_waitcnt lgkmcnt(12)
    v_mfma_f32_32x32x16_bf16 v[176:191], v[152:155], v[120:123], v[176:191]
    ds_read_b64_tr_b16 v[148:149], v236 offset:20480
    ds_read_b64_tr_b16 v[150:151], v236 offset:21504
    s_waitcnt lgkmcnt(12)
    v_mfma_f32_32x32x16_bf16 v[176:191], v[156:159], v[124:127], v[176:191]
    v_mbcnt_lo_u32_b32 v252, -1, 0
    v_and_b32 v252, 15, v252
    v_lshlrev_b32 v252, 4, v252
    s_lshl_b32 s59, s3, 1
    s_add_u32 s59, s59, 13
L_k_wa:
    global_load_dword v253, v252, s[18:19] sc1
    s_waitcnt vmcnt(0)
L_k_w0:
    v_readlane_b32 s58, v253, s59
    s_cmp_ge_u32 s58, 256
    s_cbranch_scc1 L_k_wb
    s_sleep 16
    s_sub_u32 s27, s27, 1
    s_cbranch_scc0 L_k_wa
    s_branch L_end
L_k_wb:
    s_cmp_eq_u32 s3, 1
    s_cbranch_scc1 L_k_wc
    v_cmp_ne_u32 vcc, 32, v253
    s_and_b32 s58, vcc_lo, 0x5555
    s_cbranch_scc0 L_k_wc
    global_load_dword v253, v252, s[18:19] sc1
    s_waitcnt vmcnt(0)
    v_cmp_ne_u32 vcc, 32, v253
    s_and_b32 s58, vcc_lo, 0x5555
    s_cbranch_scc1 L_safe
L_k_wc:
    ds_read_b64_tr_b16 v[152:153], v236 offset:24576
    ds_read_b64_tr_b16 v[154:155], v236 offset:25600
    s_waitcnt lgkmcnt(12)
    v_mfma_f32_32x32x16_bf16 v[160:175], v[128:131], v[0:3], 0
    buffer_load_dwordx4 a[0:3], v240, s[28:31], s32 offen offset:0 sc1
    ds_read_b64_tr_b16 v[156:157], v236 offset:28672
    ds_read_b64_tr_b16 v[158:159], v236 offset:29696
    s_waitcnt lgkmcnt(12)
    v_mfma_f32_32x32x16_bf16 v[160:175], v[132:135], v[4:7], v[160:175]
    buffer_load_dwordx4 a[4:7], v240, s[28:31], s32 offen offset:1024 sc1
    ds_read_b64_tr_b16 v[128:129], v236 offset:32768
    ds_read_b64_tr_b16 v[130:131], v236 offset:33792
    s_waitcnt lgkmcnt(12)
    v_mfma_f32_32x32x16_bf16 v[160:175], v[136:139], v[8:11], v[160:175]
    buffer_load_dwordx4 a[8:11], v240, s[28:31], s32 offen offset:2048 sc1
    ds_read_b64_tr_b16 v[132:133], v236 offset:36864
    ds_read_b64_tr_b16 v[134:135], v236 offset:37888
    s_waitcnt lgkmcnt(12)
    v_mfma_f32_32x32x16_bf16 v[160:175], v[140:143], v[12:15], v[160:175]
    buffer_load_dwordx4 a[12:15], v240, s[28:31], s32 offen offset:3072 sc1
    v_cvt_pk_bf16_f32 v200, v176, v177
    v_cvt_pk_bf16_f32 v201, v178, v179
    ds_read_b64_tr_b16 v[136:137], v236 offset:40960
    ds_read_b64_tr_b16 v[138:139], v236 offset:41984
    s_waitcnt lgkmcnt(12)
    v_mfma_f32_32x32x16_bf16 v[160:175], v[144:147], v[16:19], v[160:175]
    buffer_load_dwordx4 a[16:19], v240, s[28:31], s33 offen offset:0 sc1
    v_cvt_pk_bf16_f32 v202, v180, v181
    v_cvt_pk_bf16_f32 v203, v182, v183
    ds_read_b64_tr_b16 v[140:141], v236 offset:45056
    ds_read_b64_tr_b16 v[142:143], v236 offset:46080
    s_waitcnt lgkmcnt(12)
    v_mfma_f32_32x32x16_bf16 v[160:175], v[148:151], v[20:23], v[160:175]
    buffer_load_dwordx4 a[20:23], v240, s[28:31], s33 offen offset:1024 sc1
    v_cvt_pk_bf16_f32 v204, v184, v185
    v_cvt_pk_bf16_f32 v205, v186, v187
    ds_read_b64_tr_b16 v[144:145], v236 offset:49152
    ds_read_b64_tr_b16 v[146:147], v236 offset:50176
    s_waitcnt lgkmcnt(12)
    v_mfma_f32_32x32x16_bf16 v[160:175], v[152:155], v[24:27], v[160:175]
    buffer_load_dwordx4 a[24:27], v240, s[28:31], s33 offen offset:2048 sc1
    v_cvt_pk_bf16_f32 v206, v188, v189
    v_cvt_pk_bf16_f32 v207, v190, v191
    buffer_store_dwordx4 v[200:203], v242, s[52:55], s33 offen offset:0 sc1
    ds_read_b64_tr_b16 v[148:149], v236 offset:53248
    ds_read_b64_tr_b16 v[150:151], v236 offset:54272
    s_waitcnt lgkmcnt(12)
    v_mfma_f32_32x32x16_bf16 v[160:175], v[156:159], v[28:31], v[160:175]
    buffer_load_dwordx4 a[28:31], v240, s[28:31], s33 offen offset:3072 sc1
    ds_read_b64_tr_b16 v[152:153], v236 offset:57344
    ds_read_b64_tr_b16 v[154:155], v236 offset:58368
    s_waitcnt lgkmcnt(12)
    v_mfma_f32_32x32x16_bf16 v[160:175], v[128:131], v[32:35], v[160:175]
    buffer_load_dwordx4 a[32:35], v240, s[28:31], s34 offen offset:0 sc1
    ds_read_b64_tr_b16 v[156:157], v236 offset:61440
    ds_read_b64_tr_b16 v[158:159], v236 offset:62464
    s_waitcnt lgkmcnt(12)
    v_mfma_f32_32x32x16_bf16 v[160:175], v[132:135], v[36:39], v[160:175]
    buffer_load_dwordx4 a[36:39], v240, s[28:31], s34 offen offset:1024 sc1
    buffer_store_dwordx4 v[204:207], v242, s[52:55], s33 offen offset:512 sc1
    ds_read_b64_tr_b16 v[128:129], v237 offset:0
    ds_read_b64_tr_b16 v[130:131], v237 offset:1024
    s_waitcnt lgkmcnt(12)
    v_mfma_f32_32x32x16_bf16 v[160:175], v[136:139], v[40:43], v[160:175]
    buffer_load_dwordx4 a[40:43], v240, s[28:31], s34 offen offset:2048 sc1
    ds_read_b64_tr_b16 v[132:133], v237 offset:4096
    ds_read_b64_tr_b16 v[134:135], v237 offset:5120
    s_waitcnt lgkmcnt(12)
    v_mfma_f32_32x32x16_bf16 v[160:175], v[140:143], v[44:47], v[160:175]
    buffer_load_dwordx4 a[44:47], v240, s[28:31], s34 offen offset:3072 sc1
    ds_read_b64_tr_b16 v[136:137], v237 offset:8192
    ds_read_b64_tr_b16 v[138:139], v237 offset:9216
    s_waitcnt lgkmcnt(12)
    v_mfma_f32_32x32x16_bf16 v[160:175], v[144:147], v[48:51], v[160:175]
    buffer_load_dwordx4 a[48:51], v240, s[28:31], s35 offen offset:0 sc1
    ds_read_b64_tr_b16 v[140:141], v237 offset:12288
    ds_read_b64_tr_b16 v[142:143], v237 offset:13312
    s_waitcnt lgkmcnt(12)
    v_mfma_f32_32x32x16_bf16 v[160:175], v[148:151], v[52:55], v[160:175]
    buffer_load_dwordx4 a[52:55], v240, s[28:31], s35 offen offset:1024 sc1
    ds_read_b64_tr_b16 v[144:145], v237 offset:16384
    ds_read_b64_tr_b16 v[146:147], v237 offset:17408
    s_waitcnt lgkmcnt(12)
    v_mfma_f32_32x32x16_bf16 v[160:175], v[152:155], v[56:59], v[160:175]
    buffer_load_dwordx4 a[56:59], v240, s[28:31], s35 offen offset:2048 sc1
    ds_read_b64_tr_b16 v[148:149], v237 offset:20480
    ds_read_b64_tr_b16 v[150:151], v237 offset:21504
    s_waitcnt lgkmcnt(12)
    v_mfma_f32_32x32x16_bf16 v[160:175], v[156:159], v[60:63], v[160:175]
    buffer_load_dwordx4 a[60:63], v240, s[28:31], s35 offen offset:3072 sc1
    ds_read_b64_tr_b16 v[152:153], v237 offset:24576
    ds_read_b64_tr_b16 v[154:155], v237 offset:25600
    s_waitcnt lgkmcnt(12)
    v_mfma_f32_32x32x16_bf16 v[160:175], v[128:131], v[64:67], v[160:175]
    buffer_load_dwordx4 a[64:67], v240, s[28:31], s36 offen offset:0 sc1
    ds_read_b64_tr_b16 v[156:157], v237 offset:28672
    ds_read_b64_tr_b16 v[158:159], v237 offset:29696
    s_waitcnt lgkmcnt(12)
    v_mfma_f32_32x32x16_bf16 v[160:175], v[132:135], v[68:71], v[160:175]
    buffer_load_dwordx4 a[68:71], v240, s[28:31], s36 offen offset:1024 sc1
    ds_read_b64_tr_b16 v[128:129], v237 offset:32768
    ds_read_b64_tr_b16 v[130:131], v237 offset:33792
    s_waitcnt lgkmcnt(12)
    v_mfma_f32_32x32x16_bf16 v[160:175], v[136:139], v[72:75], v[160:175]
    buffer_load_dwordx4 a[72:75], v240, s[28:31], s36 offen offset:2048 sc1
    ds_read_b64_tr_b16 v[132:133], v237 offset:36864
    ds_read_b64_tr_b16 v[134:135], v237 offset:37888
    s_waitcnt lgkmcnt(12)
    v_mfma_f32_32x32x16_bf16 v[160:175], v[140:143], v[76:79], v[160:175]
    buffer_load_dwordx4 a[76:79], v240, s[28:31], s36 offen offset:3072 sc1
    ds_read_b64_tr_b16 v[136:137], v237 offset:40960
    ds_read_b64_tr_b16 v[138:139], v237 offset:41984
    s_waitcnt lgkmcnt(12)
    v_mfma_f32_32x32x16_bf16 v[160:175], v[144:147], v[80:83], v[160:175]
    buffer_load_dwordx4 a[80:83], v240, s[28:31], s37 offen offset:0 sc1
    ds_read_b64_tr_b16 v[140:141], v237 offset:45056
    ds_read_b64_tr_b16 v[142:143], v237 offset:46080
    s_waitcnt lgkmcnt(12)
    v_mfma_f32_32x32x16_bf16 v[160:175], v[148:151], v[84:87], v[160:175]
    buffer_load_dwordx4 a[84:87], v240, s[28:31], s37 offen offset:1024 sc1
    ds_read_b64_tr_b16 v[144:145], v237 offset:49152
    ds_read_b64_tr_b16 v[146:147], v237 offset:50176
    s_waitcnt lgkmcnt(12)
    v_mfma_f32_32x32x16_bf16 v[160:175], v[152:155], v[88:91], v[160:175]
    buffer_load_dwordx4 a[88:91], v240, s[28:31], s37 offen offset:2048 sc1
    ds_read_b64_tr_b16 v[148:149], v237 offset:53248
    ds_read_b64_tr_b16 v[150:151], v237 offset:54272
    s_waitcnt lgkmcnt(12)
    v_mfma_f32_32x32x16_bf16 v[160:175], v[156:159], v[92:95], v[160:175]
    buffer_load_dwordx4 a[92:95], v240, s[28:31], s37 offen offset:3072 sc1
    ds_read_b64_tr_b16 v[152:153], v237 offset:57344
    ds_read_b64_tr_b16 v[154:155], v237 offset:58368
    s_waitcnt lgkmcnt(12)
    v_mfma_f32_32x32x16_bf16 v[160:175], v[128:131], v[96:99], v[160:175]
    buffer_load_dwordx4 a[96:99], v240, s[28:31], s38 offen offset:0 sc1
    ds_read_b64_tr_b16 v[156:157], v237 offset:61440
    ds_read_b64_tr_b16 v[158:159], v237 offset:62464
    s_waitcnt lgkmcnt(12)
    v_mfma_f32_32x32x16_bf16 v[160:175], v[132:135], v[100:103], v[160:175]
    buffer_load_dwordx4 a[100:103], v240, s[28:31], s38 offen offset:1024 sc1
    ds_read_b64_tr_b16 v[128:129], v238 offset:0
    ds_read_b64_tr_b16 v[130:131], v238 offset:1024
    s_waitcnt lgkmcnt(12)
    v_mfma_f32_32x32x16_bf16 v[160:175], v[136:139], v[104:107], v[160:175]
    buffer_load_dwordx4 a[104:107], v240, s[28:31], s38 offen offset:2048 sc1
    ds_read_b64_tr_b16 v[132:133], v238 offset:4096
    ds_read_b64_tr_b16 v[134:135], v238 offset:5120
    s_waitcnt lgkmcnt(12)
    v_mfma_f32_32x32x16_bf16 v[160:175], v[140:143], v[108:111], v[160:175]
    buffer_load_dwordx4 a[108:111], v240, s[28:31], s38 offen offset:3072 sc1
    ds_read_b64_tr_b16 v[136:137], v238 offset:8192
    ds_read_b64_tr_b16 v[138:139], v238 offset:9216
    s_waitcnt lgkmcnt(12)
    v_mfma_f32_32x32x16_bf16 v[160:175], v[144:147], v[112:115], v[160:175]
    buffer_load_dwordx4 a[112:115], v240, s[28:31], s39 offen offset:0 sc1
    ds_read_b64_tr_b16 v[140:141], v238 offset:12288
    ds_read_b64_tr_b16 v[142:143], v238 offset:13312
    s_waitcnt lgkmcnt(12)
    v_mfma_f32_32x32x16_bf16 v[160:175], v[148:151], v[116:119], v[160:175]
    buffer_load_dwordx4 a[116:119], v240, s[28:31], s39 offen offset:1024 sc1
    ds_read_b64_tr_b16 v[144:145], v238 offset:16384
    ds_read_b64_tr_b16 v[146:147], v238 offset:17408
    s_waitcnt lgkmcnt(12)
    v_mfma_f32_32x32x16_bf16 v[160:175], v[152:155], v[120:123], v[160:175]
    buffer_load_dwordx4 a[120:123], v240, s[28:31], s39 offen offset:2048 sc1
    ds_read_b64_tr_b16 v[148:149], v238 offset:20480
    ds_read_b64_tr_b16 v[150:151], v238 offset:21504
    s_waitcnt lgkmcnt(12)
    v_mfma_f32_32x32x16_bf16 v[160:175], v[156:159], v[124:127], v[160:175]
    buffer_load_dwordx4 a[124:127], v240, s[28:31], s39 offen offset:3072 sc1
    ds_read_b64_tr_b16 v[152:153], v238 offset:24576
    ds_read_b64_tr_b16 v[154:155], v238 offset:25600
    s_waitcnt lgkmcnt(12)
    v_mfma_f32_32x32x16_bf16 v[176:191], v[128:131], v[0:3], 0
    ds_read_b64_tr_b16 v[156:157], v238 offset:28672
    ds_read_b64_tr_b16 v[158:159], v238 offset:29696
    s_waitcnt lgkmcnt(12)
    v_mfma_f32_32x32x16_bf16 v[176:191], v[132:135], v[4:7], v[176:191]
    ds_read_b64_tr_b16 v[128:129], v238 offset:32768
    ds_read_b64_tr_b16 v[130:131], v238 offset:33792
    s_waitcnt lgkmcnt(12)
    v_mfma_f32_32x32x16_bf16 v[176:191], v[136:139], v[8:11], v[176:191]
    ds_read_b64_tr_b16 v[132:133], v238 offset:36864
    ds_read_b64_tr_b16 v[134:135], v238 offset:37888
    s_waitcnt lgkmcnt(12)
    v_mfma_f32_32x32x16_bf16 v[176:191], v[140:143], v[12:15], v[176:191]
    v_cvt_pk_bf16_f32 v192, v160, v161
    v_cvt_pk_bf16_f32 v193, v162, v163
    ds_read_b64_tr_b16 v[136:137], v238 offset:40960
    ds_read_b64_tr_b16 v[138:139], v238 offset:41984
    s_waitcnt lgkmcnt(12)
    v_mfma_f32_32x32x16_bf16 v[176:191], v[144:147], v[16:19], v[176:191]
    v_cvt_pk_bf16_f32 v194, v164, v165
    v_cvt_pk_bf16_f32 v195, v166, v167
    ds_read_b64_tr_b16 v[140:141], v238 offset:45056
    ds_read_b64_tr_b16 v[142:143], v238 offset:46080
    s_waitcnt lgkmcnt(12)
    v_mfma_f32_32x32x16_bf16 v[176:191], v[148:151], v[20:23], v[176:191]
    v_cvt_pk_bf16_f32 v196, v168, v169
    v_cvt_pk_bf16_f32 v197, v170, v171
    ds_read_b64_tr_b16 v[144:145], v238 offset:49152
    ds_read_b64_tr_b16 v[146:147], v238 offset:50176
    s_waitcnt lgkmcnt(12)
    v_mfma_f32_32x32x16_bf16 v[176:191], v[152:155], v[24:27], v[176:191]
    v_cvt_pk_bf16_f32 v198, v172, v173
    v_cvt_pk_bf16_f32 v199, v174, v175
    buffer_store_dwordx4 v[192:195], v242, s[52:55], s34 offen offset:0 sc1
    ds_read_b64_tr_b16 v[148:149], v238 offset:53248
    ds_read_b64_tr_b16 v[150:151], v238 offset:54272
    s_waitcnt lgkmcnt(12)
    v_mfma_f32_32x32x16_bf16 v[176:191], v[156:159], v[28:31], v[176:191]
    ds_read_b64_tr_b16 v[152:153], v238 offset:57344
    ds_read_b64_tr_b16 v[154:155], v238 offset:58368
    s_waitcnt lgkmcnt(12)
    v_mfma_f32_32x32x16_bf16 v[176:191], v[128:131], v[32:35], v[176:191]
    ds_read_b64_tr_b16 v[156:157], v238 offset:61440
    ds_read_b64_tr_b16 v[158:159], v238 offset:62464
    s_waitcnt lgkmcnt(12)
    v_mfma_f32_32x32x16_bf16 v[176:191], v[132:135], v[36:39], v[176:191]
    buffer_store_dwordx4 v[196:199], v242, s[52:55], s34 offen offset:512 sc1
    ds_read_b64_tr_b16 v[128:129], v239 offset:0
    ds_read_b64_tr_b16 v[130:131], v239 offset:1024
    s_waitcnt lgkmcnt(12)
    v_mfma_f32_32x32x16_bf16 v[176:191], v[136:139], v[40:43], v[176:191]
    ds_read_b64_tr_b16 v[132:133], v239 offset:4096
    ds_read_b64_tr_b16 v[134:135], v239 offset:5120
    s_waitcnt lgkmcnt(12)
    v_mfma_f32_32x32x16_bf16 v[176:191], v[140:143], v[44:47], v[176:191]
    ds_read_b64_tr_b16 v[136:137], v239 offset:8192
    ds_read_b64_tr_b16 v[138:139], v239 offset:9216
    s_waitcnt lgkmcnt(12)
    v_mfma_f32_32x32x16_bf16 v[176:191], v[144:147], v[48:51], v[176:191]
    ds_read_b64_tr_b16 v[140:141], v239 offset:12288
    ds_read_b64_tr_b16 v[142:143], v239 offset:13312
    s_waitcnt lgkmcnt(12)
    v_mfma_f32_32x32x16_bf16 v[176:191], v[148:151], v[52:55], v[176:191]
    ds_read_b64_tr_b16 v[144:145], v239 offset:16384
    ds_read_b64_tr_b16 v[146:147], v239 offset:17408
    s_waitcnt lgkmcnt(12)
    v_mfma_f32_32x32x16_bf16 v[176:191], v[152:155], v[56:59], v[176:191]
    ds_read_b64_tr_b16 v[148:149], v239 offset:20480
    ds_read_b64_tr_b16 v[150:151], v239 offset:21504
    s_waitcnt lgkmcnt(12)
    v_mfma_f32_32x32x16_bf16 v[176:191], v[156:159], v[60:63], v[176:191]
    ds_read_b64_tr_b16 v[152:153], v239 offset:24576
    ds_read_b64_tr_b16 v[154:155], v239 offset:25600
    s_waitcnt lgkmcnt(12)
    v_mfma_f32_32x32x16_bf16 v[176:191], v[128:131], v[64:67], v[176:191]
    ds_read_b64_tr_b16 v[156:157], v239 offset:28672
    ds_read_b64_tr_b16 v[158:159], v239 offset:29696
    s_waitcnt lgkmcnt(12)
    v_mfma_f32_32x32x16_bf16 v[176:191], v[132:135], v[68:71], v[176:191]
    ds_read_b64_tr_b16 v[128:129], v239 offset:32768
    ds_read_b64_tr_b16 v[130:131], v239 offset:33792
    s_waitcnt lgkmcnt(12)
    v_mfma_f32_32x32x16_bf16 v[176:191], v[136:139], v[72:75], v[176:191]
    ds_read_b64_tr_b16 v[132:133], v239 offset:36864
    ds_read_b64_tr_b16 v[134:135], v239 offset:37888
    s_waitcnt lgkmcnt(12)
    v_mfma_f32_32x32x16_bf16 v[176:191], v[140:143], v[76:79], v[176:191]
    ds_read_b64_tr_b16 v[136:137], v239 offset:40960
    ds_read_b64_tr_b16 v[138:139], v239 offset:41984
    s_waitcnt lgkmcnt(12)
    v_mfma_f32_32x32x16_bf16 v[176:191], v[144:147], v[80:83], v[176:191]
    ds_read_b64_tr_b16 v[140:141], v239 offset:45056
    ds_read_b64_tr_b16 v[142:143], v239 offset:46080
    s_waitcnt lgkmcnt(12)
    v_mfma_f32_32x32x16_bf16 v[176:191], v[148:151], v[84:87], v[176:191]
    ds_read_b64_tr_b16 v[144:145], v239 offset:49152
    ds_read_b64_tr_b16 v[146:147], v239 offset:50176
    s_waitcnt lgkmcnt(12)
    v_mfma_f32_32x32x16_bf16 v[176:191], v[152:155], v[88:91], v[176:191]
    ds_read_b64_tr_b16 v[148:149], v239 offset:53248
    ds_read_b64_tr_b16 v[150:151], v239 offset:54272
    s_waitcnt lgkmcnt(12)
    v_mfma_f32_32x32x16_bf16 v[176:191], v[156:159], v[92:95], v[176:191]
    ds_read_b64_tr_b16 v[152:153], v239 offset:57344
    ds_read_b64_tr_b16 v[154:155], v239 offset:58368
    s_waitcnt lgkmcnt(12)
    v_mfma_f32_32x32x16_bf16 v[176:191], v[128:131], v[96:99], v[176:191]
    ds_read_b64_tr_b16 v[156:157], v239 offset:61440
    ds_read_b64_tr_b16 v[158:159], v239 offset:62464
    s_waitcnt lgkmcnt(12)
    v_mfma_f32_32x32x16_bf16 v[176:191], v[132:135], v[100:103], v[176:191]
    ds_read_b64_tr_b16 v[128:129], v232 offset:0
    ds_read_b64_tr_b16 v[130:131], v232 offset:1024
    s_waitcnt lgkmcnt(12)
    v_mfma_f32_32x32x16_bf16 v[176:191], v[136:139], v[104:107], v[176:191]
    ds_read_b64_tr_b16 v[132:133], v232 offset:4096
    ds_read_b64_tr_b16 v[134:135], v232 offset:5120
    s_waitcnt lgkmcnt(12)
    v_mfma_f32_32x32x16_bf16 v[176:191], v[140:143], v[108:111], v[176:191]
    ds_read_b64_tr_b16 v[136:137], v232 offset:8192
    ds_read_b64_tr_b16 v[138:139], v232 offset:9216
    s_waitcnt lgkmcnt(12)
    v_mfma_f32_32x32x16_bf16 v[176:191], v[144:147], v[112:115], v[176:191]
    ds_read_b64_tr_b16 v[140:141], v232 offset:12288
    ds_read_b64_tr_b16 v[142:143], v232 offset:13312
    s_waitcnt lgkmcnt(12)
    v_mfma_f32_32x32x16_bf16 v[176:191], v[148:151], v[116:119], v[176:191]
    ds_read_b64_tr_b16 v[144:145], v232 offset:16384
    ds_read_b64_tr_b16 v[146:147], v232 offset:17408
    s_waitcnt lgkmcnt(12)
    v_mfma_f32_32x32x16_bf16 v[176:191], v[152:155], v[120:123], v[176:191]
    ds_read_b64_tr_b16 v[148:149], v232 offset:20480
    ds_read_b64_tr_b16 v[150:151], v232 offset:21504
    s_waitcnt lgkmcnt(12)
    v_mfma_f32_32x32x16_bf16 v[176:191], v[156:159], v[124:127], v[176:191]
    s_add_u32 s28, s28, 131072
    s_addc_u32 s29, s29, 0
    s_add_u32 s26, s26, 1
L_k_loop:
    s_waitcnt vmcnt(2)
    ds_read_b64_tr_b16 v[152:153], v232 offset:24576
    ds_read_b64_tr_b16 v[154:155], v232 offset:25600
    s_waitcnt lgkmcnt(12)
    v_mfma_f32_32x32x16_bf16 v[160:175], v[128:131], a[0:3], 0
    ds_read_b64_tr_b16 v[156:157], v232 offset:28672
    ds_read_b64_tr_b16 v[158:159], v232 offset:29696
    s_waitcnt lgkmcnt(12)
    v_mfma_f32_32x32x16_bf16 v[160:175], v[132:135], a[4:7], v[160:175]
    ds_read_b64_tr_b16 v[128:129], v232 offset:32768
    ds_read_b64_tr_b16 v[130:131], v232 offset:33792
    s_waitcnt lgkmcnt(12)
    v_mfma_f32_32x32x16_bf16 v[160:175], v[136:139], a[8:11], v[160:175]
    buffer_load_dwordx4 v[0:3], v240, s[28:31], s32 offen offset:0 sc1
    ds_read_b64_tr_b16 v[132:133], v232 offset:36864
    ds_read_b64_tr_b16 v[134:135], v232 offset:37888
    s_waitcnt lgkmcnt(12)
    v_mfma_f32_32x32x16_bf16 v[160:175], v[140:143], a[12:15], v[160:175]
    v_cvt_pk_bf16_f32 v200, v176, v177
    v_cvt_pk_bf16_f32 v201, v178, v179
    ds_read_b64_tr_b16 v[136:137], v232 offset:40960
    ds_read_b64_tr_b16 v[138:139], v232 offset:41984
    s_waitcnt lgkmcnt(12)
    v_mfma_f32_32x32x16_bf16 v[160:175], v[144:147], a[16:19], v[160:175]
    v_cvt_pk_bf16_f32 v202, v180, v181
    v_cvt_pk_bf16_f32 v203, v182, v183
    ds_read_b64_tr_b16 v[140:141], v232 offset:45056
    ds_read_b64_tr_b16 v[142:143], v232 offset:46080
    s_waitcnt lgkmcnt(12)
    v_mfma_f32_32x32x16_bf16 v[160:175], v[148:151], a[20:23], v[160:175]
    buffer_load_dwordx4 v[4:7], v240, s[28:31], s32 offen offset:1024 sc1
    v_cvt_pk_bf16_f32 v204, v184, v185
    v_cvt_pk_bf16_f32 v205, v186, v187
    ds_read_b64_tr_b16 v[144:145], v232 offset:49152
    ds_read_b64_tr_b16 v[146:147], v232 offset:50176
    s_waitcnt lgkmcnt(12)
    v_mfma_f32_32x32x16_bf16 v[160:175], v[152:155], a[24:27], v[160:175]
    v_cvt_pk_bf16_f32 v206, v188, v189
    v_cvt_pk_bf16_f32 v207, v190, v191
    buffer_store_dwordx4 v[200:203], v242, s[52:55], s35 offen offset:0 sc1
    ds_read_b64_tr_b16 v[148:149], v232 offset:53248
    ds_read_b64_tr_b16 v[150:151], v232 offset:54272
    s_waitcnt lgkmcnt(12)
    v_mfma_f32_32x32x16_bf16 v[160:175], v[156:159], a[28:31], v[160:175]
    ds_read_b64_tr_b16 v[152:153], v232 offset:57344
    ds_read_b64_tr_b16 v[154:155], v232 offset:58368
    s_waitcnt lgkmcnt(12)
    v_mfma_f32_32x32x16_bf16 v[160:175], v[128:131], a[32:35], v[160:175]
    buffer_load_dwordx4 v[8:11], v240, s[28:31], s32 offen offset:2048 sc1
    ds_read_b64_tr_b16 v[156:157], v232 offset:61440
    ds_read_b64_tr_b16 v[158:159], v232 offset:62464
    s_waitcnt lgkmcnt(12)
    v_mfma_f32_32x32x16_bf16 v[160:175], v[132:135], a[36:39], v[160:175]
    buffer_store_dwordx4 v[204:207], v242, s[52:55], s35 offen offset:512 sc1
    s_add_u32 s52, s52, 2097152
    s_addc_u32 s53, s53, 0
    ds_read_b64_tr_b16 v[128:129], v233 offset:0
    ds_read_b64_tr_b16 v[130:131], v233 offset:1024
    s_waitcnt lgkmcnt(12)
    v_mfma_f32_32x32x16_bf16 v[160:175], v[136:139], a[40:43], v[160:175]
    ds_read_b64_tr_b16 v[132:133], v233 offset:4096
    ds_read_b64_tr_b16 v[134:135], v233 offset:5120
    s_waitcnt lgkmcnt(12)
    v_mfma_f32_32x32x16_bf16 v[160:175], v[140:143], a[44:47], v[160:175]
    buffer_load_dwordx4 v[12:15], v240, s[28:31], s32 offen offset:3072 sc1
    ds_read_b64_tr_b16 v[136:137], v233 offset:8192
    ds_read_b64_tr_b16 v[138:139], v233 offset:9216
    s_waitcnt lgkmcnt(12)
    v_mfma_f32_32x32x16_bf16 v[160:175], v[144:147], a[48:51], v[160:175]
    ds_read_b64_tr_b16 v[140:141], v233 offset:12288
    ds_read_b64_tr_b16 v[142:143], v233 offset:13312
    s_waitcnt lgkmcnt(12)
    v_mfma_f32_32x32x16_bf16 v[160:175], v[148:151], a[52:55], v[160:175]
    ds_read_b64_tr_b16 v[144:145], v233 offset:16384
    ds_read_b64_tr_b16 v[146:147], v233 offset:17408
    s_waitcnt lgkmcnt(12)
    v_mfma_f32_32x32x16_bf16 v[160:175], v[152:155], a[56:59], v[160:175]
    buffer_load_dwordx4 v[16:19], v240, s[28:31], s33 offen offset:0 sc1
    ds_read_b64_tr_b16 v[148:149], v233 offset:20480
    ds_read_b64_tr_b16 v[150:151], v233 offset:21504
    s_waitcnt lgkmcnt(12)
    v_mfma_f32_32x32x16_bf16 v[160:175], v[156:159], a[60:63], v[160:175]
    ds_read_b64_tr_b16 v[152:153], v233 offset:24576
    ds_read_b64_tr_b16 v[154:155], v233 offset:25600
    s_waitcnt lgkmcnt(12)
    v_mfma_f32_32x32x16_bf16 v[160:175], v[128:131], a[64:67], v[160:175]
    ds_read_b64_tr_b16 v[156:157], v233 offset:28672
    ds_read_b64_tr_b16 v[158:159], v233 offset:29696
    s_waitcnt lgkmcnt(12)
    v_mfma_f32_32x32x16_bf16 v[160:175], v[132:135], a[68:71], v[160:175]
    buffer_load_dwordx4 v[20:23], v240, s[28:31], s33 offen offset:1024 sc1
    ds_read_b64_tr_b16 v[128:129], v233 offset:32768
    ds_read_b64_tr_b16 v[130:131], v233 offset:33792
    s_waitcnt lgkmcnt(12)
    v_mfma_f32_32x32x16_bf16 v[160:175], v[136:139], a[72:75], v[160:175]
    ds_read_b64_tr_b16 v[132:133], v233 offset:36864
    ds_read_b64_tr_b16 v[134:135], v233 offset:37888
    s_waitcnt lgkmcnt(12)
    v_mfma_f32_32x32x16_bf16 v[160:175], v[140:143], a[76:79], v[160:175]
    ds_read_b64_tr_b16 v[136:137], v233 offset:40960
    ds_read_b64_tr_b16 v[138:139], v233 offset:41984
    s_waitcnt lgkmcnt(12)
    v_mfma_f32_32x32x16_bf16 v[160:175], v[144:147], a[80:83], v[160:175]
    buffer_load_dwordx4 v[24:27], v240, s[28:31], s33 offen offset:2048 sc1
    ds_read_b64_tr_b16 v[140:141], v233 offset:45056
    ds_read_b64_tr_b16 v[142:143], v233 offset:46080
    s_waitcnt lgkmcnt(12)
    v_mfma_f32_32x32x16_bf16 v[160:175], v[148:151], a[84:87], v[160:175]
    ds_read_b64_tr_b16 v[144:145], v233 offset:49152
    ds_read_b64_tr_b16 v[146:147], v233 offset:50176
    s_waitcnt lgkmcnt(12)
    v_mfma_f32_32x32x16_bf16 v[160:175], v[152:155], a[88:91], v[160:175]
    ds_read_b64_tr_b16 v[148:149], v233 offset:53248
    ds_read_b64_tr_b16 v[150:151], v233 offset:54272
    s_waitcnt lgkmcnt(12)
    v_mfma_f32_32x32x16_bf16 v[160:175], v[156:159], a[92:95], v[160:175]
    buffer_load_dwordx4 v[28:31], v240, s[28:31], s33 offen offset:3072 sc1
    ds_read_b64_tr_b16 v[152:153], v233 offset:57344
    ds_read_b64_tr_b16 v[154:155], v233 offset:58368
    s_waitcnt lgkmcnt(12)
    v_mfma_f32_32x32x16_bf16 v[160:175], v[128:131], a[96:99], v[160:175]
    ds_read_b64_tr_b16 v[156:157], v233 offset:61440
    ds_read_b64_tr_b16 v[158:159], v233 offset:62464
    s_waitcnt lgkmcnt(12)
    v_mfma_f32_32x32x16_bf16 v[160:175], v[132:135], a[100:103], v[160:175]
    ds_read_b64_tr_b16 v[128:129], v234 offset:0
    ds_read_b64_tr_b16 v[130:131], v234 offset:1024
    s_waitcnt lgkmcnt(12)
    v_mfma_f32_32x32x16_bf16 v[160:175], v[136:139], a[104:107], v[160:175]
    buffer_load_dwordx4 v[32:35], v240, s[28:31], s34 offen offset:0 sc1
    ds_read_b64_tr_b16 v[132:133], v234 offset:4096
    ds_read_b64_tr_b16 v[134:135], v234 offset:5120
    s_waitcnt lgkmcnt(12)
    v_mfma_f32_32x32x16_bf16 v[160:175], v[140:143], a[108:111], v[160:175]
    ds_read_b64_tr_b16 v[136:137], v234 offset:8192
    ds_read_b64_tr_b16 v[138:139], v234 offset:9216
    s_waitcnt lgkmcnt(12)
    v_mfma_f32_32x32x16_bf16 v[160:175], v[144:147], a[112:115], v[160:175]
    ds_read_b64_tr_b16 v[140:141], v234 offset:12288
    ds_read_b64_tr_b16 v[142:143], v234 offset:13312
    s_waitcnt lgkmcnt(12)
    v_mfma_f32_32x32x16_bf16 v[160:175], v[148:151], a[116:119], v[160:175]
    buffer_load_dwordx4 v[36:39], v240, s[28:31], s34 offen offset:1024 sc1
    ds_read_b64_tr_b16 v[144:145], v234 offset:16384
    ds_read_b64_tr_b16 v[146:147], v234 offset:17408
    s_waitcnt lgkmcnt(12)
    v_mfma_f32_32x32x16_bf16 v[160:175], v[152:155], a[120:123], v[160:175]
    ds_read_b64_tr_b16 v[148:149], v234 offset:20480
    ds_read_b64_tr_b16 v[150:151], v234 offset:21504
    s_waitcnt lgkmcnt(12)
    v_mfma_f32_32x32x16_bf16 v[160:175], v[156:159], a[124:127], v[160:175]
    ds_read_b64_tr_b16 v[152:153], v234 offset:24576
    ds_read_b64_tr_b16 v[154:155], v234 offset:25600
    s_waitcnt lgkmcnt(12)
    v_mfma_f32_32x32x16_bf16 v[176:191], v[128:131], a[0:3], 0
    buffer_load_dwordx4 v[40:43], v240, s[28:31], s34 offen offset:2048 sc1
    ds_read_b64_tr_b16 v[156:157], v234 offset:28672
    ds_read_b64_tr_b16 v[158:159], v234 offset:29696
    s_waitcnt lgkmcnt(12)
    v_mfma_f32_32x32x16_bf16 v[176:191], v[132:135], a[4:7], v[176:191]
    s_waitcnt vmcnt(8)
    s_lshl_b32 s58, s26, 2
    s_add_u32 s58, s58, s23
    v_mov_b32 v248, s58
    s_mov_b64 exec, 1
    global_store_dword v246, v248, s[42:43] sc1
    s_mov_b64 exec, -1
    ds_read_b64_tr_b16 v[128:129], v234 offset:32768
    ds_read_b64_tr_b16 v[130:131], v234 offset:33792
    s_waitcnt lgkmcnt(12)
    v_mfma_f32_32x32x16_bf16 v[176:191], v[136:139], a[8:11], v[176:191]
    ds_read_b64_tr_b16 v[132:133], v234 offset:36864
    ds_read_b64_tr_b16 v[134:135], v234 offset:37888
    s_waitcnt lgkmcnt(12)
    v_mfma_f32_32x32x16_bf16 v[176:191], v[140:143], a[12:15], v[176:191]
    buffer_load_dwordx4 v[44:47], v240, s[28:31], s34 offen offset:3072 sc1
    v_cvt_pk_bf16_f32 v192, v160, v161
    v_cvt_pk_bf16_f32 v193, v162, v163
    ds_read_b64_tr_b16 v[136:137], v234 offset:40960
    ds_read_b64_tr_b16 v[138:139], v234 offset:41984
    s_waitcnt lgkmcnt(12)
    v_mfma_f32_32x32x16_bf16 v[176:191], v[144:147], a[16:19], v[176:191]
    v_cvt_pk_bf16_f32 v194, v164, v165
    v_cvt_pk_bf16_f32 v195, v166, v167
    ds_read_b64_tr_b16 v[140:141], v234 offset:45056
    ds_read_b64_tr_b16 v[142:143], v234 offset:46080
    s_waitcnt lgkmcnt(12)
    v_mfma_f32_32x32x16_bf16 v[176:191], v[148:151], a[20:23], v[176:191]
    v_cvt_pk_bf16_f32 v196, v168, v169
    v_cvt_pk_bf16_f32 v197, v170, v171
    ds_read_b64_tr_b16 v[144:145], v234 offset:49152
    ds_read_b64_tr_b16 v[146:147], v234 offset:50176
    s_waitcnt lgkmcnt(12)
    v_mfma_f32_32x32x16_bf16 v[176:191], v[152:155], a[24:27], v[176:191]
    buffer_load_dwordx4 v[48:51], v240, s[28:31], s35 offen offset:0 sc1
    v_cvt_pk_bf16_f32 v198, v172, v173
    v_cvt_pk_bf16_f32 v199, v174, v175
    buffer_store_dwordx4 v[192:195], v242, s[52:55], s32 offen offset:0 sc1
    ds_read_b64_tr_b16 v[148:149], v234 offset:53248
    ds_read_b64_tr_b16 v[150:151], v234 offset:54272
    s_waitcnt lgkmcnt(12)
    v_mfma_f32_32x32x16_bf16 v[176:191], v[156:159], a[28:31], v[176:191]
    ds_read_b64_tr_b16 v[152:153], v234 offset:57344
    ds_read_b64_tr_b16 v[154:155], v234 offset:58368
    s_waitcnt lgkmcnt(12)
    v_mfma_f32_32x32x16_bf16 v[176:191], v[128:131], a[32:35], v[176:191]
    ds_read_b64_tr_b16 v[156:157], v234 offset:61440
    ds_read_b64_tr_b16 v[158:159], v234 offset:62464
    s_waitcnt lgkmcnt(12)
    v_mfma_f32_32x32x16_bf16 v[176:191], v[132:135], a[36:39], v[176:191]
    buffer_load_dwordx4 v[52:55], v240, s[28:31], s35 offen offset:1024 sc1
    buffer_store_dwordx4 v[196:199], v242, s[52:55], s32 offen offset:512 sc1
    ds_read_b64_tr_b16 v[128:129], v235 offset:0
    ds_read_b64_tr_b16 v[130:131], v235 offset:1024
    s_waitcnt lgkmcnt(12)
    v_mfma_f32_32x32x16_bf16 v[176:191], v[136:139], a[40:43], v[176:191]
    ds_read_b64_tr_b16 v[132:133], v235 offset:4096
    ds_read_b64_tr_b16 v[134:135], v235 offset:5120
    s_waitcnt lgkmcnt(12)
    v_mfma_f32_32x32x16_bf16 v[176:191], v[140:143], a[44:47], v[176:191]
    ds_read_b64_tr_b16 v[136:137], v235 offset:8192
    ds_read_b64_tr_b16 v[138:139], v235 offset:9216
    s_waitcnt lgkmcnt(12)
    v_mfma_f32_32x32x16_bf16 v[176:191], v[144:147], a[48:51], v[176:191]
    buffer_load_dwordx4 v[56:59], v240, s[28:31], s35 offen offset:2048 sc1
    ds_read_b64_tr_b16 v[140:141], v235 offset:12288
    ds_read_b64_tr_b16 v[142:143], v235 offset:13312
    s_waitcnt lgkmcnt(12)
    v_mfma_f32_32x32x16_bf16 v[176:191], v[148:151], a[52:55], v[176:191]
    ds_read_b64_tr_b16 v[144:145], v235 offset:16384
    ds_read_b64_tr_b16 v[146:147], v235 offset:17408
    s_waitcnt lgkmcnt(12)
    v_mfma_f32_32x32x16_bf16 v[176:191], v[152:155], a[56:59], v[176:191]
    ds_read_b64_tr_b16 v[148:149], v235 offset:20480
    ds_read_b64_tr_b16 v[150:151], v235 offset:21504
    s_waitcnt lgkmcnt(12)
    v_mfma_f32_32x32x16_bf16 v[176:191], v[156:159], a[60:63], v[176:191]
    buffer_load_dwordx4 v[60:63], v240, s[28:31], s35 offen offset:3072 sc1
    ds_read_b64_tr_b16 v[152:153], v235 offset:24576
    ds_read_b64_tr_b16 v[154:155], v235 offset:25600
    s_waitcnt lgkmcnt(12)
    v_mfma_f32_32x32x16_bf16 v[176:191], v[128:131], a[64:67], v[176:191]
    ds_read_b64_tr_b16 v[156:157], v235 offset:28672
    ds_read_b64_tr_b16 v[158:159], v235 offset:29696
    s_waitcnt lgkmcnt(12)
    v_mfma_f32_32x32x16_bf16 v[176:191], v[132:135], a[68:71], v[176:191]
    ds_read_b64_tr_b16 v[128:129], v235 offset:32768
    ds_read_b64_tr_b16 v[130:131], v235 offset:33792
    s_waitcnt lgkmcnt(12)
    v_mfma_f32_32x32x16_bf16 v[176:191], v[136:139], a[72:75], v[176:191]
    buffer_load_dwordx4 v[64:67], v240, s[28:31], s36 offen offset:0 sc1
    ds_read_b64_tr_b16 v[132:133], v235 offset:36864
    ds_read_b64_tr_b16 v[134:135], v235 offset:37888
    s_waitcnt lgkmcnt(12)
    v_mfma_f32_32x32x16_bf16 v[176:191], v[140:143], a[76:79], v[176:191]
    ds_read_b64_tr_b16 v[136:137], v235 offset:40960
    ds_read_b64_tr_b16 v[138:139], v235 offset:41984
    s_waitcnt lgkmcnt(12)
    v_mfma_f32_32x32x16_bf16 v[176:191], v[144:147], a[80:83], v[176:191]
    ds_read_b64_tr_b16 v[140:141], v235 offset:45056
    ds_read_b64_tr_b16 v[142:143], v235 offset:46080
    s_waitcnt lgkmcnt(12)
    v_mfma_f32_32x32x16_bf16 v[176:191], v[148:151], a[84:87], v[176:191]
    buffer_load_dwordx4 v[68:71], v240, s[28:31], s36 offen offset:1024 sc1
    ds_read_b64_tr_b16 v[144:145], v235 offset:49152
    ds_read_b64_tr_b16 v[146:147], v235 offset:50176
    s_waitcnt lgkmcnt(12)
    v_mfma_f32_32x32x16_bf16 v[176:191], v[152:155], a[88:91], v[176:191]
    ds_read_b64_tr_b16 v[148:149], v235 offset:53248
    ds_read_b64_tr_b16 v[150:151], v235 offset:54272
    s_waitcnt lgkmcnt(12)
    v_mfma_f32_32x32x16_bf16 v[176:191], v[156:159], a[92:95], v[176:191]
    ds_read_b64_tr_b16 v[152:153], v235 offset:57344
    ds_read_b64_tr_b16 v[154:155], v235 offset:58368
    s_waitcnt lgkmcnt(12)
    v_mfma_f32_32x32x16_bf16 v[176:191], v[128:131], a[96:99], v[176:191]
    buffer_load_dwordx4 v[72:75], v240, s[28:31], s36 offen offset:2048 sc1
    ds_read_b64_tr_b16 v[156:157], v235 offset:61440
    ds_read_b64_tr_b16 v[158:159], v235 offset:62464
    s_waitcnt lgkmcnt(12)
    v_mfma_f32_32x32x16_bf16 v[176:191], v[132:135], a[100:103], v[176:191]
    ds_read_b64_tr_b16 v[128:129], v236 offset:0
    ds_read_b64_tr_b16 v[130:131], v236 offset:1024
    s_waitcnt lgkmcnt(12)
    v_mfma_f32_32x32x16_bf16 v[176:191], v[136:139], a[104:107], v[176:191]
    ds_read_b64_tr_b16 v[132:133], v236 offset:4096
    ds_read_b64_tr_b16 v[134:135], v236 offset:5120
    s_waitcnt lgkmcnt(12)
    v_mfma_f32_32x32x16_bf16 v[176:191], v[140:143], a[108:111], v[176:191]
    buffer_load_dwordx4 v[76:79], v240, s[28:31], s36 offen offset:3072 sc1
    ds_read_b64_tr_b16 v[136:137], v236 offset:8192
    ds_read_b64_tr_b16 v[138:139], v236 offset:9216
    s_waitcnt lgkmcnt(12)
    v_mfma_f32_32x32x16_bf16 v[176:191], v[144:147], a[112:115], v[176:191]
    ds_read_b64_tr_b16 v[140:141], v236 offset:12288
    ds_read_b64_tr_b16 v[142:143], v236 offset:13312
    s_waitcnt lgkmcnt(12)
    v_mfma_f32_32x32x16_bf16 v[176:191], v[148:151], a[116:119], v[176:191]
    ds_read_b64_tr_b16 v[144:145], v236 offset:16384
    ds_read_b64_tr_b16 v[146:147], v236 offset:17408
    s_waitcnt lgkmcnt(12)
    v_mfma_f32_32x32x16_bf16 v[176:191], v[152:155], a[120:123], v[176:191]
    buffer_load_dwordx4 v[80:83], v240, s[28:31], s37 offen offset:0 sc1
    ds_read_b64_tr_b16 v[148:149], v236 offset:20480
    ds_read_b64_tr_b16 v[150:151], v236 offset:21504
    s_waitcnt lgkmcnt(12)
    v_mfma_f32_32x32x16_bf16 v[176:191], v[156:159], a[124:127], v[176:191]
    ds_read_b64_tr_b16 v[152:153], v236 offset:24576
    ds_read_b64_tr_b16 v[154:155], v236 offset:25600
    s_waitcnt lgkmcnt(12)
    v_mfma_f32_32x32x16_bf16 v[160:175], v[128:131], a[0:3], 0
    ds_read_b64_tr_b16 v[156:157], v236 offset:28672
    ds_read_b64_tr_b16 v[158:159], v236 offset:29696
    s_waitcnt lgkmcnt(12)
    v_mfma_f32_32x32x16_bf16 v[160:175], v[132:135], a[4:7], v[160:175]
    buffer_load_dwordx4 v[84:87], v240, s[28:31], s37 offen offset:1024 sc1
    ds_read_b64_tr_b16 v[128:129], v236 offset:32768
    ds_read_b64_tr_b16 v[130:131], v236 offset:33792
    s_waitcnt lgkmcnt(12)
    v_mfma_f32_32x32x16_bf16 v[160:175], v[136:139], a[8:11], v[160:175]
    ds_read_b64_tr_b16 v[132:133], v236 offset:36864
    ds_read_b64_tr_b16 v[134:135], v236 offset:37888
    s_waitcnt lgkmcnt(12)
    v_mfma_f32_32x32x16_bf16 v[160:175], v[140:143], a[12:15], v[160:175]
    v_cvt_pk_bf16_f32 v200, v176, v177
    v_cvt_pk_bf16_f32 v201, v178, v179
    ds_read_b64_tr_b16 v[136:137], v236 offset:40960
    ds_read_b64_tr_b16 v[138:139], v236 offset:41984
    s_waitcnt lgkmcnt(12)
    v_mfma_f32_32x32x16_bf16 v[160:175], v[144:147], a[16:19], v[160:175]
    buffer_load_dwordx4 v[88:91], v240, s[28:31], s37 offen offset:2048 sc1
    v_cvt_pk_bf16_f32 v202, v180, v181
    v_cvt_pk_bf16_f32 v203, v182, v183
    ds_read_b64_tr_b16 v[140:141], v236 offset:45056
    ds_read_b64_tr_b16 v[142:143], v236 offset:46080
    s_waitcnt lgkmcnt(12)
    v_mfma_f32_32x32x16_bf16 v[160:175], v[148:151], a[20:23], v[160:175]
    v_cvt_pk_bf16_f32 v204, v184, v185
    v_cvt_pk_bf16_f32 v205, v186, v187
    ds_read_b64_tr_b16 v[144:145], v236 offset:49152
    ds_read_b64_tr_b16 v[146:147], v236 offset:50176
    s_waitcnt lgkmcnt(12)
    v_mfma_f32_32x32x16_bf16 v[160:175], v[152:155], a[24:27], v[160:175]
    v_cvt_pk_bf16_f32 v206, v188, v189
    v_cvt_pk_bf16_f32 v207, v190, v191
    buffer_store_dwordx4 v[200:203], v242, s[52:55], s33 offen offset:0 sc1
    ds_read_b64_tr_b16 v[148:149], v236 offset:53248
    ds_read_b64_tr_b16 v[150:151], v236 offset:54272
    s_waitcnt lgkmcnt(12)
    v_mfma_f32_32x32x16_bf16 v[160:175], v[156:159], a[28:31], v[160:175]
    buffer_load_dwordx4 v[92:95], v240, s[28:31], s37 offen offset:3072 sc1
    ds_read_b64_tr_b16 v[152:153], v236 offset:57344
    ds_read_b64_tr_b16 v[154:155], v236 offset:58368
    s_waitcnt lgkmcnt(12)
    v_mfma_f32_32x32x16_bf16 v[160:175], v[128:131], a[32:35], v[160:175]
    ds_read_b64_tr_b16 v[156:157], v236 offset:61440
    ds_read_b64_tr_b16 v[158:159], v236 offset:62464
    s_waitcnt lgkmcnt(12)
    v_mfma_f32_32x32x16_bf16 v[160:175], v[132:135], a[36:39], v[160:175]
    buffer_store_dwordx4 v[204:207], v242, s[52:55], s33 offen offset:512 sc1
    ds_read_b64_tr_b16 v[128:129], v237 offset:0
    ds_read_b64_tr_b16 v[130:131], v237 offset:1024
    s_waitcnt lgkmcnt(12)
    v_mfma_f32_32x32x16_bf16 v[160:175], v[136:139], a[40:43], v[160:175]
    buffer_load_dwordx4 v[96:99], v240, s[28:31], s38 offen offset:0 sc1
    ds_read_b64_tr_b16 v[132:133], v237 offset:4096
    ds_read_b64_tr_b16 v[134:135], v237 offset:5120
    s_waitcnt lgkmcnt(12)
    v_mfma_f32_32x32x16_bf16 v[160:175], v[140:143], a[44:47], v[160:175]
    ds_read_b64_tr_b16 v[136:137], v237 offset:8192
    ds_read_b64_tr_b16 v[138:139], v237 offset:9216
    s_waitcnt lgkmcnt(12)
    v_mfma_f32_32x32x16_bf16 v[160:175], v[144:147], a[48:51], v[160:175]
    ds_read_b64_tr_b16 v[140:141], v237 offset:12288
    ds_read_b64_tr_b16 v[142:143], v237 offset:13312
    s_waitcnt lgkmcnt(12)
    v_mfma_f32_32x32x16_bf16 v[160:175], v[148:151], a[52:55], v[160:175]
    buffer_load_dwordx4 v[100:103], v240, s[28:31], s38 offen offset:1024 sc1
    ds_read_b64_tr_b16 v[144:145], v237 offset:16384
    ds_read_b64_tr_b16 v[146:147], v237 offset:17408
    s_waitcnt lgkmcnt(12)
    v_mfma_f32_32x32x16_bf16 v[160:175], v[152:155], a[56:59], v[160:175]
    ds_read_b64_tr_b16 v[148:149], v237 offset:20480
    ds_read_b64_tr_b16 v[150:151], v237 offset:21504
    s_waitcnt lgkmcnt(12)
    v_mfma_f32_32x32x16_bf16 v[160:175], v[156:159], a[60:63], v[160:175]
    ds_read_b64_tr_b16 v[152:153], v237 offset:24576
    ds_read_b64_tr_b16 v[154:155], v237 offset:25600
    s_waitcnt lgkmcnt(12)
    v_mfma_f32_32x32x16_bf16 v[160:175], v[128:131], a[64:67], v[160:175]
    buffer_load_dwordx4 v[104:107], v240, s[28:31], s38 offen offset:2048 sc1
    ds_read_b64_tr_b16 v[156:157], v237 offset:28672
    ds_read_b64_tr_b16 v[158:159], v237 offset:29696
    s_waitcnt lgkmcnt(12)
    v_mfma_f32_32x32x16_bf16 v[160:175], v[132:135], a[68:71], v[160:175]
    ds_read_b64_tr_b16 v[128:129], v237 offset:32768
    ds_read_b64_tr_b16 v[130:131], v237 offset:33792
    s_waitcnt lgkmcnt(12)
    v_mfma_f32_32x32x16_bf16 v[160:175], v[136:139], a[72:75], v[160:175]
    ds_read_b64_tr_b16 v[132:133], v237 offset:36864
    ds_read_b64_tr_b16 v[134:135], v237 offset:37888
    s_waitcnt lgkmcnt(12)
    v_mfma_f32_32x32x16_bf16 v[160:175], v[140:143], a[76:79], v[160:175]
    buffer_load_dwordx4 v[108:111], v240, s[28:31], s38 offen offset:3072 sc1
    ds_read_b64_tr_b16 v[136:137], v237 offset:40960
    ds_read_b64_tr_b16 v[138:139], v237 offset:41984
    s_waitcnt lgkmcnt(12)
    v_mfma_f32_32x32x16_bf16 v[160:175], v[144:147], a[80:83], v[160:175]
    ds_read_b64_tr_b16 v[140:141], v237 offset:45056
    ds_read_b64_tr_b16 v[142:143], v237 offset:46080
    s_waitcnt lgkmcnt(12)
    v_mfma_f32_32x32x16_bf16 v[160:175], v[148:151], a[84:87], v[160:175]
    ds_read_b64_tr_b16 v[144:145], v237 offset:49152
    ds_read_b64_tr_b16 v[146:147], v237 offset:50176
    s_waitcnt lgkmcnt(12)
    v_mfma_f32_32x32x16_bf16 v[160:175], v[152:155], a[88:91], v[160:175]
    buffer_load_dwordx4 v[112:115], v240, s[28:31], s39 offen offset:0 sc1
    ds_read_b64_tr_b16 v[148:149], v237 offset:53248
    ds_read_b64_tr_b16 v[150:151], v237 offset:54272
    s_waitcnt lgkmcnt(12)
    v_mfma_f32_32x32x16_bf16 v[160:175], v[156:159], a[92:95], v[160:175]
    ds_read_b64_tr_b16 v[152:153], v237 offset:57344
    ds_read_b64_tr_b16 v[154:155], v237 offset:58368
    s_waitcnt lgkmcnt(12)
    v_mfma_f32_32x32x16_bf16 v[160:175], v[128:131], a[96:99], v[160:175]
    ds_read_b64_tr_b16 v[156:157], v237 offset:61440
    ds_read_b64_tr_b16 v[158:159], v237 offset:62464
    s_waitcnt lgkmcnt(12)
    v_mfma_f32_32x32x16_bf16 v[160:175], v[132:135], a[100:103], v[160:175]
    buffer_load_dwordx4 v[116:119], v240, s[28:31], s39 offen offset:1024 sc1
    ds_read_b64_tr_b16 v[128:129], v238 offset:0
    ds_read_b64_tr_b16 v[130:131], v238 offset:1024
    s_waitcnt lgkmcnt(12)
    v_mfma_f32_32x32x16_bf16 v[160:175], v[136:139], a[104:107], v[160:175]
    ds_read_b64_tr_b16 v[132:133], v238 offset:4096
    ds_read_b64_tr_b16 v[134:135], v238 offset:5120
    s_waitcnt lgkmcnt(12)
    v_mfma_f32_32x32x16_bf16 v[160:175], v[140:143], a[108:111], v[160:175]
    ds_read_b64_tr_b16 v[136:137], v238 offset:8192
    ds_read_b64_tr_b16 v[138:139], v238 offset:9216
    s_waitcnt lgkmcnt(12)
    v_mfma_f32_32x32x16_bf16 v[160:175], v[144:147], a[112:115], v[160:175]
    buffer_load_dwordx4 v[120:123], v240, s[28:31], s39 offen offset:2048 sc1
    ds_read_b64_tr_b16 v[140:141], v238 offset:12288
    ds_read_b64_tr_b16 v[142:143], v238 offset:13312
    s_waitcnt lgkmcnt(12)
    v_mfma_f32_32x32x16_bf16 v[160:175], v[148:151], a[116:119], v[160:175]
    ds_read_b64_tr_b16 v[144:145], v238 offset:16384
    ds_read_b64_tr_b16 v[146:147], v238 offset:17408
    s_waitcnt lgkmcnt(12)
    v_mfma_f32_32x32x16_bf16 v[160:175], v[152:155], a[120:123], v[160:175]
    ds_read_b64_tr_b16 v[148:149], v238 offset:20480
    ds_read_b64_tr_b16 v[150:151], v238 offset:21504
    s_waitcnt lgkmcnt(12)
    v_mfma_f32_32x32x16_bf16 v[160:175], v[156:159], a[124:127], v[160:175]
    buffer_load_dwordx4 v[124:127], v240, s[28:31], s39 offen offset:3072 sc1
    ds_read_b64_tr_b16 v[152:153], v238 offset:24576
    ds_read_b64_tr_b16 v[154:155], v238 offset:25600
    s_waitcnt lgkmcnt(12)
    v_mfma_f32_32x32x16_bf16 v[176:191], v[128:131], a[0:3], 0
    ds_read_b64_tr_b16 v[156:157], v238 offset:28672
    ds_read_b64_tr_b16 v[158:159], v238 offset:29696
    s_waitcnt lgkmcnt(12)
    v_mfma_f32_32x32x16_bf16 v[176:191], v[132:135], a[4:7], v[176:191]
    ds_read_b64_tr_b16 v[128:129], v238 offset:32768
    ds_read_b64_tr_b16 v[130:131], v238 offset:33792
    s_waitcnt lgkmcnt(12)
    v_mfma_f32_32x32x16_bf16 v[176:191], v[136:139], a[8:11], v[176:191]
    ds_read_b64_tr_b16 v[132:133], v238 offset:36864
    ds_read_b64_tr_b16 v[134:135], v238 offset:37888
    s_waitcnt lgkmcnt(12)
    v_mfma_f32_32x32x16_bf16 v[176:191], v[140:143], a[12:15], v[176:191]
    v_cvt_pk_bf16_f32 v192, v160, v161
    v_cvt_pk_bf16_f32 v193, v162, v163
    ds_read_b64_tr_b16 v[136:137], v238 offset:40960
    ds_read_b64_tr_b16 v[138:139], v238 offset:41984
    s_waitcnt lgkmcnt(12)
    v_mfma_f32_32x32x16_bf16 v[176:191], v[144:147], a[16:19], v[176:191]
    v_cvt_pk_bf16_f32 v194, v164, v165
    v_cvt_pk_bf16_f32 v195, v166, v167
    ds_read_b64_tr_b16 v[140:141], v238 offset:45056
    ds_read_b64_tr_b16 v[142:143], v238 offset:46080
    s_waitcnt lgkmcnt(12)
    v_mfma_f32_32x32x16_bf16 v[176:191], v[148:151], a[20:23], v[176:191]
    v_cvt_pk_bf16_f32 v196, v168, v169
    v_cvt_pk_bf16_f32 v197, v170, v171
    ds_read_b64_tr_b16 v[144:145], v238 offset:49152
    ds_read_b64_tr_b16 v[146:147], v238 offset:50176
    s_waitcnt lgkmcnt(12)
    v_mfma_f32_32x32x16_bf16 v[176:191], v[152:155], a[24:27], v[176:191]
    v_cvt_pk_bf16_f32 v198, v172, v173
    v_cvt_pk_bf16_f32 v199, v174, v175
    buffer_store_dwordx4 v[192:195], v242, s[52:55], s34 offen offset:0 sc1
    ds_read_b64_tr_b16 v[148:149], v238 offset:53248
    ds_read_b64_tr_b16 v[150:151], v238 offset:54272
    s_waitcnt lgkmcnt(12)
    v_mfma_f32_32x32x16_bf16 v[176:191], v[156:159], a[28:31], v[176:191]
    ds_read_b64_tr_b16 v[152:153], v238 offset:57344
    ds_read_b64_tr_b16 v[154:155], v238 offset:58368
    s_waitcnt lgkmcnt(12)
    v_mfma_f32_32x32x16_bf16 v[176:191], v[128:131], a[32:35], v[176:191]
    ds_read_b64_tr_b16 v[156:157], v238 offset:61440
    ds_read_b64_tr_b16 v[158:159], v238 offset:62464
    s_waitcnt lgkmcnt(12)
    v_mfma_f32_32x32x16_bf16 v[176:191], v[132:135], a[36:39], v[176:191]
    buffer_store_dwordx4 v[196:199], v242, s[52:55], s34 offen offset:512 sc1
    ds_read_b64_tr_b16 v[128:129], v239 offset:0
    ds_read_b64_tr_b16 v[130:131], v239 offset:1024
    s_waitcnt lgkmcnt(12)
    v_mfma_f32_32x32x16_bf16 v[176:191], v[136:139], a[40:43], v[176:191]
    ds_read_b64_tr_b16 v[132:133], v239 offset:4096
    ds_read_b64_tr_b16 v[134:135], v239 offset:5120
    s_waitcnt lgkmcnt(12)
    v_mfma_f32_32x32x16_bf16 v[176:191], v[140:143], a[44:47], v[176:191]
    ds_read_b64_tr_b16 v[136:137], v239 offset:8192
    ds_read_b64_tr_b16 v[138:139], v239 offset:9216
    s_waitcnt lgkmcnt(12)
    v_mfma_f32_32x32x16_bf16 v[176:191], v[144:147], a[48:51], v[176:191]
    ds_read_b64_tr_b16 v[140:141], v239 offset:12288
    ds_read_b64_tr_b16 v[142:143], v239 offset:13312
    s_waitcnt lgkmcnt(12)
    v_mfma_f32_32x32x16_bf16 v[176:191], v[148:151], a[52:55], v[176:191]
    ds_read_b64_tr_b16 v[144:145], v239 offset:16384
    ds_read_b64_tr_b16 v[146:147], v239 offset:17408
    s_waitcnt lgkmcnt(12)
    v_mfma_f32_32x32x16_bf16 v[176:191], v[152:155], a[56:59], v[176:191]
    ds_read_b64_tr_b16 v[148:149], v239 offset:20480
    ds_read_b64_tr_b16 v[150:151], v239 offset:21504
    s_waitcnt lgkmcnt(12)
    v_mfma_f32_32x32x16_bf16 v[176:191], v[156:159], a[60:63], v[176:191]
    ds_read_b64_tr_b16 v[152:153], v239 offset:24576
    ds_read_b64_tr_b16 v[154:155], v239 offset:25600
    s_waitcnt lgkmcnt(12)
    v_mfma_f32_32x32x16_bf16 v[176:191], v[128:131], a[64:67], v[176:191]
    ds_read_b64_tr_b16 v[156:157], v239 offset:28672
    ds_read_b64_tr_b16 v[158:159], v239 offset:29696
    s_waitcnt lgkmcnt(12)
    v_mfma_f32_32x32x16_bf16 v[176:191], v[132:135], a[68:71], v[176:191]
    ds_read_b64_tr_b16 v[128:129], v239 offset:32768
    ds_read_b64_tr_b16 v[130:131], v239 offset:33792
    s_waitcnt lgkmcnt(12)
    v_mfma_f32_32x32x16_bf16 v[176:191], v[136:139], a[72:75], v[176:191]
    ds_read_b64_tr_b16 v[132:133], v239 offset:36864
    ds_read_b64_tr_b16 v[134:135], v239 offset:37888
    s_waitcnt lgkmcnt(12)
    v_mfma_f32_32x32x16_bf16 v[176:191], v[140:143], a[76:79], v[176:191]
    ds_read_b64_tr_b16 v[136:137], v239 offset:40960
    ds_read_b64_tr_b16 v[138:139], v239 offset:41984
    s_waitcnt lgkmcnt(12)
    v_mfma_f32_32x32x16_bf16 v[176:191], v[144:147], a[80:83], v[176:191]
    ds_read_b64_tr_b16 v[140:141], v239 offset:45056
    ds_read_b64_tr_b16 v[142:143], v239 offset:46080
    s_waitcnt lgkmcnt(12)
    v_mfma_f32_32x32x16_bf16 v[176:191], v[148:151], a[84:87], v[176:191]
    ds_read_b64_tr_b16 v[144:145], v239 offset:49152
    ds_read_b64_tr_b16 v[146:147], v239 offset:50176
    s_waitcnt lgkmcnt(12)
    v_mfma_f32_32x32x16_bf16 v[176:191], v[152:155], a[88:91], v[176:191]
    ds_read_b64_tr_b16 v[148:149], v239 offset:53248
    ds_read_b64_tr_b16 v[150:151], v239 offset:54272
    s_waitcnt lgkmcnt(12)
    v_mfma_f32_32x32x16_bf16 v[176:191], v[156:159], a[92:95], v[176:191]
    ds_read_b64_tr_b16 v[152:153], v239 offset:57344
    ds_read_b64_tr_b16 v[154:155], v239 offset:58368
    s_waitcnt lgkmcnt(12)
    v_mfma_f32_32x32x16_bf16 v[176:191], v[128:131], a[96:99], v[176:191]
    ds_read_b64_tr_b16 v[156:157], v239 offset:61440
    ds_read_b64_tr_b16 v[158:159], v239 offset:62464
    s_waitcnt lgkmcnt(12)
    v_mfma_f32_32x32x16_bf16 v[176:191], v[132:135], a[100:103], v[176:191]
    ds_read_b64_tr_b16 v[128:129], v232 offset:0
    ds_read_b64_tr_b16 v[130:131], v232 offset:1024
    s_waitcnt lgkmcnt(12)
    v_mfma_f32_32x32x16_bf16 v[176:191], v[136:139], a[104:107], v[176:191]
    ds_read_b64_tr_b16 v[132:133], v232 offset:4096
    ds_read_b64_tr_b16 v[134:135], v232 offset:5120
    s_waitcnt lgkmcnt(12)
    v_mfma_f32_32x32x16_bf16 v[176:191], v[140:143], a[108:111], v[176:191]
    ds_read_b64_tr_b16 v[136:137], v232 offset:8192
    ds_read_b64_tr_b16 v[138:139], v232 offset:9216
    s_waitcnt lgkmcnt(12)
    v_mfma_f32_32x32x16_bf16 v[176:191], v[144:147], a[112:115], v[176:191]
    ds_read_b64_tr_b16 v[140:141], v232 offset:12288
    ds_read_b64_tr_b16 v[142:143], v232 offset:13312
    s_waitcnt lgkmcnt(12)
    v_mfma_f32_32x32x16_bf16 v[176:191], v[148:151], a[116:119], v[176:191]
    ds_read_b64_tr_b16 v[144:145], v232 offset:16384
    ds_read_b64_tr_b16 v[146:147], v232 offset:17408
    s_waitcnt lgkmcnt(12)
    v_mfma_f32_32x32x16_bf16 v[176:191], v[152:155], a[120:123], v[176:191]
    ds_read_b64_tr_b16 v[148:149], v232 offset:20480
    ds_read_b64_tr_b16 v[150:151], v232 offset:21504
    s_waitcnt lgkmcnt(12)
    v_mfma_f32_32x32x16_bf16 v[176:191], v[156:159], a[124:127], v[176:191]
    s_add_u32 s28, s28, 131072
    s_addc_u32 s29, s29, 0
    s_add_u32 s26, s26, 1
    s_cmp_ge_u32 s26, 14
    s_cbranch_scc1 L_k_fin
    s_waitcnt vmcnt(2)
    ds_read_b64_tr_b16 v[152:153], v232 offset:24576
    ds_read_b64_tr_b16 v[154:155], v232 offset:25600
    s_waitcnt lgkmcnt(12)
    v_mfma_f32_32x32x16_bf16 v[160:175], v[128:131], v[0:3], 0
    ds_read_b64_tr_b16 v[156:157], v232 offset:28672
    ds_read_b64_tr_b16 v[158:159], v232 offset:29696
    s_waitcnt lgkmcnt(12)
    v_mfma_f32_32x32x16_bf16 v[160:175], v[132:135], v[4:7], v[160:175]
    ds_read_b64_tr_b16 v[128:129], v232 offset:32768
    ds_read_b64_tr_b16 v[130:131], v232 offset:33792
    s_waitcnt lgkmcnt(12)
    v_mfma_f32_32x32x16_bf16 v[160:175], v[136:139], v[8:11], v[160:175]
    buffer_load_dwordx4 a[0:3], v240, s[28:31], s32 offen offset:0 sc1
    ds_read_b64_tr_b16 v[132:133], v232 offset:36864
    ds_read_b64_tr_b16 v[134:135], v232 offset:37888
    s_waitcnt lgkmcnt(12)
    v_mfma_f32_32x32x16_bf16 v[160:175], v[140:143], v[12:15], v[160:175]
    v_cvt_pk_bf16_f32 v200, v176, v177
    v_cvt_pk_bf16_f32 v201, v178, v179
    ds_read_b64_tr_b16 v[136:137], v232 offset:40960
    ds_read_b64_tr_b16 v[138:139], v232 offset:41984
    s_waitcnt lgkmcnt(12)
    v_mfma_f32_32x32x16_bf16 v[160:175], v[144:147], v[16:19], v[160:175]
    v_cvt_pk_bf16_f32 v202, v180, v181
    v_cvt_pk_bf16_f32 v203, v182, v183
    ds_read_b64_tr_b16 v[140:141], v232 offset:45056
    ds_read_b64_tr_b16 v[142:143], v232 offset:46080
    s_waitcnt lgkmcnt(12)
    v_mfma_f32_32x32x16_bf16 v[160:175], v[148:151], v[20:23], v[160:175]
    buffer_load_dwordx4 a[4:7], v240, s[28:31], s32 offen offset:1024 sc1
    v_cvt_pk_bf16_f32 v204, v184, v185
    v_cvt_pk_bf16_f32 v205, v186, v187
    ds_read_b64_tr_b16 v[144:145], v232 offset:49152
    ds_read_b64_tr_b16 v[146:147], v232 offset:50176
    s_waitcnt lgkmcnt(12)
    v_mfma_f32_32x32x16_bf16 v[160:175], v[152:155], v[24:27], v[160:175]
    v_cvt_pk_bf16_f32 v206, v188, v189
    v_cvt_pk_bf16_f32 v207, v190, v191
    buffer_store_dwordx4 v[200:203], v242, s[52:55], s35 offen offset:0 sc1
    ds_read_b64_tr_b16 v[148:149], v232 offset:53248
    ds_read_b64_tr_b16 v[150:151], v232 offset:54272
    s_waitcnt lgkmcnt(12)
    v_mfma_f32_32x32x16_bf16 v[160:175], v[156:159], v[28:31], v[160:175]
    ds_read_b64_tr_b16 v[152:153], v232 offset:57344
    ds_read_b64_tr_b16 v[154:155], v232 offset:58368
    s_waitcnt lgkmcnt(12)
    v_mfma_f32_32x32x16_bf16 v[160:175], v[128:131], v[32:35], v[160:175]
    buffer_load_dwordx4 a[8:11], v240, s[28:31], s32 offen offset:2048 sc1
    ds_read_b64_tr_b16 v[156:157], v232 offset:61440
    ds_read_b64_tr_b16 v[158:159], v232 offset:62464
    s_waitcnt lgkmcnt(12)
    v_mfma_f32_32x32x16_bf16 v[160:175], v[132:135], v[36:39], v[160:175]
    buffer_store_dwordx4 v[204:207], v242, s[52:55], s35 offen offset:512 sc1
    s_add_u32 s52, s52, 2097152
    s_addc_u32 s53, s53, 0
    ds_read_b64_tr_b16 v[128:129], v233 offset:0
    ds_read_b64_tr_b16 v[130:131], v233 offset:1024
    s_waitcnt lgkmcnt(12)
    v_mfma_f32_32x32x16_bf16 v[160:175], v[136:139], v[40:43], v[160:175]
    ds_read_b64_tr_b16 v[132:133], v233 offset:4096
    ds_read_b64_tr_b16 v[134:135], v233 offset:5120
    s_waitcnt lgkmcnt(12)
    v_mfma_f32_32x32x16_bf16 v[160:175], v[140:143], v[44:47], v[160:175]
    buffer_load_dwordx4 a[12:15], v240, s[28:31], s32 offen offset:3072 sc1
    ds_read_b64_tr_b16 v[136:137], v233 offset:8192
    ds_read_b64_tr_b16 v[138:139], v233 offset:9216
    s_waitcnt lgkmcnt(12)
    v_mfma_f32_32x32x16_bf16 v[160:175], v[144:147], v[48:51], v[160:175]
    ds_read_b64_tr_b16 v[140:141], v233 offset:12288
    ds_read_b64_tr_b16 v[142:143], v233 offset:13312
    s_waitcnt lgkmcnt(12)
    v_mfma_f32_32x32x16_bf16 v[160:175], v[148:151], v[52:55], v[160:175]
    ds_read_b64_tr_b16 v[144:145], v233 offset:16384
    ds_read_b64_tr_b16 v[146:147], v233 offset:17408
    s_waitcnt lgkmcnt(12)
    v_mfma_f32_32x32x16_bf16 v[160:175], v[152:155], v[56:59], v[160:175]
    buffer_load_dwordx4 a[16:19], v240, s[28:31], s33 offen offset:0 sc1
    ds_read_b64_tr_b16 v[148:149], v233 offset:20480
    ds_read_b64_tr_b16 v[150:151], v233 offset:21504
    s_waitcnt lgkmcnt(12)
    v_mfma_f32_32x32x16_bf16 v[160:175], v[156:159], v[60:63], v[160:175]
    ds_read_b64_tr_b16 v[152:153], v233 offset:24576
    ds_read_b64_tr_b16 v[154:155], v233 offset:25600
    s_waitcnt lgkmcnt(12)
    v_mfma_f32_32x32x16_bf16 v[160:175], v[128:131], v[64:67], v[160:175]
    ds_read_b64_tr_b16 v[156:157], v233 offset:28672
    ds_read_b64_tr_b16 v[158:159], v233 offset:29696
    s_waitcnt lgkmcnt(12)
    v_mfma_f32_32x32x16_bf16 v[160:175], v[132:135], v[68:71], v[160:175]
    buffer_load_dwordx4 a[20:23], v240, s[28:31], s33 offen offset:1024 sc1
    ds_read_b64_tr_b16 v[128:129], v233 offset:32768
    ds_read_b64_tr_b16 v[130:131], v233 offset:33792
    s_waitcnt lgkmcnt(12)
    v_mfma_f32_32x32x16_bf16 v[160:175], v[136:139], v[72:75], v[160:175]
    ds_read_b64_tr_b16 v[132:133], v233 offset:36864
    ds_read_b64_tr_b16 v[134:135], v233 offset:37888
    s_waitcnt lgkmcnt(12)
    v_mfma_f32_32x32x16_bf16 v[160:175], v[140:143], v[76:79], v[160:175]
    ds_read_b64_tr_b16 v[136:137], v233 offset:40960
    ds_read_b64_tr_b16 v[138:139], v233 offset:41984
    s_waitcnt lgkmcnt(12)
    v_mfma_f32_32x32x16_bf16 v[160:175], v[144:147], v[80:83], v[160:175]
    buffer_load_dwordx4 a[24:27], v240, s[28:31], s33 offen offset:2048 sc1
    ds_read_b64_tr_b16 v[140:141], v233 offset:45056
    ds_read_b64_tr_b16 v[142:143], v233 offset:46080
    s_waitcnt lgkmcnt(12)
    v_mfma_f32_32x32x16_bf16 v[160:175], v[148:151], v[84:87], v[160:175]
    ds_read_b64_tr_b16 v[144:145], v233 offset:49152
    ds_read_b64_tr_b16 v[146:147], v233 offset:50176
    s_waitcnt lgkmcnt(12)
    v_mfma_f32_32x32x16_bf16 v[160:175], v[152:155], v[88:91], v[160:175]
    ds_read_b64_tr_b16 v[148:149], v233 offset:53248
    ds_read_b64_tr_b16 v[150:151], v233 offset:54272
    s_waitcnt lgkmcnt(12)
    v_mfma_f32_32x32x16_bf16 v[160:175], v[156:159], v[92:95], v[160:175]
    buffer_load_dwordx4 a[28:31], v240, s[28:31], s33 offen offset:3072 sc1
    ds_read_b64_tr_b16 v[152:153], v233 offset:57344
    ds_read_b64_tr_b16 v[154:155], v233 offset:58368
    s_waitcnt lgkmcnt(12)
    v_mfma_f32_32x32x16_bf16 v[160:175], v[128:131], v[96:99], v[160:175]
    ds_read_b64_tr_b16 v[156:157], v233 offset:61440
    ds_read_b64_tr_b16 v[158:159], v233 offset:62464
    s_waitcnt lgkmcnt(12)
    v_mfma_f32_32x32x16_bf16 v[160:175], v[132:135], v[100:103], v[160:175]
    ds_read_b64_tr_b16 v[128:129], v234 offset:0
    ds_read_b64_tr_b16 v[130:131], v234 offset:1024
    s_waitcnt lgkmcnt(12)
    v_mfma_f32_32x32x16_bf16 v[160:175], v[136:139], v[104:107], v[160:175]
    buffer_load_dwordx4 a[32:35], v240, s[28:31], s34 offen offset:0 sc1
    ds_read_b64_tr_b16 v[132:133], v234 offset:4096
    ds_read_b64_tr_b16 v[134:135], v234 offset:5120
    s_waitcnt lgkmcnt(12)
    v_mfma_f32_32x32x16_bf16 v[160:175], v[140:143], v[108:111], v[160:175]
    ds_read_b64_tr_b16 v[136:137], v234 offset:8192
    ds_read_b64_tr_b16 v[138:139], v234 offset:9216
    s_waitcnt lgkmcnt(12)
    v_mfma_f32_32x32x16_bf16 v[160:175], v[144:147], v[112:115], v[160:175]
    ds_read_b64_tr_b16 v[140:141], v234 offset:12288
    ds_read_b64_tr_b16 v[142:143], v234 offset:13312
    s_waitcnt lgkmcnt(12)
    v_mfma_f32_32x32x16_bf16 v[160:175], v[148:151], v[116:119], v[160:175]
    buffer_load_dwordx4 a[36:39], v240, s[28:31], s34 offen offset:1024 sc1
    ds_read_b64_tr_b16 v[144:145], v234 offset:16384
    ds_read_b64_tr_b16 v[146:147], v234 offset:17408
    s_waitcnt lgkmcnt(12)
    v_mfma_f32_32x32x16_bf16 v[160:175], v[152:155], v[120:123], v[160:175]
    ds_read_b64_tr_b16 v[148:149], v234 offset:20480
    ds_read_b64_tr_b16 v[150:151], v234 offset:21504
    s_waitcnt lgkmcnt(12)
    v_mfma_f32_32x32x16_bf16 v[160:175], v[156:159], v[124:127], v[160:175]
    ds_read_b64_tr_b16 v[152:153], v234 offset:24576
    ds_read_b64_tr_b16 v[154:155], v234 offset:25600
    s_waitcnt lgkmcnt(12)
    v_mfma_f32_32x32x16_bf16 v[176:191], v[128:131], v[0:3], 0
    buffer_load_dwordx4 a[40:43], v240, s[28:31], s34 offen offset:2048 sc1
    ds_read_b64_tr_b16 v[156:157], v234 offset:28672
    ds_read_b64_tr_b16 v[158:159], v234 offset:29696
    s_waitcnt lgkmcnt(12)
    v_mfma_f32_32x32x16_bf16 v[176:191], v[132:135], v[4:7], v[176:191]
    s_waitcnt vmcnt(8)
    s_lshl_b32 s58, s26, 2
    s_add_u32 s58, s58, s23
    v_mov_b32 v248, s58
    s_mov_b64 exec, 1
    global_store_dword v246, v248, s[42:43] sc1
    s_mov_b64 exec, -1
    ds_read_b64_tr_b16 v[128:129], v234 offset:32768
    ds_read_b64_tr_b16 v[130:131], v234 offset:33792
    s_waitcnt lgkmcnt(12)
    v_mfma_f32_32x32x16_bf16 v[176:191], v[136:139], v[8:11], v[176:191]
    ds_read_b64_tr_b16 v[132:133], v234 offset:36864
    ds_read_b64_tr_b16 v[134:135], v234 offset:37888
    s_waitcnt lgkmcnt(12)
    v_mfma_f32_32x32x16_bf16 v[176:191], v[140:143], v[12:15], v[176:191]
    buffer_load_dwordx4 a[44:47], v240, s[28:31], s34 offen offset:3072 sc1
    v_cvt_pk_bf16_f32 v192, v160, v161
    v_cvt_pk_bf16_f32 v193, v162, v163
    ds_read_b64_tr_b16 v[136:137], v234 offset:40960
    ds_read_b64_tr_b16 v[138:139], v234 offset:41984
    s_waitcnt lgkmcnt(12)
    v_mfma_f32_32x32x16_bf16 v[176:191], v[144:147], v[16:19], v[176:191]
    v_cvt_pk_bf16_f32 v194, v164, v165
    v_cvt_pk_bf16_f32 v195, v166, v167
    ds_read_b64_tr_b16 v[140:141], v234 offset:45056
    ds_read_b64_tr_b16 v[142:143], v234 offset:46080
    s_waitcnt lgkmcnt(12)
    v_mfma_f32_32x32x16_bf16 v[176:191], v[148:151], v[20:23], v[176:191]
    v_cvt_pk_bf16_f32 v196, v168, v169
    v_cvt_pk_bf16_f32 v197, v170, v171
    ds_read_b64_tr_b16 v[144:145], v234 offset:49152
    ds_read_b64_tr_b16 v[146:147], v234 offset:50176
    s_waitcnt lgkmcnt(12)
    v_mfma_f32_32x32x16_bf16 v[176:191], v[152:155], v[24:27], v[176:191]
    buffer_load_dwordx4 a[48:51], v240, s[28:31], s35 offen offset:0 sc1
    v_cvt_pk_bf16_f32 v198, v172, v173
    v_cvt_pk_bf16_f32 v199, v174, v175
    buffer_store_dwordx4 v[192:195], v242, s[52:55], s32 offen offset:0 sc1
    ds_read_b64_tr_b16 v[148:149], v234 offset:53248
    ds_read_b64_tr_b16 v[150:151], v234 offset:54272
    s_waitcnt lgkmcnt(12)
    v_mfma_f32_32x32x16_bf16 v[176:191], v[156:159], v[28:31], v[176:191]
    ds_read_b64_tr_b16 v[152:153], v234 offset:57344
    ds_read_b64_tr_b16 v[154:155], v234 offset:58368
    s_waitcnt lgkmcnt(12)
    v_mfma_f32_32x32x16_bf16 v[176:191], v[128:131], v[32:35], v[176:191]
    ds_read_b64_tr_b16 v[156:157], v234 offset:61440
    ds_read_b64_tr_b16 v[158:159], v234 offset:62464
    s_waitcnt lgkmcnt(12)
    v_mfma_f32_32x32x16_bf16 v[176:191], v[132:135], v[36:39], v[176:191]
    buffer_load_dwordx4 a[52:55], v240, s[28:31], s35 offen offset:1024 sc1
    buffer_store_dwordx4 v[196:199], v242, s[52:55], s32 offen offset:512 sc1
    ds_read_b64_tr_b16 v[128:129], v235 offset:0
    ds_read_b64_tr_b16 v[130:131], v235 offset:1024
    s_waitcnt lgkmcnt(12)
    v_mfma_f32_32x32x16_bf16 v[176:191], v[136:139], v[40:43], v[176:191]
    ds_read_b64_tr_b16 v[132:133], v235 offset:4096
    ds_read_b64_tr_b16 v[134:135], v235 offset:5120
    s_waitcnt lgkmcnt(12)
    v_mfma_f32_32x32x16_bf16 v[176:191], v[140:143], v[44:47], v[176:191]
    ds_read_b64_tr_b16 v[136:137], v235 offset:8192
    ds_read_b64_tr_b16 v[138:139], v235 offset:9216
    s_waitcnt lgkmcnt(12)
    v_mfma_f32_32x32x16_bf16 v[176:191], v[144:147], v[48:51], v[176:191]
    buffer_load_dwordx4 a[56:59], v240, s[28:31], s35 offen offset:2048 sc1
    ds_read_b64_tr_b16 v[140:141], v235 offset:12288
    ds_read_b64_tr_b16 v[142:143], v235 offset:13312
    s_waitcnt lgkmcnt(12)
    v_mfma_f32_32x32x16_bf16 v[176:191], v[148:151], v[52:55], v[176:191]
    ds_read_b64_tr_b16 v[144:145], v235 offset:16384
    ds_read_b64_tr_b16 v[146:147], v235 offset:17408
    s_waitcnt lgkmcnt(12)
    v_mfma_f32_32x32x16_bf16 v[176:191], v[152:155], v[56:59], v[176:191]
    ds_read_b64_tr_b16 v[148:149], v235 offset:20480
    ds_read_b64_tr_b16 v[150:151], v235 offset:21504
    s_waitcnt lgkmcnt(12)
    v_mfma_f32_32x32x16_bf16 v[176:191], v[156:159], v[60:63], v[176:191]
    buffer_load_dwordx4 a[60:63], v240, s[28:31], s35 offen offset:3072 sc1
    ds_read_b64_tr_b16 v[152:153], v235 offset:24576
    ds_read_b64_tr_b16 v[154:155], v235 offset:25600
    s_waitcnt lgkmcnt(12)
    v_mfma_f32_32x32x16_bf16 v[176:191], v[128:131], v[64:67], v[176:191]
    ds_read_b64_tr_b16 v[156:157], v235 offset:28672
    ds_read_b64_tr_b16 v[158:159], v235 offset:29696
    s_waitcnt lgkmcnt(12)
    v_mfma_f32_32x32x16_bf16 v[176:191], v[132:135], v[68:71], v[176:191]
    ds_read_b64_tr_b16 v[128:129], v235 offset:32768
    ds_read_b64_tr_b16 v[130:131], v235 offset:33792
    s_waitcnt lgkmcnt(12)
    v_mfma_f32_32x32x16_bf16 v[176:191], v[136:139], v[72:75], v[176:191]
    buffer_load_dwordx4 a[64:67], v240, s[28:31], s36 offen offset:0 sc1
    ds_read_b64_tr_b16 v[132:133], v235 offset:36864
    ds_read_b64_tr_b16 v[134:135], v235 offset:37888
    s_waitcnt lgkmcnt(12)
    v_mfma_f32_32x32x16_bf16 v[176:191], v[140:143], v[76:79], v[176:191]
    ds_read_b64_tr_b16 v[136:137], v235 offset:40960
    ds_read_b64_tr_b16 v[138:139], v235 offset:41984
    s_waitcnt lgkmcnt(12)
    v_mfma_f32_32x32x16_bf16 v[176:191], v[144:147], v[80:83], v[176:191]
    ds_read_b64_tr_b16 v[140:141], v235 offset:45056
    ds_read_b64_tr_b16 v[142:143], v235 offset:46080
    s_waitcnt lgkmcnt(12)
    v_mfma_f32_32x32x16_bf16 v[176:191], v[148:151], v[84:87], v[176:191]
    buffer_load_dwordx4 a[68:71], v240, s[28:31], s36 offen offset:1024 sc1
    ds_read_b64_tr_b16 v[144:145], v235 offset:49152
    ds_read_b64_tr_b16 v[146:147], v235 offset:50176
    s_waitcnt lgkmcnt(12)
    v_mfma_f32_32x32x16_bf16 v[176:191], v[152:155], v[88:91], v[176:191]
    ds_read_b64_tr_b16 v[148:149], v235 offset:53248
    ds_read_b64_tr_b16 v[150:151], v235 offset:54272
    s_waitcnt lgkmcnt(12)
    v_mfma_f32_32x32x16_bf16 v[176:191], v[156:159], v[92:95], v[176:191]
    ds_read_b64_tr_b16 v[152:153], v235 offset:57344
    ds_read_b64_tr_b16 v[154:155], v235 offset:58368
    s_waitcnt lgkmcnt(12)
    v_mfma_f32_32x32x16_bf16 v[176:191], v[128:131], v[96:99], v[176:191]
    buffer_load_dwordx4 a[72:75], v240, s[28:31], s36 offen offset:2048 sc1
    ds_read_b64_tr_b16 v[156:157], v235 offset:61440
    ds_read_b64_tr_b16 v[158:159], v235 offset:62464
    s_waitcnt lgkmcnt(12)
    v_mfma_f32_32x32x16_bf16 v[176:191], v[132:135], v[100:103], v[176:191]
    ds_read_b64_tr_b16 v[128:129], v236 offset:0
    ds_read_b64_tr_b16 v[130:131], v236 offset:1024
    s_waitcnt lgkmcnt(12)
    v_mfma_f32_32x32x16_bf16 v[176:191], v[136:139], v[104:107], v[176:191]
    ds_read_b64_tr_b16 v[132:133], v236 offset:4096
    ds_read_b64_tr_b16 v[134:135], v236 offset:5120
    s_waitcnt lgkmcnt(12)
    v_mfma_f32_32x32x16_bf16 v[176:191], v[140:143], v[108:111], v[176:191]
    buffer_load_dwordx4 a[76:79], v240, s[28:31], s36 offen offset:3072 sc1
    ds_read_b64_tr_b16 v[136:137], v236 offset:8192
    ds_read_b64_tr_b16 v[138:139], v236 offset:9216
    s_waitcnt lgkmcnt(12)
    v_mfma_f32_32x32x16_bf16 v[176:191], v[144:147], v[112:115], v[176:191]
    ds_read_b64_tr_b16 v[140:141], v236 offset:12288
    ds_read_b64_tr_b16 v[142:143], v236 offset:13312
    s_waitcnt lgkmcnt(12)
    v_mfma_f32_32x32x16_bf16 v[176:191], v[148:151], v[116:119], v[176:191]
    ds_read_b64_tr_b16 v[144:145], v236 offset:16384
    ds_read_b64_tr_b16 v[146:147], v236 offset:17408
    s_waitcnt lgkmcnt(12)
    v_mfma_f32_32x32x16_bf16 v[176:191], v[152:155], v[120:123], v[176:191]
    buffer_load_dwordx4 a[80:83], v240, s[28:31], s37 offen offset:0 sc1
    ds_read_b64_tr_b16 v[148:149], v236 offset:20480
    ds_read_b64_tr_b16 v[150:151], v236 offset:21504
    s_waitcnt lgkmcnt(12)
    v_mfma_f32_32x32x16_bf16 v[176:191], v[156:159], v[124:127], v[176:191]
    ds_read_b64_tr_b16 v[152:153], v236 offset:24576
    ds_read_b64_tr_b16 v[154:155], v236 offset:25600
    s_waitcnt lgkmcnt(12)
    v_mfma_f32_32x32x16_bf16 v[160:175], v[128:131], v[0:3], 0
    ds_read_b64_tr_b16 v[156:157], v236 offset:28672
    ds_read_b64_tr_b16 v[158:159], v236 offset:29696
    s_waitcnt lgkmcnt(12)
    v_mfma_f32_32x32x16_bf16 v[160:175], v[132:135], v[4:7], v[160:175]
    buffer_load_dwordx4 a[84:87], v240, s[28:31], s37 offen offset:1024 sc1
    ds_read_b64_tr_b16 v[128:129], v236 offset:32768
    ds_read_b64_tr_b16 v[130:131], v236 offset:33792
    s_waitcnt lgkmcnt(12)
    v_mfma_f32_32x32x16_bf16 v[160:175], v[136:139], v[8:11], v[160:175]
    ds_read_b64_tr_b16 v[132:133], v236 offset:36864
    ds_read_b64_tr_b16 v[134:135], v236 offset:37888
    s_waitcnt lgkmcnt(12)
    v_mfma_f32_32x32x16_bf16 v[160:175], v[140:143], v[12:15], v[160:175]
    v_cvt_pk_bf16_f32 v200, v176, v177
    v_cvt_pk_bf16_f32 v201, v178, v179
    ds_read_b64_tr_b16 v[136:137], v236 offset:40960
    ds_read_b64_tr_b16 v[138:139], v236 offset:41984
    s_waitcnt lgkmcnt(12)
    v_mfma_f32_32x32x16_bf16 v[160:175], v[144:147], v[16:19], v[160:175]
    buffer_load_dwordx4 a[88:91], v240, s[28:31], s37 offen offset:2048 sc1
    v_cvt_pk_bf16_f32 v202, v180, v181
    v_cvt_pk_bf16_f32 v203, v182, v183
    ds_read_b64_tr_b16 v[140:141], v236 offset:45056
    ds_read_b64_tr_b16 v[142:143], v236 offset:46080
    s_waitcnt lgkmcnt(12)
    v_mfma_f32_32x32x16_bf16 v[160:175], v[148:151], v[20:23], v[160:175]
    v_cvt_pk_bf16_f32 v204, v184, v185
    v_cvt_pk_bf16_f32 v205, v186, v187
    ds_read_b64_tr_b16 v[144:145], v236 offset:49152
    ds_read_b64_tr_b16 v[146:147], v236 offset:50176
    s_waitcnt lgkmcnt(12)
    v_mfma_f32_32x32x16_bf16 v[160:175], v[152:155], v[24:27], v[160:175]
    v_cvt_pk_bf16_f32 v206, v188, v189
    v_cvt_pk_bf16_f32 v207, v190, v191
    buffer_store_dwordx4 v[200:203], v242, s[52:55], s33 offen offset:0 sc1
    ds_read_b64_tr_b16 v[148:149], v236 offset:53248
    ds_read_b64_tr_b16 v[150:151], v236 offset:54272
    s_waitcnt lgkmcnt(12)
    v_mfma_f32_32x32x16_bf16 v[160:175], v[156:159], v[28:31], v[160:175]
    buffer_load_dwordx4 a[92:95], v240, s[28:31], s37 offen offset:3072 sc1
    ds_read_b64_tr_b16 v[152:153], v236 offset:57344
    ds_read_b64_tr_b16 v[154:155], v236 offset:58368
    s_waitcnt lgkmcnt(12)
    v_mfma_f32_32x32x16_bf16 v[160:175], v[128:131], v[32:35], v[160:175]
    ds_read_b64_tr_b16 v[156:157], v236 offset:61440
    ds_read_b64_tr_b16 v[158:159], v236 offset:62464
    s_waitcnt lgkmcnt(12)
    v_mfma_f32_32x32x16_bf16 v[160:175], v[132:135], v[36:39], v[160:175]
    buffer_store_dwordx4 v[204:207], v242, s[52:55], s33 offen offset:512 sc1
    ds_read_b64_tr_b16 v[128:129], v237 offset:0
    ds_read_b64_tr_b16 v[130:131], v237 offset:1024
    s_waitcnt lgkmcnt(12)
    v_mfma_f32_32x32x16_bf16 v[160:175], v[136:139], v[40:43], v[160:175]
    buffer_load_dwordx4 a[96:99], v240, s[28:31], s38 offen offset:0 sc1
    ds_read_b64_tr_b16 v[132:133], v237 offset:4096
    ds_read_b64_tr_b16 v[134:135], v237 offset:5120
    s_waitcnt lgkmcnt(12)
    v_mfma_f32_32x32x16_bf16 v[160:175], v[140:143], v[44:47], v[160:175]
    ds_read_b64_tr_b16 v[136:137], v237 offset:8192
    ds_read_b64_tr_b16 v[138:139], v237 offset:9216
    s_waitcnt lgkmcnt(12)
    v_mfma_f32_32x32x16_bf16 v[160:175], v[144:147], v[48:51], v[160:175]
    ds_read_b64_tr_b16 v[140:141], v237 offset:12288
    ds_read_b64_tr_b16 v[142:143], v237 offset:13312
    s_waitcnt lgkmcnt(12)
    v_mfma_f32_32x32x16_bf16 v[160:175], v[148:151], v[52:55], v[160:175]
    buffer_load_dwordx4 a[100:103], v240, s[28:31], s38 offen offset:1024 sc1
    ds_read_b64_tr_b16 v[144:145], v237 offset:16384
    ds_read_b64_tr_b16 v[146:147], v237 offset:17408
    s_waitcnt lgkmcnt(12)
    v_mfma_f32_32x32x16_bf16 v[160:175], v[152:155], v[56:59], v[160:175]
    ds_read_b64_tr_b16 v[148:149], v237 offset:20480
    ds_read_b64_tr_b16 v[150:151], v237 offset:21504
    s_waitcnt lgkmcnt(12)
    v_mfma_f32_32x32x16_bf16 v[160:175], v[156:159], v[60:63], v[160:175]
    ds_read_b64_tr_b16 v[152:153], v237 offset:24576
    ds_read_b64_tr_b16 v[154:155], v237 offset:25600
    s_waitcnt lgkmcnt(12)
    v_mfma_f32_32x32x16_bf16 v[160:175], v[128:131], v[64:67], v[160:175]
    buffer_load_dwordx4 a[104:107], v240, s[28:31], s38 offen offset:2048 sc1
    ds_read_b64_tr_b16 v[156:157], v237 offset:28672
    ds_read_b64_tr_b16 v[158:159], v237 offset:29696
    s_waitcnt lgkmcnt(12)
    v_mfma_f32_32x32x16_bf16 v[160:175], v[132:135], v[68:71], v[160:175]
    ds_read_b64_tr_b16 v[128:129], v237 offset:32768
    ds_read_b64_tr_b16 v[130:131], v237 offset:33792
    s_waitcnt lgkmcnt(12)
    v_mfma_f32_32x32x16_bf16 v[160:175], v[136:139], v[72:75], v[160:175]
    ds_read_b64_tr_b16 v[132:133], v237 offset:36864
    ds_read_b64_tr_b16 v[134:135], v237 offset:37888
    s_waitcnt lgkmcnt(12)
    v_mfma_f32_32x32x16_bf16 v[160:175], v[140:143], v[76:79], v[160:175]
    buffer_load_dwordx4 a[108:111], v240, s[28:31], s38 offen offset:3072 sc1
    ds_read_b64_tr_b16 v[136:137], v237 offset:40960
    ds_read_b64_tr_b16 v[138:139], v237 offset:41984
    s_waitcnt lgkmcnt(12)
    v_mfma_f32_32x32x16_bf16 v[160:175], v[144:147], v[80:83], v[160:175]
    ds_read_b64_tr_b16 v[140:141], v237 offset:45056
    ds_read_b64_tr_b16 v[142:143], v237 offset:46080
    s_waitcnt lgkmcnt(12)
    v_mfma_f32_32x32x16_bf16 v[160:175], v[148:151], v[84:87], v[160:175]
    ds_read_b64_tr_b16 v[144:145], v237 offset:49152
    ds_read_b64_tr_b16 v[146:147], v237 offset:50176
    s_waitcnt lgkmcnt(12)
    v_mfma_f32_32x32x16_bf16 v[160:175], v[152:155], v[88:91], v[160:175]
    buffer_load_dwordx4 a[112:115], v240, s[28:31], s39 offen offset:0 sc1
    ds_read_b64_tr_b16 v[148:149], v237 offset:53248
    ds_read_b64_tr_b16 v[150:151], v237 offset:54272
    s_waitcnt lgkmcnt(12)
    v_mfma_f32_32x32x16_bf16 v[160:175], v[156:159], v[92:95], v[160:175]
    ds_read_b64_tr_b16 v[152:153], v237 offset:57344
    ds_read_b64_tr_b16 v[154:155], v237 offset:58368
    s_waitcnt lgkmcnt(12)
    v_mfma_f32_32x32x16_bf16 v[160:175], v[128:131], v[96:99], v[160:175]
    ds_read_b64_tr_b16 v[156:157], v237 offset:61440
    ds_read_b64_tr_b16 v[158:159], v237 offset:62464
    s_waitcnt lgkmcnt(12)
    v_mfma_f32_32x32x16_bf16 v[160:175], v[132:135], v[100:103], v[160:175]
    buffer_load_dwordx4 a[116:119], v240, s[28:31], s39 offen offset:1024 sc1
    ds_read_b64_tr_b16 v[128:129], v238 offset:0
    ds_read_b64_tr_b16 v[130:131], v238 offset:1024
    s_waitcnt lgkmcnt(12)
    v_mfma_f32_32x32x16_bf16 v[160:175], v[136:139], v[104:107], v[160:175]
    ds_read_b64_tr_b16 v[132:133], v238 offset:4096
    ds_read_b64_tr_b16 v[134:135], v238 offset:5120
    s_waitcnt lgkmcnt(12)
    v_mfma_f32_32x32x16_bf16 v[160:175], v[140:143], v[108:111], v[160:175]
    ds_read_b64_tr_b16 v[136:137], v238 offset:8192
    ds_read_b64_tr_b16 v[138:139], v238 offset:9216
    s_waitcnt lgkmcnt(12)
    v_mfma_f32_32x32x16_bf16 v[160:175], v[144:147], v[112:115], v[160:175]
    buffer_load_dwordx4 a[120:123], v240, s[28:31], s39 offen offset:2048 sc1
    ds_read_b64_tr_b16 v[140:141], v238 offset:12288
    ds_read_b64_tr_b16 v[142:143], v238 offset:13312
    s_waitcnt lgkmcnt(12)
    v_mfma_f32_32x32x16_bf16 v[160:175], v[148:151], v[116:119], v[160:175]
    ds_read_b64_tr_b16 v[144:145], v238 offset:16384
    ds_read_b64_tr_b16 v[146:147], v238 offset:17408
    s_waitcnt lgkmcnt(12)
    v_mfma_f32_32x32x16_bf16 v[160:175], v[152:155], v[120:123], v[160:175]
    ds_read_b64_tr_b16 v[148:149], v238 offset:20480
    ds_read_b64_tr_b16 v[150:151], v238 offset:21504
    s_waitcnt lgkmcnt(12)
    v_mfma_f32_32x32x16_bf16 v[160:175], v[156:159], v[124:127], v[160:175]
    buffer_load_dwordx4 a[124:127], v240, s[28:31], s39 offen offset:3072 sc1
    ds_read_b64_tr_b16 v[152:153], v238 offset:24576
    ds_read_b64_tr_b16 v[154:155], v238 offset:25600
    s_waitcnt lgkmcnt(12)
    v_mfma_f32_32x32x16_bf16 v[176:191], v[128:131], v[0:3], 0
    ds_read_b64_tr_b16 v[156:157], v238 offset:28672
    ds_read_b64_tr_b16 v[158:159], v238 offset:29696
    s_waitcnt lgkmcnt(12)
    v_mfma_f32_32x32x16_bf16 v[176:191], v[132:135], v[4:7], v[176:191]
    ds_read_b64_tr_b16 v[128:129], v238 offset:32768
    ds_read_b64_tr_b16 v[130:131], v238 offset:33792
    s_waitcnt lgkmcnt(12)
    v_mfma_f32_32x32x16_bf16 v[176:191], v[136:139], v[8:11], v[176:191]
    ds_read_b64_tr_b16 v[132:133], v238 offset:36864
    ds_read_b64_tr_b16 v[134:135], v238 offset:37888
    s_waitcnt lgkmcnt(12)
    v_mfma_f32_32x32x16_bf16 v[176:191], v[140:143], v[12:15], v[176:191]
    v_cvt_pk_bf16_f32 v192, v160, v161
    v_cvt_pk_bf16_f32 v193, v162, v163
    ds_read_b64_tr_b16 v[136:137], v238 offset:40960
    ds_read_b64_tr_b16 v[138:139], v238 offset:41984
    s_waitcnt lgkmcnt(12)
    v_mfma_f32_32x32x16_bf16 v[176:191], v[144:147], v[16:19], v[176:191]
    v_cvt_pk_bf16_f32 v194, v164, v165
    v_cvt_pk_bf16_f32 v195, v166, v167
    ds_read_b64_tr_b16 v[140:141], v238 offset:45056
    ds_read_b64_tr_b16 v[142:143], v238 offset:46080
    s_waitcnt lgkmcnt(12)
    v_mfma_f32_32x32x16_bf16 v[176:191], v[148:151], v[20:23], v[176:191]
    v_cvt_pk_bf16_f32 v196, v168, v169
    v_cvt_pk_bf16_f32 v197, v170, v171
    ds_read_b64_tr_b16 v[144:145], v238 offset:49152
    ds_read_b64_tr_b16 v[146:147], v238 offset:50176
    s_waitcnt lgkmcnt(12)
    v_mfma_f32_32x32x16_bf16 v[176:191], v[152:155], v[24:27], v[176:191]
    v_cvt_pk_bf16_f32 v198, v172, v173
    v_cvt_pk_bf16_f32 v199, v174, v175
    buffer_store_dwordx4 v[192:195], v242, s[52:55], s34 offen offset:0 sc1
    ds_read_b64_tr_b16 v[148:149], v238 offset:53248
    ds_read_b64_tr_b16 v[150:151], v238 offset:54272
    s_waitcnt lgkmcnt(12)
    v_mfma_f32_32x32x16_bf16 v[176:191], v[156:159], v[28:31], v[176:191]
    ds_read_b64_tr_b16 v[152:153], v238 offset:57344
    ds_read_b64_tr_b16 v[154:155], v238 offset:58368
    s_waitcnt lgkmcnt(12)
    v_mfma_f32_32x32x16_bf16 v[176:191], v[128:131], v[32:35], v[176:191]
    ds_read_b64_tr_b16 v[156:157], v238 offset:61440
    ds_read_b64_tr_b16 v[158:159], v238 offset:62464
    s_waitcnt lgkmcnt(12)
    v_mfma_f32_32x32x16_bf16 v[176:191], v[132:135], v[36:39], v[176:191]
    buffer_store_dwordx4 v[196:199], v242, s[52:55], s34 offen offset:512 sc1
    ds_read_b64_tr_b16 v[128:129], v239 offset:0
    ds_read_b64_tr_b16 v[130:131], v239 offset:1024
    s_waitcnt lgkmcnt(12)
    v_mfma_f32_32x32x16_bf16 v[176:191], v[136:139], v[40:43], v[176:191]
    ds_read_b64_tr_b16 v[132:133], v239 offset:4096
    ds_read_b64_tr_b16 v[134:135], v239 offset:5120
    s_waitcnt lgkmcnt(12)
    v_mfma_f32_32x32x16_bf16 v[176:191], v[140:143], v[44:47], v[176:191]
    ds_read_b64_tr_b16 v[136:137], v239 offset:8192
    ds_read_b64_tr_b16 v[138:139], v239 offset:9216
    s_waitcnt lgkmcnt(12)
    v_mfma_f32_32x32x16_bf16 v[176:191], v[144:147], v[48:51], v[176:191]
    ds_read_b64_tr_b16 v[140:141], v239 offset:12288
    ds_read_b64_tr_b16 v[142:143], v239 offset:13312
    s_waitcnt lgkmcnt(12)
    v_mfma_f32_32x32x16_bf16 v[176:191], v[148:151], v[52:55], v[176:191]
    ds_read_b64_tr_b16 v[144:145], v239 offset:16384
    ds_read_b64_tr_b16 v[146:147], v239 offset:17408
    s_waitcnt lgkmcnt(12)
    v_mfma_f32_32x32x16_bf16 v[176:191], v[152:155], v[56:59], v[176:191]
    ds_read_b64_tr_b16 v[148:149], v239 offset:20480
    ds_read_b64_tr_b16 v[150:151], v239 offset:21504
    s_waitcnt lgkmcnt(12)
    v_mfma_f32_32x32x16_bf16 v[176:191], v[156:159], v[60:63], v[176:191]
    ds_read_b64_tr_b16 v[152:153], v239 offset:24576
    ds_read_b64_tr_b16 v[154:155], v239 offset:25600
    s_waitcnt lgkmcnt(12)
    v_mfma_f32_32x32x16_bf16 v[176:191], v[128:131], v[64:67], v[176:191]
    ds_read_b64_tr_b16 v[156:157], v239 offset:28672
    ds_read_b64_tr_b16 v[158:159], v239 offset:29696
    s_waitcnt lgkmcnt(12)
    v_mfma_f32_32x32x16_bf16 v[176:191], v[132:135], v[68:71], v[176:191]
    ds_read_b64_tr_b16 v[128:129], v239 offset:32768
    ds_read_b64_tr_b16 v[130:131], v239 offset:33792
    s_waitcnt lgkmcnt(12)
    v_mfma_f32_32x32x16_bf16 v[176:191], v[136:139], v[72:75], v[176:191]
    ds_read_b64_tr_b16 v[132:133], v239 offset:36864
    ds_read_b64_tr_b16 v[134:135], v239 offset:37888
    s_waitcnt lgkmcnt(12)
    v_mfma_f32_32x32x16_bf16 v[176:191], v[140:143], v[76:79], v[176:191]
    ds_read_b64_tr_b16 v[136:137], v239 offset:40960
    ds_read_b64_tr_b16 v[138:139], v239 offset:41984
    s_waitcnt lgkmcnt(12)
    v_mfma_f32_32x32x16_bf16 v[176:191], v[144:147], v[80:83], v[176:191]
    ds_read_b64_tr_b16 v[140:141], v239 offset:45056
    ds_read_b64_tr_b16 v[142:143], v239 offset:46080
    s_waitcnt lgkmcnt(12)
    v_mfma_f32_32x32x16_bf16 v[176:191], v[148:151], v[84:87], v[176:191]
    ds_read_b64_tr_b16 v[144:145], v239 offset:49152
    ds_read_b64_tr_b16 v[146:147], v239 offset:50176
    s_waitcnt lgkmcnt(12)
    v_mfma_f32_32x32x16_bf16 v[176:191], v[152:155], v[88:91], v[176:191]
    ds_read_b64_tr_b16 v[148:149], v239 offset:53248
    ds_read_b64_tr_b16 v[150:151], v239 offset:54272
    s_waitcnt lgkmcnt(12)
    v_mfma_f32_32x32x16_bf16 v[176:191], v[156:159], v[92:95], v[176:191]
    ds_read_b64_tr_b16 v[152:153], v239 offset:57344
    ds_read_b64_tr_b16 v[154:155], v239 offset:58368
    s_waitcnt lgkmcnt(12)
    v_mfma_f32_32x32x16_bf16 v[176:191], v[128:131], v[96:99], v[176:191]
    ds_read_b64_tr_b16 v[156:157], v239 offset:61440
    ds_read_b64_tr_b16 v[158:159], v239 offset:62464
    s_waitcnt lgkmcnt(12)
    v_mfma_f32_32x32x16_bf16 v[176:191], v[132:135], v[100:103], v[176:191]
    ds_read_b64_tr_b16 v[128:129], v232 offset:0
    ds_read_b64_tr_b16 v[130:131], v232 offset:1024
    s_waitcnt lgkmcnt(12)
    v_mfma_f32_32x32x16_bf16 v[176:191], v[136:139], v[104:107], v[176:191]
    ds_read_b64_tr_b16 v[132:133], v232 offset:4096
    ds_read_b64_tr_b16 v[134:135], v232 offset:5120
    s_waitcnt lgkmcnt(12)
    v_mfma_f32_32x32x16_bf16 v[176:191], v[140:143], v[108:111], v[176:191]
    ds_read_b64_tr_b16 v[136:137], v232 offset:8192
    ds_read_b64_tr_b16 v[138:139], v232 offset:9216
    s_waitcnt lgkmcnt(12)
    v_mfma_f32_32x32x16_bf16 v[176:191], v[144:147], v[112:115], v[176:191]
    ds_read_b64_tr_b16 v[140:141], v232 offset:12288
    ds_read_b64_tr_b16 v[142:143], v232 offset:13312
    s_waitcnt lgkmcnt(12)
    v_mfma_f32_32x32x16_bf16 v[176:191], v[148:151], v[116:119], v[176:191]
    ds_read_b64_tr_b16 v[144:145], v232 offset:16384
    ds_read_b64_tr_b16 v[146:147], v232 offset:17408
    s_waitcnt lgkmcnt(12)
    v_mfma_f32_32x32x16_bf16 v[176:191], v[152:155], v[120:123], v[176:191]
    ds_read_b64_tr_b16 v[148:149], v232 offset:20480
    ds_read_b64_tr_b16 v[150:151], v232 offset:21504
    s_waitcnt lgkmcnt(12)
    v_mfma_f32_32x32x16_bf16 v[176:191], v[156:159], v[124:127], v[176:191]
    s_add_u32 s28, s28, 131072
    s_addc_u32 s29, s29, 0
    s_add_u32 s26, s26, 1
    s_branch L_k_loop
L_k_fin:
    s_waitcnt vmcnt(2)
    ds_read_b64_tr_b16 v[152:153], v232 offset:24576
    ds_read_b64_tr_b16 v[154:155], v232 offset:25600
    s_waitcnt lgkmcnt(12)
    v_mfma_f32_32x32x16_bf16 v[160:175], v[128:131], v[0:3], 0
    s_add_u32 m0, s57, 0
    s_lshl_b32 s61, s80, 4
    s_add_u32 s61, s61, 0
    buffer_load_dwordx4 v228, s[72:75], s61 offen lds
    ds_read_b64_tr_b16 v[156:157], v232 offset:28672
    ds_read_b64_tr_b16 v[158:159], v232 offset:29696
    s_waitcnt lgkmcnt(12)
    v_mfma_f32_32x32x16_bf16 v[160:175], v[132:135], v[4:7], v[160:175]
    s_add_u32 m0, s57, 1024
    s_lshl_b32 s61, s80, 4
    s_add_u32 s61, s61, 16384
    buffer_load_dwordx4 v228, s[72:75], s61 offen lds
    ds_read_b64_tr_b16 v[128:129], v232 offset:32768
    ds_read_b64_tr_b16 v[130:131], v232 offset:33792
    s_waitcnt lgkmcnt(12)
    v_mfma_f32_32x32x16_bf16 v[160:175], v[136:139], v[8:11], v[160:175]
    buffer_load_dwordx4 a[0:3], v240, s[28:31], s32 offen offset:0 sc1
    s_add_u32 m0, s57, 2048
    s_lshl_b32 s61, s80, 4
    s_add_u32 s61, s61, 32768
    buffer_load_dwordx4 v228, s[72:75], s61 offen lds
    ds_read_b64_tr_b16 v[132:133], v232 offset:36864
    ds_read_b64_tr_b16 v[134:135], v232 offset:37888
    s_waitcnt lgkmcnt(12)
    v_mfma_f32_32x32x16_bf16 v[160:175], v[140:143], v[12:15], v[160:175]
    v_cvt_pk_bf16_f32 v200, v176, v177
    v_cvt_pk_bf16_f32 v201, v178, v179
    s_add_u32 m0, s57, 3072
    s_lshl_b32 s61, s80, 4
    s_add_u32 s61, s61, 49152
    buffer_load_dwordx4 v228, s[72:75], s61 offen lds
    ds_read_b64_tr_b16 v[136:137], v232 offset:40960
    ds_read_b64_tr_b16 v[138:139], v232 offset:41984
    s_waitcnt lgkmcnt(12)
    v_mfma_f32_32x32x16_bf16 v[160:175], v[144:147], v[16:19], v[160:175]
    v_cvt_pk_bf16_f32 v202, v180, v181
    v_cvt_pk_bf16_f32 v203, v182, v183
    s_add_u32 m0, s57, 4096
    s_lshl_b32 s61, s80, 4
    s_add_u32 s61, s61, 65536
    buffer_load_dwordx4 v228, s[72:75], s61 offen lds
    ds_read_b64_tr_b16 v[140:141], v232 offset:45056
    ds_read_b64_tr_b16 v[142:143], v232 offset:46080
    s_waitcnt lgkmcnt(12)
    v_mfma_f32_32x32x16_bf16 v[160:175], v[148:151], v[20:23], v[160:175]
    buffer_load_dwordx4 a[4:7], v240, s[28:31], s32 offen offset:1024 sc1
    v_cvt_pk_bf16_f32 v204, v184, v185
    v_cvt_pk_bf16_f32 v205, v186, v187
    s_add_u32 m0, s57, 5120
    s_lshl_b32 s61, s80, 4
    s_add_u32 s61, s61, 81920
    buffer_load_dwordx4 v228, s[72:75], s61 offen lds
    ds_read_b64_tr_b16 v[144:145], v232 offset:49152
    ds_read_b64_tr_b16 v[146:147], v232 offset:50176
    s_waitcnt lgkmcnt(12)
    v_mfma_f32_32x32x16_bf16 v[160:175], v[152:155], v[24:27], v[160:175]
    v_cvt_pk_bf16_f32 v206, v188, v189
    v_cvt_pk_bf16_f32 v207, v190, v191
    buffer_store_dwordx4 v[200:203], v242, s[52:55], s35 offen offset:0 sc1
    s_add_u32 m0, s57, 6144
    s_lshl_b32 s61, s80, 4
    s_add_u32 s61, s61, 98304
    buffer_load_dwordx4 v228, s[72:75], s61 offen lds
    ds_read_b64_tr_b16 v[148:149], v232 offset:53248
    ds_read_b64_tr_b16 v[150:151], v232 offset:54272
    s_waitcnt lgkmcnt(12)
    v_mfma_f32_32x32x16_bf16 v[160:175], v[156:159], v[28:31], v[160:175]
    s_add_u32 m0, s57, 7168
    s_lshl_b32 s61, s80, 4
    s_add_u32 s61, s61, 114688
    buffer_load_dwordx4 v228, s[72:75], s61 offen lds
    ds_read_b64_tr_b16 v[152:153], v232 offset:57344
    ds_read_b64_tr_b16 v[154:155], v232 offset:58368
    s_waitcnt lgkmcnt(12)
    v_mfma_f32_32x32x16_bf16 v[160:175], v[128:131], v[32:35], v[160:175]
    buffer_load_dwordx4 a[8:11], v240, s[28:31], s32 offen offset:2048 sc1
    ds_read_b64_tr_b16 v[156:157], v232 offset:61440
    ds_read_b64_tr_b16 v[158:159], v232 offset:62464
    s_waitcnt lgkmcnt(12)
    v_mfma_f32_32x32x16_bf16 v[160:175], v[132:135], v[36:39], v[160:175]
    buffer_store_dwordx4 v[204:207], v242, s[52:55], s35 offen offset:512 sc1
    s_add_u32 s52, s52, 2097152
    s_addc_u32 s53, s53, 0
    ds_read_b64_tr_b16 v[128:129], v233 offset:0
    ds_read_b64_tr_b16 v[130:131], v233 offset:1024
    s_waitcnt lgkmcnt(12)
    v_mfma_f32_32x32x16_bf16 v[160:175], v[136:139], v[40:43], v[160:175]
    ds_read_b64_tr_b16 v[132:133], v233 offset:4096
    ds_read_b64_tr_b16 v[134:135], v233 offset:5120
    s_waitcnt lgkmcnt(12)
    v_mfma_f32_32x32x16_bf16 v[160:175], v[140:143], v[44:47], v[160:175]
    buffer_load_dwordx4 a[12:15], v240, s[28:31], s32 offen offset:3072 sc1
    ds_read_b64_tr_b16 v[136:137], v233 offset:8192
    ds_read_b64_tr_b16 v[138:139], v233 offset:9216
    s_waitcnt lgkmcnt(12)
    v_mfma_f32_32x32x16_bf16 v[160:175], v[144:147], v[48:51], v[160:175]
    ds_read_b64_tr_b16 v[140:141], v233 offset:12288
    ds_read_b64_tr_b16 v[142:143], v233 offset:13312
    s_waitcnt lgkmcnt(12)
    v_mfma_f32_32x32x16_bf16 v[160:175], v[148:151], v[52:55], v[160:175]
    ds_read_b64_tr_b16 v[144:145], v233 offset:16384
    ds_read_b64_tr_b16 v[146:147], v233 offset:17408
    s_waitcnt lgkmcnt(12)
    v_mfma_f32_32x32x16_bf16 v[160:175], v[152:155], v[56:59], v[160:175]
    buffer_load_dwordx4 a[16:19], v240, s[28:31], s33 offen offset:0 sc1
    ds_read_b64_tr_b16 v[148:149], v233 offset:20480
    ds_read_b64_tr_b16 v[150:151], v233 offset:21504
    s_waitcnt lgkmcnt(12)
    v_mfma_f32_32x32x16_bf16 v[160:175], v[156:159], v[60:63], v[160:175]
    ds_read_b64_tr_b16 v[152:153], v233 offset:24576
    ds_read_b64_tr_b16 v[154:155], v233 offset:25600
    s_waitcnt lgkmcnt(12)
    v_mfma_f32_32x32x16_bf16 v[160:175], v[128:131], v[64:67], v[160:175]
    ds_read_b64_tr_b16 v[156:157], v233 offset:28672
    ds_read_b64_tr_b16 v[158:159], v233 offset:29696
    s_waitcnt lgkmcnt(12)
    v_mfma_f32_32x32x16_bf16 v[160:175], v[132:135], v[68:71], v[160:175]
    buffer_load_dwordx4 a[20:23], v240, s[28:31], s33 offen offset:1024 sc1
    ds_read_b64_tr_b16 v[128:129], v233 offset:32768
    ds_read_b64_tr_b16 v[130:131], v233 offset:33792
    s_waitcnt lgkmcnt(12)
    v_mfma_f32_32x32x16_bf16 v[160:175], v[136:139], v[72:75], v[160:175]
    ds_read_b64_tr_b16 v[132:133], v233 offset:36864
    ds_read_b64_tr_b16 v[134:135], v233 offset:37888
    s_waitcnt lgkmcnt(12)
    v_mfma_f32_32x32x16_bf16 v[160:175], v[140:143], v[76:79], v[160:175]
    ds_read_b64_tr_b16 v[136:137], v233 offset:40960
    ds_read_b64_tr_b16 v[138:139], v233 offset:41984
    s_waitcnt lgkmcnt(12)
    v_mfma_f32_32x32x16_bf16 v[160:175], v[144:147], v[80:83], v[160:175]
    buffer_load_dwordx4 a[24:27], v240, s[28:31], s33 offen offset:2048 sc1
    ds_read_b64_tr_b16 v[140:141], v233 offset:45056
    ds_read_b64_tr_b16 v[142:143], v233 offset:46080
    s_waitcnt lgkmcnt(12)
    v_mfma_f32_32x32x16_bf16 v[160:175], v[148:151], v[84:87], v[160:175]
    ds_read_b64_tr_b16 v[144:145], v233 offset:49152
    ds_read_b64_tr_b16 v[146:147], v233 offset:50176
    s_waitcnt lgkmcnt(12)
    v_mfma_f32_32x32x16_bf16 v[160:175], v[152:155], v[88:91], v[160:175]
    ds_read_b64_tr_b16 v[148:149], v233 offset:53248
    ds_read_b64_tr_b16 v[150:151], v233 offset:54272
    s_waitcnt lgkmcnt(12)
    v_mfma_f32_32x32x16_bf16 v[160:175], v[156:159], v[92:95], v[160:175]
    buffer_load_dwordx4 a[28:31], v240, s[28:31], s33 offen offset:3072 sc1
    s_waitcnt vmcnt(7)
    ds_read_b64_tr_b16 a[128:129], v229 offset:0
    ds_read_b64_tr_b16 a[130:131], v229 offset:512
    ds_read_b64_tr_b16 v[152:153], v233 offset:57344
    ds_read_b64_tr_b16 v[154:155], v233 offset:58368
    s_waitcnt lgkmcnt(14)
    v_mfma_f32_32x32x16_bf16 v[160:175], v[128:131], v[96:99], v[160:175]
    ds_read_b64_tr_b16 a[132:133], v229 offset:1024
    ds_read_b64_tr_b16 a[134:135], v229 offset:1536
    ds_read_b64_tr_b16 v[156:157], v233 offset:61440
    ds_read_b64_tr_b16 v[158:159], v233 offset:62464
    s_waitcnt lgkmcnt(15)
    v_mfma_f32_32x32x16_bf16 v[160:175], v[132:135], v[100:103], v[160:175]
    ds_read_b64_tr_b16 a[136:137], v229 offset:2048
    ds_read_b64_tr_b16 a[138:139], v229 offset:2560
    ds_read_b64_tr_b16 v[128:129], v234 offset:0
    ds_read_b64_tr_b16 v[130:131], v234 offset:1024
    s_waitcnt lgkmcnt(15)
    v_mfma_f32_32x32x16_bf16 v[160:175], v[136:139], v[104:107], v[160:175]
    buffer_load_dwordx4 a[32:35], v240, s[28:31], s34 offen offset:0 sc1
    ds_read_b64_tr_b16 a[140:141], v229 offset:3072
    ds_read_b64_tr_b16 a[142:143], v229 offset:3584
    ds_read_b64_tr_b16 v[132:133], v234 offset:4096
    ds_read_b64_tr_b16 v[134:135], v234 offset:5120
    v_mfma_f32_32x32x16_bf16 v[160:175], v[140:143], v[108:111], v[160:175]
    ds_read_b64_tr_b16 a[144:145], v229 offset:4096
    ds_read_b64_tr_b16 a[146:147], v229 offset:4608
    ds_read_b64_tr_b16 v[136:137], v234 offset:8192
    ds_read_b64_tr_b16 v[138:139], v234 offset:9216
    s_waitcnt lgkmcnt(15)
    v_mfma_f32_32x32x16_bf16 v[160:175], v[144:147], v[112:115], v[160:175]
    ds_read_b64_tr_b16 a[148:149], v229 offset:5120
    ds_read_b64_tr_b16 a[150:151], v229 offset:5632
    ds_read_b64_tr_b16 v[140:141], v234 offset:12288
    ds_read_b64_tr_b16 v[142:143], v234 offset:13312
    v_mfma_f32_32x32x16_bf16 v[160:175], v[148:151], v[116:119], v[160:175]
    buffer_load_dwordx4 a[36:39], v240, s[28:31], s34 offen offset:1024 sc1
    ds_read_b64_tr_b16 a[152:153], v229 offset:6144
    ds_read_b64_tr_b16 a[154:155], v229 offset:6656
    ds_read_b64_tr_b16 v[144:145], v234 offset:16384
    ds_read_b64_tr_b16 v[146:147], v234 offset:17408
    v_mfma_f32_32x32x16_bf16 v[160:175], v[152:155], v[120:123], v[160:175]
    ds_read_b64_tr_b16 a[156:157], v229 offset:7168
    ds_read_b64_tr_b16 a[158:159], v229 offset:7680
    ds_read_b64_tr_b16 v[148:149], v234 offset:20480
    ds_read_b64_tr_b16 v[150:151], v234 offset:21504
    s_waitcnt lgkmcnt(15)
    v_mfma_f32_32x32x16_bf16 v[160:175], v[156:159], v[124:127], v[160:175]
    ds_read_b64_tr_b16 v[152:153], v234 offset:24576
    ds_read_b64_tr_b16 v[154:155], v234 offset:25600
    v_mfma_f32_32x32x16_bf16 v[176:191], v[128:131], v[0:3], 0
    buffer_load_dwordx4 a[40:43], v240, s[28:31], s34 offen offset:2048 sc1
    s_waitcnt lgkmcnt(4)
    s_add_u32 m0, s57, 0
    s_lshl_b32 s61, s81, 4
    s_add_u32 s61, s61, 0
    buffer_load_dwordx4 v228, s[72:75], s61 offen lds
    ds_read_b64_tr_b16 v[156:157], v234 offset:28672
    ds_read_b64_tr_b16 v[158:159], v234 offset:29696
    v_mfma_f32_32x32x16_bf16 v[176:191], v[132:135], v[4:7], v[176:191]
    s_waitcnt vmcnt(9)
    s_lshl_b32 s58, s26, 2
    s_add_u32 s58, s58, s23
    v_mov_b32 v248, s58
    s_mov_b64 exec, 1
    global_store_dword v246, v248, s[42:43] sc1
    s_mov_b64 exec, -1
    s_add_u32 m0, s57, 1024
    s_lshl_b32 s61, s81, 4
    s_add_u32 s61, s61, 16384
    buffer_load_dwordx4 v228, s[72:75], s61 offen lds
    ds_read_b64_tr_b16 v[128:129], v234 offset:32768
    ds_read_b64_tr_b16 v[130:131], v234 offset:33792
    v_mfma_f32_32x32x16_bf16 v[176:191], v[136:139], v[8:11], v[176:191]
    s_add_u32 m0, s57, 2048
    s_lshl_b32 s61, s81, 4
    s_add_u32 s61, s61, 32768
    buffer_load_dwordx4 v228, s[72:75], s61 offen lds
    ds_read_b64_tr_b16 v[132:133], v234 offset:36864
    ds_read_b64_tr_b16 v[134:135], v234 offset:37888
    v_mfma_f32_32x32x16_bf16 v[176:191], v[140:143], v[12:15], v[176:191]
    buffer_load_dwordx4 a[44:47], v240, s[28:31], s34 offen offset:3072 sc1
    v_cvt_pk_bf16_f32 v192, v160, v161
    v_cvt_pk_bf16_f32 v193, v162, v163
    s_add_u32 m0, s57, 3072
    s_lshl_b32 s61, s81, 4
    s_add_u32 s61, s61, 49152
    buffer_load_dwordx4 v228, s[72:75], s61 offen lds
    ds_read_b64_tr_b16 v[136:137], v234 offset:40960
    ds_read_b64_tr_b16 v[138:139], v234 offset:41984
    v_mfma_f32_32x32x16_bf16 v[176:191], v[144:147], v[16:19], v[176:191]
    v_cvt_pk_bf16_f32 v194, v164, v165
    v_cvt_pk_bf16_f32 v195, v166, v167
    s_add_u32 m0, s57, 4096
    s_lshl_b32 s61, s81, 4
    s_add_u32 s61, s61, 65536
    buffer_load_dwordx4 v228, s[72:75], s61 offen lds
    ds_read_b64_tr_b16 v[140:141], v234 offset:45056
    ds_read_b64_tr_b16 v[142:143], v234 offset:46080
    s_waitcnt lgkmcnt(12)
    v_mfma_f32_32x32x16_bf16 v[176:191], v[148:151], v[20:23], v[176:191]
    v_cvt_pk_bf16_f32 v196, v168, v169
    v_cvt_pk_bf16_f32 v197, v170, v171
    s_add_u32 m0, s57, 5120
    s_lshl_b32 s61, s81, 4
    s_add_u32 s61, s61, 81920
    buffer_load_dwordx4 v228, s[72:75], s61 offen lds
    ds_read_b64_tr_b16 v[144:145], v234 offset:49152
    ds_read_b64_tr_b16 v[146:147], v234 offset:50176
    s_waitcnt lgkmcnt(12)
    v_mfma_f32_32x32x16_bf16 v[176:191], v[152:155], v[24:27], v[176:191]
    buffer_load_dwordx4 a[48:51], v240, s[28:31], s35 offen offset:0 sc1
    v_cvt_pk_bf16_f32 v198, v172, v173
    v_cvt_pk_bf16_f32 v199, v174, v175
    buffer_store_dwordx4 v[192:195], v242, s[52:55], s32 offen offset:0 sc1
    s_add_u32 m0, s57, 6144
    s_lshl_b32 s61, s81, 4
    s_add_u32 s61, s61, 98304
    buffer_load_dwordx4 v228, s[72:75], s61 offen lds
    ds_read_b64_tr_b16 v[148:149], v234 offset:53248
    ds_read_b64_tr_b16 v[150:151], v234 offset:54272
    s_waitcnt lgkmcnt(12)
    v_mfma_f32_32x32x16_bf16 v[176:191], v[156:159], v[28:31], v[176:191]
    s_add_u32 m0, s57, 7168
    s_lshl_b32 s61, s81, 4
    s_add_u32 s61, s61, 114688
    buffer_load_dwordx4 v228, s[72:75], s61 offen lds
    ds_read_b64_tr_b16 v[152:153], v234 offset:57344
    ds_read_b64_tr_b16 v[154:155], v234 offset:58368
    s_waitcnt lgkmcnt(12)
    v_mfma_f32_32x32x16_bf16 v[176:191], v[128:131], v[32:35], v[176:191]
    ds_read_b64_tr_b16 v[156:157], v234 offset:61440
    ds_read_b64_tr_b16 v[158:159], v234 offset:62464
    s_waitcnt lgkmcnt(12)
    v_mfma_f32_32x32x16_bf16 v[176:191], v[132:135], v[36:39], v[176:191]
    buffer_load_dwordx4 a[52:55], v240, s[28:31], s35 offen offset:1024 sc1
    buffer_store_dwordx4 v[196:199], v242, s[52:55], s32 offen offset:512 sc1
    ds_read_b64_tr_b16 v[128:129], v235 offset:0
    ds_read_b64_tr_b16 v[130:131], v235 offset:1024
    s_waitcnt lgkmcnt(12)
    v_mfma_f32_32x32x16_bf16 v[176:191], v[136:139], v[40:43], v[176:191]
    ds_read_b64_tr_b16 v[132:133], v235 offset:4096
    ds_read_b64_tr_b16 v[134:135], v235 offset:5120
    s_waitcnt lgkmcnt(12)
    v_mfma_f32_32x32x16_bf16 v[176:191], v[140:143], v[44:47], v[176:191]
    ds_read_b64_tr_b16 v[136:137], v235 offset:8192
    ds_read_b64_tr_b16 v[138:139], v235 offset:9216
    s_waitcnt lgkmcnt(12)
    v_mfma_f32_32x32x16_bf16 v[176:191], v[144:147], v[48:51], v[176:191]
    buffer_load_dwordx4 a[56:59], v240, s[28:31], s35 offen offset:2048 sc1
    ds_read_b64_tr_b16 v[140:141], v235 offset:12288
    ds_read_b64_tr_b16 v[142:143], v235 offset:13312
    s_waitcnt lgkmcnt(12)
    v_mfma_f32_32x32x16_bf16 v[176:191], v[148:151], v[52:55], v[176:191]
    ds_read_b64_tr_b16 v[144:145], v235 offset:16384
    ds_read_b64_tr_b16 v[146:147], v235 offset:17408
    s_waitcnt lgkmcnt(12)
    v_mfma_f32_32x32x16_bf16 v[176:191], v[152:155], v[56:59], v[176:191]
    ds_read_b64_tr_b16 v[148:149], v235 offset:20480
    ds_read_b64_tr_b16 v[150:151], v235 offset:21504
    s_waitcnt lgkmcnt(12)
    v_mfma_f32_32x32x16_bf16 v[176:191], v[156:159], v[60:63], v[176:191]
    buffer_load_dwordx4 a[60:63], v240, s[28:31], s35 offen offset:3072 sc1
    ds_read_b64_tr_b16 v[152:153], v235 offset:24576
    ds_read_b64_tr_b16 v[154:155], v235 offset:25600
    s_waitcnt lgkmcnt(12)
    v_mfma_f32_32x32x16_bf16 v[176:191], v[128:131], v[64:67], v[176:191]
    ds_read_b64_tr_b16 v[156:157], v235 offset:28672
    ds_read_b64_tr_b16 v[158:159], v235 offset:29696
    s_waitcnt lgkmcnt(12)
    v_mfma_f32_32x32x16_bf16 v[176:191], v[132:135], v[68:71], v[176:191]
    ds_read_b64_tr_b16 v[128:129], v235 offset:32768
    ds_read_b64_tr_b16 v[130:131], v235 offset:33792
    s_waitcnt lgkmcnt(12)
    v_mfma_f32_32x32x16_bf16 v[176:191], v[136:139], v[72:75], v[176:191]
    buffer_load_dwordx4 a[64:67], v240, s[28:31], s36 offen offset:0 sc1
    ds_read_b64_tr_b16 v[132:133], v235 offset:36864
    ds_read_b64_tr_b16 v[134:135], v235 offset:37888
    s_waitcnt lgkmcnt(12)
    v_mfma_f32_32x32x16_bf16 v[176:191], v[140:143], v[76:79], v[176:191]
    ds_read_b64_tr_b16 v[136:137], v235 offset:40960
    ds_read_b64_tr_b16 v[138:139], v235 offset:41984
    s_waitcnt lgkmcnt(12)
    v_mfma_f32_32x32x16_bf16 v[176:191], v[144:147], v[80:83], v[176:191]
    ds_read_b64_tr_b16 v[140:141], v235 offset:45056
    ds_read_b64_tr_b16 v[142:143], v235 offset:46080
    s_waitcnt lgkmcnt(12)
    v_mfma_f32_32x32x16_bf16 v[176:191], v[148:151], v[84:87], v[176:191]
    buffer_load_dwordx4 a[68:71], v240, s[28:31], s36 offen offset:1024 sc1
    ds_read_b64_tr_b16 v[144:145], v235 offset:49152
    ds_read_b64_tr_b16 v[146:147], v235 offset:50176
    s_waitcnt lgkmcnt(12)
    v_mfma_f32_32x32x16_bf16 v[176:191], v[152:155], v[88:91], v[176:191]
    ds_read_b64_tr_b16 v[148:149], v235 offset:53248
    ds_read_b64_tr_b16 v[150:151], v235 offset:54272
    s_waitcnt lgkmcnt(12)
    v_mfma_f32_32x32x16_bf16 v[176:191], v[156:159], v[92:95], v[176:191]
    s_waitcnt vmcnt(6)
    ds_read_b64_tr_b16 a[160:161], v229 offset:0
    ds_read_b64_tr_b16 a[162:163], v229 offset:512
    ds_read_b64_tr_b16 v[152:153], v235 offset:57344
    ds_read_b64_tr_b16 v[154:155], v235 offset:58368
    s_waitcnt lgkmcnt(14)
    v_mfma_f32_32x32x16_bf16 v[176:191], v[128:131], v[96:99], v[176:191]
    buffer_load_dwordx4 a[72:75], v240, s[28:31], s36 offen offset:2048 sc1
    ds_read_b64_tr_b16 a[164:165], v229 offset:1024
    ds_read_b64_tr_b16 a[166:167], v229 offset:1536
    ds_read_b64_tr_b16 v[156:157], v235 offset:61440
    ds_read_b64_tr_b16 v[158:159], v235 offset:62464
    s_waitcnt lgkmcnt(15)
    v_mfma_f32_32x32x16_bf16 v[176:191], v[132:135], v[100:103], v[176:191]
    ds_read_b64_tr_b16 a[168:169], v229 offset:2048
    ds_read_b64_tr_b16 a[170:171], v229 offset:2560
    ds_read_b64_tr_b16 v[128:129], v236 offset:0
    ds_read_b64_tr_b16 v[130:131], v236 offset:1024
    s_waitcnt lgkmcnt(15)
    v_mfma_f32_32x32x16_bf16 v[176:191], v[136:139], v[104:107], v[176:191]
    ds_read_b64_tr_b16 a[172:173], v229 offset:3072
    ds_read_b64_tr_b16 a[174:175], v229 offset:3584
    ds_read_b64_tr_b16 v[132:133], v236 offset:4096
    ds_read_b64_tr_b16 v[134:135], v236 offset:5120
    v_mfma_f32_32x32x16_bf16 v[176:191], v[140:143], v[108:111], v[176:191]
    buffer_load_dwordx4 a[76:79], v240, s[28:31], s36 offen offset:3072 sc1
    ds_read_b64_tr_b16 a[176:177], v229 offset:4096
    ds_read_b64_tr_b16 a[178:179], v229 offset:4608
    ds_read_b64_tr_b16 v[136:137], v236 offset:8192
    ds_read_b64_tr_b16 v[138:139], v236 offset:9216
    s_waitcnt lgkmcnt(15)
    v_mfma_f32_32x32x16_bf16 v[176:191], v[144:147], v[112:115], v[176:191]
    ds_read_b64_tr_b16 a[180:181], v229 offset:5120
    ds_read_b64_tr_b16 a[182:183], v229 offset:5632
    ds_read_b64_tr_b16 v[140:141], v236 offset:12288
    ds_read_b64_tr_b16 v[142:143], v236 offset:13312
    v_mfma_f32_32x32x16_bf16 v[176:191], v[148:151], v[116:119], v[176:191]
    ds_read_b64_tr_b16 a[184:185], v229 offset:6144
    ds_read_b64_tr_b16 a[186:187], v229 offset:6656
    ds_read_b64_tr_b16 v[144:145], v236 offset:16384
    ds_read_b64_tr_b16 v[146:147], v236 offset:17408
    v_mfma_f32_32x32x16_bf16 v[176:191], v[152:155], v[120:123], v[176:191]
    buffer_load_dwordx4 a[80:83], v240, s[28:31], s37 offen offset:0 sc1
    ds_read_b64_tr_b16 a[188:189], v229 offset:7168
    ds_read_b64_tr_b16 a[190:191], v229 offset:7680
    ds_read_b64_tr_b16 v[148:149], v236 offset:20480
    ds_read_b64_tr_b16 v[150:151], v236 offset:21504
    s_waitcnt lgkmcnt(15)
    v_mfma_f32_32x32x16_bf16 v[176:191], v[156:159], v[124:127], v[176:191]
    ds_read_b64_tr_b16 v[152:153], v236 offset:24576
    ds_read_b64_tr_b16 v[154:155], v236 offset:25600
    v_mfma_f32_32x32x16_bf16 v[160:175], v[128:131], v[0:3], 0
    s_waitcnt lgkmcnt(4)
    s_add_u32 m0, s57, 0
    s_lshl_b32 s61, s82, 4
    s_add_u32 s61, s61, 0
    buffer_load_dwordx4 v228, s[72:75], s61 offen lds
    ds_read_b64_tr_b16 v[156:157], v236 offset:28672
    ds_read_b64_tr_b16 v[158:159], v236 offset:29696
    v_mfma_f32_32x32x16_bf16 v[160:175], v[132:135], v[4:7], v[160:175]
    buffer_load_dwordx4 a[84:87], v240, s[28:31], s37 offen offset:1024 sc1
    s_add_u32 m0, s57, 1024
    s_lshl_b32 s61, s82, 4
    s_add_u32 s61, s61, 16384
    buffer_load_dwordx4 v228, s[72:75], s61 offen lds
    ds_read_b64_tr_b16 v[128:129], v236 offset:32768
    ds_read_b64_tr_b16 v[130:131], v236 offset:33792
    v_mfma_f32_32x32x16_bf16 v[160:175], v[136:139], v[8:11], v[160:175]
    s_add_u32 m0, s57, 2048
    s_lshl_b32 s61, s82, 4
    s_add_u32 s61, s61, 32768
    buffer_load_dwordx4 v228, s[72:75], s61 offen lds
    ds_read_b64_tr_b16 v[132:133], v236 offset:36864
    ds_read_b64_tr_b16 v[134:135], v236 offset:37888
    v_mfma_f32_32x32x16_bf16 v[160:175], v[140:143], v[12:15], v[160:175]
    v_cvt_pk_bf16_f32 v200, v176, v177
    v_cvt_pk_bf16_f32 v201, v178, v179
    s_add_u32 m0, s57, 3072
    s_lshl_b32 s61, s82, 4
    s_add_u32 s61, s61, 49152
    buffer_load_dwordx4 v228, s[72:75], s61 offen lds
    ds_read_b64_tr_b16 v[136:137], v236 offset:40960
    ds_read_b64_tr_b16 v[138:139], v236 offset:41984
    v_mfma_f32_32x32x16_bf16 v[160:175], v[144:147], v[16:19], v[160:175]
    buffer_load_dwordx4 a[88:91], v240, s[28:31], s37 offen offset:2048 sc1
    v_cvt_pk_bf16_f32 v202, v180, v181
    v_cvt_pk_bf16_f32 v203, v182, v183
    s_add_u32 m0, s57, 4096
    s_lshl_b32 s61, s82, 4
    s_add_u32 s61, s61, 65536
    buffer_load_dwordx4 v228, s[72:75], s61 offen lds
    ds_read_b64_tr_b16 v[140:141], v236 offset:45056
    ds_read_b64_tr_b16 v[142:143], v236 offset:46080
    s_waitcnt lgkmcnt(12)
    v_mfma_f32_32x32x16_bf16 v[160:175], v[148:151], v[20:23], v[160:175]
    v_cvt_pk_bf16_f32 v204, v184, v185
    v_cvt_pk_bf16_f32 v205, v186, v187
    s_add_u32 m0, s57, 5120
    s_lshl_b32 s61, s82, 4
    s_add_u32 s61, s61, 81920
    buffer_load_dwordx4 v228, s[72:75], s61 offen lds
    ds_read_b64_tr_b16 v[144:145], v236 offset:49152
    ds_read_b64_tr_b16 v[146:147], v236 offset:50176
    s_waitcnt lgkmcnt(12)
    v_mfma_f32_32x32x16_bf16 v[160:175], v[152:155], v[24:27], v[160:175]
    v_cvt_pk_bf16_f32 v206, v188, v189
    v_cvt_pk_bf16_f32 v207, v190, v191
    buffer_store_dwordx4 v[200:203], v242, s[52:55], s33 offen offset:0 sc1
    s_add_u32 m0, s57, 6144
    s_lshl_b32 s61, s82, 4
    s_add_u32 s61, s61, 98304
    buffer_load_dwordx4 v228, s[72:75], s61 offen lds
    ds_read_b64_tr_b16 v[148:149], v236 offset:53248
    ds_read_b64_tr_b16 v[150:151], v236 offset:54272
    s_waitcnt lgkmcnt(12)
    v_mfma_f32_32x32x16_bf16 v[160:175], v[156:159], v[28:31], v[160:175]
    buffer_load_dwordx4 a[92:95], v240, s[28:31], s37 offen offset:3072 sc1
    s_add_u32 m0, s57, 7168
    s_lshl_b32 s61, s82, 4
    s_add_u32 s61, s61, 114688
    buffer_load_dwordx4 v228, s[72:75], s61 offen lds
    ds_read_b64_tr_b16 v[152:153], v236 offset:57344
    ds_read_b64_tr_b16 v[154:155], v236 offset:58368
    s_waitcnt lgkmcnt(12)
    v_mfma_f32_32x32x16_bf16 v[160:175], v[128:131], v[32:35], v[160:175]
    ds_read_b64_tr_b16 v[156:157], v236 offset:61440
    ds_read_b64_tr_b16 v[158:159], v236 offset:62464
    s_waitcnt lgkmcnt(12)
    v_mfma_f32_32x32x16_bf16 v[160:175], v[132:135], v[36:39], v[160:175]
    buffer_store_dwordx4 v[204:207], v242, s[52:55], s33 offen offset:512 sc1
    ds_read_b64_tr_b16 v[128:129], v237 offset:0
    ds_read_b64_tr_b16 v[130:131], v237 offset:1024
    s_waitcnt lgkmcnt(12)
    v_mfma_f32_32x32x16_bf16 v[160:175], v[136:139], v[40:43], v[160:175]
    buffer_load_dwordx4 a[96:99], v240, s[28:31], s38 offen offset:0 sc1
    ds_read_b64_tr_b16 v[132:133], v237 offset:4096
    ds_read_b64_tr_b16 v[134:135], v237 offset:5120
    s_waitcnt lgkmcnt(12)
    v_mfma_f32_32x32x16_bf16 v[160:175], v[140:143], v[44:47], v[160:175]
    ds_read_b64_tr_b16 v[136:137], v237 offset:8192
    ds_read_b64_tr_b16 v[138:139], v237 offset:9216
    s_waitcnt lgkmcnt(12)
    v_mfma_f32_32x32x16_bf16 v[160:175], v[144:147], v[48:51], v[160:175]
    ds_read_b64_tr_b16 v[140:141], v237 offset:12288
    ds_read_b64_tr_b16 v[142:143], v237 offset:13312
    s_waitcnt lgkmcnt(12)
    v_mfma_f32_32x32x16_bf16 v[160:175], v[148:151], v[52:55], v[160:175]
    buffer_load_dwordx4 a[100:103], v240, s[28:31], s38 offen offset:1024 sc1
    ds_read_b64_tr_b16 v[144:145], v237 offset:16384
    ds_read_b64_tr_b16 v[146:147], v237 offset:17408
    s_waitcnt lgkmcnt(12)
    v_mfma_f32_32x32x16_bf16 v[160:175], v[152:155], v[56:59], v[160:175]
    ds_read_b64_tr_b16 v[148:149], v237 offset:20480
    ds_read_b64_tr_b16 v[150:151], v237 offset:21504
    s_waitcnt lgkmcnt(12)
    v_mfma_f32_32x32x16_bf16 v[160:175], v[156:159], v[60:63], v[160:175]
    ds_read_b64_tr_b16 v[152:153], v237 offset:24576
    ds_read_b64_tr_b16 v[154:155], v237 offset:25600
    s_waitcnt lgkmcnt(12)
    v_mfma_f32_32x32x16_bf16 v[160:175], v[128:131], v[64:67], v[160:175]
    buffer_load_dwordx4 a[104:107], v240, s[28:31], s38 offen offset:2048 sc1
    ds_read_b64_tr_b16 v[156:157], v237 offset:28672
    ds_read_b64_tr_b16 v[158:159], v237 offset:29696
    s_waitcnt lgkmcnt(12)
    v_mfma_f32_32x32x16_bf16 v[160:175], v[132:135], v[68:71], v[160:175]
    ds_read_b64_tr_b16 v[128:129], v237 offset:32768
    ds_read_b64_tr_b16 v[130:131], v237 offset:33792
    s_waitcnt lgkmcnt(12)
    v_mfma_f32_32x32x16_bf16 v[160:175], v[136:139], v[72:75], v[160:175]
    ds_read_b64_tr_b16 v[132:133], v237 offset:36864
    ds_read_b64_tr_b16 v[134:135], v237 offset:37888
    s_waitcnt lgkmcnt(12)
    v_mfma_f32_32x32x16_bf16 v[160:175], v[140:143], v[76:79], v[160:175]
    buffer_load_dwordx4 a[108:111], v240, s[28:31], s38 offen offset:3072 sc1
    ds_read_b64_tr_b16 v[136:137], v237 offset:40960
    ds_read_b64_tr_b16 v[138:139], v237 offset:41984
    s_waitcnt lgkmcnt(12)
    v_mfma_f32_32x32x16_bf16 v[160:175], v[144:147], v[80:83], v[160:175]
    ds_read_b64_tr_b16 v[140:141], v237 offset:45056
    ds_read_b64_tr_b16 v[142:143], v237 offset:46080
    s_waitcnt lgkmcnt(12)
    v_mfma_f32_32x32x16_bf16 v[160:175], v[148:151], v[84:87], v[160:175]
    ds_read_b64_tr_b16 v[144:145], v237 offset:49152
    ds_read_b64_tr_b16 v[146:147], v237 offset:50176
    s_waitcnt lgkmcnt(12)
    v_mfma_f32_32x32x16_bf16 v[160:175], v[152:155], v[88:91], v[160:175]
    buffer_load_dwordx4 a[112:115], v240, s[28:31], s39 offen offset:0 sc1
    ds_read_b64_tr_b16 v[148:149], v237 offset:53248
    ds_read_b64_tr_b16 v[150:151], v237 offset:54272
    s_waitcnt lgkmcnt(12)
    v_mfma_f32_32x32x16_bf16 v[160:175], v[156:159], v[92:95], v[160:175]
    s_waitcnt vmcnt(6)
    ds_read_b64_tr_b16 a[192:193], v229 offset:0
    ds_read_b64_tr_b16 a[194:195], v229 offset:512
    ds_read_b64_tr_b16 v[152:153], v237 offset:57344
    ds_read_b64_tr_b16 v[154:155], v237 offset:58368
    s_waitcnt lgkmcnt(14)
    v_mfma_f32_32x32x16_bf16 v[160:175], v[128:131], v[96:99], v[160:175]
    ds_read_b64_tr_b16 a[196:197], v229 offset:1024
    ds_read_b64_tr_b16 a[198:199], v229 offset:1536
    ds_read_b64_tr_b16 v[156:157], v237 offset:61440
    ds_read_b64_tr_b16 v[158:159], v237 offset:62464
    s_waitcnt lgkmcnt(15)
    v_mfma_f32_32x32x16_bf16 v[160:175], v[132:135], v[100:103], v[160:175]
    buffer_load_dwordx4 a[116:119], v240, s[28:31], s39 offen offset:1024 sc1
    ds_read_b64_tr_b16 a[200:201], v229 offset:2048
    ds_read_b64_tr_b16 a[202:203], v229 offset:2560
    ds_read_b64_tr_b16 v[128:129], v238 offset:0
    ds_read_b64_tr_b16 v[130:131], v238 offset:1024
    s_waitcnt lgkmcnt(15)
    v_mfma_f32_32x32x16_bf16 v[160:175], v[136:139], v[104:107], v[160:175]
    ds_read_b64_tr_b16 a[204:205], v229 offset:3072
    ds_read_b64_tr_b16 a[206:207], v229 offset:3584
    ds_read_b64_tr_b16 v[132:133], v238 offset:4096
    ds_read_b64_tr_b16 v[134:135], v238 offset:5120
    v_mfma_f32_32x32x16_bf16 v[160:175], v[140:143], v[108:111], v[160:175]
    ds_read_b64_tr_b16 a[208:209], v229 offset:4096
    ds_read_b64_tr_b16 a[210:211], v229 offset:4608
    ds_read_b64_tr_b16 v[136:137], v238 offset:8192
    ds_read_b64_tr_b16 v[138:139], v238 offset:9216
    s_waitcnt lgkmcnt(15)
    v_mfma_f32_32x32x16_bf16 v[160:175], v[144:147], v[112:115], v[160:175]
    buffer_load_dwordx4 a[120:123], v240, s[28:31], s39 offen offset:2048 sc1
    ds_read_b64_tr_b16 a[212:213], v229 offset:5120
    ds_read_b64_tr_b16 a[214:215], v229 offset:5632
    ds_read_b64_tr_b16 v[140:141], v238 offset:12288
    ds_read_b64_tr_b16 v[142:143], v238 offset:13312
    v_mfma_f32_32x32x16_bf16 v[160:175], v[148:151], v[116:119], v[160:175]
    ds_read_b64_tr_b16 a[216:217], v229 offset:6144
    ds_read_b64_tr_b16 a[218:219], v229 offset:6656
    ds_read_b64_tr_b16 v[144:145], v238 offset:16384
    ds_read_b64_tr_b16 v[146:147], v238 offset:17408
    v_mfma_f32_32x32x16_bf16 v[160:175], v[152:155], v[120:123], v[160:175]
    ds_read_b64_tr_b16 a[220:221], v229 offset:7168
    ds_read_b64_tr_b16 a[222:223], v229 offset:7680
    ds_read_b64_tr_b16 v[148:149], v238 offset:20480
    ds_read_b64_tr_b16 v[150:151], v238 offset:21504
    s_waitcnt lgkmcnt(15)
    v_mfma_f32_32x32x16_bf16 v[160:175], v[156:159], v[124:127], v[160:175]
    buffer_load_dwordx4 a[124:127], v240, s[28:31], s39 offen offset:3072 sc1
    ds_read_b64_tr_b16 v[152:153], v238 offset:24576
    ds_read_b64_tr_b16 v[154:155], v238 offset:25600
    v_mfma_f32_32x32x16_bf16 v[176:191], v[128:131], v[0:3], 0
    s_waitcnt lgkmcnt(4)
    s_add_u32 m0, s57, 0
    s_lshl_b32 s61, s83, 4
    s_add_u32 s61, s61, 0
    buffer_load_dwordx4 v228, s[72:75], s61 offen lds
    ds_read_b64_tr_b16 v[156:157], v238 offset:28672
    ds_read_b64_tr_b16 v[158:159], v238 offset:29696
    v_mfma_f32_32x32x16_bf16 v[176:191], v[132:135], v[4:7], v[176:191]
    s_add_u32 m0, s57, 1024
    s_lshl_b32 s61, s83, 4
    s_add_u32 s61, s61, 16384
    buffer_load_dwordx4 v228, s[72:75], s61 offen lds
    ds_read_b64_tr_b16 v[128:129], v238 offset:32768
    ds_read_b64_tr_b16 v[130:131], v238 offset:33792
    v_mfma_f32_32x32x16_bf16 v[176:191], v[136:139], v[8:11], v[176:191]
    s_add_u32 m0, s57, 2048
    s_lshl_b32 s61, s83, 4
    s_add_u32 s61, s61, 32768
    buffer_load_dwordx4 v228, s[72:75], s61 offen lds
    ds_read_b64_tr_b16 v[132:133], v238 offset:36864
    ds_read_b64_tr_b16 v[134:135], v238 offset:37888
    v_mfma_f32_32x32x16_bf16 v[176:191], v[140:143], v[12:15], v[176:191]
    v_cvt_pk_bf16_f32 v192, v160, v161
    v_cvt_pk_bf16_f32 v193, v162, v163
    s_add_u32 m0, s57, 3072
    s_lshl_b32 s61, s83, 4
    s_add_u32 s61, s61, 49152
    buffer_load_dwordx4 v228, s[72:75], s61 offen lds
    ds_read_b64_tr_b16 v[136:137], v238 offset:40960
    ds_read_b64_tr_b16 v[138:139], v238 offset:41984
    v_mfma_f32_32x32x16_bf16 v[176:191], v[144:147], v[16:19], v[176:191]
    v_cvt_pk_bf16_f32 v194, v164, v165
    v_cvt_pk_bf16_f32 v195, v166, v167
    s_add_u32 m0, s57, 4096
    s_lshl_b32 s61, s83, 4
    s_add_u32 s61, s61, 65536
    buffer_load_dwordx4 v228, s[72:75], s61 offen lds
    ds_read_b64_tr_b16 v[140:141], v238 offset:45056
    ds_read_b64_tr_b16 v[142:143], v238 offset:46080
    s_waitcnt lgkmcnt(12)
    v_mfma_f32_32x32x16_bf16 v[176:191], v[148:151], v[20:23], v[176:191]
    v_cvt_pk_bf16_f32 v196, v168, v169
    v_cvt_pk_bf16_f32 v197, v170, v171
    s_add_u32 m0, s57, 5120
    s_lshl_b32 s61, s83, 4
    s_add_u32 s61, s61, 81920
    buffer_load_dwordx4 v228, s[72:75], s61 offen lds
    ds_read_b64_tr_b16 v[144:145], v238 offset:49152
    ds_read_b64_tr_b16 v[146:147], v238 offset:50176
    s_waitcnt lgkmcnt(12)
    v_mfma_f32_32x32x16_bf16 v[176:191], v[152:155], v[24:27], v[176:191]
    v_cvt_pk_bf16_f32 v198, v172, v173
    v_cvt_pk_bf16_f32 v199, v174, v175
    buffer_store_dwordx4 v[192:195], v242, s[52:55], s34 offen offset:0 sc1
    s_add_u32 m0, s57, 6144
    s_lshl_b32 s61, s83, 4
    s_add_u32 s61, s61, 98304
    buffer_load_dwordx4 v228, s[72:75], s61 offen lds
    ds_read_b64_tr_b16 v[148:149], v238 offset:53248
    ds_read_b64_tr_b16 v[150:151], v238 offset:54272
    s_waitcnt lgkmcnt(12)
    v_mfma_f32_32x32x16_bf16 v[176:191], v[156:159], v[28:31], v[176:191]
    s_add_u32 m0, s57, 7168
    s_lshl_b32 s61, s83, 4
    s_add_u32 s61, s61, 114688
    buffer_load_dwordx4 v228, s[72:75], s61 offen lds
    ds_read_b64_tr_b16 v[152:153], v238 offset:57344
    ds_read_b64_tr_b16 v[154:155], v238 offset:58368
    s_waitcnt lgkmcnt(12)
    v_mfma_f32_32x32x16_bf16 v[176:191], v[128:131], v[32:35], v[176:191]
    ds_read_b64_tr_b16 v[156:157], v238 offset:61440
    ds_read_b64_tr_b16 v[158:159], v238 offset:62464
    s_waitcnt lgkmcnt(12)
    v_mfma_f32_32x32x16_bf16 v[176:191], v[132:135], v[36:39], v[176:191]
    buffer_store_dwordx4 v[196:199], v242, s[52:55], s34 offen offset:512 sc1
    ds_read_b64_tr_b16 v[128:129], v239 offset:0
    ds_read_b64_tr_b16 v[130:131], v239 offset:1024
    s_waitcnt lgkmcnt(12)
    v_mfma_f32_32x32x16_bf16 v[176:191], v[136:139], v[40:43], v[176:191]
    ds_read_b64_tr_b16 v[132:133], v239 offset:4096
    ds_read_b64_tr_b16 v[134:135], v239 offset:5120
    s_waitcnt lgkmcnt(12)
    v_mfma_f32_32x32x16_bf16 v[176:191], v[140:143], v[44:47], v[176:191]
    ds_read_b64_tr_b16 v[136:137], v239 offset:8192
    ds_read_b64_tr_b16 v[138:139], v239 offset:9216
    s_waitcnt lgkmcnt(12)
    v_mfma_f32_32x32x16_bf16 v[176:191], v[144:147], v[48:51], v[176:191]
    ds_read_b64_tr_b16 v[140:141], v239 offset:12288
    ds_read_b64_tr_b16 v[142:143], v239 offset:13312
    s_waitcnt lgkmcnt(12)
    v_mfma_f32_32x32x16_bf16 v[176:191], v[148:151], v[52:55], v[176:191]
    ds_read_b64_tr_b16 v[144:145], v239 offset:16384
    ds_read_b64_tr_b16 v[146:147], v239 offset:17408
    s_waitcnt lgkmcnt(12)
    v_mfma_f32_32x32x16_bf16 v[176:191], v[152:155], v[56:59], v[176:191]
    ds_read_b64_tr_b16 v[148:149], v239 offset:20480
    ds_read_b64_tr_b16 v[150:151], v239 offset:21504
    s_waitcnt lgkmcnt(12)
    v_mfma_f32_32x32x16_bf16 v[176:191], v[156:159], v[60:63], v[176:191]
    ds_read_b64_tr_b16 v[152:153], v239 offset:24576
    ds_read_b64_tr_b16 v[154:155], v239 offset:25600
    s_waitcnt lgkmcnt(12)
    v_mfma_f32_32x32x16_bf16 v[176:191], v[128:131], v[64:67], v[176:191]
    ds_read_b64_tr_b16 v[156:157], v239 offset:28672
    ds_read_b64_tr_b16 v[158:159], v239 offset:29696
    s_waitcnt lgkmcnt(12)
    v_mfma_f32_32x32x16_bf16 v[176:191], v[132:135], v[68:71], v[176:191]
    ds_read_b64_tr_b16 v[128:129], v239 offset:32768
    ds_read_b64_tr_b16 v[130:131], v239 offset:33792
    s_waitcnt lgkmcnt(12)
    v_mfma_f32_32x32x16_bf16 v[176:191], v[136:139], v[72:75], v[176:191]
    ds_read_b64_tr_b16 v[132:133], v239 offset:36864
    ds_read_b64_tr_b16 v[134:135], v239 offset:37888
    s_waitcnt lgkmcnt(12)
    v_mfma_f32_32x32x16_bf16 v[176:191], v[140:143], v[76:79], v[176:191]
    ds_read_b64_tr_b16 v[136:137], v239 offset:40960
    ds_read_b64_tr_b16 v[138:139], v239 offset:41984
    s_waitcnt lgkmcnt(12)
    v_mfma_f32_32x32x16_bf16 v[176:191], v[144:147], v[80:83], v[176:191]
    ds_read_b64_tr_b16 v[140:141], v239 offset:45056
    ds_read_b64_tr_b16 v[142:143], v239 offset:46080
    s_waitcnt lgkmcnt(12)
    v_mfma_f32_32x32x16_bf16 v[176:191], v[148:151], v[84:87], v[176:191]
    ds_read_b64_tr_b16 v[144:145], v239 offset:49152
    ds_read_b64_tr_b16 v[146:147], v239 offset:50176
    s_waitcnt lgkmcnt(12)
    v_mfma_f32_32x32x16_bf16 v[176:191], v[152:155], v[88:91], v[176:191]
    ds_read_b64_tr_b16 v[148:149], v239 offset:53248
    ds_read_b64_tr_b16 v[150:151], v239 offset:54272
    s_waitcnt lgkmcnt(12)
    v_mfma_f32_32x32x16_bf16 v[176:191], v[156:159], v[92:95], v[176:191]
    s_waitcnt vmcnt(1)
    ds_read_b64_tr_b16 a[224:225], v229 offset:0
    ds_read_b64_tr_b16 a[226:227], v229 offset:512
    ds_read_b64_tr_b16 v[152:153], v239 offset:57344
    ds_read_b64_tr_b16 v[154:155], v239 offset:58368
    s_waitcnt lgkmcnt(14)
    v_mfma_f32_32x32x16_bf16 v[176:191], v[128:131], v[96:99], v[176:191]
    ds_read_b64_tr_b16 a[228:229], v229 offset:1024
    ds_read_b64_tr_b16 a[230:231], v229 offset:1536
    ds_read_b64_tr_b16 v[156:157], v239 offset:61440
    ds_read_b64_tr_b16 v[158:159], v239 offset:62464
    s_waitcnt lgkmcnt(15)
    v_mfma_f32_32x32x16_bf16 v[176:191], v[132:135], v[100:103], v[176:191]
    ds_read_b64_tr_b16 a[232:233], v229 offset:2048
    ds_read_b64_tr_b16 a[234:235], v229 offset:2560
    ds_read_b64_tr_b16 v[128:129], v232 offset:0
    ds_read_b64_tr_b16 v[130:131], v232 offset:1024
    s_waitcnt lgkmcnt(15)
    v_mfma_f32_32x32x16_bf16 v[176:191], v[136:139], v[104:107], v[176:191]
    ds_read_b64_tr_b16 a[236:237], v229 offset:3072
    ds_read_b64_tr_b16 a[238:239], v229 offset:3584
    ds_read_b64_tr_b16 v[132:133], v232 offset:4096
    ds_read_b64_tr_b16 v[134:135], v232 offset:5120
    v_mfma_f32_32x32x16_bf16 v[176:191], v[140:143], v[108:111], v[176:191]
    ds_read_b64_tr_b16 a[240:241], v229 offset:4096
    ds_read_b64_tr_b16 a[242:243], v229 offset:4608
    ds_read_b64_tr_b16 v[136:137], v232 offset:8192
    ds_read_b64_tr_b16 v[138:139], v232 offset:9216
    s_waitcnt lgkmcnt(15)
    v_mfma_f32_32x32x16_bf16 v[176:191], v[144:147], v[112:115], v[176:191]
    ds_read_b64_tr_b16 a[244:245], v229 offset:5120
    ds_read_b64_tr_b16 a[246:247], v229 offset:5632
    ds_read_b64_tr_b16 v[140:141], v232 offset:12288
    ds_read_b64_tr_b16 v[142:143], v232 offset:13312
    v_mfma_f32_32x32x16_bf16 v[176:191], v[148:151], v[116:119], v[176:191]
    ds_read_b64_tr_b16 a[248:249], v229 offset:6144
    ds_read_b64_tr_b16 a[250:251], v229 offset:6656
    ds_read_b64_tr_b16 v[144:145], v232 offset:16384
    ds_read_b64_tr_b16 v[146:147], v232 offset:17408
    v_mfma_f32_32x32x16_bf16 v[176:191], v[152:155], v[120:123], v[176:191]
    ds_read_b64_tr_b16 a[252:253], v229 offset:7168
    ds_read_b64_tr_b16 a[254:255], v229 offset:7680
    ds_read_b64_tr_b16 v[148:149], v232 offset:20480
    ds_read_b64_tr_b16 v[150:151], v232 offset:21504
    s_waitcnt lgkmcnt(15)
    v_mfma_f32_32x32x16_bf16 v[176:191], v[156:159], v[124:127], v[176:191]
    s_add_u32 s28, s28, 131072
    s_addc_u32 s29, s29, 0
    s_add_u32 s26, s26, 1
    ds_read_b64_tr_b16 v[152:153], v232 offset:24576
    ds_read_b64_tr_b16 v[154:155], v232 offset:25600
    v_mfma_f32_32x32x16_bf16 v[160:175], v[128:131], a[0:3], 0
    s_waitcnt lgkmcnt(4)
    s_add_u32 m0, s57, 0
    s_lshl_b32 s61, s84, 4
    s_add_u32 s61, s61, 0
    buffer_load_dwordx4 v228, s[72:75], s61 offen lds
    ds_read_b64_tr_b16 v[156:157], v232 offset:28672
    ds_read_b64_tr_b16 v[158:159], v232 offset:29696
    v_mfma_f32_32x32x16_bf16 v[160:175], v[132:135], a[4:7], v[160:175]
    s_add_u32 m0, s57, 1024
    s_lshl_b32 s61, s84, 4
    s_add_u32 s61, s61, 16384
    buffer_load_dwordx4 v228, s[72:75], s61 offen lds
    ds_read_b64_tr_b16 v[128:129], v232 offset:32768
    ds_read_b64_tr_b16 v[130:131], v232 offset:33792
    v_mfma_f32_32x32x16_bf16 v[160:175], v[136:139], a[8:11], v[160:175]
    s_add_u32 m0, s57, 2048
    s_lshl_b32 s61, s84, 4
    s_add_u32 s61, s61, 32768
    buffer_load_dwordx4 v228, s[72:75], s61 offen lds
    ds_read_b64_tr_b16 v[132:133], v232 offset:36864
    ds_read_b64_tr_b16 v[134:135], v232 offset:37888
    v_mfma_f32_32x32x16_bf16 v[160:175], v[140:143], a[12:15], v[160:175]
    v_cvt_pk_bf16_f32 v200, v176, v177
    v_cvt_pk_bf16_f32 v201, v178, v179
    s_add_u32 m0, s57, 3072
    s_lshl_b32 s61, s84, 4
    s_add_u32 s61, s61, 49152
    buffer_load_dwordx4 v228, s[72:75], s61 offen lds
    ds_read_b64_tr_b16 v[136:137], v232 offset:40960
    ds_read_b64_tr_b16 v[138:139], v232 offset:41984
    v_mfma_f32_32x32x16_bf16 v[160:175], v[144:147], a[16:19], v[160:175]
    v_cvt_pk_bf16_f32 v202, v180, v181
    v_cvt_pk_bf16_f32 v203, v182, v183
    s_add_u32 m0, s57, 4096
    s_lshl_b32 s61, s84, 4
    s_add_u32 s61, s61, 65536
    buffer_load_dwordx4 v228, s[72:75], s61 offen lds
    ds_read_b64_tr_b16 v[140:141], v232 offset:45056
    ds_read_b64_tr_b16 v[142:143], v232 offset:46080
    s_waitcnt lgkmcnt(12)
    v_mfma_f32_32x32x16_bf16 v[160:175], v[148:151], a[20:23], v[160:175]
    v_cvt_pk_bf16_f32 v204, v184, v185
    v_cvt_pk_bf16_f32 v205, v186, v187
    s_add_u32 m0, s57, 5120
    s_lshl_b32 s61, s84, 4
    s_add_u32 s61, s61, 81920
    buffer_load_dwordx4 v228, s[72:75], s61 offen lds
    ds_read_b64_tr_b16 v[144:145], v232 offset:49152
    ds_read_b64_tr_b16 v[146:147], v232 offset:50176
    s_waitcnt lgkmcnt(12)
    v_mfma_f32_32x32x16_bf16 v[160:175], v[152:155], a[24:27], v[160:175]
    v_cvt_pk_bf16_f32 v206, v188, v189
    v_cvt_pk_bf16_f32 v207, v190, v191
    buffer_store_dwordx4 v[200:203], v242, s[52:55], s35 offen offset:0 sc1
    s_add_u32 m0, s57, 6144
    s_lshl_b32 s61, s84, 4
    s_add_u32 s61, s61, 98304
    buffer_load_dwordx4 v228, s[72:75], s61 offen lds
    ds_read_b64_tr_b16 v[148:149], v232 offset:53248
    ds_read_b64_tr_b16 v[150:151], v232 offset:54272
    s_waitcnt lgkmcnt(12)
    v_mfma_f32_32x32x16_bf16 v[160:175], v[156:159], a[28:31], v[160:175]
    s_add_u32 m0, s57, 7168
    s_lshl_b32 s61, s84, 4
    s_add_u32 s61, s61, 114688
    buffer_load_dwordx4 v228, s[72:75], s61 offen lds
    ds_read_b64_tr_b16 v[152:153], v232 offset:57344
    ds_read_b64_tr_b16 v[154:155], v232 offset:58368
    s_waitcnt lgkmcnt(12)
    v_mfma_f32_32x32x16_bf16 v[160:175], v[128:131], a[32:35], v[160:175]
    ds_read_b64_tr_b16 v[156:157], v232 offset:61440
    ds_read_b64_tr_b16 v[158:159], v232 offset:62464
    s_waitcnt lgkmcnt(12)
    v_mfma_f32_32x32x16_bf16 v[160:175], v[132:135], a[36:39], v[160:175]
    buffer_store_dwordx4 v[204:207], v242, s[52:55], s35 offen offset:512 sc1
    s_add_u32 s52, s52, 2097152
    s_addc_u32 s53, s53, 0
    ds_read_b64_tr_b16 v[128:129], v233 offset:0
    ds_read_b64_tr_b16 v[130:131], v233 offset:1024
    s_waitcnt lgkmcnt(12)
    v_mfma_f32_32x32x16_bf16 v[160:175], v[136:139], a[40:43], v[160:175]
    ds_read_b64_tr_b16 v[132:133], v233 offset:4096
    ds_read_b64_tr_b16 v[134:135], v233 offset:5120
    s_waitcnt lgkmcnt(12)
    v_mfma_f32_32x32x16_bf16 v[160:175], v[140:143], a[44:47], v[160:175]
    ds_read_b64_tr_b16 v[136:137], v233 offset:8192
    ds_read_b64_tr_b16 v[138:139], v233 offset:9216
    s_waitcnt lgkmcnt(12)
    v_mfma_f32_32x32x16_bf16 v[160:175], v[144:147], a[48:51], v[160:175]
    ds_read_b64_tr_b16 v[140:141], v233 offset:12288
    ds_read_b64_tr_b16 v[142:143], v233 offset:13312
    s_waitcnt lgkmcnt(12)
    v_mfma_f32_32x32x16_bf16 v[160:175], v[148:151], a[52:55], v[160:175]
    ds_read_b64_tr_b16 v[144:145], v233 offset:16384
    ds_read_b64_tr_b16 v[146:147], v233 offset:17408
    s_waitcnt lgkmcnt(12)
    v_mfma_f32_32x32x16_bf16 v[160:175], v[152:155], a[56:59], v[160:175]
    ds_read_b64_tr_b16 v[148:149], v233 offset:20480
    ds_read_b64_tr_b16 v[150:151], v233 offset:21504
    s_waitcnt lgkmcnt(12)
    v_mfma_f32_32x32x16_bf16 v[160:175], v[156:159], a[60:63], v[160:175]
    ds_read_b64_tr_b16 v[152:153], v233 offset:24576
    ds_read_b64_tr_b16 v[154:155], v233 offset:25600
    s_waitcnt lgkmcnt(12)
    v_mfma_f32_32x32x16_bf16 v[160:175], v[128:131], a[64:67], v[160:175]
    ds_read_b64_tr_b16 v[156:157], v233 offset:28672
    ds_read_b64_tr_b16 v[158:159], v233 offset:29696
    s_waitcnt lgkmcnt(12)
    v_mfma_f32_32x32x16_bf16 v[160:175], v[132:135], a[68:71], v[160:175]
    ds_read_b64_tr_b16 v[128:129], v233 offset:32768
    ds_read_b64_tr_b16 v[130:131], v233 offset:33792
    s_waitcnt lgkmcnt(12)
    v_mfma_f32_32x32x16_bf16 v[160:175], v[136:139], a[72:75], v[160:175]
    ds_read_b64_tr_b16 v[132:133], v233 offset:36864
    ds_read_b64_tr_b16 v[134:135], v233 offset:37888
    s_waitcnt lgkmcnt(12)
    v_mfma_f32_32x32x16_bf16 v[160:175], v[140:143], a[76:79], v[160:175]
    ds_read_b64_tr_b16 v[136:137], v233 offset:40960
    ds_read_b64_tr_b16 v[138:139], v233 offset:41984
    s_waitcnt lgkmcnt(12)
    v_mfma_f32_32x32x16_bf16 v[160:175], v[144:147], a[80:83], v[160:175]
    ds_read_b64_tr_b16 v[140:141], v233 offset:45056
    ds_read_b64_tr_b16 v[142:143], v233 offset:46080
    s_waitcnt lgkmcnt(12)
    v_mfma_f32_32x32x16_bf16 v[160:175], v[148:151], a[84:87], v[160:175]
    ds_read_b64_tr_b16 v[144:145], v233 offset:49152
    ds_read_b64_tr_b16 v[146:147], v233 offset:50176
    s_waitcnt lgkmcnt(12)
    v_mfma_f32_32x32x16_bf16 v[160:175], v[152:155], a[88:91], v[160:175]
    ds_read_b64_tr_b16 v[148:149], v233 offset:53248
    ds_read_b64_tr_b16 v[150:151], v233 offset:54272
    s_waitcnt lgkmcnt(12)
    v_mfma_f32_32x32x16_bf16 v[160:175], v[156:159], a[92:95], v[160:175]
    s_waitcnt vmcnt(1)
    ds_read_b64_tr_b16 v[0:1], v229 offset:0
    ds_read_b64_tr_b16 v[2:3], v229 offset:512
    ds_read_b64_tr_b16 v[152:153], v233 offset:57344
    ds_read_b64_tr_b16 v[154:155], v233 offset:58368
    s_waitcnt lgkmcnt(14)
    v_mfma_f32_32x32x16_bf16 v[160:175], v[128:131], a[96:99], v[160:175]
    ds_read_b64_tr_b16 v[4:5], v229 offset:1024
    ds_read_b64_tr_b16 v[6:7], v229 offset:1536
    ds_read_b64_tr_b16 v[156:157], v233 offset:61440
    ds_read_b64_tr_b16 v[158:159], v233 offset:62464
    s_waitcnt lgkmcnt(15)
    v_mfma_f32_32x32x16_bf16 v[160:175], v[132:135], a[100:103], v[160:175]
    ds_read_b64_tr_b16 v[8:9], v229 offset:2048
    ds_read_b64_tr_b16 v[10:11], v229 offset:2560
    ds_read_b64_tr_b16 v[128:129], v234 offset:0
    ds_read_b64_tr_b16 v[130:131], v234 offset:1024
    s_waitcnt lgkmcnt(15)
    v_mfma_f32_32x32x16_bf16 v[160:175], v[136:139], a[104:107], v[160:175]
    ds_read_b64_tr_b16 v[12:13], v229 offset:3072
    ds_read_b64_tr_b16 v[14:15], v229 offset:3584
    ds_read_b64_tr_b16 v[132:133], v234 offset:4096
    ds_read_b64_tr_b16 v[134:135], v234 offset:5120
    v_mfma_f32_32x32x16_bf16 v[160:175], v[140:143], a[108:111], v[160:175]
    ds_read_b64_tr_b16 v[16:17], v229 offset:4096
    ds_read_b64_tr_b16 v[18:19], v229 offset:4608
    ds_read_b64_tr_b16 v[136:137], v234 offset:8192
    ds_read_b64_tr_b16 v[138:139], v234 offset:9216
    s_waitcnt lgkmcnt(15)
    v_mfma_f32_32x32x16_bf16 v[160:175], v[144:147], a[112:115], v[160:175]
    ds_read_b64_tr_b16 v[20:21], v229 offset:5120
    ds_read_b64_tr_b16 v[22:23], v229 offset:5632
    ds_read_b64_tr_b16 v[140:141], v234 offset:12288
    ds_read_b64_tr_b16 v[142:143], v234 offset:13312
    v_mfma_f32_32x32x16_bf16 v[160:175], v[148:151], a[116:119], v[160:175]
    ds_read_b64_tr_b16 v[24:25], v229 offset:6144
    ds_read_b64_tr_b16 v[26:27], v229 offset:6656
    ds_read_b64_tr_b16 v[144:145], v234 offset:16384
    ds_read_b64_tr_b16 v[146:147], v234 offset:17408
    v_mfma_f32_32x32x16_bf16 v[160:175], v[152:155], a[120:123], v[160:175]
    ds_read_b64_tr_b16 v[28:29], v229 offset:7168
    ds_read_b64_tr_b16 v[30:31], v229 offset:7680
    ds_read_b64_tr_b16 v[148:149], v234 offset:20480
    ds_read_b64_tr_b16 v[150:151], v234 offset:21504
    s_waitcnt lgkmcnt(15)
    v_mfma_f32_32x32x16_bf16 v[160:175], v[156:159], a[124:127], v[160:175]
    ds_read_b64_tr_b16 v[152:153], v234 offset:24576
    ds_read_b64_tr_b16 v[154:155], v234 offset:25600
    v_mfma_f32_32x32x16_bf16 v[176:191], v[128:131], a[0:3], 0
    s_waitcnt lgkmcnt(4)
    s_add_u32 m0, s57, 0
    s_lshl_b32 s61, s85, 4
    s_add_u32 s61, s61, 0
    buffer_load_dwordx4 v228, s[72:75], s61 offen lds
    ds_read_b64_tr_b16 v[156:157], v234 offset:28672
    ds_read_b64_tr_b16 v[158:159], v234 offset:29696
    v_mfma_f32_32x32x16_bf16 v[176:191], v[132:135], a[4:7], v[176:191]
    s_waitcnt vmcnt(1)
    s_lshl_b32 s58, s26, 2
    s_add_u32 s58, s58, s23
    v_mov_b32 v248, s58
    s_mov_b64 exec, 1
    global_store_dword v246, v248, s[42:43] sc1
    s_mov_b64 exec, -1
    s_add_u32 m0, s57, 1024
    s_lshl_b32 s61, s85, 4
    s_add_u32 s61, s61, 16384
    buffer_load_dwordx4 v228, s[72:75], s61 offen lds
    ds_read_b64_tr_b16 v[128:129], v234 offset:32768
    ds_read_b64_tr_b16 v[130:131], v234 offset:33792
    v_mfma_f32_32x32x16_bf16 v[176:191], v[136:139], a[8:11], v[176:191]
    s_add_u32 m0, s57, 2048
    s_lshl_b32 s61, s85, 4
    s_add_u32 s61, s61, 32768
    buffer_load_dwordx4 v228, s[72:75], s61 offen lds
    ds_read_b64_tr_b16 v[132:133], v234 offset:36864
    ds_read_b64_tr_b16 v[134:135], v234 offset:37888
    v_mfma_f32_32x32x16_bf16 v[176:191], v[140:143], a[12:15], v[176:191]
    v_cvt_pk_bf16_f32 v192, v160, v161
    v_cvt_pk_bf16_f32 v193, v162, v163
    s_add_u32 m0, s57, 3072
    s_lshl_b32 s61, s85, 4
    s_add_u32 s61, s61, 49152
    buffer_load_dwordx4 v228, s[72:75], s61 offen lds
    ds_read_b64_tr_b16 v[136:137], v234 offset:40960
    ds_read_b64_tr_b16 v[138:139], v234 offset:41984
    v_mfma_f32_32x32x16_bf16 v[176:191], v[144:147], a[16:19], v[176:191]
    v_cvt_pk_bf16_f32 v194, v164, v165
    v_cvt_pk_bf16_f32 v195, v166, v167
    s_add_u32 m0, s57, 4096
    s_lshl_b32 s61, s85, 4
    s_add_u32 s61, s61, 65536
    buffer_load_dwordx4 v228, s[72:75], s61 offen lds
    ds_read_b64_tr_b16 v[140:141], v234 offset:45056
    ds_read_b64_tr_b16 v[142:143], v234 offset:46080
    s_waitcnt lgkmcnt(12)
    v_mfma_f32_32x32x16_bf16 v[176:191], v[148:151], a[20:23], v[176:191]
    v_cvt_pk_bf16_f32 v196, v168, v169
    v_cvt_pk_bf16_f32 v197, v170, v171
    s_add_u32 m0, s57, 5120
    s_lshl_b32 s61, s85, 4
    s_add_u32 s61, s61, 81920
    buffer_load_dwordx4 v228, s[72:75], s61 offen lds
    ds_read_b64_tr_b16 v[144:145], v234 offset:49152
    ds_read_b64_tr_b16 v[146:147], v234 offset:50176
    s_waitcnt lgkmcnt(12)
    v_mfma_f32_32x32x16_bf16 v[176:191], v[152:155], a[24:27], v[176:191]
    v_cvt_pk_bf16_f32 v198, v172, v173
    v_cvt_pk_bf16_f32 v199, v174, v175
    buffer_store_dwordx4 v[192:195], v242, s[52:55], s32 offen offset:0 sc1
    s_add_u32 m0, s57, 6144
    s_lshl_b32 s61, s85, 4
    s_add_u32 s61, s61, 98304
    buffer_load_dwordx4 v228, s[72:75], s61 offen lds
    ds_read_b64_tr_b16 v[148:149], v234 offset:53248
    ds_read_b64_tr_b16 v[150:151], v234 offset:54272
    s_waitcnt lgkmcnt(12)
    v_mfma_f32_32x32x16_bf16 v[176:191], v[156:159], a[28:31], v[176:191]
    s_add_u32 m0, s57, 7168
    s_lshl_b32 s61, s85, 4
    s_add_u32 s61, s61, 114688
    buffer_load_dwordx4 v228, s[72:75], s61 offen lds
    ds_read_b64_tr_b16 v[152:153], v234 offset:57344
    ds_read_b64_tr_b16 v[154:155], v234 offset:58368
    s_waitcnt lgkmcnt(12)
    v_mfma_f32_32x32x16_bf16 v[176:191], v[128:131], a[32:35], v[176:191]
    ds_read_b64_tr_b16 v[156:157], v234 offset:61440
    ds_read_b64_tr_b16 v[158:159], v234 offset:62464
    s_waitcnt lgkmcnt(12)
    v_mfma_f32_32x32x16_bf16 v[176:191], v[132:135], a[36:39], v[176:191]
    buffer_store_dwordx4 v[196:199], v242, s[52:55], s32 offen offset:512 sc1
    ds_read_b64_tr_b16 v[128:129], v235 offset:0
    ds_read_b64_tr_b16 v[130:131], v235 offset:1024
    s_waitcnt lgkmcnt(12)
    v_mfma_f32_32x32x16_bf16 v[176:191], v[136:139], a[40:43], v[176:191]
    ds_read_b64_tr_b16 v[132:133], v235 offset:4096
    ds_read_b64_tr_b16 v[134:135], v235 offset:5120
    s_waitcnt lgkmcnt(12)
    v_mfma_f32_32x32x16_bf16 v[176:191], v[140:143], a[44:47], v[176:191]
    ds_read_b64_tr_b16 v[136:137], v235 offset:8192
    ds_read_b64_tr_b16 v[138:139], v235 offset:9216
    s_waitcnt lgkmcnt(12)
    v_mfma_f32_32x32x16_bf16 v[176:191], v[144:147], a[48:51], v[176:191]
    ds_read_b64_tr_b16 v[140:141], v235 offset:12288
    ds_read_b64_tr_b16 v[142:143], v235 offset:13312
    s_waitcnt lgkmcnt(12)
    v_mfma_f32_32x32x16_bf16 v[176:191], v[148:151], a[52:55], v[176:191]
    ds_read_b64_tr_b16 v[144:145], v235 offset:16384
    ds_read_b64_tr_b16 v[146:147], v235 offset:17408
    s_waitcnt lgkmcnt(12)
    v_mfma_f32_32x32x16_bf16 v[176:191], v[152:155], a[56:59], v[176:191]
    ds_read_b64_tr_b16 v[148:149], v235 offset:20480
    ds_read_b64_tr_b16 v[150:151], v235 offset:21504
    s_waitcnt lgkmcnt(12)
    v_mfma_f32_32x32x16_bf16 v[176:191], v[156:159], a[60:63], v[176:191]
    ds_read_b64_tr_b16 v[152:153], v235 offset:24576
    ds_read_b64_tr_b16 v[154:155], v235 offset:25600
    s_waitcnt lgkmcnt(12)
    v_mfma_f32_32x32x16_bf16 v[176:191], v[128:131], a[64:67], v[176:191]
    ds_read_b64_tr_b16 v[156:157], v235 offset:28672
    ds_read_b64_tr_b16 v[158:159], v235 offset:29696
    s_waitcnt lgkmcnt(12)
    v_mfma_f32_32x32x16_bf16 v[176:191], v[132:135], a[68:71], v[176:191]
    ds_read_b64_tr_b16 v[128:129], v235 offset:32768
    ds_read_b64_tr_b16 v[130:131], v235 offset:33792
    s_waitcnt lgkmcnt(12)
    v_mfma_f32_32x32x16_bf16 v[176:191], v[136:139], a[72:75], v[176:191]
    ds_read_b64_tr_b16 v[132:133], v235 offset:36864
    ds_read_b64_tr_b16 v[134:135], v235 offset:37888
    s_waitcnt lgkmcnt(12)
    v_mfma_f32_32x32x16_bf16 v[176:191], v[140:143], a[76:79], v[176:191]
    ds_read_b64_tr_b16 v[136:137], v235 offset:40960
    ds_read_b64_tr_b16 v[138:139], v235 offset:41984
    s_waitcnt lgkmcnt(12)
    v_mfma_f32_32x32x16_bf16 v[176:191], v[144:147], a[80:83], v[176:191]
    ds_read_b64_tr_b16 v[140:141], v235 offset:45056
    ds_read_b64_tr_b16 v[142:143], v235 offset:46080
    s_waitcnt lgkmcnt(12)
    v_mfma_f32_32x32x16_bf16 v[176:191], v[148:151], a[84:87], v[176:191]
    ds_read_b64_tr_b16 v[144:145], v235 offset:49152
    ds_read_b64_tr_b16 v[146:147], v235 offset:50176
    s_waitcnt lgkmcnt(12)
    v_mfma_f32_32x32x16_bf16 v[176:191], v[152:155], a[88:91], v[176:191]
    ds_read_b64_tr_b16 v[148:149], v235 offset:53248
    ds_read_b64_tr_b16 v[150:151], v235 offset:54272
    s_waitcnt lgkmcnt(12)
    v_mfma_f32_32x32x16_bf16 v[176:191], v[156:159], a[92:95], v[176:191]
    s_waitcnt vmcnt(1)
    ds_read_b64_tr_b16 v[32:33], v229 offset:0
    ds_read_b64_tr_b16 v[34:35], v229 offset:512
    ds_read_b64_tr_b16 v[152:153], v235 offset:57344
    ds_read_b64_tr_b16 v[154:155], v235 offset:58368
    s_waitcnt lgkmcnt(14)
    v_mfma_f32_32x32x16_bf16 v[176:191], v[128:131], a[96:99], v[176:191]
    ds_read_b64_tr_b16 v[36:37], v229 offset:1024
    ds_read_b64_tr_b16 v[38:39], v229 offset:1536
    ds_read_b64_tr_b16 v[156:157], v235 offset:61440
    ds_read_b64_tr_b16 v[158:159], v235 offset:62464
    s_waitcnt lgkmcnt(15)
    v_mfma_f32_32x32x16_bf16 v[176:191], v[132:135], a[100:103], v[176:191]
    ds_read_b64_tr_b16 v[40:41], v229 offset:2048
    ds_read_b64_tr_b16 v[42:43], v229 offset:2560
    ds_read_b64_tr_b16 v[128:129], v236 offset:0
    ds_read_b64_tr_b16 v[130:131], v236 offset:1024
    s_waitcnt lgkmcnt(15)
    v_mfma_f32_32x32x16_bf16 v[176:191], v[136:139], a[104:107], v[176:191]
    ds_read_b64_tr_b16 v[44:45], v229 offset:3072
    ds_read_b64_tr_b16 v[46:47], v229 offset:3584
    ds_read_b64_tr_b16 v[132:133], v236 offset:4096
    ds_read_b64_tr_b16 v[134:135], v236 offset:5120
    v_mfma_f32_32x32x16_bf16 v[176:191], v[140:143], a[108:111], v[176:191]
    ds_read_b64_tr_b16 v[48:49], v229 offset:4096
    ds_read_b64_tr_b16 v[50:51], v229 offset:4608
    ds_read_b64_tr_b16 v[136:137], v236 offset:8192
    ds_read_b64_tr_b16 v[138:139], v236 offset:9216
    s_waitcnt lgkmcnt(15)
    v_mfma_f32_32x32x16_bf16 v[176:191], v[144:147], a[112:115], v[176:191]
    ds_read_b64_tr_b16 v[52:53], v229 offset:5120
    ds_read_b64_tr_b16 v[54:55], v229 offset:5632
    ds_read_b64_tr_b16 v[140:141], v236 offset:12288
    ds_read_b64_tr_b16 v[142:143], v236 offset:13312
    v_mfma_f32_32x32x16_bf16 v[176:191], v[148:151], a[116:119], v[176:191]
    ds_read_b64_tr_b16 v[56:57], v229 offset:6144
    ds_read_b64_tr_b16 v[58:59], v229 offset:6656
    ds_read_b64_tr_b16 v[144:145], v236 offset:16384
    ds_read_b64_tr_b16 v[146:147], v236 offset:17408
    v_mfma_f32_32x32x16_bf16 v[176:191], v[152:155], a[120:123], v[176:191]
    ds_read_b64_tr_b16 v[60:61], v229 offset:7168
    ds_read_b64_tr_b16 v[62:63], v229 offset:7680
    ds_read_b64_tr_b16 v[148:149], v236 offset:20480
    ds_read_b64_tr_b16 v[150:151], v236 offset:21504
    s_waitcnt lgkmcnt(15)
    v_mfma_f32_32x32x16_bf16 v[176:191], v[156:159], a[124:127], v[176:191]
    ds_read_b64_tr_b16 v[152:153], v236 offset:24576
    ds_read_b64_tr_b16 v[154:155], v236 offset:25600
    v_mfma_f32_32x32x16_bf16 v[160:175], v[128:131], a[0:3], 0
    s_waitcnt lgkmcnt(4)
    s_add_u32 m0, s57, 0
    s_lshl_b32 s61, s86, 4
    s_add_u32 s61, s61, 0
    buffer_load_dwordx4 v228, s[72:75], s61 offen lds
    ds_read_b64_tr_b16 v[156:157], v236 offset:28672
    ds_read_b64_tr_b16 v[158:159], v236 offset:29696
    v_mfma_f32_32x32x16_bf16 v[160:175], v[132:135], a[4:7], v[160:175]
    s_add_u32 m0, s57, 1024
    s_lshl_b32 s61, s86, 4
    s_add_u32 s61, s61, 16384
    buffer_load_dwordx4 v228, s[72:75], s61 offen lds
    ds_read_b64_tr_b16 v[128:129], v236 offset:32768
    ds_read_b64_tr_b16 v[130:131], v236 offset:33792
    v_mfma_f32_32x32x16_bf16 v[160:175], v[136:139], a[8:11], v[160:175]
    s_add_u32 m0, s57, 2048
    s_lshl_b32 s61, s86, 4
    s_add_u32 s61, s61, 32768
    buffer_load_dwordx4 v228, s[72:75], s61 offen lds
    ds_read_b64_tr_b16 v[132:133], v236 offset:36864
    ds_read_b64_tr_b16 v[134:135], v236 offset:37888
    v_mfma_f32_32x32x16_bf16 v[160:175], v[140:143], a[12:15], v[160:175]
    v_cvt_pk_bf16_f32 v200, v176, v177
    v_cvt_pk_bf16_f32 v201, v178, v179
    s_add_u32 m0, s57, 3072
    s_lshl_b32 s61, s86, 4
    s_add_u32 s61, s61, 49152
    buffer_load_dwordx4 v228, s[72:75], s61 offen lds
    ds_read_b64_tr_b16 v[136:137], v236 offset:40960
    ds_read_b64_tr_b16 v[138:139], v236 offset:41984
    v_mfma_f32_32x32x16_bf16 v[160:175], v[144:147], a[16:19], v[160:175]
    v_cvt_pk_bf16_f32 v202, v180, v181
    v_cvt_pk_bf16_f32 v203, v182, v183
    s_add_u32 m0, s57, 4096
    s_lshl_b32 s61, s86, 4
    s_add_u32 s61, s61, 65536
    buffer_load_dwordx4 v228, s[72:75], s61 offen lds
    ds_read_b64_tr_b16 v[140:141], v236 offset:45056
    ds_read_b64_tr_b16 v[142:143], v236 offset:46080
    s_waitcnt lgkmcnt(12)
    v_mfma_f32_32x32x16_bf16 v[160:175], v[148:151], a[20:23], v[160:175]
    v_cvt_pk_bf16_f32 v204, v184, v185
    v_cvt_pk_bf16_f32 v205, v186, v187
    s_add_u32 m0, s57, 5120
    s_lshl_b32 s61, s86, 4
    s_add_u32 s61, s61, 81920
    buffer_load_dwordx4 v228, s[72:75], s61 offen lds
    ds_read_b64_tr_b16 v[144:145], v236 offset:49152
    ds_read_b64_tr_b16 v[146:147], v236 offset:50176
    s_waitcnt lgkmcnt(12)
    v_mfma_f32_32x32x16_bf16 v[160:175], v[152:155], a[24:27], v[160:175]
    v_cvt_pk_bf16_f32 v206, v188, v189
    v_cvt_pk_bf16_f32 v207, v190, v191
    buffer_store_dwordx4 v[200:203], v242, s[52:55], s33 offen offset:0 sc1
    s_add_u32 m0, s57, 6144
    s_lshl_b32 s61, s86, 4
    s_add_u32 s61, s61, 98304
    buffer_load_dwordx4 v228, s[72:75], s61 offen lds
    ds_read_b64_tr_b16 v[148:149], v236 offset:53248
    ds_read_b64_tr_b16 v[150:151], v236 offset:54272
    s_waitcnt lgkmcnt(12)
    v_mfma_f32_32x32x16_bf16 v[160:175], v[156:159], a[28:31], v[160:175]
    s_add_u32 m0, s57, 7168
    s_lshl_b32 s61, s86, 4
    s_add_u32 s61, s61, 114688
    buffer_load_dwordx4 v228, s[72:75], s61 offen lds
    ds_read_b64_tr_b16 v[152:153], v236 offset:57344
    ds_read_b64_tr_b16 v[154:155], v236 offset:58368
    s_waitcnt lgkmcnt(12)
    v_mfma_f32_32x32x16_bf16 v[160:175], v[128:131], a[32:35], v[160:175]
    ds_read_b64_tr_b16 v[156:157], v236 offset:61440
    ds_read_b64_tr_b16 v[158:159], v236 offset:62464
    s_waitcnt lgkmcnt(12)
    v_mfma_f32_32x32x16_bf16 v[160:175], v[132:135], a[36:39], v[160:175]
    buffer_store_dwordx4 v[204:207], v242, s[52:55], s33 offen offset:512 sc1
    ds_read_b64_tr_b16 v[128:129], v237 offset:0
    ds_read_b64_tr_b16 v[130:131], v237 offset:1024
    s_waitcnt lgkmcnt(12)
    v_mfma_f32_32x32x16_bf16 v[160:175], v[136:139], a[40:43], v[160:175]
    ds_read_b64_tr_b16 v[132:133], v237 offset:4096
    ds_read_b64_tr_b16 v[134:135], v237 offset:5120
    s_waitcnt lgkmcnt(12)
    v_mfma_f32_32x32x16_bf16 v[160:175], v[140:143], a[44:47], v[160:175]
    ds_read_b64_tr_b16 v[136:137], v237 offset:8192
    ds_read_b64_tr_b16 v[138:139], v237 offset:9216
    s_waitcnt lgkmcnt(12)
    v_mfma_f32_32x32x16_bf16 v[160:175], v[144:147], a[48:51], v[160:175]
    ds_read_b64_tr_b16 v[140:141], v237 offset:12288
    ds_read_b64_tr_b16 v[142:143], v237 offset:13312
    s_waitcnt lgkmcnt(12)
    v_mfma_f32_32x32x16_bf16 v[160:175], v[148:151], a[52:55], v[160:175]
    ds_read_b64_tr_b16 v[144:145], v237 offset:16384
    ds_read_b64_tr_b16 v[146:147], v237 offset:17408
    s_waitcnt lgkmcnt(12)
    v_mfma_f32_32x32x16_bf16 v[160:175], v[152:155], a[56:59], v[160:175]
    ds_read_b64_tr_b16 v[148:149], v237 offset:20480
    ds_read_b64_tr_b16 v[150:151], v237 offset:21504
    s_waitcnt lgkmcnt(12)
    v_mfma_f32_32x32x16_bf16 v[160:175], v[156:159], a[60:63], v[160:175]
    ds_read_b64_tr_b16 v[152:153], v237 offset:24576
    ds_read_b64_tr_b16 v[154:155], v237 offset:25600
    s_waitcnt lgkmcnt(12)
    v_mfma_f32_32x32x16_bf16 v[160:175], v[128:131], a[64:67], v[160:175]
    ds_read_b64_tr_b16 v[156:157], v237 offset:28672
    ds_read_b64_tr_b16 v[158:159], v237 offset:29696
    s_waitcnt lgkmcnt(12)
    v_mfma_f32_32x32x16_bf16 v[160:175], v[132:135], a[68:71], v[160:175]
    ds_read_b64_tr_b16 v[128:129], v237 offset:32768
    ds_read_b64_tr_b16 v[130:131], v237 offset:33792
    s_waitcnt lgkmcnt(12)
    v_mfma_f32_32x32x16_bf16 v[160:175], v[136:139], a[72:75], v[160:175]
    ds_read_b64_tr_b16 v[132:133], v237 offset:36864
    ds_read_b64_tr_b16 v[134:135], v237 offset:37888
    s_waitcnt lgkmcnt(12)
    v_mfma_f32_32x32x16_bf16 v[160:175], v[140:143], a[76:79], v[160:175]
    ds_read_b64_tr_b16 v[136:137], v237 offset:40960
    ds_read_b64_tr_b16 v[138:139], v237 offset:41984
    s_waitcnt lgkmcnt(12)
    v_mfma_f32_32x32x16_bf16 v[160:175], v[144:147], a[80:83], v[160:175]
    ds_read_b64_tr_b16 v[140:141], v237 offset:45056
    ds_read_b64_tr_b16 v[142:143], v237 offset:46080
    s_waitcnt lgkmcnt(12)
    v_mfma_f32_32x32x16_bf16 v[160:175], v[148:151], a[84:87], v[160:175]
    ds_read_b64_tr_b16 v[144:145], v237 offset:49152
    ds_read_b64_tr_b16 v[146:147], v237 offset:50176
    s_waitcnt lgkmcnt(12)
    v_mfma_f32_32x32x16_bf16 v[160:175], v[152:155], a[88:91], v[160:175]
    ds_read_b64_tr_b16 v[148:149], v237 offset:53248
    ds_read_b64_tr_b16 v[150:151], v237 offset:54272
    s_waitcnt lgkmcnt(12)
    v_mfma_f32_32x32x16_bf16 v[160:175], v[156:159], a[92:95], v[160:175]
    s_waitcnt vmcnt(1)
    ds_read_b64_tr_b16 v[64:65], v229 offset:0
    ds_read_b64_tr_b16 v[66:67], v229 offset:512
    ds_read_b64_tr_b16 v[152:153], v237 offset:57344
    ds_read_b64_tr_b16 v[154:155], v237 offset:58368
    s_waitcnt lgkmcnt(14)
    v_mfma_f32_32x32x16_bf16 v[160:175], v[128:131], a[96:99], v[160:175]
    ds_read_b64_tr_b16 v[68:69], v229 offset:1024
    ds_read_b64_tr_b16 v[70:71], v229 offset:1536
    ds_read_b64_tr_b16 v[156:157], v237 offset:61440
    ds_read_b64_tr_b16 v[158:159], v237 offset:62464
    s_waitcnt lgkmcnt(15)
    v_mfma_f32_32x32x16_bf16 v[160:175], v[132:135], a[100:103], v[160:175]
    ds_read_b64_tr_b16 v[72:73], v229 offset:2048
    ds_read_b64_tr_b16 v[74:75], v229 offset:2560
    ds_read_b64_tr_b16 v[128:129], v238 offset:0
    ds_read_b64_tr_b16 v[130:131], v238 offset:1024
    s_waitcnt lgkmcnt(15)
    v_mfma_f32_32x32x16_bf16 v[160:175], v[136:139], a[104:107], v[160:175]
    ds_read_b64_tr_b16 v[76:77], v229 offset:3072
    ds_read_b64_tr_b16 v[78:79], v229 offset:3584
    ds_read_b64_tr_b16 v[132:133], v238 offset:4096
    ds_read_b64_tr_b16 v[134:135], v238 offset:5120
    v_mfma_f32_32x32x16_bf16 v[160:175], v[140:143], a[108:111], v[160:175]
    ds_read_b64_tr_b16 v[80:81], v229 offset:4096
    ds_read_b64_tr_b16 v[82:83], v229 offset:4608
    ds_read_b64_tr_b16 v[136:137], v238 offset:8192
    ds_read_b64_tr_b16 v[138:139], v238 offset:9216
    s_waitcnt lgkmcnt(15)
    v_mfma_f32_32x32x16_bf16 v[160:175], v[144:147], a[112:115], v[160:175]
    ds_read_b64_tr_b16 v[84:85], v229 offset:5120
    ds_read_b64_tr_b16 v[86:87], v229 offset:5632
    ds_read_b64_tr_b16 v[140:141], v238 offset:12288
    ds_read_b64_tr_b16 v[142:143], v238 offset:13312
    v_mfma_f32_32x32x16_bf16 v[160:175], v[148:151], a[116:119], v[160:175]
    ds_read_b64_tr_b16 v[88:89], v229 offset:6144
    ds_read_b64_tr_b16 v[90:91], v229 offset:6656
    ds_read_b64_tr_b16 v[144:145], v238 offset:16384
    ds_read_b64_tr_b16 v[146:147], v238 offset:17408
    v_mfma_f32_32x32x16_bf16 v[160:175], v[152:155], a[120:123], v[160:175]
    ds_read_b64_tr_b16 v[92:93], v229 offset:7168
    ds_read_b64_tr_b16 v[94:95], v229 offset:7680
    ds_read_b64_tr_b16 v[148:149], v238 offset:20480
    ds_read_b64_tr_b16 v[150:151], v238 offset:21504
    s_waitcnt lgkmcnt(15)
    v_mfma_f32_32x32x16_bf16 v[160:175], v[156:159], a[124:127], v[160:175]
    ds_read_b64_tr_b16 v[152:153], v238 offset:24576
    ds_read_b64_tr_b16 v[154:155], v238 offset:25600
    v_mfma_f32_32x32x16_bf16 v[176:191], v[128:131], a[0:3], 0
    s_waitcnt lgkmcnt(4)
    s_add_u32 m0, s57, 0
    s_lshl_b32 s61, s87, 4
    s_add_u32 s61, s61, 0
    buffer_load_dwordx4 v228, s[72:75], s61 offen lds
    ds_read_b64_tr_b16 v[156:157], v238 offset:28672
    ds_read_b64_tr_b16 v[158:159], v238 offset:29696
    v_mfma_f32_32x32x16_bf16 v[176:191], v[132:135], a[4:7], v[176:191]
    s_add_u32 m0, s57, 1024
    s_lshl_b32 s61, s87, 4
    s_add_u32 s61, s61, 16384
    buffer_load_dwordx4 v228, s[72:75], s61 offen lds
    ds_read_b64_tr_b16 v[128:129], v238 offset:32768
    ds_read_b64_tr_b16 v[130:131], v238 offset:33792
    v_mfma_f32_32x32x16_bf16 v[176:191], v[136:139], a[8:11], v[176:191]
    s_add_u32 m0, s57, 2048
    s_lshl_b32 s61, s87, 4
    s_add_u32 s61, s61, 32768
    buffer_load_dwordx4 v228, s[72:75], s61 offen lds
    ds_read_b64_tr_b16 v[132:133], v238 offset:36864
    ds_read_b64_tr_b16 v[134:135], v238 offset:37888
    v_mfma_f32_32x32x16_bf16 v[176:191], v[140:143], a[12:15], v[176:191]
    v_cvt_pk_bf16_f32 v192, v160, v161
    v_cvt_pk_bf16_f32 v193, v162, v163
    s_add_u32 m0, s57, 3072
    s_lshl_b32 s61, s87, 4
    s_add_u32 s61, s61, 49152
    buffer_load_dwordx4 v228, s[72:75], s61 offen lds
    ds_read_b64_tr_b16 v[136:137], v238 offset:40960
    ds_read_b64_tr_b16 v[138:139], v238 offset:41984
    v_mfma_f32_32x32x16_bf16 v[176:191], v[144:147], a[16:19], v[176:191]
    v_cvt_pk_bf16_f32 v194, v164, v165
    v_cvt_pk_bf16_f32 v195, v166, v167
    s_add_u32 m0, s57, 4096
    s_lshl_b32 s61, s87, 4
    s_add_u32 s61, s61, 65536
    buffer_load_dwordx4 v228, s[72:75], s61 offen lds
    ds_read_b64_tr_b16 v[140:141], v238 offset:45056
    ds_read_b64_tr_b16 v[142:143], v238 offset:46080
    s_waitcnt lgkmcnt(12)
    v_mfma_f32_32x32x16_bf16 v[176:191], v[148:151], a[20:23], v[176:191]
    v_cvt_pk_bf16_f32 v196, v168, v169
    v_cvt_pk_bf16_f32 v197, v170, v171
    s_add_u32 m0, s57, 5120
    s_lshl_b32 s61, s87, 4
    s_add_u32 s61, s61, 81920
    buffer_load_dwordx4 v228, s[72:75], s61 offen lds
    ds_read_b64_tr_b16 v[144:145], v238 offset:49152
    ds_read_b64_tr_b16 v[146:147], v238 offset:50176
    s_waitcnt lgkmcnt(12)
    v_mfma_f32_32x32x16_bf16 v[176:191], v[152:155], a[24:27], v[176:191]
    v_cvt_pk_bf16_f32 v198, v172, v173
    v_cvt_pk_bf16_f32 v199, v174, v175
    buffer_store_dwordx4 v[192:195], v242, s[52:55], s34 offen offset:0 sc1
    s_add_u32 m0, s57, 6144
    s_lshl_b32 s61, s87, 4
    s_add_u32 s61, s61, 98304
    buffer_load_dwordx4 v228, s[72:75], s61 offen lds
    ds_read_b64_tr_b16 v[148:149], v238 offset:53248
    ds_read_b64_tr_b16 v[150:151], v238 offset:54272
    s_waitcnt lgkmcnt(12)
    v_mfma_f32_32x32x16_bf16 v[176:191], v[156:159], a[28:31], v[176:191]
    s_add_u32 m0, s57, 7168
    s_lshl_b32 s61, s87, 4
    s_add_u32 s61, s61, 114688
    buffer_load_dwordx4 v228, s[72:75], s61 offen lds
    ds_read_b64_tr_b16 v[152:153], v238 offset:57344
    ds_read_b64_tr_b16 v[154:155], v238 offset:58368
    s_waitcnt lgkmcnt(12)
    v_mfma_f32_32x32x16_bf16 v[176:191], v[128:131], a[32:35], v[176:191]
    ds_read_b64_tr_b16 v[156:157], v238 offset:61440
    ds_read_b64_tr_b16 v[158:159], v238 offset:62464
    s_waitcnt lgkmcnt(12)
    v_mfma_f32_32x32x16_bf16 v[176:191], v[132:135], a[36:39], v[176:191]
    buffer_store_dwordx4 v[196:199], v242, s[52:55], s34 offen offset:512 sc1
    ds_read_b64_tr_b16 v[128:129], v239 offset:0
    ds_read_b64_tr_b16 v[130:131], v239 offset:1024
    s_waitcnt lgkmcnt(12)
    v_mfma_f32_32x32x16_bf16 v[176:191], v[136:139], a[40:43], v[176:191]
    ds_read_b64_tr_b16 v[132:133], v239 offset:4096
    ds_read_b64_tr_b16 v[134:135], v239 offset:5120
    s_waitcnt lgkmcnt(12)
    v_mfma_f32_32x32x16_bf16 v[176:191], v[140:143], a[44:47], v[176:191]
    ds_read_b64_tr_b16 v[136:137], v239 offset:8192
    ds_read_b64_tr_b16 v[138:139], v239 offset:9216
    s_waitcnt lgkmcnt(12)
    v_mfma_f32_32x32x16_bf16 v[176:191], v[144:147], a[48:51], v[176:191]
    ds_read_b64_tr_b16 v[140:141], v239 offset:12288
    ds_read_b64_tr_b16 v[142:143], v239 offset:13312
    s_waitcnt lgkmcnt(12)
    v_mfma_f32_32x32x16_bf16 v[176:191], v[148:151], a[52:55], v[176:191]
    ds_read_b64_tr_b16 v[144:145], v239 offset:16384
    ds_read_b64_tr_b16 v[146:147], v239 offset:17408
    s_waitcnt lgkmcnt(12)
    v_mfma_f32_32x32x16_bf16 v[176:191], v[152:155], a[56:59], v[176:191]
    ds_read_b64_tr_b16 v[148:149], v239 offset:20480
    ds_read_b64_tr_b16 v[150:151], v239 offset:21504
    s_waitcnt lgkmcnt(12)
    v_mfma_f32_32x32x16_bf16 v[176:191], v[156:159], a[60:63], v[176:191]
    ds_read_b64_tr_b16 v[152:153], v239 offset:24576
    ds_read_b64_tr_b16 v[154:155], v239 offset:25600
    s_waitcnt lgkmcnt(12)
    v_mfma_f32_32x32x16_bf16 v[176:191], v[128:131], a[64:67], v[176:191]
    ds_read_b64_tr_b16 v[156:157], v239 offset:28672
    ds_read_b64_tr_b16 v[158:159], v239 offset:29696
    s_waitcnt lgkmcnt(12)
    v_mfma_f32_32x32x16_bf16 v[176:191], v[132:135], a[68:71], v[176:191]
    ds_read_b64_tr_b16 v[128:129], v239 offset:32768
    ds_read_b64_tr_b16 v[130:131], v239 offset:33792
    s_waitcnt lgkmcnt(12)
    v_mfma_f32_32x32x16_bf16 v[176:191], v[136:139], a[72:75], v[176:191]
    ds_read_b64_tr_b16 v[132:133], v239 offset:36864
    ds_read_b64_tr_b16 v[134:135], v239 offset:37888
    s_waitcnt lgkmcnt(12)
    v_mfma_f32_32x32x16_bf16 v[176:191], v[140:143], a[76:79], v[176:191]
    ds_read_b64_tr_b16 v[136:137], v239 offset:40960
    ds_read_b64_tr_b16 v[138:139], v239 offset:41984
    s_waitcnt lgkmcnt(12)
    v_mfma_f32_32x32x16_bf16 v[176:191], v[144:147], a[80:83], v[176:191]
    ds_read_b64_tr_b16 v[140:141], v239 offset:45056
    ds_read_b64_tr_b16 v[142:143], v239 offset:46080
    s_waitcnt lgkmcnt(12)
    v_mfma_f32_32x32x16_bf16 v[176:191], v[148:151], a[84:87], v[176:191]
    ds_read_b64_tr_b16 v[144:145], v239 offset:49152
    ds_read_b64_tr_b16 v[146:147], v239 offset:50176
    s_waitcnt lgkmcnt(12)
    v_mfma_f32_32x32x16_bf16 v[176:191], v[152:155], a[88:91], v[176:191]
    ds_read_b64_tr_b16 v[148:149], v239 offset:53248
    ds_read_b64_tr_b16 v[150:151], v239 offset:54272
    s_waitcnt lgkmcnt(12)
    v_mfma_f32_32x32x16_bf16 v[176:191], v[156:159], a[92:95], v[176:191]
    s_waitcnt vmcnt(1)
    ds_read_b64_tr_b16 v[96:97], v229 offset:0
    ds_read_b64_tr_b16 v[98:99], v229 offset:512
    ds_read_b64_tr_b16 v[152:153], v239 offset:57344
    ds_read_b64_tr_b16 v[154:155], v239 offset:58368
    s_waitcnt lgkmcnt(14)
    v_mfma_f32_32x32x16_bf16 v[176:191], v[128:131], a[96:99], v[176:191]
    ds_read_b64_tr_b16 v[100:101], v229 offset:1024
    ds_read_b64_tr_b16 v[102:103], v229 offset:1536
    ds_read_b64_tr_b16 v[156:157], v239 offset:61440
    ds_read_b64_tr_b16 v[158:159], v239 offset:62464
    s_waitcnt lgkmcnt(15)
    v_mfma_f32_32x32x16_bf16 v[176:191], v[132:135], a[100:103], v[176:191]
    ds_read_b64_tr_b16 v[104:105], v229 offset:2048
    ds_read_b64_tr_b16 v[106:107], v229 offset:2560
    s_waitcnt lgkmcnt(15)
    v_mfma_f32_32x32x16_bf16 v[176:191], v[136:139], a[104:107], v[176:191]
    ds_read_b64_tr_b16 v[108:109], v229 offset:3072
    ds_read_b64_tr_b16 v[110:111], v229 offset:3584
    s_waitcnt lgkmcnt(15)
    v_mfma_f32_32x32x16_bf16 v[176:191], v[140:143], a[108:111], v[176:191]
    ds_read_b64_tr_b16 v[112:113], v229 offset:4096
    ds_read_b64_tr_b16 v[114:115], v229 offset:4608
    s_waitcnt lgkmcnt(15)
    v_mfma_f32_32x32x16_bf16 v[176:191], v[144:147], a[112:115], v[176:191]
    ds_read_b64_tr_b16 v[116:117], v229 offset:5120
    ds_read_b64_tr_b16 v[118:119], v229 offset:5632
    s_waitcnt lgkmcnt(15)
    v_mfma_f32_32x32x16_bf16 v[176:191], v[148:151], a[116:119], v[176:191]
    ds_read_b64_tr_b16 v[120:121], v229 offset:6144
    ds_read_b64_tr_b16 v[122:123], v229 offset:6656
    s_waitcnt lgkmcnt(14)
    v_mfma_f32_32x32x16_bf16 v[176:191], v[152:155], a[120:123], v[176:191]
    ds_read_b64_tr_b16 v[124:125], v229 offset:7168
    ds_read_b64_tr_b16 v[126:127], v229 offset:7680
    s_waitcnt lgkmcnt(12)
    v_mfma_f32_32x32x16_bf16 v[176:191], v[156:159], a[124:127], v[176:191]
    s_add_u32 s26, s26, 1
    s_nop 10
    v_cvt_pk_bf16_f32 v200, v176, v177
    v_cvt_pk_bf16_f32 v201, v178, v179
    v_cvt_pk_bf16_f32 v202, v180, v181
    v_cvt_pk_bf16_f32 v203, v182, v183
    v_cvt_pk_bf16_f32 v204, v184, v185
    v_cvt_pk_bf16_f32 v205, v186, v187
    v_cvt_pk_bf16_f32 v206, v188, v189
    v_cvt_pk_bf16_f32 v207, v190, v191
    buffer_store_dwordx4 v[200:203], v242, s[52:55], s35 offen offset:0 sc1
    buffer_store_dwordx4 v[204:207], v242, s[52:55], s35 offen offset:512 sc1
    s_waitcnt vmcnt(0)
    s_lshl_b32 s58, s26, 2
    s_add_u32 s58, s58, s23
    v_mov_b32 v248, s58
    s_mov_b64 exec, 1
    global_store_dword v246, v248, s[42:43] sc1
    s_mov_b64 exec, -1
    s_mov_b32 s24, s56
    s_waitcnt lgkmcnt(0)
    s_branch L_ow
L_vw:
    v_lshlrev_b32 v240, 4, v0
    v_add_u32 v241, 0x10000, v240
    v_mov_b32 v246, 0
    s_mov_b32 s68, 0x05040100
    s_mov_b32 s69, 0x07060302
    s_mov_b32 s32, 0
    s_mov_b32 s33, 4096
    s_mov_b32 s34, 8192
    s_mov_b32 s35, 12288
    s_mov_b32 s36, 16384
    s_mov_b32 s37, 20480
    s_mov_b32 s38, 24576
    s_mov_b32 s39, 28672
    v_lshrrev_b32 v1, 5, v0
    v_lshlrev_b32 v1, 8, v1
    v_and_b32 v2, 8, v0
    v_lshl_add_u32 v2, v2, 7, v1
    v_and_b32 v3, 16, v0
    v_lshl_add_u32 v2, v3, 3, v2
    v_and_b32 v3, 7, v0
    v_lshl_add_u32 v242, v3, 4, v2
    v_and_b32 v3, 16, v0
    v_lshl_add_u32 v2, v3, 6, v1
    v_and_b32 v3, 15, v0
    v_lshl_add_u32 v2, v3, 4, v2
    v_add_u32 v243, 0x800, v2
L_v_c1:
    s_lshl_b32 s58, s24, 9
    s_lshl_b32 s59, s23, 7
    s_add_u32 s58, s58, s59
    s_add_u32 s58, s58, 61882368
    s_add_u32 s42, s20, s58
    s_addc_u32 s43, s21, 0
    v_mov_b32 v253, s23
    s_mov_b64 exec, 1
    global_store_dword v246, v253, s[42:43] sc1
    s_mov_b64 exec, -1
    s_mov_b32 s52, s4
    s_and_b32 s53, s5, 0xffff
    s_mov_b32 s54, 2097152
    s_mov_b32 s55, 0x20000
    s_lshl_b32 s60, s23, 15
    v_xor_b32 v128, 0, v240
    s_add_u32 m0, s60, 32768
    s_add_u32 s61, s60, 0
    buffer_load_dwordx4 v128, s[52:55], s61 offen  lds
    v_xor_b32 v129, 16, v240
    s_add_u32 m0, s60, 33792
    s_add_u32 s61, s60, 1024
    buffer_load_dwordx4 v129, s[52:55], s61 offen  lds
    v_xor_b32 v130, 32, v240
    s_add_u32 m0, s60, 34816
    s_add_u32 s61, s60, 2048
    buffer_load_dwordx4 v130, s[52:55], s61 offen  lds
    v_xor_b32 v131, 48, v240
    s_add_u32 m0, s60, 35840
    s_add_u32 s61, s60, 3072
    buffer_load_dwordx4 v131, s[52:55], s61 offen  lds
    v_xor_b32 v132, 64, v240
    s_add_u32 m0, s60, 36864
    s_add_u32 s61, s60, 4096
    buffer_load_dwordx4 v132, s[52:55], s61 offen  lds
    v_xor_b32 v133, 80, v240
    s_add_u32 m0, s60, 37888
    s_add_u32 s61, s60, 5120
    buffer_load_dwordx4 v133, s[52:55], s61 offen  lds
    v_xor_b32 v134, 96, v240
    s_add_u32 m0, s60, 38912
    s_add_u32 s61, s60, 6144
    buffer_load_dwordx4 v134, s[52:55], s61 offen  lds
    v_xor_b32 v135, 112, v240
    s_add_u32 m0, s60, 39936
    s_add_u32 s61, s60, 7168
    buffer_load_dwordx4 v135, s[52:55], s61 offen  lds
    v_xor_b32 v136, 128, v240
    s_add_u32 m0, s60, 40960
    s_add_u32 s61, s60, 8192
    buffer_load_dwordx4 v136, s[52:55], s61 offen  lds
    v_xor_b32 v137, 144, v240
    s_add_u32 m0, s60, 41984
    s_add_u32 s61, s60, 9216
    buffer_load_dwordx4 v137, s[52:55], s61 offen  lds
    v_xor_b32 v138, 160, v240
    s_add_u32 m0, s60, 43008
    s_add_u32 s61, s60, 10240
    buffer_load_dwordx4 v138, s[52:55], s61 offen  lds
    v_xor_b32 v139, 176, v240
    s_add_u32 m0, s60, 44032
    s_add_u32 s61, s60, 11264
    buffer_load_dwordx4 v139, s[52:55], s61 offen  lds
    v_xor_b32 v140, 192, v240
    s_add_u32 m0, s60, 45056
    s_add_u32 s61, s60, 12288
    buffer_load_dwordx4 v140, s[52:55], s61 offen  lds
    v_xor_b32 v141, 208, v240
    s_add_u32 m0, s60, 46080
    s_add_u32 s61, s60, 13312
    buffer_load_dwordx4 v141, s[52:55], s61 offen  lds
    v_xor_b32 v142, 224, v240
    s_add_u32 m0, s60, 47104
    s_add_u32 s61, s60, 14336
    buffer_load_dwordx4 v142, s[52:55], s61 offen  lds
    v_xor_b32 v143, 240, v240
    s_add_u32 m0, s60, 48128
    s_add_u32 s61, s60, 15360
    buffer_load_dwordx4 v143, s[52:55], s61 offen  lds
    s_nop 0
    s_add_u32 m0, s60, 49152
    s_add_u32 s61, s60, 16384
    buffer_load_dwordx4 v128, s[52:55], s61 offen  lds
    s_nop 0
    s_add_u32 m0, s60, 50176
    s_add_u32 s61, s60, 17408
    buffer_load_dwordx4 v129, s[52:55], s61 offen  lds
    s_nop 0
    s_add_u32 m0, s60, 51200
    s_add_u32 s61, s60, 18432
    buffer_load_dwordx4 v130, s[52:55], s61 offen  lds
    s_nop 0
    s_add_u32 m0, s60, 52224
    s_add_u32 s61, s60, 19456
    buffer_load_dwordx4 v131, s[52:55], s61 offen  lds
    s_nop 0
    s_add_u32 m0, s60, 53248
    s_add_u32 s61, s60, 20480
    buffer_load_dwordx4 v132, s[52:55], s61 offen  lds
    s_nop 0
    s_add_u32 m0, s60, 54272
    s_add_u32 s61, s60, 21504
    buffer_load_dwordx4 v133, s[52:55], s61 offen  lds
    s_nop 0
    s_add_u32 m0, s60, 55296
    s_add_u32 s61, s60, 22528
    buffer_load_dwordx4 v134, s[52:55], s61 offen  lds
    s_nop 0
    s_add_u32 m0, s60, 56320
    s_add_u32 s61, s60, 23552
    buffer_load_dwordx4 v135, s[52:55], s61 offen  lds
    s_nop 0
    s_add_u32 m0, s60, 57344
    s_add_u32 s61, s60, 24576
    buffer_load_dwordx4 v136, s[52:55], s61 offen  lds
    s_nop 0
    s_add_u32 m0, s60, 58368
    s_add_u32 s61, s60, 25600
    buffer_load_dwordx4 v137, s[52:55], s61 offen  lds
    s_nop 0
    s_add_u32 m0, s60, 59392
    s_add_u32 s61, s60, 26624
    buffer_load_dwordx4 v138, s[52:55], s61 offen  lds
    s_nop 0
    s_add_u32 m0, s60, 60416
    s_add_u32 s61, s60, 27648
    buffer_load_dwordx4 v139, s[52:55], s61 offen  lds
    s_nop 0
    s_add_u32 m0, s60, 61440
    s_add_u32 s61, s60, 28672
    buffer_load_dwordx4 v140, s[52:55], s61 offen  lds
    s_nop 0
    s_add_u32 m0, s60, 62464
    s_add_u32 s61, s60, 29696
    buffer_load_dwordx4 v141, s[52:55], s61 offen  lds
    s_nop 0
    s_add_u32 m0, s60, 63488
    s_add_u32 s61, s60, 30720
    buffer_load_dwordx4 v142, s[52:55], s61 offen  lds
    s_nop 0
    s_add_u32 m0, s60, 64512
    s_add_u32 s61, s60, 31744
    buffer_load_dwordx4 v143, s[52:55], s61 offen  lds
    v_mov_b32 v249, v0
    v_lshrrev_b32 v2, 4, v0
    v_lshlrev_b32 v3, 2, v2
    v_and_b32 v1, 15, v0
    v_xor_b32 v1, v1, v3
    v_lshlrev_b32 v3, 13, v2
    v_lshl_add_u32 v3, v1, 4, v3
    s_lshl_b32 s58, s23, 15
    s_lshl_b32 s59, s24, 8
    s_add_u32 s58, s58, s59
    v_add_u32 v248, s58, v3
    s_lshl_b32 s60, s23, 10
    v_lshrrev_b32 v1, 5, v0
    v_lshlrev_b32 v1, 11, v1
    v_and_b32 v2, 12, v0
    v_lshl_add_u32 v1, v2, 6, v1
    v_lshl_add_u32 v1, v2, 4, v1
    v_and_b32 v2, 1, v0
    v_lshl_add_u32 v1, v2, 3, v1
    v_and_b32 v2, 2, v0
    v_and_b32 v3, 16, v0
    v_lshl_add_u32 v1, v2, 3, v1
    v_lshl_add_u32 v1, v3, 1, v1
    v_xor_b32 v232, 0, v1
    v_add_u32 v233, 0x10000, v232
    v_xor_b32 v234, 64, v1
    v_add_u32 v235, 0x10000, v234
    v_xor_b32 v236, 128, v1
    v_add_u32 v237, 0x10000, v236
    v_xor_b32 v238, 192, v1
    v_add_u32 v239, 0x10000, v238
    s_mov_b32 s28, s12
    s_and_b32 s29, s13, 0xffff
    s_mov_b32 s30, 4194304
    s_mov_b32 s31, 0x20000
    s_add_u32 m0, s60, 0
    s_mov_b32 s61, 0
    buffer_load_dwordx4 v248, s[28:31], s61 offen  lds
    s_add_u32 m0, s60, 4096
    s_mov_b32 s61, 131072
    buffer_load_dwordx4 v248, s[28:31], s61 offen  lds
    s_add_u32 m0, s60, 8192
    s_mov_b32 s61, 262144
    buffer_load_dwordx4 v248, s[28:31], s61 offen  lds
    s_add_u32 m0, s60, 12288
    s_mov_b32 s61, 393216
    buffer_load_dwordx4 v248, s[28:31], s61 offen  lds
    s_add_u32 m0, s60, 16384
    s_mov_b32 s61, 524288
    buffer_load_dwordx4 v248, s[28:31], s61 offen  lds
    s_add_u32 m0, s60, 20480
    s_mov_b32 s61, 655360
    buffer_load_dwordx4 v248, s[28:31], s61 offen  lds
    s_add_u32 m0, s60, 24576
    s_mov_b32 s61, 786432
    buffer_load_dwordx4 v248, s[28:31], s61 offen  lds
    s_add_u32 m0, s60, 28672
    s_mov_b32 s61, 917504
    buffer_load_dwordx4 v248, s[28:31], s61 offen  lds
    v_and_b32 v144, 31, v249
    v_lshlrev_b32 v145, 10, v144
    v_and_b32 v144, 15, v144
    v_lshrrev_b32 v146, 5, v249
    v_xor_b32 v144, v144, v146
    v_lshl_add_u32 v145, v144, 4, v145
    s_lshl_b32 s58, s23, 15
    s_add_u32 s58, s58, 0x8000
    v_add_u32 v145, s58, v145
    v_xor_b32 v128, 0, v145
    v_xor_b32 v129, 32, v145
    v_xor_b32 v130, 64, v145
    v_xor_b32 v131, 96, v145
    v_xor_b32 v132, 128, v145
    v_xor_b32 v133, 160, v145
    v_xor_b32 v134, 192, v145
    v_xor_b32 v135, 224, v145
    s_waitcnt vmcnt(8)
    ds_read_b128 v[0:3], v128 offset:0
    ds_read_b128 v[4:7], v129 offset:0
    ds_read_b128 v[8:11], v130 offset:0
    ds_read_b128 v[12:15], v131 offset:0
    ds_read_b128 v[16:19], v132 offset:0
    ds_read_b128 v[20:23], v133 offset:0
    ds_read_b128 v[24:27], v134 offset:0
    ds_read_b128 v[28:31], v135 offset:0
    s_waitcnt lgkmcnt(0)
    ds_read_b128 v[32:35], v128 offset:256
    ds_read_b128 v[36:39], v129 offset:256
    ds_read_b128 v[40:43], v130 offset:256
    ds_read_b128 v[44:47], v131 offset:256
    ds_read_b128 v[48:51], v132 offset:256
    ds_read_b128 v[52:55], v133 offset:256
    ds_read_b128 v[56:59], v134 offset:256
    ds_read_b128 v[60:63], v135 offset:256
    s_waitcnt lgkmcnt(0)
    ds_read_b128 v[64:67], v128 offset:512
    ds_read_b128 v[68:71], v129 offset:512
    ds_read_b128 v[72:75], v130 offset:512
    ds_read_b128 v[76:79], v131 offset:512
    ds_read_b128 v[80:83], v132 offset:512
    ds_read_b128 v[84:87], v133 offset:512
    ds_read_b128 v[88:91], v134 offset:512
    ds_read_b128 v[92:95], v135 offset:512
    s_waitcnt lgkmcnt(0)
    ds_read_b128 v[96:99], v128 offset:768
    ds_read_b128 v[100:103], v129 offset:768
    ds_read_b128 v[104:107], v130 offset:768
    ds_read_b128 v[108:111], v131 offset:768
    ds_read_b128 v[112:115], v132 offset:768
    ds_read_b128 v[116:119], v133 offset:768
    ds_read_b128 v[120:123], v134 offset:768
    ds_read_b128 v[124:127], v135 offset:768
    s_waitcnt lgkmcnt(0)
    s_waitcnt vmcnt(8) lgkmcnt(0)
    s_barrier
    s_cmp_eq_u32 s23, 0
    s_cbranch_scc0 L_v_noarr
    s_mov_b64 exec, 1
    s_lshl_b32 s58, s3, 5
    s_add_u32 s58, s58, 208
    v_mov_b32 v252, s58
    v_mov_b32 v253, 1
    global_atomic_add v252, v253, s[18:19]
    s_mov_b64 exec, -1
L_v_noarr:
    s_add_u32 m0, s60, 32768
    s_mov_b32 s61, 1048576
    buffer_load_dwordx4 v248, s[28:31], s61 offen  lds
    s_add_u32 m0, s60, 36864
    s_mov_b32 s61, 1179648
    buffer_load_dwordx4 v248, s[28:31], s61 offen  lds
    s_add_u32 m0, s60, 40960
    s_mov_b32 s61, 1310720
    buffer_load_dwordx4 v248, s[28:31], s61 offen  lds
    s_add_u32 m0, s60, 45056
    s_mov_b32 s61, 1441792
    buffer_load_dwordx4 v248, s[28:31], s61 offen  lds
    s_add_u32 m0, s60, 49152
    s_mov_b32 s61, 1572864
    buffer_load_dwordx4 v248, s[28:31], s61 offen  lds
    s_add_u32 m0, s60, 53248
    s_mov_b32 s61, 1703936
    buffer_load_dwordx4 v248, s[28:31], s61 offen  lds
    s_add_u32 m0, s60, 57344
    s_mov_b32 s61, 1835008
    buffer_load_dwordx4 v248, s[28:31], s61 offen  lds
    s_add_u32 m0, s60, 61440
    s_mov_b32 s61, 1966080
    buffer_load_dwordx4 v248, s[28:31], s61 offen  lds
    s_add_u32 m0, s60, 65536
    s_mov_b32 s61, 2097152
    buffer_load_dwordx4 v248, s[28:31], s61 offen  lds
    s_add_u32 m0, s60, 69632
    s_mov_b32 s61, 2228224
    buffer_load_dwordx4 v248, s[28:31], s61 offen  lds
    s_add_u32 m0, s60, 73728
    s_mov_b32 s61, 2359296
    buffer_load_dwordx4 v248, s[28:31], s61 offen  lds
    s_add_u32 m0, s60, 77824
    s_mov_b32 s61, 2490368
    buffer_load_dwordx4 v248, s[28:31], s61 offen  lds
    s_add_u32 m0, s60, 81920
    s_mov_b32 s61, 2621440
    buffer_load_dwordx4 v248, s[28:31], s61 offen  lds
    s_add_u32 m0, s60, 86016
    s_mov_b32 s61, 2752512
    buffer_load_dwordx4 v248, s[28:31], s61 offen  lds
    s_add_u32 m0, s60, 90112
    s_mov_b32 s61, 2883584
    buffer_load_dwordx4 v248, s[28:31], s61 offen  lds
    s_add_u32 m0, s60, 94208
    s_mov_b32 s61, 3014656
    buffer_load_dwordx4 v248, s[28:31], s61 offen  lds
    s_add_u32 m0, s60, 98304
    s_mov_b32 s61, 3145728
    buffer_load_dwordx4 v248, s[28:31], s61 offen  lds
    s_add_u32 m0, s60, 102400
    s_mov_b32 s61, 3276800
    buffer_load_dwordx4 v248, s[28:31], s61 offen  lds
    s_add_u32 m0, s60, 106496
    s_mov_b32 s61, 3407872
    buffer_load_dwordx4 v248, s[28:31], s61 offen  lds
    s_add_u32 m0, s60, 110592
    s_mov_b32 s61, 3538944
    buffer_load_dwordx4 v248, s[28:31], s61 offen  lds
    s_add_u32 m0, s60, 114688
    s_mov_b32 s61, 3670016
    buffer_load_dwordx4 v248, s[28:31], s61 offen  lds
    s_add_u32 m0, s60, 118784
    s_mov_b32 s61, 3801088
    buffer_load_dwordx4 v248, s[28:31], s61 offen  lds
    s_add_u32 m0, s60, 122880
    s_mov_b32 s61, 3932160
    buffer_load_dwordx4 v248, s[28:31], s61 offen  lds
    s_add_u32 m0, s60, 126976
    s_mov_b32 s61, 4063232
    buffer_load_dwordx4 v248, s[28:31], s61 offen  lds
    s_lshl_b32 s58, s23, 15
    s_add_u32 s58, s58, 58720256
    s_add_u32 s28, s20, s58
    s_addc_u32 s29, s21, 0
    s_mov_b32 s30, 0x8000
    s_mov_b32 s31, 0x20000
    s_add_u32 s28, s28, 131072
    s_addc_u32 s29, s29, 0
    s_lshl_b32 s58, s23, 19
    s_lshl_b32 s59, s24, 14
    s_add_u32 s58, s58, s59
    s_add_u32 s52, s20, s58
    s_addc_u32 s53, s21, 0
    s_mov_b32 s54, 0x4000
    s_mov_b32 s55, 0x20000
    s_mov_b32 s26, 0
    s_waitcnt vmcnt(0)
    s_barrier
    ds_read_b64_tr_b16 v[128:129], v232 offset:0
    ds_read_b64_tr_b16 v[130:131], v232 offset:1024
    ds_read_b64_tr_b16 v[132:133], v232 offset:4096
    ds_read_b64_tr_b16 v[134:135], v232 offset:5120
    ds_read_b64_tr_b16 v[136:137], v232 offset:8192
    ds_read_b64_tr_b16 v[138:139], v232 offset:9216
    ds_read_b64_tr_b16 v[140:141], v232 offset:12288
    ds_read_b64_tr_b16 v[142:143], v232 offset:13312
    ds_read_b64_tr_b16 v[144:145], v232 offset:16384
    ds_read_b64_tr_b16 v[146:147], v232 offset:17408
    ds_read_b64_tr_b16 v[148:149], v232 offset:20480
    ds_read_b64_tr_b16 v[150:151], v232 offset:21504
    s_lshl_b32 s56, s24, 1
    s_add_u32 s56, s56, s22
    v_lshrrev_b32 v224, 2, v249
    v_lshlrev_b32 v224, 10, v224
    v_and_b32 v225, 3, v249
    v_lshl_add_u32 v224, v225, 4, v224
    s_lshl_b32 s58, s23, 20
    s_and_b32 s59, s56, 15
    s_lshl_b32 s59, s59, 6
    s_add_u32 s58, s58, s59
    v_add_u32 v228, s58, v224
    v_lshlrev_b32 v226, 10, v249
    v_add_u32 v230, s58, v226
    s_lshl_b32 s57, s23, 13
    s_add_u32 s57, s57, 0x20000
    v_lshrrev_b32 v224, 5, v249
    v_lshlrev_b32 v224, 8, v224
    v_and_b32 v226, 12, v249
    v_lshl_add_u32 v224, v226, 4, v224
    v_and_b32 v226, 16, v249
    v_lshl_add_u32 v224, v226, 1, v224
    v_lshl_add_u32 v224, v225, 3, v224
    v_add_u32 v229, s57, v224
    s_mov_b32 s72, s14
    s_and_b32 s73, s15, 0xffff
    s_mov_b32 s74, 4194304
    s_mov_b32 s75, 0x20000
    s_mov_b32 s80, 0
    s_and_b32 s80, s80, 7
    s_lshl_b32 s80, s80, 13
    s_mov_b32 s81, 1
    s_and_b32 s81, s81, 7
    s_lshl_b32 s81, s81, 13
    s_mov_b32 s82, 2
    s_and_b32 s82, s82, 7
    s_lshl_b32 s82, s82, 13
    s_mov_b32 s83, 3
    s_and_b32 s83, s83, 7
    s_lshl_b32 s83, s83, 13
    s_mov_b32 s84, 4
    s_and_b32 s84, s84, 7
    s_lshl_b32 s84, s84, 13
    s_mov_b32 s85, 5
    s_and_b32 s85, s85, 7
    s_lshl_b32 s85, s85, 13
    s_mov_b32 s86, 6
    s_and_b32 s86, s86, 7
    s_lshl_b32 s86, s86, 13
    s_mov_b32 s87, 7
    s_and_b32 s87, s87, 7
    s_lshl_b32 s87, s87, 13
    s_lshl_b32 s58, s24, 9
    s_add_u32 s58, s58, 61898752
    s_add_u32 s50, s20, s58
    s_addc_u32 s51, s21, 0
    s_waitcnt vmcnt(0)
    ds_read_b64_tr_b16 v[152:153], v232 offset:24576
    ds_read_b64_tr_b16 v[154:155], v232 offset:25600
    s_waitcnt lgkmcnt(12)
    v_mfma_f32_32x32x16_bf16 v[160:175], v[0:3], v[128:131], 0
    ds_read_b64_tr_b16 v[156:157], v232 offset:28672
    ds_read_b64_tr_b16 v[158:159], v232 offset:29696
    s_waitcnt lgkmcnt(12)
    v_mfma_f32_32x32x16_bf16 v[160:175], v[4:7], v[132:135], v[160:175]
    ds_read_b64_tr_b16 v[128:129], v232 offset:32768
    ds_read_b64_tr_b16 v[130:131], v232 offset:33792
    s_waitcnt lgkmcnt(12)
    v_mfma_f32_32x32x16_bf16 v[160:175], v[8:11], v[136:139], v[160:175]
    ds_read_b64_tr_b16 v[132:133], v232 offset:36864
    ds_read_b64_tr_b16 v[134:135], v232 offset:37888
    s_waitcnt lgkmcnt(12)
    v_mfma_f32_32x32x16_bf16 v[160:175], v[12:15], v[140:143], v[160:175]
    ds_read_b64_tr_b16 v[136:137], v232 offset:40960
    ds_read_b64_tr_b16 v[138:139], v232 offset:41984
    s_waitcnt lgkmcnt(12)
    v_mfma_f32_32x32x16_bf16 v[160:175], v[16:19], v[144:147], v[160:175]
    ds_read_b64_tr_b16 v[140:141], v232 offset:45056
    ds_read_b64_tr_b16 v[142:143], v232 offset:46080
    s_waitcnt lgkmcnt(12)
    v_mfma_f32_32x32x16_bf16 v[160:175], v[20:23], v[148:151], v[160:175]
    ds_read_b64_tr_b16 v[144:145], v232 offset:49152
    ds_read_b64_tr_b16 v[146:147], v232 offset:50176
    s_waitcnt lgkmcnt(12)
    v_mfma_f32_32x32x16_bf16 v[160:175], v[24:27], v[152:155], v[160:175]
    ds_read_b64_tr_b16 v[148:149], v232 offset:53248
    ds_read_b64_tr_b16 v[150:151], v232 offset:54272
    s_waitcnt lgkmcnt(12)
    v_mfma_f32_32x32x16_bf16 v[160:175], v[28:31], v[156:159], v[160:175]
    ds_read_b64_tr_b16 v[152:153], v232 offset:57344
    ds_read_b64_tr_b16 v[154:155], v232 offset:58368
    s_waitcnt lgkmcnt(12)
    v_mfma_f32_32x32x16_bf16 v[160:175], v[32:35], v[128:131], v[160:175]
    ds_read_b64_tr_b16 v[156:157], v232 offset:61440
    ds_read_b64_tr_b16 v[158:159], v232 offset:62464
    s_waitcnt lgkmcnt(12)
    v_mfma_f32_32x32x16_bf16 v[160:175], v[36:39], v[132:135], v[160:175]
    ds_read_b64_tr_b16 v[128:129], v233 offset:0
    ds_read_b64_tr_b16 v[130:131], v233 offset:1024
    s_waitcnt lgkmcnt(12)
    v_mfma_f32_32x32x16_bf16 v[160:175], v[40:43], v[136:139], v[160:175]
    ds_read_b64_tr_b16 v[132:133], v233 offset:4096
    ds_read_b64_tr_b16 v[134:135], v233 offset:5120
    s_waitcnt lgkmcnt(12)
    v_mfma_f32_32x32x16_bf16 v[160:175], v[44:47], v[140:143], v[160:175]
    ds_read_b64_tr_b16 v[136:137], v233 offset:8192
    ds_read_b64_tr_b16 v[138:139], v233 offset:9216
    s_waitcnt lgkmcnt(12)
    v_mfma_f32_32x32x16_bf16 v[160:175], v[48:51], v[144:147], v[160:175]
    ds_read_b64_tr_b16 v[140:141], v233 offset:12288
    ds_read_b64_tr_b16 v[142:143], v233 offset:13312
    s_waitcnt lgkmcnt(12)
    v_mfma_f32_32x32x16_bf16 v[160:175], v[52:55], v[148:151], v[160:175]
    ds_read_b64_tr_b16 v[144:145], v233 offset:16384
    ds_read_b64_tr_b16 v[146:147], v233 offset:17408
    s_waitcnt lgkmcnt(12)
    v_mfma_f32_32x32x16_bf16 v[160:175], v[56:59], v[152:155], v[160:175]
    ds_read_b64_tr_b16 v[148:149], v233 offset:20480
    ds_read_b64_tr_b16 v[150:151], v233 offset:21504
    s_waitcnt lgkmcnt(12)
    v_mfma_f32_32x32x16_bf16 v[160:175], v[60:63], v[156:159], v[160:175]
    ds_read_b64_tr_b16 v[152:153], v233 offset:24576
    ds_read_b64_tr_b16 v[154:155], v233 offset:25600
    s_waitcnt lgkmcnt(12)
    v_mfma_f32_32x32x16_bf16 v[160:175], v[64:67], v[128:131], v[160:175]
    ds_read_b64_tr_b16 v[156:157], v233 offset:28672
    ds_read_b64_tr_b16 v[158:159], v233 offset:29696
    s_waitcnt lgkmcnt(12)
    v_mfma_f32_32x32x16_bf16 v[160:175], v[68:71], v[132:135], v[160:175]
    ds_read_b64_tr_b16 v[128:129], v233 offset:32768
    ds_read_b64_tr_b16 v[130:131], v233 offset:33792
    s_waitcnt lgkmcnt(12)
    v_mfma_f32_32x32x16_bf16 v[160:175], v[72:75], v[136:139], v[160:175]
    ds_read_b64_tr_b16 v[132:133], v233 offset:36864
    ds_read_b64_tr_b16 v[134:135], v233 offset:37888
    s_waitcnt lgkmcnt(12)
    v_mfma_f32_32x32x16_bf16 v[160:175], v[76:79], v[140:143], v[160:175]
    ds_read_b64_tr_b16 v[136:137], v233 offset:40960
    ds_read_b64_tr_b16 v[138:139], v233 offset:41984
    s_waitcnt lgkmcnt(12)
    v_mfma_f32_32x32x16_bf16 v[160:175], v[80:83], v[144:147], v[160:175]
    ds_read_b64_tr_b16 v[140:141], v233 offset:45056
    ds_read_b64_tr_b16 v[142:143], v233 offset:46080
    s_waitcnt lgkmcnt(12)
    v_mfma_f32_32x32x16_bf16 v[160:175], v[84:87], v[148:151], v[160:175]
    ds_read_b64_tr_b16 v[144:145], v233 offset:49152
    ds_read_b64_tr_b16 v[146:147], v233 offset:50176
    s_waitcnt lgkmcnt(12)
    v_mfma_f32_32x32x16_bf16 v[160:175], v[88:91], v[152:155], v[160:175]
    ds_read_b64_tr_b16 v[148:149], v233 offset:53248
    ds_read_b64_tr_b16 v[150:151], v233 offset:54272
    s_waitcnt lgkmcnt(12)
    v_mfma_f32_32x32x16_bf16 v[160:175], v[92:95], v[156:159], v[160:175]
    ds_read_b64_tr_b16 v[152:153], v233 offset:57344
    ds_read_b64_tr_b16 v[154:155], v233 offset:58368
    s_waitcnt lgkmcnt(12)
    v_mfma_f32_32x32x16_bf16 v[160:175], v[96:99], v[128:131], v[160:175]
    ds_read_b64_tr_b16 v[156:157], v233 offset:61440
    ds_read_b64_tr_b16 v[158:159], v233 offset:62464
    s_waitcnt lgkmcnt(12)
    v_mfma_f32_32x32x16_bf16 v[160:175], v[100:103], v[132:135], v[160:175]
    ds_read_b64_tr_b16 v[128:129], v234 offset:0
    ds_read_b64_tr_b16 v[130:131], v234 offset:1024
    s_waitcnt lgkmcnt(12)
    v_mfma_f32_32x32x16_bf16 v[160:175], v[104:107], v[136:139], v[160:175]
    ds_read_b64_tr_b16 v[132:133], v234 offset:4096
    ds_read_b64_tr_b16 v[134:135], v234 offset:5120
    s_waitcnt lgkmcnt(12)
    v_mfma_f32_32x32x16_bf16 v[160:175], v[108:111], v[140:143], v[160:175]
    ds_read_b64_tr_b16 v[136:137], v234 offset:8192
    ds_read_b64_tr_b16 v[138:139], v234 offset:9216
    s_waitcnt lgkmcnt(12)
    v_mfma_f32_32x32x16_bf16 v[160:175], v[112:115], v[144:147], v[160:175]
    ds_read_b64_tr_b16 v[140:141], v234 offset:12288
    ds_read_b64_tr_b16 v[142:143], v234 offset:13312
    s_waitcnt lgkmcnt(12)
    v_mfma_f32_32x32x16_bf16 v[160:175], v[116:119], v[148:151], v[160:175]
    ds_read_b64_tr_b16 v[144:145], v234 offset:16384
    ds_read_b64_tr_b16 v[146:147], v234 offset:17408
    s_waitcnt lgkmcnt(12)
    v_mfma_f32_32x32x16_bf16 v[160:175], v[120:123], v[152:155], v[160:175]
    ds_read_b64_tr_b16 v[148:149], v234 offset:20480
    ds_read_b64_tr_b16 v[150:151], v234 offset:21504
    s_waitcnt lgkmcnt(12)
    v_mfma_f32_32x32x16_bf16 v[160:175], v[124:127], v[156:159], v[160:175]
    ds_read_b64_tr_b16 v[152:153], v234 offset:24576
    ds_read_b64_tr_b16 v[154:155], v234 offset:25600
    s_waitcnt lgkmcnt(12)
    v_mfma_f32_32x32x16_bf16 v[176:191], v[0:3], v[128:131], 0
    ds_read_b64_tr_b16 v[156:157], v234 offset:28672
    ds_read_b64_tr_b16 v[158:159], v234 offset:29696
    s_waitcnt lgkmcnt(12)
    v_mfma_f32_32x32x16_bf16 v[176:191], v[4:7], v[132:135], v[176:191]
    ds_read_b64_tr_b16 v[128:129], v234 offset:32768
    ds_read_b64_tr_b16 v[130:131], v234 offset:33792
    s_waitcnt lgkmcnt(12)
    v_mfma_f32_32x32x16_bf16 v[176:191], v[8:11], v[136:139], v[176:191]
    ds_read_b64_tr_b16 v[132:133], v234 offset:36864
    ds_read_b64_tr_b16 v[134:135], v234 offset:37888
    s_waitcnt lgkmcnt(12)
    v_mfma_f32_32x32x16_bf16 v[176:191], v[12:15], v[140:143], v[176:191]
    v_cvt_pk_bf16_f32 v192, v160, v161
    v_cvt_pk_bf16_f32 v193, v162, v163
    ds_read_b64_tr_b16 v[136:137], v234 offset:40960
    ds_read_b64_tr_b16 v[138:139], v234 offset:41984
    s_waitcnt lgkmcnt(12)
    v_mfma_f32_32x32x16_bf16 v[176:191], v[16:19], v[144:147], v[176:191]
    v_cvt_pk_bf16_f32 v194, v164, v165
    v_cvt_pk_bf16_f32 v195, v166, v167
    ds_read_b64_tr_b16 v[140:141], v234 offset:45056
    ds_read_b64_tr_b16 v[142:143], v234 offset:46080
    s_waitcnt lgkmcnt(12)
    v_mfma_f32_32x32x16_bf16 v[176:191], v[20:23], v[148:151], v[176:191]
    v_cvt_pk_bf16_f32 v196, v168, v169
    v_cvt_pk_bf16_f32 v197, v170, v171
    ds_read_b64_tr_b16 v[144:145], v234 offset:49152
    ds_read_b64_tr_b16 v[146:147], v234 offset:50176
    s_waitcnt lgkmcnt(12)
    v_mfma_f32_32x32x16_bf16 v[176:191], v[24:27], v[152:155], v[176:191]
    v_cvt_pk_bf16_f32 v198, v172, v173
    v_cvt_pk_bf16_f32 v199, v174, v175
    buffer_store_dwordx4 v[192:195], v243, s[52:55], s32 offen offset:0 sc1
    ds_read_b64_tr_b16 v[148:149], v234 offset:53248
    ds_read_b64_tr_b16 v[150:151], v234 offset:54272
    s_waitcnt lgkmcnt(12)
    v_mfma_f32_32x32x16_bf16 v[176:191], v[28:31], v[156:159], v[176:191]
    ds_read_b64_tr_b16 v[152:153], v234 offset:57344
    ds_read_b64_tr_b16 v[154:155], v234 offset:58368
    s_waitcnt lgkmcnt(12)
    v_mfma_f32_32x32x16_bf16 v[176:191], v[32:35], v[128:131], v[176:191]
    ds_read_b64_tr_b16 v[156:157], v234 offset:61440
    ds_read_b64_tr_b16 v[158:159], v234 offset:62464
    s_waitcnt lgkmcnt(12)
    v_mfma_f32_32x32x16_bf16 v[176:191], v[36:39], v[132:135], v[176:191]
    buffer_store_dwordx4 v[196:199], v243, s[52:55], s32 offen offset:512 sc1
    ds_read_b64_tr_b16 v[128:129], v235 offset:0
    ds_read_b64_tr_b16 v[130:131], v235 offset:1024
    s_waitcnt lgkmcnt(12)
    v_mfma_f32_32x32x16_bf16 v[176:191], v[40:43], v[136:139], v[176:191]
    ds_read_b64_tr_b16 v[132:133], v235 offset:4096
    ds_read_b64_tr_b16 v[134:135], v235 offset:5120
    s_waitcnt lgkmcnt(12)
    v_mfma_f32_32x32x16_bf16 v[176:191], v[44:47], v[140:143], v[176:191]
    ds_read_b64_tr_b16 v[136:137], v235 offset:8192
    ds_read_b64_tr_b16 v[138:139], v235 offset:9216
    s_waitcnt lgkmcnt(12)
    v_mfma_f32_32x32x16_bf16 v[176:191], v[48:51], v[144:147], v[176:191]
    ds_read_b64_tr_b16 v[140:141], v235 offset:12288
    ds_read_b64_tr_b16 v[142:143], v235 offset:13312
    s_waitcnt lgkmcnt(12)
    v_mfma_f32_32x32x16_bf16 v[176:191], v[52:55], v[148:151], v[176:191]
    ds_read_b64_tr_b16 v[144:145], v235 offset:16384
    ds_read_b64_tr_b16 v[146:147], v235 offset:17408
    s_waitcnt lgkmcnt(12)
    v_mfma_f32_32x32x16_bf16 v[176:191], v[56:59], v[152:155], v[176:191]
    ds_read_b64_tr_b16 v[148:149], v235 offset:20480
    ds_read_b64_tr_b16 v[150:151], v235 offset:21504
    s_waitcnt lgkmcnt(12)
    v_mfma_f32_32x32x16_bf16 v[176:191], v[60:63], v[156:159], v[176:191]
    ds_read_b64_tr_b16 v[152:153], v235 offset:24576
    ds_read_b64_tr_b16 v[154:155], v235 offset:25600
    s_waitcnt lgkmcnt(12)
    v_mfma_f32_32x32x16_bf16 v[176:191], v[64:67], v[128:131], v[176:191]
    ds_read_b64_tr_b16 v[156:157], v235 offset:28672
    ds_read_b64_tr_b16 v[158:159], v235 offset:29696
    s_waitcnt lgkmcnt(12)
    v_mfma_f32_32x32x16_bf16 v[176:191], v[68:71], v[132:135], v[176:191]
    ds_read_b64_tr_b16 v[128:129], v235 offset:32768
    ds_read_b64_tr_b16 v[130:131], v235 offset:33792
    s_waitcnt lgkmcnt(12)
    v_mfma_f32_32x32x16_bf16 v[176:191], v[72:75], v[136:139], v[176:191]
    ds_read_b64_tr_b16 v[132:133], v235 offset:36864
    ds_read_b64_tr_b16 v[134:135], v235 offset:37888
    s_waitcnt lgkmcnt(12)
    v_mfma_f32_32x32x16_bf16 v[176:191], v[76:79], v[140:143], v[176:191]
    ds_read_b64_tr_b16 v[136:137], v235 offset:40960
    ds_read_b64_tr_b16 v[138:139], v235 offset:41984
    s_waitcnt lgkmcnt(12)
    v_mfma_f32_32x32x16_bf16 v[176:191], v[80:83], v[144:147], v[176:191]
    ds_read_b64_tr_b16 v[140:141], v235 offset:45056
    ds_read_b64_tr_b16 v[142:143], v235 offset:46080
    s_waitcnt lgkmcnt(12)
    v_mfma_f32_32x32x16_bf16 v[176:191], v[84:87], v[148:151], v[176:191]
    ds_read_b64_tr_b16 v[144:145], v235 offset:49152
    ds_read_b64_tr_b16 v[146:147], v235 offset:50176
    s_waitcnt lgkmcnt(12)
    v_mfma_f32_32x32x16_bf16 v[176:191], v[88:91], v[152:155], v[176:191]
    ds_read_b64_tr_b16 v[148:149], v235 offset:53248
    ds_read_b64_tr_b16 v[150:151], v235 offset:54272
    s_waitcnt lgkmcnt(12)
    v_mfma_f32_32x32x16_bf16 v[176:191], v[92:95], v[156:159], v[176:191]
    ds_read_b64_tr_b16 v[152:153], v235 offset:57344
    ds_read_b64_tr_b16 v[154:155], v235 offset:58368
    s_waitcnt lgkmcnt(12)
    v_mfma_f32_32x32x16_bf16 v[176:191], v[96:99], v[128:131], v[176:191]
    ds_read_b64_tr_b16 v[156:157], v235 offset:61440
    ds_read_b64_tr_b16 v[158:159], v235 offset:62464
    s_waitcnt lgkmcnt(12)
    v_mfma_f32_32x32x16_bf16 v[176:191], v[100:103], v[132:135], v[176:191]
    ds_read_b64_tr_b16 v[128:129], v236 offset:0
    ds_read_b64_tr_b16 v[130:131], v236 offset:1024
    s_waitcnt lgkmcnt(12)
    v_mfma_f32_32x32x16_bf16 v[176:191], v[104:107], v[136:139], v[176:191]
    ds_read_b64_tr_b16 v[132:133], v236 offset:4096
    ds_read_b64_tr_b16 v[134:135], v236 offset:5120
    s_waitcnt lgkmcnt(12)
    v_mfma_f32_32x32x16_bf16 v[176:191], v[108:111], v[140:143], v[176:191]
    ds_read_b64_tr_b16 v[136:137], v236 offset:8192
    ds_read_b64_tr_b16 v[138:139], v236 offset:9216
    s_waitcnt lgkmcnt(12)
    v_mfma_f32_32x32x16_bf16 v[176:191], v[112:115], v[144:147], v[176:191]
    ds_read_b64_tr_b16 v[140:141], v236 offset:12288
    ds_read_b64_tr_b16 v[142:143], v236 offset:13312
    s_waitcnt lgkmcnt(12)
    v_mfma_f32_32x32x16_bf16 v[176:191], v[116:119], v[148:151], v[176:191]
    ds_read_b64_tr_b16 v[144:145], v236 offset:16384
    ds_read_b64_tr_b16 v[146:147], v236 offset:17408
    s_waitcnt lgkmcnt(12)
    v_mfma_f32_32x32x16_bf16 v[176:191], v[120:123], v[152:155], v[176:191]
    ds_read_b64_tr_b16 v[148:149], v236 offset:20480
    ds_read_b64_tr_b16 v[150:151], v236 offset:21504
    s_waitcnt lgkmcnt(12)
    v_mfma_f32_32x32x16_bf16 v[176:191], v[124:127], v[156:159], v[176:191]
    v_mbcnt_lo_u32_b32 v252, -1, 0
    v_and_b32 v252, 15, v252
    v_lshlrev_b32 v252, 4, v252
    s_lshl_b32 s59, s3, 1
    s_add_u32 s59, s59, 13
L_v_wa:
    global_load_dword v253, v252, s[18:19] sc1
    s_waitcnt vmcnt(0)
L_v_w0:
    v_readlane_b32 s58, v253, s59
    s_cmp_ge_u32 s58, 256
    s_cbranch_scc1 L_v_wb
    s_sleep 16
    s_sub_u32 s27, s27, 1
    s_cbranch_scc0 L_v_wa
    s_branch L_end
L_v_wb:
    s_cmp_eq_u32 s3, 1
    s_cbranch_scc1 L_v_wc
    v_cmp_ne_u32 vcc, 32, v253
    s_and_b32 s58, vcc_lo, 0x5555
    s_cbranch_scc0 L_v_wc
    global_load_dword v253, v252, s[18:19] sc1
    s_waitcnt vmcnt(0)
    v_cmp_ne_u32 vcc, 32, v253
    s_and_b32 s58, vcc_lo, 0x5555
    s_cbranch_scc1 L_safe
L_v_wc:
    ds_read_b64_tr_b16 v[152:153], v236 offset:24576
    ds_read_b64_tr_b16 v[154:155], v236 offset:25600
    s_waitcnt lgkmcnt(12)
    v_mfma_f32_32x32x16_bf16 v[160:175], v[0:3], v[128:131], 0
    buffer_load_dwordx4 a[0:3], v240, s[28:31], s32 offen offset:0 sc1
    ds_read_b64_tr_b16 v[156:157], v236 offset:28672
    ds_read_b64_tr_b16 v[158:159], v236 offset:29696
    s_waitcnt lgkmcnt(12)
    v_mfma_f32_32x32x16_bf16 v[160:175], v[4:7], v[132:135], v[160:175]
    buffer_load_dwordx4 a[4:7], v240, s[28:31], s32 offen offset:1024 sc1
    ds_read_b64_tr_b16 v[128:129], v236 offset:32768
    ds_read_b64_tr_b16 v[130:131], v236 offset:33792
    s_waitcnt lgkmcnt(12)
    v_mfma_f32_32x32x16_bf16 v[160:175], v[8:11], v[136:139], v[160:175]
    buffer_load_dwordx4 a[8:11], v240, s[28:31], s32 offen offset:2048 sc1
    ds_read_b64_tr_b16 v[132:133], v236 offset:36864
    ds_read_b64_tr_b16 v[134:135], v236 offset:37888
    s_waitcnt lgkmcnt(12)
    v_mfma_f32_32x32x16_bf16 v[160:175], v[12:15], v[140:143], v[160:175]
    buffer_load_dwordx4 a[12:15], v240, s[28:31], s32 offen offset:3072 sc1
    v_cvt_pk_bf16_f32 v200, v176, v177
    v_cvt_pk_bf16_f32 v201, v178, v179
    ds_read_b64_tr_b16 v[136:137], v236 offset:40960
    ds_read_b64_tr_b16 v[138:139], v236 offset:41984
    s_waitcnt lgkmcnt(12)
    v_mfma_f32_32x32x16_bf16 v[160:175], v[16:19], v[144:147], v[160:175]
    buffer_load_dwordx4 a[16:19], v240, s[28:31], s33 offen offset:0 sc1
    v_cvt_pk_bf16_f32 v202, v180, v181
    v_cvt_pk_bf16_f32 v203, v182, v183
    ds_read_b64_tr_b16 v[140:141], v236 offset:45056
    ds_read_b64_tr_b16 v[142:143], v236 offset:46080
    s_waitcnt lgkmcnt(12)
    v_mfma_f32_32x32x16_bf16 v[160:175], v[20:23], v[148:151], v[160:175]
    buffer_load_dwordx4 a[20:23], v240, s[28:31], s33 offen offset:1024 sc1
    v_cvt_pk_bf16_f32 v204, v184, v185
    v_cvt_pk_bf16_f32 v205, v186, v187
    ds_read_b64_tr_b16 v[144:145], v236 offset:49152
    ds_read_b64_tr_b16 v[146:147], v236 offset:50176
    s_waitcnt lgkmcnt(12)
    v_mfma_f32_32x32x16_bf16 v[160:175], v[24:27], v[152:155], v[160:175]
    buffer_load_dwordx4 a[24:27], v240, s[28:31], s33 offen offset:2048 sc1
    v_cvt_pk_bf16_f32 v206, v188, v189
    v_cvt_pk_bf16_f32 v207, v190, v191
    buffer_store_dwordx4 v[200:203], v243, s[52:55], s33 offen offset:0 sc1
    ds_read_b64_tr_b16 v[148:149], v236 offset:53248
    ds_read_b64_tr_b16 v[150:151], v236 offset:54272
    s_waitcnt lgkmcnt(12)
    v_mfma_f32_32x32x16_bf16 v[160:175], v[28:31], v[156:159], v[160:175]
    buffer_load_dwordx4 a[28:31], v240, s[28:31], s33 offen offset:3072 sc1
    ds_read_b64_tr_b16 v[152:153], v236 offset:57344
    ds_read_b64_tr_b16 v[154:155], v236 offset:58368
    s_waitcnt lgkmcnt(12)
    v_mfma_f32_32x32x16_bf16 v[160:175], v[32:35], v[128:131], v[160:175]
    buffer_load_dwordx4 a[32:35], v240, s[28:31], s34 offen offset:0 sc1
    ds_read_b64_tr_b16 v[156:157], v236 offset:61440
    ds_read_b64_tr_b16 v[158:159], v236 offset:62464
    s_waitcnt lgkmcnt(12)
    v_mfma_f32_32x32x16_bf16 v[160:175], v[36:39], v[132:135], v[160:175]
    buffer_load_dwordx4 a[36:39], v240, s[28:31], s34 offen offset:1024 sc1
    buffer_store_dwordx4 v[204:207], v243, s[52:55], s33 offen offset:512 sc1
    ds_read_b64_tr_b16 v[128:129], v237 offset:0
    ds_read_b64_tr_b16 v[130:131], v237 offset:1024
    s_waitcnt lgkmcnt(12)
    v_mfma_f32_32x32x16_bf16 v[160:175], v[40:43], v[136:139], v[160:175]
    buffer_load_dwordx4 a[40:43], v240, s[28:31], s34 offen offset:2048 sc1
    ds_read_b64_tr_b16 v[132:133], v237 offset:4096
    ds_read_b64_tr_b16 v[134:135], v237 offset:5120
    s_waitcnt lgkmcnt(12)
    v_mfma_f32_32x32x16_bf16 v[160:175], v[44:47], v[140:143], v[160:175]
    buffer_load_dwordx4 a[44:47], v240, s[28:31], s34 offen offset:3072 sc1
    ds_read_b64_tr_b16 v[136:137], v237 offset:8192
    ds_read_b64_tr_b16 v[138:139], v237 offset:9216
    s_waitcnt lgkmcnt(12)
    v_mfma_f32_32x32x16_bf16 v[160:175], v[48:51], v[144:147], v[160:175]
    buffer_load_dwordx4 a[48:51], v240, s[28:31], s35 offen offset:0 sc1
    ds_read_b64_tr_b16 v[140:141], v237 offset:12288
    ds_read_b64_tr_b16 v[142:143], v237 offset:13312
    s_waitcnt lgkmcnt(12)
    v_mfma_f32_32x32x16_bf16 v[160:175], v[52:55], v[148:151], v[160:175]
    buffer_load_dwordx4 a[52:55], v240, s[28:31], s35 offen offset:1024 sc1
    ds_read_b64_tr_b16 v[144:145], v237 offset:16384
    ds_read_b64_tr_b16 v[146:147], v237 offset:17408
    s_waitcnt lgkmcnt(12)
    v_mfma_f32_32x32x16_bf16 v[160:175], v[56:59], v[152:155], v[160:175]
    buffer_load_dwordx4 a[56:59], v240, s[28:31], s35 offen offset:2048 sc1
    ds_read_b64_tr_b16 v[148:149], v237 offset:20480
    ds_read_b64_tr_b16 v[150:151], v237 offset:21504
    s_waitcnt lgkmcnt(12)
    v_mfma_f32_32x32x16_bf16 v[160:175], v[60:63], v[156:159], v[160:175]
    buffer_load_dwordx4 a[60:63], v240, s[28:31], s35 offen offset:3072 sc1
    ds_read_b64_tr_b16 v[152:153], v237 offset:24576
    ds_read_b64_tr_b16 v[154:155], v237 offset:25600
    s_waitcnt lgkmcnt(12)
    v_mfma_f32_32x32x16_bf16 v[160:175], v[64:67], v[128:131], v[160:175]
    buffer_load_dwordx4 a[64:67], v240, s[28:31], s36 offen offset:0 sc1
    ds_read_b64_tr_b16 v[156:157], v237 offset:28672
    ds_read_b64_tr_b16 v[158:159], v237 offset:29696
    s_waitcnt lgkmcnt(12)
    v_mfma_f32_32x32x16_bf16 v[160:175], v[68:71], v[132:135], v[160:175]
    buffer_load_dwordx4 a[68:71], v240, s[28:31], s36 offen offset:1024 sc1
    ds_read_b64_tr_b16 v[128:129], v237 offset:32768
    ds_read_b64_tr_b16 v[130:131], v237 offset:33792
    s_waitcnt lgkmcnt(12)
    v_mfma_f32_32x32x16_bf16 v[160:175], v[72:75], v[136:139], v[160:175]
    buffer_load_dwordx4 a[72:75], v240, s[28:31], s36 offen offset:2048 sc1
    ds_read_b64_tr_b16 v[132:133], v237 offset:36864
    ds_read_b64_tr_b16 v[134:135], v237 offset:37888
    s_waitcnt lgkmcnt(12)
    v_mfma_f32_32x32x16_bf16 v[160:175], v[76:79], v[140:143], v[160:175]
    buffer_load_dwordx4 a[76:79], v240, s[28:31], s36 offen offset:3072 sc1
    ds_read_b64_tr_b16 v[136:137], v237 offset:40960
    ds_read_b64_tr_b16 v[138:139], v237 offset:41984
    s_waitcnt lgkmcnt(12)
    v_mfma_f32_32x32x16_bf16 v[160:175], v[80:83], v[144:147], v[160:175]
    buffer_load_dwordx4 a[80:83], v240, s[28:31], s37 offen offset:0 sc1
    ds_read_b64_tr_b16 v[140:141], v237 offset:45056
    ds_read_b64_tr_b16 v[142:143], v237 offset:46080
    s_waitcnt lgkmcnt(12)
    v_mfma_f32_32x32x16_bf16 v[160:175], v[84:87], v[148:151], v[160:175]
    buffer_load_dwordx4 a[84:87], v240, s[28:31], s37 offen offset:1024 sc1
    ds_read_b64_tr_b16 v[144:145], v237 offset:49152
    ds_read_b64_tr_b16 v[146:147], v237 offset:50176
    s_waitcnt lgkmcnt(12)
    v_mfma_f32_32x32x16_bf16 v[160:175], v[88:91], v[152:155], v[160:175]
    buffer_load_dwordx4 a[88:91], v240, s[28:31], s37 offen offset:2048 sc1
    ds_read_b64_tr_b16 v[148:149], v237 offset:53248
    ds_read_b64_tr_b16 v[150:151], v237 offset:54272
    s_waitcnt lgkmcnt(12)
    v_mfma_f32_32x32x16_bf16 v[160:175], v[92:95], v[156:159], v[160:175]
    buffer_load_dwordx4 a[92:95], v240, s[28:31], s37 offen offset:3072 sc1
    ds_read_b64_tr_b16 v[152:153], v237 offset:57344
    ds_read_b64_tr_b16 v[154:155], v237 offset:58368
    s_waitcnt lgkmcnt(12)
    v_mfma_f32_32x32x16_bf16 v[160:175], v[96:99], v[128:131], v[160:175]
    buffer_load_dwordx4 a[96:99], v240, s[28:31], s38 offen offset:0 sc1
    ds_read_b64_tr_b16 v[156:157], v237 offset:61440
    ds_read_b64_tr_b16 v[158:159], v237 offset:62464
    s_waitcnt lgkmcnt(12)
    v_mfma_f32_32x32x16_bf16 v[160:175], v[100:103], v[132:135], v[160:175]
    buffer_load_dwordx4 a[100:103], v240, s[28:31], s38 offen offset:1024 sc1
    ds_read_b64_tr_b16 v[128:129], v238 offset:0
    ds_read_b64_tr_b16 v[130:131], v238 offset:1024
    s_waitcnt lgkmcnt(12)
    v_mfma_f32_32x32x16_bf16 v[160:175], v[104:107], v[136:139], v[160:175]
    buffer_load_dwordx4 a[104:107], v240, s[28:31], s38 offen offset:2048 sc1
    ds_read_b64_tr_b16 v[132:133], v238 offset:4096
    ds_read_b64_tr_b16 v[134:135], v238 offset:5120
    s_waitcnt lgkmcnt(12)
    v_mfma_f32_32x32x16_bf16 v[160:175], v[108:111], v[140:143], v[160:175]
    buffer_load_dwordx4 a[108:111], v240, s[28:31], s38 offen offset:3072 sc1
    ds_read_b64_tr_b16 v[136:137], v238 offset:8192
    ds_read_b64_tr_b16 v[138:139], v238 offset:9216
    s_waitcnt lgkmcnt(12)
    v_mfma_f32_32x32x16_bf16 v[160:175], v[112:115], v[144:147], v[160:175]
    buffer_load_dwordx4 a[112:115], v240, s[28:31], s39 offen offset:0 sc1
    ds_read_b64_tr_b16 v[140:141], v238 offset:12288
    ds_read_b64_tr_b16 v[142:143], v238 offset:13312
    s_waitcnt lgkmcnt(12)
    v_mfma_f32_32x32x16_bf16 v[160:175], v[116:119], v[148:151], v[160:175]
    buffer_load_dwordx4 a[116:119], v240, s[28:31], s39 offen offset:1024 sc1
    ds_read_b64_tr_b16 v[144:145], v238 offset:16384
    ds_read_b64_tr_b16 v[146:147], v238 offset:17408
    s_waitcnt lgkmcnt(12)
    v_mfma_f32_32x32x16_bf16 v[160:175], v[120:123], v[152:155], v[160:175]
    buffer_load_dwordx4 a[120:123], v240, s[28:31], s39 offen offset:2048 sc1
    ds_read_b64_tr_b16 v[148:149], v238 offset:20480
    ds_read_b64_tr_b16 v[150:151], v238 offset:21504
    s_waitcnt lgkmcnt(12)
    v_mfma_f32_32x32x16_bf16 v[160:175], v[124:127], v[156:159], v[160:175]
    buffer_load_dwordx4 a[124:127], v240, s[28:31], s39 offen offset:3072 sc1
    ds_read_b64_tr_b16 v[152:153], v238 offset:24576
    ds_read_b64_tr_b16 v[154:155], v238 offset:25600
    s_waitcnt lgkmcnt(12)
    v_mfma_f32_32x32x16_bf16 v[176:191], v[0:3], v[128:131], 0
    ds_read_b64_tr_b16 v[156:157], v238 offset:28672
    ds_read_b64_tr_b16 v[158:159], v238 offset:29696
    s_waitcnt lgkmcnt(12)
    v_mfma_f32_32x32x16_bf16 v[176:191], v[4:7], v[132:135], v[176:191]
    ds_read_b64_tr_b16 v[128:129], v238 offset:32768
    ds_read_b64_tr_b16 v[130:131], v238 offset:33792
    s_waitcnt lgkmcnt(12)
    v_mfma_f32_32x32x16_bf16 v[176:191], v[8:11], v[136:139], v[176:191]
    ds_read_b64_tr_b16 v[132:133], v238 offset:36864
    ds_read_b64_tr_b16 v[134:135], v238 offset:37888
    s_waitcnt lgkmcnt(12)
    v_mfma_f32_32x32x16_bf16 v[176:191], v[12:15], v[140:143], v[176:191]
    v_cvt_pk_bf16_f32 v192, v160, v161
    v_cvt_pk_bf16_f32 v193, v162, v163
    ds_read_b64_tr_b16 v[136:137], v238 offset:40960
    ds_read_b64_tr_b16 v[138:139], v238 offset:41984
    s_waitcnt lgkmcnt(12)
    v_mfma_f32_32x32x16_bf16 v[176:191], v[16:19], v[144:147], v[176:191]
    v_cvt_pk_bf16_f32 v194, v164, v165
    v_cvt_pk_bf16_f32 v195, v166, v167
    ds_read_b64_tr_b16 v[140:141], v238 offset:45056
    ds_read_b64_tr_b16 v[142:143], v238 offset:46080
    s_waitcnt lgkmcnt(12)
    v_mfma_f32_32x32x16_bf16 v[176:191], v[20:23], v[148:151], v[176:191]
    v_cvt_pk_bf16_f32 v196, v168, v169
    v_cvt_pk_bf16_f32 v197, v170, v171
    ds_read_b64_tr_b16 v[144:145], v238 offset:49152
    ds_read_b64_tr_b16 v[146:147], v238 offset:50176
    s_waitcnt lgkmcnt(12)
    v_mfma_f32_32x32x16_bf16 v[176:191], v[24:27], v[152:155], v[176:191]
    v_cvt_pk_bf16_f32 v198, v172, v173
    v_cvt_pk_bf16_f32 v199, v174, v175
    buffer_store_dwordx4 v[192:195], v243, s[52:55], s34 offen offset:0 sc1
    ds_read_b64_tr_b16 v[148:149], v238 offset:53248
    ds_read_b64_tr_b16 v[150:151], v238 offset:54272
    s_waitcnt lgkmcnt(12)
    v_mfma_f32_32x32x16_bf16 v[176:191], v[28:31], v[156:159], v[176:191]
    ds_read_b64_tr_b16 v[152:153], v238 offset:57344
    ds_read_b64_tr_b16 v[154:155], v238 offset:58368
    s_waitcnt lgkmcnt(12)
    v_mfma_f32_32x32x16_bf16 v[176:191], v[32:35], v[128:131], v[176:191]
    ds_read_b64_tr_b16 v[156:157], v238 offset:61440
    ds_read_b64_tr_b16 v[158:159], v238 offset:62464
    s_waitcnt lgkmcnt(12)
    v_mfma_f32_32x32x16_bf16 v[176:191], v[36:39], v[132:135], v[176:191]
    buffer_store_dwordx4 v[196:199], v243, s[52:55], s34 offen offset:512 sc1
    ds_read_b64_tr_b16 v[128:129], v239 offset:0
    ds_read_b64_tr_b16 v[130:131], v239 offset:1024
    s_waitcnt lgkmcnt(12)
    v_mfma_f32_32x32x16_bf16 v[176:191], v[40:43], v[136:139], v[176:191]
    ds_read_b64_tr_b16 v[132:133], v239 offset:4096
    ds_read_b64_tr_b16 v[134:135], v239 offset:5120
    s_waitcnt lgkmcnt(12)
    v_mfma_f32_32x32x16_bf16 v[176:191], v[44:47], v[140:143], v[176:191]
    ds_read_b64_tr_b16 v[136:137], v239 offset:8192
    ds_read_b64_tr_b16 v[138:139], v239 offset:9216
    s_waitcnt lgkmcnt(12)
    v_mfma_f32_32x32x16_bf16 v[176:191], v[48:51], v[144:147], v[176:191]
    ds_read_b64_tr_b16 v[140:141], v239 offset:12288
    ds_read_b64_tr_b16 v[142:143], v239 offset:13312
    s_waitcnt lgkmcnt(12)
    v_mfma_f32_32x32x16_bf16 v[176:191], v[52:55], v[148:151], v[176:191]
    ds_read_b64_tr_b16 v[144:145], v239 offset:16384
    ds_read_b64_tr_b16 v[146:147], v239 offset:17408
    s_waitcnt lgkmcnt(12)
    v_mfma_f32_32x32x16_bf16 v[176:191], v[56:59], v[152:155], v[176:191]
    ds_read_b64_tr_b16 v[148:149], v239 offset:20480
    ds_read_b64_tr_b16 v[150:151], v239 offset:21504
    s_waitcnt lgkmcnt(12)
    v_mfma_f32_32x32x16_bf16 v[176:191], v[60:63], v[156:159], v[176:191]
    ds_read_b64_tr_b16 v[152:153], v239 offset:24576
    ds_read_b64_tr_b16 v[154:155], v239 offset:25600
    s_waitcnt lgkmcnt(12)
    v_mfma_f32_32x32x16_bf16 v[176:191], v[64:67], v[128:131], v[176:191]
    ds_read_b64_tr_b16 v[156:157], v239 offset:28672
    ds_read_b64_tr_b16 v[158:159], v239 offset:29696
    s_waitcnt lgkmcnt(12)
    v_mfma_f32_32x32x16_bf16 v[176:191], v[68:71], v[132:135], v[176:191]
    ds_read_b64_tr_b16 v[128:129], v239 offset:32768
    ds_read_b64_tr_b16 v[130:131], v239 offset:33792
    s_waitcnt lgkmcnt(12)
    v_mfma_f32_32x32x16_bf16 v[176:191], v[72:75], v[136:139], v[176:191]
    ds_read_b64_tr_b16 v[132:133], v239 offset:36864
    ds_read_b64_tr_b16 v[134:135], v239 offset:37888
    s_waitcnt lgkmcnt(12)
    v_mfma_f32_32x32x16_bf16 v[176:191], v[76:79], v[140:143], v[176:191]
    ds_read_b64_tr_b16 v[136:137], v239 offset:40960
    ds_read_b64_tr_b16 v[138:139], v239 offset:41984
    s_waitcnt lgkmcnt(12)
    v_mfma_f32_32x32x16_bf16 v[176:191], v[80:83], v[144:147], v[176:191]
    ds_read_b64_tr_b16 v[140:141], v239 offset:45056
    ds_read_b64_tr_b16 v[142:143], v239 offset:46080
    s_waitcnt lgkmcnt(12)
    v_mfma_f32_32x32x16_bf16 v[176:191], v[84:87], v[148:151], v[176:191]
    ds_read_b64_tr_b16 v[144:145], v239 offset:49152
    ds_read_b64_tr_b16 v[146:147], v239 offset:50176
    s_waitcnt lgkmcnt(12)
    v_mfma_f32_32x32x16_bf16 v[176:191], v[88:91], v[152:155], v[176:191]
    ds_read_b64_tr_b16 v[148:149], v239 offset:53248
    ds_read_b64_tr_b16 v[150:151], v239 offset:54272
    s_waitcnt lgkmcnt(12)
    v_mfma_f32_32x32x16_bf16 v[176:191], v[92:95], v[156:159], v[176:191]
    ds_read_b64_tr_b16 v[152:153], v239 offset:57344
    ds_read_b64_tr_b16 v[154:155], v239 offset:58368
    s_waitcnt lgkmcnt(12)
    v_mfma_f32_32x32x16_bf16 v[176:191], v[96:99], v[128:131], v[176:191]
    ds_read_b64_tr_b16 v[156:157], v239 offset:61440
    ds_read_b64_tr_b16 v[158:159], v239 offset:62464
    s_waitcnt lgkmcnt(12)
    v_mfma_f32_32x32x16_bf16 v[176:191], v[100:103], v[132:135], v[176:191]
    ds_read_b64_tr_b16 v[128:129], v232 offset:0
    ds_read_b64_tr_b16 v[130:131], v232 offset:1024
    s_waitcnt lgkmcnt(12)
    v_mfma_f32_32x32x16_bf16 v[176:191], v[104:107], v[136:139], v[176:191]
    ds_read_b64_tr_b16 v[132:133], v232 offset:4096
    ds_read_b64_tr_b16 v[134:135], v232 offset:5120
    s_waitcnt lgkmcnt(12)
    v_mfma_f32_32x32x16_bf16 v[176:191], v[108:111], v[140:143], v[176:191]
    ds_read_b64_tr_b16 v[136:137], v232 offset:8192
    ds_read_b64_tr_b16 v[138:139], v232 offset:9216
    s_waitcnt lgkmcnt(12)
    v_mfma_f32_32x32x16_bf16 v[176:191], v[112:115], v[144:147], v[176:191]
    ds_read_b64_tr_b16 v[140:141], v232 offset:12288
    ds_read_b64_tr_b16 v[142:143], v232 offset:13312
    s_waitcnt lgkmcnt(12)
    v_mfma_f32_32x32x16_bf16 v[176:191], v[116:119], v[148:151], v[176:191]
    ds_read_b64_tr_b16 v[144:145], v232 offset:16384
    ds_read_b64_tr_b16 v[146:147], v232 offset:17408
    s_waitcnt lgkmcnt(12)
    v_mfma_f32_32x32x16_bf16 v[176:191], v[120:123], v[152:155], v[176:191]
    ds_read_b64_tr_b16 v[148:149], v232 offset:20480
    ds_read_b64_tr_b16 v[150:151], v232 offset:21504
    s_waitcnt lgkmcnt(12)
    v_mfma_f32_32x32x16_bf16 v[176:191], v[124:127], v[156:159], v[176:191]
    s_add_u32 s28, s28, 131072
    s_addc_u32 s29, s29, 0
    s_add_u32 s26, s26, 1
L_v_loop:
    s_waitcnt vmcnt(2)
    ds_read_b64_tr_b16 v[152:153], v232 offset:24576
    ds_read_b64_tr_b16 v[154:155], v232 offset:25600
    s_waitcnt lgkmcnt(12)
    v_mfma_f32_32x32x16_bf16 v[160:175], a[0:3], v[128:131], 0
    ds_read_b64_tr_b16 v[156:157], v232 offset:28672
    ds_read_b64_tr_b16 v[158:159], v232 offset:29696
    s_waitcnt lgkmcnt(12)
    v_mfma_f32_32x32x16_bf16 v[160:175], a[4:7], v[132:135], v[160:175]
    ds_read_b64_tr_b16 v[128:129], v232 offset:32768
    ds_read_b64_tr_b16 v[130:131], v232 offset:33792
    s_waitcnt lgkmcnt(12)
    v_mfma_f32_32x32x16_bf16 v[160:175], a[8:11], v[136:139], v[160:175]
    buffer_load_dwordx4 v[0:3], v240, s[28:31], s32 offen offset:0 sc1
    ds_read_b64_tr_b16 v[132:133], v232 offset:36864
    ds_read_b64_tr_b16 v[134:135], v232 offset:37888
    s_waitcnt lgkmcnt(12)
    v_mfma_f32_32x32x16_bf16 v[160:175], a[12:15], v[140:143], v[160:175]
    v_cvt_pk_bf16_f32 v200, v176, v177
    v_cvt_pk_bf16_f32 v201, v178, v179
    ds_read_b64_tr_b16 v[136:137], v232 offset:40960
    ds_read_b64_tr_b16 v[138:139], v232 offset:41984
    s_waitcnt lgkmcnt(12)
    v_mfma_f32_32x32x16_bf16 v[160:175], a[16:19], v[144:147], v[160:175]
    v_cvt_pk_bf16_f32 v202, v180, v181
    v_cvt_pk_bf16_f32 v203, v182, v183
    ds_read_b64_tr_b16 v[140:141], v232 offset:45056
    ds_read_b64_tr_b16 v[142:143], v232 offset:46080
    s_waitcnt lgkmcnt(12)
    v_mfma_f32_32x32x16_bf16 v[160:175], a[20:23], v[148:151], v[160:175]
    buffer_load_dwordx4 v[4:7], v240, s[28:31], s32 offen offset:1024 sc1
    v_cvt_pk_bf16_f32 v204, v184, v185
    v_cvt_pk_bf16_f32 v205, v186, v187
    ds_read_b64_tr_b16 v[144:145], v232 offset:49152
    ds_read_b64_tr_b16 v[146:147], v232 offset:50176
    s_waitcnt lgkmcnt(12)
    v_mfma_f32_32x32x16_bf16 v[160:175], a[24:27], v[152:155], v[160:175]
    v_cvt_pk_bf16_f32 v206, v188, v189
    v_cvt_pk_bf16_f32 v207, v190, v191
    buffer_store_dwordx4 v[200:203], v243, s[52:55], s35 offen offset:0 sc1
    ds_read_b64_tr_b16 v[148:149], v232 offset:53248
    ds_read_b64_tr_b16 v[150:151], v232 offset:54272
    s_waitcnt lgkmcnt(12)
    v_mfma_f32_32x32x16_bf16 v[160:175], a[28:31], v[156:159], v[160:175]
    ds_read_b64_tr_b16 v[152:153], v232 offset:57344
    ds_read_b64_tr_b16 v[154:155], v232 offset:58368
    s_waitcnt lgkmcnt(12)
    v_mfma_f32_32x32x16_bf16 v[160:175], a[32:35], v[128:131], v[160:175]
    buffer_load_dwordx4 v[8:11], v240, s[28:31], s32 offen offset:2048 sc1
    ds_read_b64_tr_b16 v[156:157], v232 offset:61440
    ds_read_b64_tr_b16 v[158:159], v232 offset:62464
    s_waitcnt lgkmcnt(12)
    v_mfma_f32_32x32x16_bf16 v[160:175], a[36:39], v[132:135], v[160:175]
    buffer_store_dwordx4 v[204:207], v243, s[52:55], s35 offen offset:512 sc1
    s_add_u32 s52, s52, 2097152
    s_addc_u32 s53, s53, 0
    ds_read_b64_tr_b16 v[128:129], v233 offset:0
    ds_read_b64_tr_b16 v[130:131], v233 offset:1024
    s_waitcnt lgkmcnt(12)
    v_mfma_f32_32x32x16_bf16 v[160:175], a[40:43], v[136:139], v[160:175]
    ds_read_b64_tr_b16 v[132:133], v233 offset:4096
    ds_read_b64_tr_b16 v[134:135], v233 offset:5120
    s_waitcnt lgkmcnt(12)
    v_mfma_f32_32x32x16_bf16 v[160:175], a[44:47], v[140:143], v[160:175]
    buffer_load_dwordx4 v[12:15], v240, s[28:31], s32 offen offset:3072 sc1
    ds_read_b64_tr_b16 v[136:137], v233 offset:8192
    ds_read_b64_tr_b16 v[138:139], v233 offset:9216
    s_waitcnt lgkmcnt(12)
    v_mfma_f32_32x32x16_bf16 v[160:175], a[48:51], v[144:147], v[160:175]
    ds_read_b64_tr_b16 v[140:141], v233 offset:12288
    ds_read_b64_tr_b16 v[142:143], v233 offset:13312
    s_waitcnt lgkmcnt(12)
    v_mfma_f32_32x32x16_bf16 v[160:175], a[52:55], v[148:151], v[160:175]
    ds_read_b64_tr_b16 v[144:145], v233 offset:16384
    ds_read_b64_tr_b16 v[146:147], v233 offset:17408
    s_waitcnt lgkmcnt(12)
    v_mfma_f32_32x32x16_bf16 v[160:175], a[56:59], v[152:155], v[160:175]
    buffer_load_dwordx4 v[16:19], v240, s[28:31], s33 offen offset:0 sc1
    ds_read_b64_tr_b16 v[148:149], v233 offset:20480
    ds_read_b64_tr_b16 v[150:151], v233 offset:21504
    s_waitcnt lgkmcnt(12)
    v_mfma_f32_32x32x16_bf16 v[160:175], a[60:63], v[156:159], v[160:175]
    ds_read_b64_tr_b16 v[152:153], v233 offset:24576
    ds_read_b64_tr_b16 v[154:155], v233 offset:25600
    s_waitcnt lgkmcnt(12)
    v_mfma_f32_32x32x16_bf16 v[160:175], a[64:67], v[128:131], v[160:175]
    ds_read_b64_tr_b16 v[156:157], v233 offset:28672
    ds_read_b64_tr_b16 v[158:159], v233 offset:29696
    s_waitcnt lgkmcnt(12)
    v_mfma_f32_32x32x16_bf16 v[160:175], a[68:71], v[132:135], v[160:175]
    buffer_load_dwordx4 v[20:23], v240, s[28:31], s33 offen offset:1024 sc1
    ds_read_b64_tr_b16 v[128:129], v233 offset:32768
    ds_read_b64_tr_b16 v[130:131], v233 offset:33792
    s_waitcnt lgkmcnt(12)
    v_mfma_f32_32x32x16_bf16 v[160:175], a[72:75], v[136:139], v[160:175]
    ds_read_b64_tr_b16 v[132:133], v233 offset:36864
    ds_read_b64_tr_b16 v[134:135], v233 offset:37888
    s_waitcnt lgkmcnt(12)
    v_mfma_f32_32x32x16_bf16 v[160:175], a[76:79], v[140:143], v[160:175]
    ds_read_b64_tr_b16 v[136:137], v233 offset:40960
    ds_read_b64_tr_b16 v[138:139], v233 offset:41984
    s_waitcnt lgkmcnt(12)
    v_mfma_f32_32x32x16_bf16 v[160:175], a[80:83], v[144:147], v[160:175]
    buffer_load_dwordx4 v[24:27], v240, s[28:31], s33 offen offset:2048 sc1
    ds_read_b64_tr_b16 v[140:141], v233 offset:45056
    ds_read_b64_tr_b16 v[142:143], v233 offset:46080
    s_waitcnt lgkmcnt(12)
    v_mfma_f32_32x32x16_bf16 v[160:175], a[84:87], v[148:151], v[160:175]
    ds_read_b64_tr_b16 v[144:145], v233 offset:49152
    ds_read_b64_tr_b16 v[146:147], v233 offset:50176
    s_waitcnt lgkmcnt(12)
    v_mfma_f32_32x32x16_bf16 v[160:175], a[88:91], v[152:155], v[160:175]
    ds_read_b64_tr_b16 v[148:149], v233 offset:53248
    ds_read_b64_tr_b16 v[150:151], v233 offset:54272
    s_waitcnt lgkmcnt(12)
    v_mfma_f32_32x32x16_bf16 v[160:175], a[92:95], v[156:159], v[160:175]
    buffer_load_dwordx4 v[28:31], v240, s[28:31], s33 offen offset:3072 sc1
    ds_read_b64_tr_b16 v[152:153], v233 offset:57344
    ds_read_b64_tr_b16 v[154:155], v233 offset:58368
    s_waitcnt lgkmcnt(12)
    v_mfma_f32_32x32x16_bf16 v[160:175], a[96:99], v[128:131], v[160:175]
    ds_read_b64_tr_b16 v[156:157], v233 offset:61440
    ds_read_b64_tr_b16 v[158:159], v233 offset:62464
    s_waitcnt lgkmcnt(12)
    v_mfma_f32_32x32x16_bf16 v[160:175], a[100:103], v[132:135], v[160:175]
    ds_read_b64_tr_b16 v[128:129], v234 offset:0
    ds_read_b64_tr_b16 v[130:131], v234 offset:1024
    s_waitcnt lgkmcnt(12)
    v_mfma_f32_32x32x16_bf16 v[160:175], a[104:107], v[136:139], v[160:175]
    buffer_load_dwordx4 v[32:35], v240, s[28:31], s34 offen offset:0 sc1
    ds_read_b64_tr_b16 v[132:133], v234 offset:4096
    ds_read_b64_tr_b16 v[134:135], v234 offset:5120
    s_waitcnt lgkmcnt(12)
    v_mfma_f32_32x32x16_bf16 v[160:175], a[108:111], v[140:143], v[160:175]
    ds_read_b64_tr_b16 v[136:137], v234 offset:8192
    ds_read_b64_tr_b16 v[138:139], v234 offset:9216
    s_waitcnt lgkmcnt(12)
    v_mfma_f32_32x32x16_bf16 v[160:175], a[112:115], v[144:147], v[160:175]
    ds_read_b64_tr_b16 v[140:141], v234 offset:12288
    ds_read_b64_tr_b16 v[142:143], v234 offset:13312
    s_waitcnt lgkmcnt(12)
    v_mfma_f32_32x32x16_bf16 v[160:175], a[116:119], v[148:151], v[160:175]
    buffer_load_dwordx4 v[36:39], v240, s[28:31], s34 offen offset:1024 sc1
    ds_read_b64_tr_b16 v[144:145], v234 offset:16384
    ds_read_b64_tr_b16 v[146:147], v234 offset:17408
    s_waitcnt lgkmcnt(12)
    v_mfma_f32_32x32x16_bf16 v[160:175], a[120:123], v[152:155], v[160:175]
    ds_read_b64_tr_b16 v[148:149], v234 offset:20480
    ds_read_b64_tr_b16 v[150:151], v234 offset:21504
    s_waitcnt lgkmcnt(12)
    v_mfma_f32_32x32x16_bf16 v[160:175], a[124:127], v[156:159], v[160:175]
    ds_read_b64_tr_b16 v[152:153], v234 offset:24576
    ds_read_b64_tr_b16 v[154:155], v234 offset:25600
    s_waitcnt lgkmcnt(12)
    v_mfma_f32_32x32x16_bf16 v[176:191], a[0:3], v[128:131], 0
    buffer_load_dwordx4 v[40:43], v240, s[28:31], s34 offen offset:2048 sc1
    ds_read_b64_tr_b16 v[156:157], v234 offset:28672
    ds_read_b64_tr_b16 v[158:159], v234 offset:29696
    s_waitcnt lgkmcnt(12)
    v_mfma_f32_32x32x16_bf16 v[176:191], a[4:7], v[132:135], v[176:191]
    s_waitcnt vmcnt(8)
    s_lshl_b32 s58, s26, 2
    s_add_u32 s58, s58, s23
    v_mov_b32 v248, s58
    s_mov_b64 exec, 1
    global_store_dword v246, v248, s[42:43] sc1
    s_mov_b64 exec, -1
    ds_read_b64_tr_b16 v[128:129], v234 offset:32768
    ds_read_b64_tr_b16 v[130:131], v234 offset:33792
    s_waitcnt lgkmcnt(12)
    v_mfma_f32_32x32x16_bf16 v[176:191], a[8:11], v[136:139], v[176:191]
    ds_read_b64_tr_b16 v[132:133], v234 offset:36864
    ds_read_b64_tr_b16 v[134:135], v234 offset:37888
    s_waitcnt lgkmcnt(12)
    v_mfma_f32_32x32x16_bf16 v[176:191], a[12:15], v[140:143], v[176:191]
    buffer_load_dwordx4 v[44:47], v240, s[28:31], s34 offen offset:3072 sc1
    v_cvt_pk_bf16_f32 v192, v160, v161
    v_cvt_pk_bf16_f32 v193, v162, v163
    ds_read_b64_tr_b16 v[136:137], v234 offset:40960
    ds_read_b64_tr_b16 v[138:139], v234 offset:41984
    s_waitcnt lgkmcnt(12)
    v_mfma_f32_32x32x16_bf16 v[176:191], a[16:19], v[144:147], v[176:191]
    v_cvt_pk_bf16_f32 v194, v164, v165
    v_cvt_pk_bf16_f32 v195, v166, v167
    ds_read_b64_tr_b16 v[140:141], v234 offset:45056
    ds_read_b64_tr_b16 v[142:143], v234 offset:46080
    s_waitcnt lgkmcnt(12)
    v_mfma_f32_32x32x16_bf16 v[176:191], a[20:23], v[148:151], v[176:191]
    v_cvt_pk_bf16_f32 v196, v168, v169
    v_cvt_pk_bf16_f32 v197, v170, v171
    ds_read_b64_tr_b16 v[144:145], v234 offset:49152
    ds_read_b64_tr_b16 v[146:147], v234 offset:50176
    s_waitcnt lgkmcnt(12)
    v_mfma_f32_32x32x16_bf16 v[176:191], a[24:27], v[152:155], v[176:191]
    buffer_load_dwordx4 v[48:51], v240, s[28:31], s35 offen offset:0 sc1
    v_cvt_pk_bf16_f32 v198, v172, v173
    v_cvt_pk_bf16_f32 v199, v174, v175
    buffer_store_dwordx4 v[192:195], v243, s[52:55], s32 offen offset:0 sc1
    ds_read_b64_tr_b16 v[148:149], v234 offset:53248
    ds_read_b64_tr_b16 v[150:151], v234 offset:54272
    s_waitcnt lgkmcnt(12)
    v_mfma_f32_32x32x16_bf16 v[176:191], a[28:31], v[156:159], v[176:191]
    ds_read_b64_tr_b16 v[152:153], v234 offset:57344
    ds_read_b64_tr_b16 v[154:155], v234 offset:58368
    s_waitcnt lgkmcnt(12)
    v_mfma_f32_32x32x16_bf16 v[176:191], a[32:35], v[128:131], v[176:191]
    ds_read_b64_tr_b16 v[156:157], v234 offset:61440
    ds_read_b64_tr_b16 v[158:159], v234 offset:62464
    s_waitcnt lgkmcnt(12)
    v_mfma_f32_32x32x16_bf16 v[176:191], a[36:39], v[132:135], v[176:191]
    buffer_load_dwordx4 v[52:55], v240, s[28:31], s35 offen offset:1024 sc1
    buffer_store_dwordx4 v[196:199], v243, s[52:55], s32 offen offset:512 sc1
    ds_read_b64_tr_b16 v[128:129], v235 offset:0
    ds_read_b64_tr_b16 v[130:131], v235 offset:1024
    s_waitcnt lgkmcnt(12)
    v_mfma_f32_32x32x16_bf16 v[176:191], a[40:43], v[136:139], v[176:191]
    ds_read_b64_tr_b16 v[132:133], v235 offset:4096
    ds_read_b64_tr_b16 v[134:135], v235 offset:5120
    s_waitcnt lgkmcnt(12)
    v_mfma_f32_32x32x16_bf16 v[176:191], a[44:47], v[140:143], v[176:191]
    ds_read_b64_tr_b16 v[136:137], v235 offset:8192
    ds_read_b64_tr_b16 v[138:139], v235 offset:9216
    s_waitcnt lgkmcnt(12)
    v_mfma_f32_32x32x16_bf16 v[176:191], a[48:51], v[144:147], v[176:191]
    buffer_load_dwordx4 v[56:59], v240, s[28:31], s35 offen offset:2048 sc1
    ds_read_b64_tr_b16 v[140:141], v235 offset:12288
    ds_read_b64_tr_b16 v[142:143], v235 offset:13312
    s_waitcnt lgkmcnt(12)
    v_mfma_f32_32x32x16_bf16 v[176:191], a[52:55], v[148:151], v[176:191]
    ds_read_b64_tr_b16 v[144:145], v235 offset:16384
    ds_read_b64_tr_b16 v[146:147], v235 offset:17408
    s_waitcnt lgkmcnt(12)
    v_mfma_f32_32x32x16_bf16 v[176:191], a[56:59], v[152:155], v[176:191]
    ds_read_b64_tr_b16 v[148:149], v235 offset:20480
    ds_read_b64_tr_b16 v[150:151], v235 offset:21504
    s_waitcnt lgkmcnt(12)
    v_mfma_f32_32x32x16_bf16 v[176:191], a[60:63], v[156:159], v[176:191]
    buffer_load_dwordx4 v[60:63], v240, s[28:31], s35 offen offset:3072 sc1
    ds_read_b64_tr_b16 v[152:153], v235 offset:24576
    ds_read_b64_tr_b16 v[154:155], v235 offset:25600
    s_waitcnt lgkmcnt(12)
    v_mfma_f32_32x32x16_bf16 v[176:191], a[64:67], v[128:131], v[176:191]
    ds_read_b64_tr_b16 v[156:157], v235 offset:28672
    ds_read_b64_tr_b16 v[158:159], v235 offset:29696
    s_waitcnt lgkmcnt(12)
    v_mfma_f32_32x32x16_bf16 v[176:191], a[68:71], v[132:135], v[176:191]
    ds_read_b64_tr_b16 v[128:129], v235 offset:32768
    ds_read_b64_tr_b16 v[130:131], v235 offset:33792
    s_waitcnt lgkmcnt(12)
    v_mfma_f32_32x32x16_bf16 v[176:191], a[72:75], v[136:139], v[176:191]
    buffer_load_dwordx4 v[64:67], v240, s[28:31], s36 offen offset:0 sc1
    ds_read_b64_tr_b16 v[132:133], v235 offset:36864
    ds_read_b64_tr_b16 v[134:135], v235 offset:37888
    s_waitcnt lgkmcnt(12)
    v_mfma_f32_32x32x16_bf16 v[176:191], a[76:79], v[140:143], v[176:191]
    ds_read_b64_tr_b16 v[136:137], v235 offset:40960
    ds_read_b64_tr_b16 v[138:139], v235 offset:41984
    s_waitcnt lgkmcnt(12)
    v_mfma_f32_32x32x16_bf16 v[176:191], a[80:83], v[144:147], v[176:191]
    ds_read_b64_tr_b16 v[140:141], v235 offset:45056
    ds_read_b64_tr_b16 v[142:143], v235 offset:46080
    s_waitcnt lgkmcnt(12)
    v_mfma_f32_32x32x16_bf16 v[176:191], a[84:87], v[148:151], v[176:191]
    buffer_load_dwordx4 v[68:71], v240, s[28:31], s36 offen offset:1024 sc1
    ds_read_b64_tr_b16 v[144:145], v235 offset:49152
    ds_read_b64_tr_b16 v[146:147], v235 offset:50176
    s_waitcnt lgkmcnt(12)
    v_mfma_f32_32x32x16_bf16 v[176:191], a[88:91], v[152:155], v[176:191]
    ds_read_b64_tr_b16 v[148:149], v235 offset:53248
    ds_read_b64_tr_b16 v[150:151], v235 offset:54272
    s_waitcnt lgkmcnt(12)
    v_mfma_f32_32x32x16_bf16 v[176:191], a[92:95], v[156:159], v[176:191]
    ds_read_b64_tr_b16 v[152:153], v235 offset:57344
    ds_read_b64_tr_b16 v[154:155], v235 offset:58368
    s_waitcnt lgkmcnt(12)
    v_mfma_f32_32x32x16_bf16 v[176:191], a[96:99], v[128:131], v[176:191]
    buffer_load_dwordx4 v[72:75], v240, s[28:31], s36 offen offset:2048 sc1
    ds_read_b64_tr_b16 v[156:157], v235 offset:61440
    ds_read_b64_tr_b16 v[158:159], v235 offset:62464
    s_waitcnt lgkmcnt(12)
    v_mfma_f32_32x32x16_bf16 v[176:191], a[100:103], v[132:135], v[176:191]
    ds_read_b64_tr_b16 v[128:129], v236 offset:0
    ds_read_b64_tr_b16 v[130:131], v236 offset:1024
    s_waitcnt lgkmcnt(12)
    v_mfma_f32_32x32x16_bf16 v[176:191], a[104:107], v[136:139], v[176:191]
    ds_read_b64_tr_b16 v[132:133], v236 offset:4096
    ds_read_b64_tr_b16 v[134:135], v236 offset:5120
    s_waitcnt lgkmcnt(12)
    v_mfma_f32_32x32x16_bf16 v[176:191], a[108:111], v[140:143], v[176:191]
    buffer_load_dwordx4 v[76:79], v240, s[28:31], s36 offen offset:3072 sc1
    ds_read_b64_tr_b16 v[136:137], v236 offset:8192
    ds_read_b64_tr_b16 v[138:139], v236 offset:9216
    s_waitcnt lgkmcnt(12)
    v_mfma_f32_32x32x16_bf16 v[176:191], a[112:115], v[144:147], v[176:191]
    ds_read_b64_tr_b16 v[140:141], v236 offset:12288
    ds_read_b64_tr_b16 v[142:143], v236 offset:13312
    s_waitcnt lgkmcnt(12)
    v_mfma_f32_32x32x16_bf16 v[176:191], a[116:119], v[148:151], v[176:191]
    ds_read_b64_tr_b16 v[144:145], v236 offset:16384
    ds_read_b64_tr_b16 v[146:147], v236 offset:17408
    s_waitcnt lgkmcnt(12)
    v_mfma_f32_32x32x16_bf16 v[176:191], a[120:123], v[152:155], v[176:191]
    buffer_load_dwordx4 v[80:83], v240, s[28:31], s37 offen offset:0 sc1
    ds_read_b64_tr_b16 v[148:149], v236 offset:20480
    ds_read_b64_tr_b16 v[150:151], v236 offset:21504
    s_waitcnt lgkmcnt(12)
    v_mfma_f32_32x32x16_bf16 v[176:191], a[124:127], v[156:159], v[176:191]
    ds_read_b64_tr_b16 v[152:153], v236 offset:24576
    ds_read_b64_tr_b16 v[154:155], v236 offset:25600
    s_waitcnt lgkmcnt(12)
    v_mfma_f32_32x32x16_bf16 v[160:175], a[0:3], v[128:131], 0
    ds_read_b64_tr_b16 v[156:157], v236 offset:28672
    ds_read_b64_tr_b16 v[158:159], v236 offset:29696
    s_waitcnt lgkmcnt(12)
    v_mfma_f32_32x32x16_bf16 v[160:175], a[4:7], v[132:135], v[160:175]
    buffer_load_dwordx4 v[84:87], v240, s[28:31], s37 offen offset:1024 sc1
    ds_read_b64_tr_b16 v[128:129], v236 offset:32768
    ds_read_b64_tr_b16 v[130:131], v236 offset:33792
    s_waitcnt lgkmcnt(12)
    v_mfma_f32_32x32x16_bf16 v[160:175], a[8:11], v[136:139], v[160:175]
    ds_read_b64_tr_b16 v[132:133], v236 offset:36864
    ds_read_b64_tr_b16 v[134:135], v236 offset:37888
    s_waitcnt lgkmcnt(12)
    v_mfma_f32_32x32x16_bf16 v[160:175], a[12:15], v[140:143], v[160:175]
    v_cvt_pk_bf16_f32 v200, v176, v177
    v_cvt_pk_bf16_f32 v201, v178, v179
    ds_read_b64_tr_b16 v[136:137], v236 offset:40960
    ds_read_b64_tr_b16 v[138:139], v236 offset:41984
    s_waitcnt lgkmcnt(12)
    v_mfma_f32_32x32x16_bf16 v[160:175], a[16:19], v[144:147], v[160:175]
    buffer_load_dwordx4 v[88:91], v240, s[28:31], s37 offen offset:2048 sc1
    v_cvt_pk_bf16_f32 v202, v180, v181
    v_cvt_pk_bf16_f32 v203, v182, v183
    ds_read_b64_tr_b16 v[140:141], v236 offset:45056
    ds_read_b64_tr_b16 v[142:143], v236 offset:46080
    s_waitcnt lgkmcnt(12)
    v_mfma_f32_32x32x16_bf16 v[160:175], a[20:23], v[148:151], v[160:175]
    v_cvt_pk_bf16_f32 v204, v184, v185
    v_cvt_pk_bf16_f32 v205, v186, v187
    ds_read_b64_tr_b16 v[144:145], v236 offset:49152
    ds_read_b64_tr_b16 v[146:147], v236 offset:50176
    s_waitcnt lgkmcnt(12)
    v_mfma_f32_32x32x16_bf16 v[160:175], a[24:27], v[152:155], v[160:175]
    v_cvt_pk_bf16_f32 v206, v188, v189
    v_cvt_pk_bf16_f32 v207, v190, v191
    buffer_store_dwordx4 v[200:203], v243, s[52:55], s33 offen offset:0 sc1
    ds_read_b64_tr_b16 v[148:149], v236 offset:53248
    ds_read_b64_tr_b16 v[150:151], v236 offset:54272
    s_waitcnt lgkmcnt(12)
    v_mfma_f32_32x32x16_bf16 v[160:175], a[28:31], v[156:159], v[160:175]
    buffer_load_dwordx4 v[92:95], v240, s[28:31], s37 offen offset:3072 sc1
    ds_read_b64_tr_b16 v[152:153], v236 offset:57344
    ds_read_b64_tr_b16 v[154:155], v236 offset:58368
    s_waitcnt lgkmcnt(12)
    v_mfma_f32_32x32x16_bf16 v[160:175], a[32:35], v[128:131], v[160:175]
    ds_read_b64_tr_b16 v[156:157], v236 offset:61440
    ds_read_b64_tr_b16 v[158:159], v236 offset:62464
    s_waitcnt lgkmcnt(12)
    v_mfma_f32_32x32x16_bf16 v[160:175], a[36:39], v[132:135], v[160:175]
    buffer_store_dwordx4 v[204:207], v243, s[52:55], s33 offen offset:512 sc1
    ds_read_b64_tr_b16 v[128:129], v237 offset:0
    ds_read_b64_tr_b16 v[130:131], v237 offset:1024
    s_waitcnt lgkmcnt(12)
    v_mfma_f32_32x32x16_bf16 v[160:175], a[40:43], v[136:139], v[160:175]
    buffer_load_dwordx4 v[96:99], v240, s[28:31], s38 offen offset:0 sc1
    ds_read_b64_tr_b16 v[132:133], v237 offset:4096
    ds_read_b64_tr_b16 v[134:135], v237 offset:5120
    s_waitcnt lgkmcnt(12)
    v_mfma_f32_32x32x16_bf16 v[160:175], a[44:47], v[140:143], v[160:175]
    ds_read_b64_tr_b16 v[136:137], v237 offset:8192
    ds_read_b64_tr_b16 v[138:139], v237 offset:9216
    s_waitcnt lgkmcnt(12)
    v_mfma_f32_32x32x16_bf16 v[160:175], a[48:51], v[144:147], v[160:175]
    ds_read_b64_tr_b16 v[140:141], v237 offset:12288
    ds_read_b64_tr_b16 v[142:143], v237 offset:13312
    s_waitcnt lgkmcnt(12)
    v_mfma_f32_32x32x16_bf16 v[160:175], a[52:55], v[148:151], v[160:175]
    buffer_load_dwordx4 v[100:103], v240, s[28:31], s38 offen offset:1024 sc1
    ds_read_b64_tr_b16 v[144:145], v237 offset:16384
    ds_read_b64_tr_b16 v[146:147], v237 offset:17408
    s_waitcnt lgkmcnt(12)
    v_mfma_f32_32x32x16_bf16 v[160:175], a[56:59], v[152:155], v[160:175]
    ds_read_b64_tr_b16 v[148:149], v237 offset:20480
    ds_read_b64_tr_b16 v[150:151], v237 offset:21504
    s_waitcnt lgkmcnt(12)
    v_mfma_f32_32x32x16_bf16 v[160:175], a[60:63], v[156:159], v[160:175]
    ds_read_b64_tr_b16 v[152:153], v237 offset:24576
    ds_read_b64_tr_b16 v[154:155], v237 offset:25600
    s_waitcnt lgkmcnt(12)
    v_mfma_f32_32x32x16_bf16 v[160:175], a[64:67], v[128:131], v[160:175]
    buffer_load_dwordx4 v[104:107], v240, s[28:31], s38 offen offset:2048 sc1
    ds_read_b64_tr_b16 v[156:157], v237 offset:28672
    ds_read_b64_tr_b16 v[158:159], v237 offset:29696
    s_waitcnt lgkmcnt(12)
    v_mfma_f32_32x32x16_bf16 v[160:175], a[68:71], v[132:135], v[160:175]
    ds_read_b64_tr_b16 v[128:129], v237 offset:32768
    ds_read_b64_tr_b16 v[130:131], v237 offset:33792
    s_waitcnt lgkmcnt(12)
    v_mfma_f32_32x32x16_bf16 v[160:175], a[72:75], v[136:139], v[160:175]
    ds_read_b64_tr_b16 v[132:133], v237 offset:36864
    ds_read_b64_tr_b16 v[134:135], v237 offset:37888
    s_waitcnt lgkmcnt(12)
    v_mfma_f32_32x32x16_bf16 v[160:175], a[76:79], v[140:143], v[160:175]
    buffer_load_dwordx4 v[108:111], v240, s[28:31], s38 offen offset:3072 sc1
    ds_read_b64_tr_b16 v[136:137], v237 offset:40960
    ds_read_b64_tr_b16 v[138:139], v237 offset:41984
    s_waitcnt lgkmcnt(12)
    v_mfma_f32_32x32x16_bf16 v[160:175], a[80:83], v[144:147], v[160:175]
    ds_read_b64_tr_b16 v[140:141], v237 offset:45056
    ds_read_b64_tr_b16 v[142:143], v237 offset:46080
    s_waitcnt lgkmcnt(12)
    v_mfma_f32_32x32x16_bf16 v[160:175], a[84:87], v[148:151], v[160:175]
    ds_read_b64_tr_b16 v[144:145], v237 offset:49152
    ds_read_b64_tr_b16 v[146:147], v237 offset:50176
    s_waitcnt lgkmcnt(12)
    v_mfma_f32_32x32x16_bf16 v[160:175], a[88:91], v[152:155], v[160:175]
    buffer_load_dwordx4 v[112:115], v240, s[28:31], s39 offen offset:0 sc1
    ds_read_b64_tr_b16 v[148:149], v237 offset:53248
    ds_read_b64_tr_b16 v[150:151], v237 offset:54272
    s_waitcnt lgkmcnt(12)
    v_mfma_f32_32x32x16_bf16 v[160:175], a[92:95], v[156:159], v[160:175]
    ds_read_b64_tr_b16 v[152:153], v237 offset:57344
    ds_read_b64_tr_b16 v[154:155], v237 offset:58368
    s_waitcnt lgkmcnt(12)
    v_mfma_f32_32x32x16_bf16 v[160:175], a[96:99], v[128:131], v[160:175]
    ds_read_b64_tr_b16 v[156:157], v237 offset:61440
    ds_read_b64_tr_b16 v[158:159], v237 offset:62464
    s_waitcnt lgkmcnt(12)
    v_mfma_f32_32x32x16_bf16 v[160:175], a[100:103], v[132:135], v[160:175]
    buffer_load_dwordx4 v[116:119], v240, s[28:31], s39 offen offset:1024 sc1
    ds_read_b64_tr_b16 v[128:129], v238 offset:0
    ds_read_b64_tr_b16 v[130:131], v238 offset:1024
    s_waitcnt lgkmcnt(12)
    v_mfma_f32_32x32x16_bf16 v[160:175], a[104:107], v[136:139], v[160:175]
    ds_read_b64_tr_b16 v[132:133], v238 offset:4096
    ds_read_b64_tr_b16 v[134:135], v238 offset:5120
    s_waitcnt lgkmcnt(12)
    v_mfma_f32_32x32x16_bf16 v[160:175], a[108:111], v[140:143], v[160:175]
    ds_read_b64_tr_b16 v[136:137], v238 offset:8192
    ds_read_b64_tr_b16 v[138:139], v238 offset:9216
    s_waitcnt lgkmcnt(12)
    v_mfma_f32_32x32x16_bf16 v[160:175], a[112:115], v[144:147], v[160:175]
    buffer_load_dwordx4 v[120:123], v240, s[28:31], s39 offen offset:2048 sc1
    ds_read_b64_tr_b16 v[140:141], v238 offset:12288
    ds_read_b64_tr_b16 v[142:143], v238 offset:13312
    s_waitcnt lgkmcnt(12)
    v_mfma_f32_32x32x16_bf16 v[160:175], a[116:119], v[148:151], v[160:175]
    ds_read_b64_tr_b16 v[144:145], v238 offset:16384
    ds_read_b64_tr_b16 v[146:147], v238 offset:17408
    s_waitcnt lgkmcnt(12)
    v_mfma_f32_32x32x16_bf16 v[160:175], a[120:123], v[152:155], v[160:175]
    ds_read_b64_tr_b16 v[148:149], v238 offset:20480
    ds_read_b64_tr_b16 v[150:151], v238 offset:21504
    s_waitcnt lgkmcnt(12)
    v_mfma_f32_32x32x16_bf16 v[160:175], a[124:127], v[156:159], v[160:175]
    buffer_load_dwordx4 v[124:127], v240, s[28:31], s39 offen offset:3072 sc1
    ds_read_b64_tr_b16 v[152:153], v238 offset:24576
    ds_read_b64_tr_b16 v[154:155], v238 offset:25600
    s_waitcnt lgkmcnt(12)
    v_mfma_f32_32x32x16_bf16 v[176:191], a[0:3], v[128:131], 0
    ds_read_b64_tr_b16 v[156:157], v238 offset:28672
    ds_read_b64_tr_b16 v[158:159], v238 offset:29696
    s_waitcnt lgkmcnt(12)
    v_mfma_f32_32x32x16_bf16 v[176:191], a[4:7], v[132:135], v[176:191]
    ds_read_b64_tr_b16 v[128:129], v238 offset:32768
    ds_read_b64_tr_b16 v[130:131], v238 offset:33792
    s_waitcnt lgkmcnt(12)
    v_mfma_f32_32x32x16_bf16 v[176:191], a[8:11], v[136:139], v[176:191]
    ds_read_b64_tr_b16 v[132:133], v238 offset:36864
    ds_read_b64_tr_b16 v[134:135], v238 offset:37888
    s_waitcnt lgkmcnt(12)
    v_mfma_f32_32x32x16_bf16 v[176:191], a[12:15], v[140:143], v[176:191]
    v_cvt_pk_bf16_f32 v192, v160, v161
    v_cvt_pk_bf16_f32 v193, v162, v163
    ds_read_b64_tr_b16 v[136:137], v238 offset:40960
    ds_read_b64_tr_b16 v[138:139], v238 offset:41984
    s_waitcnt lgkmcnt(12)
    v_mfma_f32_32x32x16_bf16 v[176:191], a[16:19], v[144:147], v[176:191]
    v_cvt_pk_bf16_f32 v194, v164, v165
    v_cvt_pk_bf16_f32 v195, v166, v167
    ds_read_b64_tr_b16 v[140:141], v238 offset:45056
    ds_read_b64_tr_b16 v[142:143], v238 offset:46080
    s_waitcnt lgkmcnt(12)
    v_mfma_f32_32x32x16_bf16 v[176:191], a[20:23], v[148:151], v[176:191]
    v_cvt_pk_bf16_f32 v196, v168, v169
    v_cvt_pk_bf16_f32 v197, v170, v171
    ds_read_b64_tr_b16 v[144:145], v238 offset:49152
    ds_read_b64_tr_b16 v[146:147], v238 offset:50176
    s_waitcnt lgkmcnt(12)
    v_mfma_f32_32x32x16_bf16 v[176:191], a[24:27], v[152:155], v[176:191]
    v_cvt_pk_bf16_f32 v198, v172, v173
    v_cvt_pk_bf16_f32 v199, v174, v175
    buffer_store_dwordx4 v[192:195], v243, s[52:55], s34 offen offset:0 sc1
    ds_read_b64_tr_b16 v[148:149], v238 offset:53248
    ds_read_b64_tr_b16 v[150:151], v238 offset:54272
    s_waitcnt lgkmcnt(12)
    v_mfma_f32_32x32x16_bf16 v[176:191], a[28:31], v[156:159], v[176:191]
    ds_read_b64_tr_b16 v[152:153], v238 offset:57344
    ds_read_b64_tr_b16 v[154:155], v238 offset:58368
    s_waitcnt lgkmcnt(12)
    v_mfma_f32_32x32x16_bf16 v[176:191], a[32:35], v[128:131], v[176:191]
    ds_read_b64_tr_b16 v[156:157], v238 offset:61440
    ds_read_b64_tr_b16 v[158:159], v238 offset:62464
    s_waitcnt lgkmcnt(12)
    v_mfma_f32_32x32x16_bf16 v[176:191], a[36:39], v[132:135], v[176:191]
    buffer_store_dwordx4 v[196:199], v243, s[52:55], s34 offen offset:512 sc1
    ds_read_b64_tr_b16 v[128:129], v239 offset:0
    ds_read_b64_tr_b16 v[130:131], v239 offset:1024
    s_waitcnt lgkmcnt(12)
    v_mfma_f32_32x32x16_bf16 v[176:191], a[40:43], v[136:139], v[176:191]
    ds_read_b64_tr_b16 v[132:133], v239 offset:4096
    ds_read_b64_tr_b16 v[134:135], v239 offset:5120
    s_waitcnt lgkmcnt(12)
    v_mfma_f32_32x32x16_bf16 v[176:191], a[44:47], v[140:143], v[176:191]
    ds_read_b64_tr_b16 v[136:137], v239 offset:8192
    ds_read_b64_tr_b16 v[138:139], v239 offset:9216
    s_waitcnt lgkmcnt(12)
    v_mfma_f32_32x32x16_bf16 v[176:191], a[48:51], v[144:147], v[176:191]
    ds_read_b64_tr_b16 v[140:141], v239 offset:12288
    ds_read_b64_tr_b16 v[142:143], v239 offset:13312
    s_waitcnt lgkmcnt(12)
    v_mfma_f32_32x32x16_bf16 v[176:191], a[52:55], v[148:151], v[176:191]
    ds_read_b64_tr_b16 v[144:145], v239 offset:16384
    ds_read_b64_tr_b16 v[146:147], v239 offset:17408
    s_waitcnt lgkmcnt(12)
    v_mfma_f32_32x32x16_bf16 v[176:191], a[56:59], v[152:155], v[176:191]
    ds_read_b64_tr_b16 v[148:149], v239 offset:20480
    ds_read_b64_tr_b16 v[150:151], v239 offset:21504
    s_waitcnt lgkmcnt(12)
    v_mfma_f32_32x32x16_bf16 v[176:191], a[60:63], v[156:159], v[176:191]
    ds_read_b64_tr_b16 v[152:153], v239 offset:24576
    ds_read_b64_tr_b16 v[154:155], v239 offset:25600
    s_waitcnt lgkmcnt(12)
    v_mfma_f32_32x32x16_bf16 v[176:191], a[64:67], v[128:131], v[176:191]
    ds_read_b64_tr_b16 v[156:157], v239 offset:28672
    ds_read_b64_tr_b16 v[158:159], v239 offset:29696
    s_waitcnt lgkmcnt(12)
    v_mfma_f32_32x32x16_bf16 v[176:191], a[68:71], v[132:135], v[176:191]
    ds_read_b64_tr_b16 v[128:129], v239 offset:32768
    ds_read_b64_tr_b16 v[130:131], v239 offset:33792
    s_waitcnt lgkmcnt(12)
    v_mfma_f32_32x32x16_bf16 v[176:191], a[72:75], v[136:139], v[176:191]
    ds_read_b64_tr_b16 v[132:133], v239 offset:36864
    ds_read_b64_tr_b16 v[134:135], v239 offset:37888
    s_waitcnt lgkmcnt(12)
    v_mfma_f32_32x32x16_bf16 v[176:191], a[76:79], v[140:143], v[176:191]
    ds_read_b64_tr_b16 v[136:137], v239 offset:40960
    ds_read_b64_tr_b16 v[138:139], v239 offset:41984
    s_waitcnt lgkmcnt(12)
    v_mfma_f32_32x32x16_bf16 v[176:191], a[80:83], v[144:147], v[176:191]
    ds_read_b64_tr_b16 v[140:141], v239 offset:45056
    ds_read_b64_tr_b16 v[142:143], v239 offset:46080
    s_waitcnt lgkmcnt(12)
    v_mfma_f32_32x32x16_bf16 v[176:191], a[84:87], v[148:151], v[176:191]
    ds_read_b64_tr_b16 v[144:145], v239 offset:49152
    ds_read_b64_tr_b16 v[146:147], v239 offset:50176
    s_waitcnt lgkmcnt(12)
    v_mfma_f32_32x32x16_bf16 v[176:191], a[88:91], v[152:155], v[176:191]
    ds_read_b64_tr_b16 v[148:149], v239 offset:53248
    ds_read_b64_tr_b16 v[150:151], v239 offset:54272
    s_waitcnt lgkmcnt(12)
    v_mfma_f32_32x32x16_bf16 v[176:191], a[92:95], v[156:159], v[176:191]
    ds_read_b64_tr_b16 v[152:153], v239 offset:57344
    ds_read_b64_tr_b16 v[154:155], v239 offset:58368
    s_waitcnt lgkmcnt(12)
    v_mfma_f32_32x32x16_bf16 v[176:191], a[96:99], v[128:131], v[176:191]
    ds_read_b64_tr_b16 v[156:157], v239 offset:61440
    ds_read_b64_tr_b16 v[158:159], v239 offset:62464
    s_waitcnt lgkmcnt(12)
    v_mfma_f32_32x32x16_bf16 v[176:191], a[100:103], v[132:135], v[176:191]
    ds_read_b64_tr_b16 v[128:129], v232 offset:0
    ds_read_b64_tr_b16 v[130:131], v232 offset:1024
    s_waitcnt lgkmcnt(12)
    v_mfma_f32_32x32x16_bf16 v[176:191], a[104:107], v[136:139], v[176:191]
    ds_read_b64_tr_b16 v[132:133], v232 offset:4096
    ds_read_b64_tr_b16 v[134:135], v232 offset:5120
    s_waitcnt lgkmcnt(12)
    v_mfma_f32_32x32x16_bf16 v[176:191], a[108:111], v[140:143], v[176:191]
    ds_read_b64_tr_b16 v[136:137], v232 offset:8192
    ds_read_b64_tr_b16 v[138:139], v232 offset:9216
    s_waitcnt lgkmcnt(12)
    v_mfma_f32_32x32x16_bf16 v[176:191], a[112:115], v[144:147], v[176:191]
    ds_read_b64_tr_b16 v[140:141], v232 offset:12288
    ds_read_b64_tr_b16 v[142:143], v232 offset:13312
    s_waitcnt lgkmcnt(12)
    v_mfma_f32_32x32x16_bf16 v[176:191], a[116:119], v[148:151], v[176:191]
    ds_read_b64_tr_b16 v[144:145], v232 offset:16384
    ds_read_b64_tr_b16 v[146:147], v232 offset:17408
    s_waitcnt lgkmcnt(12)
    v_mfma_f32_32x32x16_bf16 v[176:191], a[120:123], v[152:155], v[176:191]
    ds_read_b64_tr_b16 v[148:149], v232 offset:20480
    ds_read_b64_tr_b16 v[150:151], v232 offset:21504
    s_waitcnt lgkmcnt(12)
    v_mfma_f32_32x32x16_bf16 v[176:191], a[124:127], v[156:159], v[176:191]
    s_add_u32 s28, s28, 131072
    s_addc_u32 s29, s29, 0
    s_add_u32 s26, s26, 1
    s_cmp_ge_u32 s26, 14
    s_cbranch_scc1 L_v_fin
    s_waitcnt vmcnt(2)
    ds_read_b64_tr_b16 v[152:153], v232 offset:24576
    ds_read_b64_tr_b16 v[154:155], v232 offset:25600
    s_waitcnt lgkmcnt(12)
    v_mfma_f32_32x32x16_bf16 v[160:175], v[0:3], v[128:131], 0
    ds_read_b64_tr_b16 v[156:157], v232 offset:28672
    ds_read_b64_tr_b16 v[158:159], v232 offset:29696
    s_waitcnt lgkmcnt(12)
    v_mfma_f32_32x32x16_bf16 v[160:175], v[4:7], v[132:135], v[160:175]
    ds_read_b64_tr_b16 v[128:129], v232 offset:32768
    ds_read_b64_tr_b16 v[130:131], v232 offset:33792
    s_waitcnt lgkmcnt(12)
    v_mfma_f32_32x32x16_bf16 v[160:175], v[8:11], v[136:139], v[160:175]
    buffer_load_dwordx4 a[0:3], v240, s[28:31], s32 offen offset:0 sc1
    ds_read_b64_tr_b16 v[132:133], v232 offset:36864
    ds_read_b64_tr_b16 v[134:135], v232 offset:37888
    s_waitcnt lgkmcnt(12)
    v_mfma_f32_32x32x16_bf16 v[160:175], v[12:15], v[140:143], v[160:175]
    v_cvt_pk_bf16_f32 v200, v176, v177
    v_cvt_pk_bf16_f32 v201, v178, v179
    ds_read_b64_tr_b16 v[136:137], v232 offset:40960
    ds_read_b64_tr_b16 v[138:139], v232 offset:41984
    s_waitcnt lgkmcnt(12)
    v_mfma_f32_32x32x16_bf16 v[160:175], v[16:19], v[144:147], v[160:175]
    v_cvt_pk_bf16_f32 v202, v180, v181
    v_cvt_pk_bf16_f32 v203, v182, v183
    ds_read_b64_tr_b16 v[140:141], v232 offset:45056
    ds_read_b64_tr_b16 v[142:143], v232 offset:46080
    s_waitcnt lgkmcnt(12)
    v_mfma_f32_32x32x16_bf16 v[160:175], v[20:23], v[148:151], v[160:175]
    buffer_load_dwordx4 a[4:7], v240, s[28:31], s32 offen offset:1024 sc1
    v_cvt_pk_bf16_f32 v204, v184, v185
    v_cvt_pk_bf16_f32 v205, v186, v187
    ds_read_b64_tr_b16 v[144:145], v232 offset:49152
    ds_read_b64_tr_b16 v[146:147], v232 offset:50176
    s_waitcnt lgkmcnt(12)
    v_mfma_f32_32x32x16_bf16 v[160:175], v[24:27], v[152:155], v[160:175]
    v_cvt_pk_bf16_f32 v206, v188, v189
    v_cvt_pk_bf16_f32 v207, v190, v191
    buffer_store_dwordx4 v[200:203], v243, s[52:55], s35 offen offset:0 sc1
    ds_read_b64_tr_b16 v[148:149], v232 offset:53248
    ds_read_b64_tr_b16 v[150:151], v232 offset:54272
    s_waitcnt lgkmcnt(12)
    v_mfma_f32_32x32x16_bf16 v[160:175], v[28:31], v[156:159], v[160:175]
    ds_read_b64_tr_b16 v[152:153], v232 offset:57344
    ds_read_b64_tr_b16 v[154:155], v232 offset:58368
    s_waitcnt lgkmcnt(12)
    v_mfma_f32_32x32x16_bf16 v[160:175], v[32:35], v[128:131], v[160:175]
    buffer_load_dwordx4 a[8:11], v240, s[28:31], s32 offen offset:2048 sc1
    ds_read_b64_tr_b16 v[156:157], v232 offset:61440
    ds_read_b64_tr_b16 v[158:159], v232 offset:62464
    s_waitcnt lgkmcnt(12)
    v_mfma_f32_32x32x16_bf16 v[160:175], v[36:39], v[132:135], v[160:175]
    buffer_store_dwordx4 v[204:207], v243, s[52:55], s35 offen offset:512 sc1
    s_add_u32 s52, s52, 2097152
    s_addc_u32 s53, s53, 0
    ds_read_b64_tr_b16 v[128:129], v233 offset:0
    ds_read_b64_tr_b16 v[130:131], v233 offset:1024
    s_waitcnt lgkmcnt(12)
    v_mfma_f32_32x32x16_bf16 v[160:175], v[40:43], v[136:139], v[160:175]
    ds_read_b64_tr_b16 v[132:133], v233 offset:4096
    ds_read_b64_tr_b16 v[134:135], v233 offset:5120
    s_waitcnt lgkmcnt(12)
    v_mfma_f32_32x32x16_bf16 v[160:175], v[44:47], v[140:143], v[160:175]
    buffer_load_dwordx4 a[12:15], v240, s[28:31], s32 offen offset:3072 sc1
    ds_read_b64_tr_b16 v[136:137], v233 offset:8192
    ds_read_b64_tr_b16 v[138:139], v233 offset:9216
    s_waitcnt lgkmcnt(12)
    v_mfma_f32_32x32x16_bf16 v[160:175], v[48:51], v[144:147], v[160:175]
    ds_read_b64_tr_b16 v[140:141], v233 offset:12288
    ds_read_b64_tr_b16 v[142:143], v233 offset:13312
    s_waitcnt lgkmcnt(12)
    v_mfma_f32_32x32x16_bf16 v[160:175], v[52:55], v[148:151], v[160:175]
    ds_read_b64_tr_b16 v[144:145], v233 offset:16384
    ds_read_b64_tr_b16 v[146:147], v233 offset:17408
    s_waitcnt lgkmcnt(12)
    v_mfma_f32_32x32x16_bf16 v[160:175], v[56:59], v[152:155], v[160:175]
    buffer_load_dwordx4 a[16:19], v240, s[28:31], s33 offen offset:0 sc1
    ds_read_b64_tr_b16 v[148:149], v233 offset:20480
    ds_read_b64_tr_b16 v[150:151], v233 offset:21504
    s_waitcnt lgkmcnt(12)
    v_mfma_f32_32x32x16_bf16 v[160:175], v[60:63], v[156:159], v[160:175]
    ds_read_b64_tr_b16 v[152:153], v233 offset:24576
    ds_read_b64_tr_b16 v[154:155], v233 offset:25600
    s_waitcnt lgkmcnt(12)
    v_mfma_f32_32x32x16_bf16 v[160:175], v[64:67], v[128:131], v[160:175]
    ds_read_b64_tr_b16 v[156:157], v233 offset:28672
    ds_read_b64_tr_b16 v[158:159], v233 offset:29696
    s_waitcnt lgkmcnt(12)
    v_mfma_f32_32x32x16_bf16 v[160:175], v[68:71], v[132:135], v[160:175]
    buffer_load_dwordx4 a[20:23], v240, s[28:31], s33 offen offset:1024 sc1
    ds_read_b64_tr_b16 v[128:129], v233 offset:32768
    ds_read_b64_tr_b16 v[130:131], v233 offset:33792
    s_waitcnt lgkmcnt(12)
    v_mfma_f32_32x32x16_bf16 v[160:175], v[72:75], v[136:139], v[160:175]
    ds_read_b64_tr_b16 v[132:133], v233 offset:36864
    ds_read_b64_tr_b16 v[134:135], v233 offset:37888
    s_waitcnt lgkmcnt(12)
    v_mfma_f32_32x32x16_bf16 v[160:175], v[76:79], v[140:143], v[160:175]
    ds_read_b64_tr_b16 v[136:137], v233 offset:40960
    ds_read_b64_tr_b16 v[138:139], v233 offset:41984
    s_waitcnt lgkmcnt(12)
    v_mfma_f32_32x32x16_bf16 v[160:175], v[80:83], v[144:147], v[160:175]
    buffer_load_dwordx4 a[24:27], v240, s[28:31], s33 offen offset:2048 sc1
    ds_read_b64_tr_b16 v[140:141], v233 offset:45056
    ds_read_b64_tr_b16 v[142:143], v233 offset:46080
    s_waitcnt lgkmcnt(12)
    v_mfma_f32_32x32x16_bf16 v[160:175], v[84:87], v[148:151], v[160:175]
    ds_read_b64_tr_b16 v[144:145], v233 offset:49152
    ds_read_b64_tr_b16 v[146:147], v233 offset:50176
    s_waitcnt lgkmcnt(12)
    v_mfma_f32_32x32x16_bf16 v[160:175], v[88:91], v[152:155], v[160:175]
    ds_read_b64_tr_b16 v[148:149], v233 offset:53248
    ds_read_b64_tr_b16 v[150:151], v233 offset:54272
    s_waitcnt lgkmcnt(12)
    v_mfma_f32_32x32x16_bf16 v[160:175], v[92:95], v[156:159], v[160:175]
    buffer_load_dwordx4 a[28:31], v240, s[28:31], s33 offen offset:3072 sc1
    ds_read_b64_tr_b16 v[152:153], v233 offset:57344
    ds_read_b64_tr_b16 v[154:155], v233 offset:58368
    s_waitcnt lgkmcnt(12)
    v_mfma_f32_32x32x16_bf16 v[160:175], v[96:99], v[128:131], v[160:175]
    ds_read_b64_tr_b16 v[156:157], v233 offset:61440
    ds_read_b64_tr_b16 v[158:159], v233 offset:62464
    s_waitcnt lgkmcnt(12)
    v_mfma_f32_32x32x16_bf16 v[160:175], v[100:103], v[132:135], v[160:175]
    ds_read_b64_tr_b16 v[128:129], v234 offset:0
    ds_read_b64_tr_b16 v[130:131], v234 offset:1024
    s_waitcnt lgkmcnt(12)
    v_mfma_f32_32x32x16_bf16 v[160:175], v[104:107], v[136:139], v[160:175]
    buffer_load_dwordx4 a[32:35], v240, s[28:31], s34 offen offset:0 sc1
    ds_read_b64_tr_b16 v[132:133], v234 offset:4096
    ds_read_b64_tr_b16 v[134:135], v234 offset:5120
    s_waitcnt lgkmcnt(12)
    v_mfma_f32_32x32x16_bf16 v[160:175], v[108:111], v[140:143], v[160:175]
    ds_read_b64_tr_b16 v[136:137], v234 offset:8192
    ds_read_b64_tr_b16 v[138:139], v234 offset:9216
    s_waitcnt lgkmcnt(12)
    v_mfma_f32_32x32x16_bf16 v[160:175], v[112:115], v[144:147], v[160:175]
    ds_read_b64_tr_b16 v[140:141], v234 offset:12288
    ds_read_b64_tr_b16 v[142:143], v234 offset:13312
    s_waitcnt lgkmcnt(12)
    v_mfma_f32_32x32x16_bf16 v[160:175], v[116:119], v[148:151], v[160:175]
    buffer_load_dwordx4 a[36:39], v240, s[28:31], s34 offen offset:1024 sc1
    ds_read_b64_tr_b16 v[144:145], v234 offset:16384
    ds_read_b64_tr_b16 v[146:147], v234 offset:17408
    s_waitcnt lgkmcnt(12)
    v_mfma_f32_32x32x16_bf16 v[160:175], v[120:123], v[152:155], v[160:175]
    ds_read_b64_tr_b16 v[148:149], v234 offset:20480
    ds_read_b64_tr_b16 v[150:151], v234 offset:21504
    s_waitcnt lgkmcnt(12)
    v_mfma_f32_32x32x16_bf16 v[160:175], v[124:127], v[156:159], v[160:175]
    ds_read_b64_tr_b16 v[152:153], v234 offset:24576
    ds_read_b64_tr_b16 v[154:155], v234 offset:25600
    s_waitcnt lgkmcnt(12)
    v_mfma_f32_32x32x16_bf16 v[176:191], v[0:3], v[128:131], 0
    buffer_load_dwordx4 a[40:43], v240, s[28:31], s34 offen offset:2048 sc1
    ds_read_b64_tr_b16 v[156:157], v234 offset:28672
    ds_read_b64_tr_b16 v[158:159], v234 offset:29696
    s_waitcnt lgkmcnt(12)
    v_mfma_f32_32x32x16_bf16 v[176:191], v[4:7], v[132:135], v[176:191]
    s_waitcnt vmcnt(8)
    s_lshl_b32 s58, s26, 2
    s_add_u32 s58, s58, s23
    v_mov_b32 v248, s58
    s_mov_b64 exec, 1
    global_store_dword v246, v248, s[42:43] sc1
    s_mov_b64 exec, -1
    ds_read_b64_tr_b16 v[128:129], v234 offset:32768
    ds_read_b64_tr_b16 v[130:131], v234 offset:33792
    s_waitcnt lgkmcnt(12)
    v_mfma_f32_32x32x16_bf16 v[176:191], v[8:11], v[136:139], v[176:191]
    ds_read_b64_tr_b16 v[132:133], v234 offset:36864
    ds_read_b64_tr_b16 v[134:135], v234 offset:37888
    s_waitcnt lgkmcnt(12)
    v_mfma_f32_32x32x16_bf16 v[176:191], v[12:15], v[140:143], v[176:191]
    buffer_load_dwordx4 a[44:47], v240, s[28:31], s34 offen offset:3072 sc1
    v_cvt_pk_bf16_f32 v192, v160, v161
    v_cvt_pk_bf16_f32 v193, v162, v163
    ds_read_b64_tr_b16 v[136:137], v234 offset:40960
    ds_read_b64_tr_b16 v[138:139], v234 offset:41984
    s_waitcnt lgkmcnt(12)
    v_mfma_f32_32x32x16_bf16 v[176:191], v[16:19], v[144:147], v[176:191]
    v_cvt_pk_bf16_f32 v194, v164, v165
    v_cvt_pk_bf16_f32 v195, v166, v167
    ds_read_b64_tr_b16 v[140:141], v234 offset:45056
    ds_read_b64_tr_b16 v[142:143], v234 offset:46080
    s_waitcnt lgkmcnt(12)
    v_mfma_f32_32x32x16_bf16 v[176:191], v[20:23], v[148:151], v[176:191]
    v_cvt_pk_bf16_f32 v196, v168, v169
    v_cvt_pk_bf16_f32 v197, v170, v171
    ds_read_b64_tr_b16 v[144:145], v234 offset:49152
    ds_read_b64_tr_b16 v[146:147], v234 offset:50176
    s_waitcnt lgkmcnt(12)
    v_mfma_f32_32x32x16_bf16 v[176:191], v[24:27], v[152:155], v[176:191]
    buffer_load_dwordx4 a[48:51], v240, s[28:31], s35 offen offset:0 sc1
    v_cvt_pk_bf16_f32 v198, v172, v173
    v_cvt_pk_bf16_f32 v199, v174, v175
    buffer_store_dwordx4 v[192:195], v243, s[52:55], s32 offen offset:0 sc1
    ds_read_b64_tr_b16 v[148:149], v234 offset:53248
    ds_read_b64_tr_b16 v[150:151], v234 offset:54272
    s_waitcnt lgkmcnt(12)
    v_mfma_f32_32x32x16_bf16 v[176:191], v[28:31], v[156:159], v[176:191]
    ds_read_b64_tr_b16 v[152:153], v234 offset:57344
    ds_read_b64_tr_b16 v[154:155], v234 offset:58368
    s_waitcnt lgkmcnt(12)
    v_mfma_f32_32x32x16_bf16 v[176:191], v[32:35], v[128:131], v[176:191]
    ds_read_b64_tr_b16 v[156:157], v234 offset:61440
    ds_read_b64_tr_b16 v[158:159], v234 offset:62464
    s_waitcnt lgkmcnt(12)
    v_mfma_f32_32x32x16_bf16 v[176:191], v[36:39], v[132:135], v[176:191]
    buffer_load_dwordx4 a[52:55], v240, s[28:31], s35 offen offset:1024 sc1
    buffer_store_dwordx4 v[196:199], v243, s[52:55], s32 offen offset:512 sc1
    ds_read_b64_tr_b16 v[128:129], v235 offset:0
    ds_read_b64_tr_b16 v[130:131], v235 offset:1024
    s_waitcnt lgkmcnt(12)
    v_mfma_f32_32x32x16_bf16 v[176:191], v[40:43], v[136:139], v[176:191]
    ds_read_b64_tr_b16 v[132:133], v235 offset:4096
    ds_read_b64_tr_b16 v[134:135], v235 offset:5120
    s_waitcnt lgkmcnt(12)
    v_mfma_f32_32x32x16_bf16 v[176:191], v[44:47], v[140:143], v[176:191]
    ds_read_b64_tr_b16 v[136:137], v235 offset:8192
    ds_read_b64_tr_b16 v[138:139], v235 offset:9216
    s_waitcnt lgkmcnt(12)
    v_mfma_f32_32x32x16_bf16 v[176:191], v[48:51], v[144:147], v[176:191]
    buffer_load_dwordx4 a[56:59], v240, s[28:31], s35 offen offset:2048 sc1
    ds_read_b64_tr_b16 v[140:141], v235 offset:12288
    ds_read_b64_tr_b16 v[142:143], v235 offset:13312
    s_waitcnt lgkmcnt(12)
    v_mfma_f32_32x32x16_bf16 v[176:191], v[52:55], v[148:151], v[176:191]
    ds_read_b64_tr_b16 v[144:145], v235 offset:16384
    ds_read_b64_tr_b16 v[146:147], v235 offset:17408
    s_waitcnt lgkmcnt(12)
    v_mfma_f32_32x32x16_bf16 v[176:191], v[56:59], v[152:155], v[176:191]
    ds_read_b64_tr_b16 v[148:149], v235 offset:20480
    ds_read_b64_tr_b16 v[150:151], v235 offset:21504
    s_waitcnt lgkmcnt(12)
    v_mfma_f32_32x32x16_bf16 v[176:191], v[60:63], v[156:159], v[176:191]
    buffer_load_dwordx4 a[60:63], v240, s[28:31], s35 offen offset:3072 sc1
    ds_read_b64_tr_b16 v[152:153], v235 offset:24576
    ds_read_b64_tr_b16 v[154:155], v235 offset:25600
    s_waitcnt lgkmcnt(12)
    v_mfma_f32_32x32x16_bf16 v[176:191], v[64:67], v[128:131], v[176:191]
    ds_read_b64_tr_b16 v[156:157], v235 offset:28672
    ds_read_b64_tr_b16 v[158:159], v235 offset:29696
    s_waitcnt lgkmcnt(12)
    v_mfma_f32_32x32x16_bf16 v[176:191], v[68:71], v[132:135], v[176:191]
    ds_read_b64_tr_b16 v[128:129], v235 offset:32768
    ds_read_b64_tr_b16 v[130:131], v235 offset:33792
    s_waitcnt lgkmcnt(12)
    v_mfma_f32_32x32x16_bf16 v[176:191], v[72:75], v[136:139], v[176:191]
    buffer_load_dwordx4 a[64:67], v240, s[28:31], s36 offen offset:0 sc1
    ds_read_b64_tr_b16 v[132:133], v235 offset:36864
    ds_read_b64_tr_b16 v[134:135], v235 offset:37888
    s_waitcnt lgkmcnt(12)
    v_mfma_f32_32x32x16_bf16 v[176:191], v[76:79], v[140:143], v[176:191]
    ds_read_b64_tr_b16 v[136:137], v235 offset:40960
    ds_read_b64_tr_b16 v[138:139], v235 offset:41984
    s_waitcnt lgkmcnt(12)
    v_mfma_f32_32x32x16_bf16 v[176:191], v[80:83], v[144:147], v[176:191]
    ds_read_b64_tr_b16 v[140:141], v235 offset:45056
    ds_read_b64_tr_b16 v[142:143], v235 offset:46080
    s_waitcnt lgkmcnt(12)
    v_mfma_f32_32x32x16_bf16 v[176:191], v[84:87], v[148:151], v[176:191]
    buffer_load_dwordx4 a[68:71], v240, s[28:31], s36 offen offset:1024 sc1
    ds_read_b64_tr_b16 v[144:145], v235 offset:49152
    ds_read_b64_tr_b16 v[146:147], v235 offset:50176
    s_waitcnt lgkmcnt(12)
    v_mfma_f32_32x32x16_bf16 v[176:191], v[88:91], v[152:155], v[176:191]
    ds_read_b64_tr_b16 v[148:149], v235 offset:53248
    ds_read_b64_tr_b16 v[150:151], v235 offset:54272
    s_waitcnt lgkmcnt(12)
    v_mfma_f32_32x32x16_bf16 v[176:191], v[92:95], v[156:159], v[176:191]
    ds_read_b64_tr_b16 v[152:153], v235 offset:57344
    ds_read_b64_tr_b16 v[154:155], v235 offset:58368
    s_waitcnt lgkmcnt(12)
    v_mfma_f32_32x32x16_bf16 v[176:191], v[96:99], v[128:131], v[176:191]
    buffer_load_dwordx4 a[72:75], v240, s[28:31], s36 offen offset:2048 sc1
    ds_read_b64_tr_b16 v[156:157], v235 offset:61440
    ds_read_b64_tr_b16 v[158:159], v235 offset:62464
    s_waitcnt lgkmcnt(12)
    v_mfma_f32_32x32x16_bf16 v[176:191], v[100:103], v[132:135], v[176:191]
    ds_read_b64_tr_b16 v[128:129], v236 offset:0
    ds_read_b64_tr_b16 v[130:131], v236 offset:1024
    s_waitcnt lgkmcnt(12)
    v_mfma_f32_32x32x16_bf16 v[176:191], v[104:107], v[136:139], v[176:191]
    ds_read_b64_tr_b16 v[132:133], v236 offset:4096
    ds_read_b64_tr_b16 v[134:135], v236 offset:5120
    s_waitcnt lgkmcnt(12)
    v_mfma_f32_32x32x16_bf16 v[176:191], v[108:111], v[140:143], v[176:191]
    buffer_load_dwordx4 a[76:79], v240, s[28:31], s36 offen offset:3072 sc1
    ds_read_b64_tr_b16 v[136:137], v236 offset:8192
    ds_read_b64_tr_b16 v[138:139], v236 offset:9216
    s_waitcnt lgkmcnt(12)
    v_mfma_f32_32x32x16_bf16 v[176:191], v[112:115], v[144:147], v[176:191]
    ds_read_b64_tr_b16 v[140:141], v236 offset:12288
    ds_read_b64_tr_b16 v[142:143], v236 offset:13312
    s_waitcnt lgkmcnt(12)
    v_mfma_f32_32x32x16_bf16 v[176:191], v[116:119], v[148:151], v[176:191]
    ds_read_b64_tr_b16 v[144:145], v236 offset:16384
    ds_read_b64_tr_b16 v[146:147], v236 offset:17408
    s_waitcnt lgkmcnt(12)
    v_mfma_f32_32x32x16_bf16 v[176:191], v[120:123], v[152:155], v[176:191]
    buffer_load_dwordx4 a[80:83], v240, s[28:31], s37 offen offset:0 sc1
    ds_read_b64_tr_b16 v[148:149], v236 offset:20480
    ds_read_b64_tr_b16 v[150:151], v236 offset:21504
    s_waitcnt lgkmcnt(12)
    v_mfma_f32_32x32x16_bf16 v[176:191], v[124:127], v[156:159], v[176:191]
    ds_read_b64_tr_b16 v[152:153], v236 offset:24576
    ds_read_b64_tr_b16 v[154:155], v236 offset:25600
    s_waitcnt lgkmcnt(12)
    v_mfma_f32_32x32x16_bf16 v[160:175], v[0:3], v[128:131], 0
    ds_read_b64_tr_b16 v[156:157], v236 offset:28672
    ds_read_b64_tr_b16 v[158:159], v236 offset:29696
    s_waitcnt lgkmcnt(12)
    v_mfma_f32_32x32x16_bf16 v[160:175], v[4:7], v[132:135], v[160:175]
    buffer_load_dwordx4 a[84:87], v240, s[28:31], s37 offen offset:1024 sc1
    ds_read_b64_tr_b16 v[128:129], v236 offset:32768
    ds_read_b64_tr_b16 v[130:131], v236 offset:33792
    s_waitcnt lgkmcnt(12)
    v_mfma_f32_32x32x16_bf16 v[160:175], v[8:11], v[136:139], v[160:175]
    ds_read_b64_tr_b16 v[132:133], v236 offset:36864
    ds_read_b64_tr_b16 v[134:135], v236 offset:37888
    s_waitcnt lgkmcnt(12)
    v_mfma_f32_32x32x16_bf16 v[160:175], v[12:15], v[140:143], v[160:175]
    v_cvt_pk_bf16_f32 v200, v176, v177
    v_cvt_pk_bf16_f32 v201, v178, v179
    ds_read_b64_tr_b16 v[136:137], v236 offset:40960
    ds_read_b64_tr_b16 v[138:139], v236 offset:41984
    s_waitcnt lgkmcnt(12)
    v_mfma_f32_32x32x16_bf16 v[160:175], v[16:19], v[144:147], v[160:175]
    buffer_load_dwordx4 a[88:91], v240, s[28:31], s37 offen offset:2048 sc1
    v_cvt_pk_bf16_f32 v202, v180, v181
    v_cvt_pk_bf16_f32 v203, v182, v183
    ds_read_b64_tr_b16 v[140:141], v236 offset:45056
    ds_read_b64_tr_b16 v[142:143], v236 offset:46080
    s_waitcnt lgkmcnt(12)
    v_mfma_f32_32x32x16_bf16 v[160:175], v[20:23], v[148:151], v[160:175]
    v_cvt_pk_bf16_f32 v204, v184, v185
    v_cvt_pk_bf16_f32 v205, v186, v187
    ds_read_b64_tr_b16 v[144:145], v236 offset:49152
    ds_read_b64_tr_b16 v[146:147], v236 offset:50176
    s_waitcnt lgkmcnt(12)
    v_mfma_f32_32x32x16_bf16 v[160:175], v[24:27], v[152:155], v[160:175]
    v_cvt_pk_bf16_f32 v206, v188, v189
    v_cvt_pk_bf16_f32 v207, v190, v191
    buffer_store_dwordx4 v[200:203], v243, s[52:55], s33 offen offset:0 sc1
    ds_read_b64_tr_b16 v[148:149], v236 offset:53248
    ds_read_b64_tr_b16 v[150:151], v236 offset:54272
    s_waitcnt lgkmcnt(12)
    v_mfma_f32_32x32x16_bf16 v[160:175], v[28:31], v[156:159], v[160:175]
    buffer_load_dwordx4 a[92:95], v240, s[28:31], s37 offen offset:3072 sc1
    ds_read_b64_tr_b16 v[152:153], v236 offset:57344
    ds_read_b64_tr_b16 v[154:155], v236 offset:58368
    s_waitcnt lgkmcnt(12)
    v_mfma_f32_32x32x16_bf16 v[160:175], v[32:35], v[128:131], v[160:175]
    ds_read_b64_tr_b16 v[156:157], v236 offset:61440
    ds_read_b64_tr_b16 v[158:159], v236 offset:62464
    s_waitcnt lgkmcnt(12)
    v_mfma_f32_32x32x16_bf16 v[160:175], v[36:39], v[132:135], v[160:175]
    buffer_store_dwordx4 v[204:207], v243, s[52:55], s33 offen offset:512 sc1
    ds_read_b64_tr_b16 v[128:129], v237 offset:0
    ds_read_b64_tr_b16 v[130:131], v237 offset:1024
    s_waitcnt lgkmcnt(12)
    v_mfma_f32_32x32x16_bf16 v[160:175], v[40:43], v[136:139], v[160:175]
    buffer_load_dwordx4 a[96:99], v240, s[28:31], s38 offen offset:0 sc1
    ds_read_b64_tr_b16 v[132:133], v237 offset:4096
    ds_read_b64_tr_b16 v[134:135], v237 offset:5120
    s_waitcnt lgkmcnt(12)
    v_mfma_f32_32x32x16_bf16 v[160:175], v[44:47], v[140:143], v[160:175]
    ds_read_b64_tr_b16 v[136:137], v237 offset:8192
    ds_read_b64_tr_b16 v[138:139], v237 offset:9216
    s_waitcnt lgkmcnt(12)
    v_mfma_f32_32x32x16_bf16 v[160:175], v[48:51], v[144:147], v[160:175]
    ds_read_b64_tr_b16 v[140:141], v237 offset:12288
    ds_read_b64_tr_b16 v[142:143], v237 offset:13312
    s_waitcnt lgkmcnt(12)
    v_mfma_f32_32x32x16_bf16 v[160:175], v[52:55], v[148:151], v[160:175]
    buffer_load_dwordx4 a[100:103], v240, s[28:31], s38 offen offset:1024 sc1
    ds_read_b64_tr_b16 v[144:145], v237 offset:16384
    ds_read_b64_tr_b16 v[146:147], v237 offset:17408
    s_waitcnt lgkmcnt(12)
    v_mfma_f32_32x32x16_bf16 v[160:175], v[56:59], v[152:155], v[160:175]
    ds_read_b64_tr_b16 v[148:149], v237 offset:20480
    ds_read_b64_tr_b16 v[150:151], v237 offset:21504
    s_waitcnt lgkmcnt(12)
    v_mfma_f32_32x32x16_bf16 v[160:175], v[60:63], v[156:159], v[160:175]
    ds_read_b64_tr_b16 v[152:153], v237 offset:24576
    ds_read_b64_tr_b16 v[154:155], v237 offset:25600
    s_waitcnt lgkmcnt(12)
    v_mfma_f32_32x32x16_bf16 v[160:175], v[64:67], v[128:131], v[160:175]
    buffer_load_dwordx4 a[104:107], v240, s[28:31], s38 offen offset:2048 sc1
    ds_read_b64_tr_b16 v[156:157], v237 offset:28672
    ds_read_b64_tr_b16 v[158:159], v237 offset:29696
    s_waitcnt lgkmcnt(12)
    v_mfma_f32_32x32x16_bf16 v[160:175], v[68:71], v[132:135], v[160:175]
    ds_read_b64_tr_b16 v[128:129], v237 offset:32768
    ds_read_b64_tr_b16 v[130:131], v237 offset:33792
    s_waitcnt lgkmcnt(12)
    v_mfma_f32_32x32x16_bf16 v[160:175], v[72:75], v[136:139], v[160:175]
    ds_read_b64_tr_b16 v[132:133], v237 offset:36864
    ds_read_b64_tr_b16 v[134:135], v237 offset:37888
    s_waitcnt lgkmcnt(12)
    v_mfma_f32_32x32x16_bf16 v[160:175], v[76:79], v[140:143], v[160:175]
    buffer_load_dwordx4 a[108:111], v240, s[28:31], s38 offen offset:3072 sc1
    ds_read_b64_tr_b16 v[136:137], v237 offset:40960
    ds_read_b64_tr_b16 v[138:139], v237 offset:41984
    s_waitcnt lgkmcnt(12)
    v_mfma_f32_32x32x16_bf16 v[160:175], v[80:83], v[144:147], v[160:175]
    ds_read_b64_tr_b16 v[140:141], v237 offset:45056
    ds_read_b64_tr_b16 v[142:143], v237 offset:46080
    s_waitcnt lgkmcnt(12)
    v_mfma_f32_32x32x16_bf16 v[160:175], v[84:87], v[148:151], v[160:175]
    ds_read_b64_tr_b16 v[144:145], v237 offset:49152
    ds_read_b64_tr_b16 v[146:147], v237 offset:50176
    s_waitcnt lgkmcnt(12)
    v_mfma_f32_32x32x16_bf16 v[160:175], v[88:91], v[152:155], v[160:175]
    buffer_load_dwordx4 a[112:115], v240, s[28:31], s39 offen offset:0 sc1
    ds_read_b64_tr_b16 v[148:149], v237 offset:53248
    ds_read_b64_tr_b16 v[150:151], v237 offset:54272
    s_waitcnt lgkmcnt(12)
    v_mfma_f32_32x32x16_bf16 v[160:175], v[92:95], v[156:159], v[160:175]
    ds_read_b64_tr_b16 v[152:153], v237 offset:57344
    ds_read_b64_tr_b16 v[154:155], v237 offset:58368
    s_waitcnt lgkmcnt(12)
    v_mfma_f32_32x32x16_bf16 v[160:175], v[96:99], v[128:131], v[160:175]
    ds_read_b64_tr_b16 v[156:157], v237 offset:61440
    ds_read_b64_tr_b16 v[158:159], v237 offset:62464
    s_waitcnt lgkmcnt(12)
    v_mfma_f32_32x32x16_bf16 v[160:175], v[100:103], v[132:135], v[160:175]
    buffer_load_dwordx4 a[116:119], v240, s[28:31], s39 offen offset:1024 sc1
    ds_read_b64_tr_b16 v[128:129], v238 offset:0
    ds_read_b64_tr_b16 v[130:131], v238 offset:1024
    s_waitcnt lgkmcnt(12)
    v_mfma_f32_32x32x16_bf16 v[160:175], v[104:107], v[136:139], v[160:175]
    ds_read_b64_tr_b16 v[132:133], v238 offset:4096
    ds_read_b64_tr_b16 v[134:135], v238 offset:5120
    s_waitcnt lgkmcnt(12)
    v_mfma_f32_32x32x16_bf16 v[160:175], v[108:111], v[140:143], v[160:175]
    ds_read_b64_tr_b16 v[136:137], v238 offset:8192
    ds_read_b64_tr_b16 v[138:139], v238 offset:9216
    s_waitcnt lgkmcnt(12)
    v_mfma_f32_32x32x16_bf16 v[160:175], v[112:115], v[144:147], v[160:175]
    buffer_load_dwordx4 a[120:123], v240, s[28:31], s39 offen offset:2048 sc1
    ds_read_b64_tr_b16 v[140:141], v238 offset:12288
    ds_read_b64_tr_b16 v[142:143], v238 offset:13312
    s_waitcnt lgkmcnt(12)
    v_mfma_f32_32x32x16_bf16 v[160:175], v[116:119], v[148:151], v[160:175]
    ds_read_b64_tr_b16 v[144:145], v238 offset:16384
    ds_read_b64_tr_b16 v[146:147], v238 offset:17408
    s_waitcnt lgkmcnt(12)
    v_mfma_f32_32x32x16_bf16 v[160:175], v[120:123], v[152:155], v[160:175]
    ds_read_b64_tr_b16 v[148:149], v238 offset:20480
    ds_read_b64_tr_b16 v[150:151], v238 offset:21504
    s_waitcnt lgkmcnt(12)
    v_mfma_f32_32x32x16_bf16 v[160:175], v[124:127], v[156:159], v[160:175]
    buffer_load_dwordx4 a[124:127], v240, s[28:31], s39 offen offset:3072 sc1
    ds_read_b64_tr_b16 v[152:153], v238 offset:24576
    ds_read_b64_tr_b16 v[154:155], v238 offset:25600
    s_waitcnt lgkmcnt(12)
    v_mfma_f32_32x32x16_bf16 v[176:191], v[0:3], v[128:131], 0
    ds_read_b64_tr_b16 v[156:157], v238 offset:28672
    ds_read_b64_tr_b16 v[158:159], v238 offset:29696
    s_waitcnt lgkmcnt(12)
    v_mfma_f32_32x32x16_bf16 v[176:191], v[4:7], v[132:135], v[176:191]
    ds_read_b64_tr_b16 v[128:129], v238 offset:32768
    ds_read_b64_tr_b16 v[130:131], v238 offset:33792
    s_waitcnt lgkmcnt(12)
    v_mfma_f32_32x32x16_bf16 v[176:191], v[8:11], v[136:139], v[176:191]
    ds_read_b64_tr_b16 v[132:133], v238 offset:36864
    ds_read_b64_tr_b16 v[134:135], v238 offset:37888
    s_waitcnt lgkmcnt(12)
    v_mfma_f32_32x32x16_bf16 v[176:191], v[12:15], v[140:143], v[176:191]
    v_cvt_pk_bf16_f32 v192, v160, v161
    v_cvt_pk_bf16_f32 v193, v162, v163
    ds_read_b64_tr_b16 v[136:137], v238 offset:40960
    ds_read_b64_tr_b16 v[138:139], v238 offset:41984
    s_waitcnt lgkmcnt(12)
    v_mfma_f32_32x32x16_bf16 v[176:191], v[16:19], v[144:147], v[176:191]
    v_cvt_pk_bf16_f32 v194, v164, v165
    v_cvt_pk_bf16_f32 v195, v166, v167
    ds_read_b64_tr_b16 v[140:141], v238 offset:45056
    ds_read_b64_tr_b16 v[142:143], v238 offset:46080
    s_waitcnt lgkmcnt(12)
    v_mfma_f32_32x32x16_bf16 v[176:191], v[20:23], v[148:151], v[176:191]
    v_cvt_pk_bf16_f32 v196, v168, v169
    v_cvt_pk_bf16_f32 v197, v170, v171
    ds_read_b64_tr_b16 v[144:145], v238 offset:49152
    ds_read_b64_tr_b16 v[146:147], v238 offset:50176
    s_waitcnt lgkmcnt(12)
    v_mfma_f32_32x32x16_bf16 v[176:191], v[24:27], v[152:155], v[176:191]
    v_cvt_pk_bf16_f32 v198, v172, v173
    v_cvt_pk_bf16_f32 v199, v174, v175
    buffer_store_dwordx4 v[192:195], v243, s[52:55], s34 offen offset:0 sc1
    ds_read_b64_tr_b16 v[148:149], v238 offset:53248
    ds_read_b64_tr_b16 v[150:151], v238 offset:54272
    s_waitcnt lgkmcnt(12)
    v_mfma_f32_32x32x16_bf16 v[176:191], v[28:31], v[156:159], v[176:191]
    ds_read_b64_tr_b16 v[152:153], v238 offset:57344
    ds_read_b64_tr_b16 v[154:155], v238 offset:58368
    s_waitcnt lgkmcnt(12)
    v_mfma_f32_32x32x16_bf16 v[176:191], v[32:35], v[128:131], v[176:191]
    ds_read_b64_tr_b16 v[156:157], v238 offset:61440
    ds_read_b64_tr_b16 v[158:159], v238 offset:62464
    s_waitcnt lgkmcnt(12)
    v_mfma_f32_32x32x16_bf16 v[176:191], v[36:39], v[132:135], v[176:191]
    buffer_store_dwordx4 v[196:199], v243, s[52:55], s34 offen offset:512 sc1
    ds_read_b64_tr_b16 v[128:129], v239 offset:0
    ds_read_b64_tr_b16 v[130:131], v239 offset:1024
    s_waitcnt lgkmcnt(12)
    v_mfma_f32_32x32x16_bf16 v[176:191], v[40:43], v[136:139], v[176:191]
    ds_read_b64_tr_b16 v[132:133], v239 offset:4096
    ds_read_b64_tr_b16 v[134:135], v239 offset:5120
    s_waitcnt lgkmcnt(12)
    v_mfma_f32_32x32x16_bf16 v[176:191], v[44:47], v[140:143], v[176:191]
    ds_read_b64_tr_b16 v[136:137], v239 offset:8192
    ds_read_b64_tr_b16 v[138:139], v239 offset:9216
    s_waitcnt lgkmcnt(12)
    v_mfma_f32_32x32x16_bf16 v[176:191], v[48:51], v[144:147], v[176:191]
    ds_read_b64_tr_b16 v[140:141], v239 offset:12288
    ds_read_b64_tr_b16 v[142:143], v239 offset:13312
    s_waitcnt lgkmcnt(12)
    v_mfma_f32_32x32x16_bf16 v[176:191], v[52:55], v[148:151], v[176:191]
    ds_read_b64_tr_b16 v[144:145], v239 offset:16384
    ds_read_b64_tr_b16 v[146:147], v239 offset:17408
    s_waitcnt lgkmcnt(12)
    v_mfma_f32_32x32x16_bf16 v[176:191], v[56:59], v[152:155], v[176:191]
    ds_read_b64_tr_b16 v[148:149], v239 offset:20480
    ds_read_b64_tr_b16 v[150:151], v239 offset:21504
    s_waitcnt lgkmcnt(12)
    v_mfma_f32_32x32x16_bf16 v[176:191], v[60:63], v[156:159], v[176:191]
    ds_read_b64_tr_b16 v[152:153], v239 offset:24576
    ds_read_b64_tr_b16 v[154:155], v239 offset:25600
    s_waitcnt lgkmcnt(12)
    v_mfma_f32_32x32x16_bf16 v[176:191], v[64:67], v[128:131], v[176:191]
    ds_read_b64_tr_b16 v[156:157], v239 offset:28672
    ds_read_b64_tr_b16 v[158:159], v239 offset:29696
    s_waitcnt lgkmcnt(12)
    v_mfma_f32_32x32x16_bf16 v[176:191], v[68:71], v[132:135], v[176:191]
    ds_read_b64_tr_b16 v[128:129], v239 offset:32768
    ds_read_b64_tr_b16 v[130:131], v239 offset:33792
    s_waitcnt lgkmcnt(12)
    v_mfma_f32_32x32x16_bf16 v[176:191], v[72:75], v[136:139], v[176:191]
    ds_read_b64_tr_b16 v[132:133], v239 offset:36864
    ds_read_b64_tr_b16 v[134:135], v239 offset:37888
    s_waitcnt lgkmcnt(12)
    v_mfma_f32_32x32x16_bf16 v[176:191], v[76:79], v[140:143], v[176:191]
    ds_read_b64_tr_b16 v[136:137], v239 offset:40960
    ds_read_b64_tr_b16 v[138:139], v239 offset:41984
    s_waitcnt lgkmcnt(12)
    v_mfma_f32_32x32x16_bf16 v[176:191], v[80:83], v[144:147], v[176:191]
    ds_read_b64_tr_b16 v[140:141], v239 offset:45056
    ds_read_b64_tr_b16 v[142:143], v239 offset:46080
    s_waitcnt lgkmcnt(12)
    v_mfma_f32_32x32x16_bf16 v[176:191], v[84:87], v[148:151], v[176:191]
    ds_read_b64_tr_b16 v[144:145], v239 offset:49152
    ds_read_b64_tr_b16 v[146:147], v239 offset:50176
    s_waitcnt lgkmcnt(12)
    v_mfma_f32_32x32x16_bf16 v[176:191], v[88:91], v[152:155], v[176:191]
    ds_read_b64_tr_b16 v[148:149], v239 offset:53248
    ds_read_b64_tr_b16 v[150:151], v239 offset:54272
    s_waitcnt lgkmcnt(12)
    v_mfma_f32_32x32x16_bf16 v[176:191], v[92:95], v[156:159], v[176:191]
    ds_read_b64_tr_b16 v[152:153], v239 offset:57344
    ds_read_b64_tr_b16 v[154:155], v239 offset:58368
    s_waitcnt lgkmcnt(12)
    v_mfma_f32_32x32x16_bf16 v[176:191], v[96:99], v[128:131], v[176:191]
    ds_read_b64_tr_b16 v[156:157], v239 offset:61440
    ds_read_b64_tr_b16 v[158:159], v239 offset:62464
    s_waitcnt lgkmcnt(12)
    v_mfma_f32_32x32x16_bf16 v[176:191], v[100:103], v[132:135], v[176:191]
    ds_read_b64_tr_b16 v[128:129], v232 offset:0
    ds_read_b64_tr_b16 v[130:131], v232 offset:1024
    s_waitcnt lgkmcnt(12)
    v_mfma_f32_32x32x16_bf16 v[176:191], v[104:107], v[136:139], v[176:191]
    ds_read_b64_tr_b16 v[132:133], v232 offset:4096
    ds_read_b64_tr_b16 v[134:135], v232 offset:5120
    s_waitcnt lgkmcnt(12)
    v_mfma_f32_32x32x16_bf16 v[176:191], v[108:111], v[140:143], v[176:191]
    ds_read_b64_tr_b16 v[136:137], v232 offset:8192
    ds_read_b64_tr_b16 v[138:139], v232 offset:9216
    s_waitcnt lgkmcnt(12)
    v_mfma_f32_32x32x16_bf16 v[176:191], v[112:115], v[144:147], v[176:191]
    ds_read_b64_tr_b16 v[140:141], v232 offset:12288
    ds_read_b64_tr_b16 v[142:143], v232 offset:13312
    s_waitcnt lgkmcnt(12)
    v_mfma_f32_32x32x16_bf16 v[176:191], v[116:119], v[148:151], v[176:191]
    ds_read_b64_tr_b16 v[144:145], v232 offset:16384
    ds_read_b64_tr_b16 v[146:147], v232 offset:17408
    s_waitcnt lgkmcnt(12)
    v_mfma_f32_32x32x16_bf16 v[176:191], v[120:123], v[152:155], v[176:191]
    ds_read_b64_tr_b16 v[148:149], v232 offset:20480
    ds_read_b64_tr_b16 v[150:151], v232 offset:21504
    s_waitcnt lgkmcnt(12)
    v_mfma_f32_32x32x16_bf16 v[176:191], v[124:127], v[156:159], v[176:191]
    s_add_u32 s28, s28, 131072
    s_addc_u32 s29, s29, 0
    s_add_u32 s26, s26, 1
    s_branch L_v_loop
L_v_fin:
    s_waitcnt vmcnt(2)
    ds_read_b64_tr_b16 v[152:153], v232 offset:24576
    ds_read_b64_tr_b16 v[154:155], v232 offset:25600
    s_waitcnt lgkmcnt(12)
    v_mfma_f32_32x32x16_bf16 v[160:175], v[0:3], v[128:131], 0
    s_add_u32 m0, s57, 0
    s_lshl_b32 s61, s80, 4
    s_add_u32 s61, s61, 0
    buffer_load_dwordx4 v228, s[72:75], s61 offen lds
    ds_read_b64_tr_b16 v[156:157], v232 offset:28672
    ds_read_b64_tr_b16 v[158:159], v232 offset:29696
    s_waitcnt lgkmcnt(12)
    v_mfma_f32_32x32x16_bf16 v[160:175], v[4:7], v[132:135], v[160:175]
    s_add_u32 m0, s57, 1024
    s_lshl_b32 s61, s80, 4
    s_add_u32 s61, s61, 16384
    buffer_load_dwordx4 v228, s[72:75], s61 offen lds
    ds_read_b64_tr_b16 v[128:129], v232 offset:32768
    ds_read_b64_tr_b16 v[130:131], v232 offset:33792
    s_waitcnt lgkmcnt(12)
    v_mfma_f32_32x32x16_bf16 v[160:175], v[8:11], v[136:139], v[160:175]
    buffer_load_dwordx4 a[0:3], v240, s[28:31], s32 offen offset:0 sc1
    s_add_u32 m0, s57, 2048
    s_lshl_b32 s61, s80, 4
    s_add_u32 s61, s61, 32768
    buffer_load_dwordx4 v228, s[72:75], s61 offen lds
    ds_read_b64_tr_b16 v[132:133], v232 offset:36864
    ds_read_b64_tr_b16 v[134:135], v232 offset:37888
    s_waitcnt lgkmcnt(12)
    v_mfma_f32_32x32x16_bf16 v[160:175], v[12:15], v[140:143], v[160:175]
    v_cvt_pk_bf16_f32 v200, v176, v177
    v_cvt_pk_bf16_f32 v201, v178, v179
    s_add_u32 m0, s57, 3072
    s_lshl_b32 s61, s80, 4
    s_add_u32 s61, s61, 49152
    buffer_load_dwordx4 v228, s[72:75], s61 offen lds
    ds_read_b64_tr_b16 v[136:137], v232 offset:40960
    ds_read_b64_tr_b16 v[138:139], v232 offset:41984
    s_waitcnt lgkmcnt(12)
    v_mfma_f32_32x32x16_bf16 v[160:175], v[16:19], v[144:147], v[160:175]
    v_cvt_pk_bf16_f32 v202, v180, v181
    v_cvt_pk_bf16_f32 v203, v182, v183
    s_add_u32 m0, s57, 4096
    s_lshl_b32 s61, s80, 4
    s_add_u32 s61, s61, 65536
    buffer_load_dwordx4 v228, s[72:75], s61 offen lds
    ds_read_b64_tr_b16 v[140:141], v232 offset:45056
    ds_read_b64_tr_b16 v[142:143], v232 offset:46080
    s_waitcnt lgkmcnt(12)
    v_mfma_f32_32x32x16_bf16 v[160:175], v[20:23], v[148:151], v[160:175]
    buffer_load_dwordx4 a[4:7], v240, s[28:31], s32 offen offset:1024 sc1
    v_cvt_pk_bf16_f32 v204, v184, v185
    v_cvt_pk_bf16_f32 v205, v186, v187
    s_add_u32 m0, s57, 5120
    s_lshl_b32 s61, s80, 4
    s_add_u32 s61, s61, 81920
    buffer_load_dwordx4 v228, s[72:75], s61 offen lds
    ds_read_b64_tr_b16 v[144:145], v232 offset:49152
    ds_read_b64_tr_b16 v[146:147], v232 offset:50176
    s_waitcnt lgkmcnt(12)
    v_mfma_f32_32x32x16_bf16 v[160:175], v[24:27], v[152:155], v[160:175]
    v_cvt_pk_bf16_f32 v206, v188, v189
    v_cvt_pk_bf16_f32 v207, v190, v191
    buffer_store_dwordx4 v[200:203], v243, s[52:55], s35 offen offset:0 sc1
    s_add_u32 m0, s57, 6144
    s_lshl_b32 s61, s80, 4
    s_add_u32 s61, s61, 98304
    buffer_load_dwordx4 v228, s[72:75], s61 offen lds
    ds_read_b64_tr_b16 v[148:149], v232 offset:53248
    ds_read_b64_tr_b16 v[150:151], v232 offset:54272
    s_waitcnt lgkmcnt(12)
    v_mfma_f32_32x32x16_bf16 v[160:175], v[28:31], v[156:159], v[160:175]
    s_add_u32 m0, s57, 7168
    s_lshl_b32 s61, s80, 4
    s_add_u32 s61, s61, 114688
    buffer_load_dwordx4 v228, s[72:75], s61 offen lds
    ds_read_b64_tr_b16 v[152:153], v232 offset:57344
    ds_read_b64_tr_b16 v[154:155], v232 offset:58368
    s_waitcnt lgkmcnt(12)
    v_mfma_f32_32x32x16_bf16 v[160:175], v[32:35], v[128:131], v[160:175]
    buffer_load_dwordx4 a[8:11], v240, s[28:31], s32 offen offset:2048 sc1
    ds_read_b64_tr_b16 v[156:157], v232 offset:61440
    ds_read_b64_tr_b16 v[158:159], v232 offset:62464
    s_waitcnt lgkmcnt(12)
    v_mfma_f32_32x32x16_bf16 v[160:175], v[36:39], v[132:135], v[160:175]
    buffer_store_dwordx4 v[204:207], v243, s[52:55], s35 offen offset:512 sc1
    s_add_u32 s52, s52, 2097152
    s_addc_u32 s53, s53, 0
    ds_read_b64_tr_b16 v[128:129], v233 offset:0
    ds_read_b64_tr_b16 v[130:131], v233 offset:1024
    s_waitcnt lgkmcnt(12)
    v_mfma_f32_32x32x16_bf16 v[160:175], v[40:43], v[136:139], v[160:175]
    ds_read_b64_tr_b16 v[132:133], v233 offset:4096
    ds_read_b64_tr_b16 v[134:135], v233 offset:5120
    s_waitcnt lgkmcnt(12)
    v_mfma_f32_32x32x16_bf16 v[160:175], v[44:47], v[140:143], v[160:175]
    buffer_load_dwordx4 a[12:15], v240, s[28:31], s32 offen offset:3072 sc1
    ds_read_b64_tr_b16 v[136:137], v233 offset:8192
    ds_read_b64_tr_b16 v[138:139], v233 offset:9216
    s_waitcnt lgkmcnt(12)
    v_mfma_f32_32x32x16_bf16 v[160:175], v[48:51], v[144:147], v[160:175]
    ds_read_b64_tr_b16 v[140:141], v233 offset:12288
    ds_read_b64_tr_b16 v[142:143], v233 offset:13312
    s_waitcnt lgkmcnt(12)
    v_mfma_f32_32x32x16_bf16 v[160:175], v[52:55], v[148:151], v[160:175]
    ds_read_b64_tr_b16 v[144:145], v233 offset:16384
    ds_read_b64_tr_b16 v[146:147], v233 offset:17408
    s_waitcnt lgkmcnt(12)
    v_mfma_f32_32x32x16_bf16 v[160:175], v[56:59], v[152:155], v[160:175]
    buffer_load_dwordx4 a[16:19], v240, s[28:31], s33 offen offset:0 sc1
    ds_read_b64_tr_b16 v[148:149], v233 offset:20480
    ds_read_b64_tr_b16 v[150:151], v233 offset:21504
    s_waitcnt lgkmcnt(12)
    v_mfma_f32_32x32x16_bf16 v[160:175], v[60:63], v[156:159], v[160:175]
    ds_read_b64_tr_b16 v[152:153], v233 offset:24576
    ds_read_b64_tr_b16 v[154:155], v233 offset:25600
    s_waitcnt lgkmcnt(12)
    v_mfma_f32_32x32x16_bf16 v[160:175], v[64:67], v[128:131], v[160:175]
    ds_read_b64_tr_b16 v[156:157], v233 offset:28672
    ds_read_b64_tr_b16 v[158:159], v233 offset:29696
    s_waitcnt lgkmcnt(12)
    v_mfma_f32_32x32x16_bf16 v[160:175], v[68:71], v[132:135], v[160:175]
    buffer_load_dwordx4 a[20:23], v240, s[28:31], s33 offen offset:1024 sc1
    ds_read_b64_tr_b16 v[128:129], v233 offset:32768
    ds_read_b64_tr_b16 v[130:131], v233 offset:33792
    s_waitcnt lgkmcnt(12)
    v_mfma_f32_32x32x16_bf16 v[160:175], v[72:75], v[136:139], v[160:175]
    ds_read_b64_tr_b16 v[132:133], v233 offset:36864
    ds_read_b64_tr_b16 v[134:135], v233 offset:37888
    s_waitcnt lgkmcnt(12)
    v_mfma_f32_32x32x16_bf16 v[160:175], v[76:79], v[140:143], v[160:175]
    ds_read_b64_tr_b16 v[136:137], v233 offset:40960
    ds_read_b64_tr_b16 v[138:139], v233 offset:41984
    s_waitcnt lgkmcnt(12)
    v_mfma_f32_32x32x16_bf16 v[160:175], v[80:83], v[144:147], v[160:175]
    buffer_load_dwordx4 a[24:27], v240, s[28:31], s33 offen offset:2048 sc1
    ds_read_b64_tr_b16 v[140:141], v233 offset:45056
    ds_read_b64_tr_b16 v[142:143], v233 offset:46080
    s_waitcnt lgkmcnt(12)
    v_mfma_f32_32x32x16_bf16 v[160:175], v[84:87], v[148:151], v[160:175]
    ds_read_b64_tr_b16 v[144:145], v233 offset:49152
    ds_read_b64_tr_b16 v[146:147], v233 offset:50176
    s_waitcnt lgkmcnt(12)
    v_mfma_f32_32x32x16_bf16 v[160:175], v[88:91], v[152:155], v[160:175]
    ds_read_b64_tr_b16 v[148:149], v233 offset:53248
    ds_read_b64_tr_b16 v[150:151], v233 offset:54272
    s_waitcnt lgkmcnt(12)
    v_mfma_f32_32x32x16_bf16 v[160:175], v[92:95], v[156:159], v[160:175]
    buffer_load_dwordx4 a[28:31], v240, s[28:31], s33 offen offset:3072 sc1
    s_waitcnt vmcnt(7)
    ds_read_b64_tr_b16 a[128:129], v229 offset:0
    ds_read_b64_tr_b16 a[130:131], v229 offset:512
    ds_read_b64_tr_b16 v[152:153], v233 offset:57344
    ds_read_b64_tr_b16 v[154:155], v233 offset:58368
    s_waitcnt lgkmcnt(14)
    v_mfma_f32_32x32x16_bf16 v[160:175], v[96:99], v[128:131], v[160:175]
    ds_read_b64_tr_b16 a[132:133], v229 offset:1024
    ds_read_b64_tr_b16 a[134:135], v229 offset:1536
    ds_read_b64_tr_b16 v[156:157], v233 offset:61440
    ds_read_b64_tr_b16 v[158:159], v233 offset:62464
    s_waitcnt lgkmcnt(15)
    v_mfma_f32_32x32x16_bf16 v[160:175], v[100:103], v[132:135], v[160:175]
    ds_read_b64_tr_b16 a[136:137], v229 offset:2048
    ds_read_b64_tr_b16 a[138:139], v229 offset:2560
    ds_read_b64_tr_b16 v[128:129], v234 offset:0
    ds_read_b64_tr_b16 v[130:131], v234 offset:1024
    s_waitcnt lgkmcnt(15)
    v_mfma_f32_32x32x16_bf16 v[160:175], v[104:107], v[136:139], v[160:175]
    buffer_load_dwordx4 a[32:35], v240, s[28:31], s34 offen offset:0 sc1
    ds_read_b64_tr_b16 a[140:141], v229 offset:3072
    ds_read_b64_tr_b16 a[142:143], v229 offset:3584
    ds_read_b64_tr_b16 v[132:133], v234 offset:4096
    ds_read_b64_tr_b16 v[134:135], v234 offset:5120
    v_mfma_f32_32x32x16_bf16 v[160:175], v[108:111], v[140:143], v[160:175]
    ds_read_b64_tr_b16 a[144:145], v229 offset:4096
    ds_read_b64_tr_b16 a[146:147], v229 offset:4608
    ds_read_b64_tr_b16 v[136:137], v234 offset:8192
    ds_read_b64_tr_b16 v[138:139], v234 offset:9216
    s_waitcnt lgkmcnt(15)
    v_mfma_f32_32x32x16_bf16 v[160:175], v[112:115], v[144:147], v[160:175]
    ds_read_b64_tr_b16 a[148:149], v229 offset:5120
    ds_read_b64_tr_b16 a[150:151], v229 offset:5632
    ds_read_b64_tr_b16 v[140:141], v234 offset:12288
    ds_read_b64_tr_b16 v[142:143], v234 offset:13312
    v_mfma_f32_32x32x16_bf16 v[160:175], v[116:119], v[148:151], v[160:175]
    buffer_load_dwordx4 a[36:39], v240, s[28:31], s34 offen offset:1024 sc1
    ds_read_b64_tr_b16 a[152:153], v229 offset:6144
    ds_read_b64_tr_b16 a[154:155], v229 offset:6656
    ds_read_b64_tr_b16 v[144:145], v234 offset:16384
    ds_read_b64_tr_b16 v[146:147], v234 offset:17408
    v_mfma_f32_32x32x16_bf16 v[160:175], v[120:123], v[152:155], v[160:175]
    ds_read_b64_tr_b16 a[156:157], v229 offset:7168
    ds_read_b64_tr_b16 a[158:159], v229 offset:7680
    ds_read_b64_tr_b16 v[148:149], v234 offset:20480
    ds_read_b64_tr_b16 v[150:151], v234 offset:21504
    s_waitcnt lgkmcnt(15)
    v_mfma_f32_32x32x16_bf16 v[160:175], v[124:127], v[156:159], v[160:175]
    ds_read_b64_tr_b16 v[152:153], v234 offset:24576
    ds_read_b64_tr_b16 v[154:155], v234 offset:25600
    v_mfma_f32_32x32x16_bf16 v[176:191], v[0:3], v[128:131], 0
    buffer_load_dwordx4 a[40:43], v240, s[28:31], s34 offen offset:2048 sc1
    s_waitcnt lgkmcnt(4)
    s_add_u32 m0, s57, 0
    s_lshl_b32 s61, s81, 4
    s_add_u32 s61, s61, 0
    buffer_load_dwordx4 v228, s[72:75], s61 offen lds
    ds_read_b64_tr_b16 v[156:157], v234 offset:28672
    ds_read_b64_tr_b16 v[158:159], v234 offset:29696
    v_mfma_f32_32x32x16_bf16 v[176:191], v[4:7], v[132:135], v[176:191]
    s_waitcnt vmcnt(9)
    s_lshl_b32 s58, s26, 2
    s_add_u32 s58, s58, s23
    v_mov_b32 v248, s58
    s_mov_b64 exec, 1
    global_store_dword v246, v248, s[42:43] sc1
    s_mov_b64 exec, -1
    s_add_u32 m0, s57, 1024
    s_lshl_b32 s61, s81, 4
    s_add_u32 s61, s61, 16384
    buffer_load_dwordx4 v228, s[72:75], s61 offen lds
    ds_read_b64_tr_b16 v[128:129], v234 offset:32768
    ds_read_b64_tr_b16 v[130:131], v234 offset:33792
    v_mfma_f32_32x32x16_bf16 v[176:191], v[8:11], v[136:139], v[176:191]
    s_add_u32 m0, s57, 2048
    s_lshl_b32 s61, s81, 4
    s_add_u32 s61, s61, 32768
    buffer_load_dwordx4 v228, s[72:75], s61 offen lds
    ds_read_b64_tr_b16 v[132:133], v234 offset:36864
    ds_read_b64_tr_b16 v[134:135], v234 offset:37888
    v_mfma_f32_32x32x16_bf16 v[176:191], v[12:15], v[140:143], v[176:191]
    buffer_load_dwordx4 a[44:47], v240, s[28:31], s34 offen offset:3072 sc1
    v_cvt_pk_bf16_f32 v192, v160, v161
    v_cvt_pk_bf16_f32 v193, v162, v163
    s_add_u32 m0, s57, 3072
    s_lshl_b32 s61, s81, 4
    s_add_u32 s61, s61, 49152
    buffer_load_dwordx4 v228, s[72:75], s61 offen lds
    ds_read_b64_tr_b16 v[136:137], v234 offset:40960
    ds_read_b64_tr_b16 v[138:139], v234 offset:41984
    v_mfma_f32_32x32x16_bf16 v[176:191], v[16:19], v[144:147], v[176:191]
    v_cvt_pk_bf16_f32 v194, v164, v165
    v_cvt_pk_bf16_f32 v195, v166, v167
    s_add_u32 m0, s57, 4096
    s_lshl_b32 s61, s81, 4
    s_add_u32 s61, s61, 65536
    buffer_load_dwordx4 v228, s[72:75], s61 offen lds
    ds_read_b64_tr_b16 v[140:141], v234 offset:45056
    ds_read_b64_tr_b16 v[142:143], v234 offset:46080
    s_waitcnt lgkmcnt(12)
    v_mfma_f32_32x32x16_bf16 v[176:191], v[20:23], v[148:151], v[176:191]
    v_cvt_pk_bf16_f32 v196, v168, v169
    v_cvt_pk_bf16_f32 v197, v170, v171
    s_add_u32 m0, s57, 5120
    s_lshl_b32 s61, s81, 4
    s_add_u32 s61, s61, 81920
    buffer_load_dwordx4 v228, s[72:75], s61 offen lds
    ds_read_b64_tr_b16 v[144:145], v234 offset:49152
    ds_read_b64_tr_b16 v[146:147], v234 offset:50176
    s_waitcnt lgkmcnt(12)
    v_mfma_f32_32x32x16_bf16 v[176:191], v[24:27], v[152:155], v[176:191]
    buffer_load_dwordx4 a[48:51], v240, s[28:31], s35 offen offset:0 sc1
    v_cvt_pk_bf16_f32 v198, v172, v173
    v_cvt_pk_bf16_f32 v199, v174, v175
    buffer_store_dwordx4 v[192:195], v243, s[52:55], s32 offen offset:0 sc1
    s_add_u32 m0, s57, 6144
    s_lshl_b32 s61, s81, 4
    s_add_u32 s61, s61, 98304
    buffer_load_dwordx4 v228, s[72:75], s61 offen lds
    ds_read_b64_tr_b16 v[148:149], v234 offset:53248
    ds_read_b64_tr_b16 v[150:151], v234 offset:54272
    s_waitcnt lgkmcnt(12)
    v_mfma_f32_32x32x16_bf16 v[176:191], v[28:31], v[156:159], v[176:191]
    s_add_u32 m0, s57, 7168
    s_lshl_b32 s61, s81, 4
    s_add_u32 s61, s61, 114688
    buffer_load_dwordx4 v228, s[72:75], s61 offen lds
    ds_read_b64_tr_b16 v[152:153], v234 offset:57344
    ds_read_b64_tr_b16 v[154:155], v234 offset:58368
    s_waitcnt lgkmcnt(12)
    v_mfma_f32_32x32x16_bf16 v[176:191], v[32:35], v[128:131], v[176:191]
    ds_read_b64_tr_b16 v[156:157], v234 offset:61440
    ds_read_b64_tr_b16 v[158:159], v234 offset:62464
    s_waitcnt lgkmcnt(12)
    v_mfma_f32_32x32x16_bf16 v[176:191], v[36:39], v[132:135], v[176:191]
    buffer_load_dwordx4 a[52:55], v240, s[28:31], s35 offen offset:1024 sc1
    buffer_store_dwordx4 v[196:199], v243, s[52:55], s32 offen offset:512 sc1
    ds_read_b64_tr_b16 v[128:129], v235 offset:0
    ds_read_b64_tr_b16 v[130:131], v235 offset:1024
    s_waitcnt lgkmcnt(12)
    v_mfma_f32_32x32x16_bf16 v[176:191], v[40:43], v[136:139], v[176:191]
    ds_read_b64_tr_b16 v[132:133], v235 offset:4096
    ds_read_b64_tr_b16 v[134:135], v235 offset:5120
    s_waitcnt lgkmcnt(12)
    v_mfma_f32_32x32x16_bf16 v[176:191], v[44:47], v[140:143], v[176:191]
    ds_read_b64_tr_b16 v[136:137], v235 offset:8192
    ds_read_b64_tr_b16 v[138:139], v235 offset:9216
    s_waitcnt lgkmcnt(12)
    v_mfma_f32_32x32x16_bf16 v[176:191], v[48:51], v[144:147], v[176:191]
    buffer_load_dwordx4 a[56:59], v240, s[28:31], s35 offen offset:2048 sc1
    ds_read_b64_tr_b16 v[140:141], v235 offset:12288
    ds_read_b64_tr_b16 v[142:143], v235 offset:13312
    s_waitcnt lgkmcnt(12)
    v_mfma_f32_32x32x16_bf16 v[176:191], v[52:55], v[148:151], v[176:191]
    ds_read_b64_tr_b16 v[144:145], v235 offset:16384
    ds_read_b64_tr_b16 v[146:147], v235 offset:17408
    s_waitcnt lgkmcnt(12)
    v_mfma_f32_32x32x16_bf16 v[176:191], v[56:59], v[152:155], v[176:191]
    ds_read_b64_tr_b16 v[148:149], v235 offset:20480
    ds_read_b64_tr_b16 v[150:151], v235 offset:21504
    s_waitcnt lgkmcnt(12)
    v_mfma_f32_32x32x16_bf16 v[176:191], v[60:63], v[156:159], v[176:191]
    buffer_load_dwordx4 a[60:63], v240, s[28:31], s35 offen offset:3072 sc1
    ds_read_b64_tr_b16 v[152:153], v235 offset:24576
    ds_read_b64_tr_b16 v[154:155], v235 offset:25600
    s_waitcnt lgkmcnt(12)
    v_mfma_f32_32x32x16_bf16 v[176:191], v[64:67], v[128:131], v[176:191]
    ds_read_b64_tr_b16 v[156:157], v235 offset:28672
    ds_read_b64_tr_b16 v[158:159], v235 offset:29696
    s_waitcnt lgkmcnt(12)
    v_mfma_f32_32x32x16_bf16 v[176:191], v[68:71], v[132:135], v[176:191]
    ds_read_b64_tr_b16 v[128:129], v235 offset:32768
    ds_read_b64_tr_b16 v[130:131], v235 offset:33792
    s_waitcnt lgkmcnt(12)
    v_mfma_f32_32x32x16_bf16 v[176:191], v[72:75], v[136:139], v[176:191]
    buffer_load_dwordx4 a[64:67], v240, s[28:31], s36 offen offset:0 sc1
    ds_read_b64_tr_b16 v[132:133], v235 offset:36864
    ds_read_b64_tr_b16 v[134:135], v235 offset:37888
    s_waitcnt lgkmcnt(12)
    v_mfma_f32_32x32x16_bf16 v[176:191], v[76:79], v[140:143], v[176:191]
    ds_read_b64_tr_b16 v[136:137], v235 offset:40960
    ds_read_b64_tr_b16 v[138:139], v235 offset:41984
    s_waitcnt lgkmcnt(12)
    v_mfma_f32_32x32x16_bf16 v[176:191], v[80:83], v[144:147], v[176:191]
    ds_read_b64_tr_b16 v[140:141], v235 offset:45056
    ds_read_b64_tr_b16 v[142:143], v235 offset:46080
    s_waitcnt lgkmcnt(12)
    v_mfma_f32_32x32x16_bf16 v[176:191], v[84:87], v[148:151], v[176:191]
    buffer_load_dwordx4 a[68:71], v240, s[28:31], s36 offen offset:1024 sc1
    ds_read_b64_tr_b16 v[144:145], v235 offset:49152
    ds_read_b64_tr_b16 v[146:147], v235 offset:50176
    s_waitcnt lgkmcnt(12)
    v_mfma_f32_32x32x16_bf16 v[176:191], v[88:91], v[152:155], v[176:191]
    ds_read_b64_tr_b16 v[148:149], v235 offset:53248
    ds_read_b64_tr_b16 v[150:151], v235 offset:54272
    s_waitcnt lgkmcnt(12)
    v_mfma_f32_32x32x16_bf16 v[176:191], v[92:95], v[156:159], v[176:191]
    s_waitcnt vmcnt(6)
    ds_read_b64_tr_b16 a[160:161], v229 offset:0
    ds_read_b64_tr_b16 a[162:163], v229 offset:512
    ds_read_b64_tr_b16 v[152:153], v235 offset:57344
    ds_read_b64_tr_b16 v[154:155], v235 offset:58368
    s_waitcnt lgkmcnt(14)
    v_mfma_f32_32x32x16_bf16 v[176:191], v[96:99], v[128:131], v[176:191]
    buffer_load_dwordx4 a[72:75], v240, s[28:31], s36 offen offset:2048 sc1
    ds_read_b64_tr_b16 a[164:165], v229 offset:1024
    ds_read_b64_tr_b16 a[166:167], v229 offset:1536
    ds_read_b64_tr_b16 v[156:157], v235 offset:61440
    ds_read_b64_tr_b16 v[158:159], v235 offset:62464
    s_waitcnt lgkmcnt(15)
    v_mfma_f32_32x32x16_bf16 v[176:191], v[100:103], v[132:135], v[176:191]
    ds_read_b64_tr_b16 a[168:169], v229 offset:2048
    ds_read_b64_tr_b16 a[170:171], v229 offset:2560
    ds_read_b64_tr_b16 v[128:129], v236 offset:0
    ds_read_b64_tr_b16 v[130:131], v236 offset:1024
    s_waitcnt lgkmcnt(15)
    v_mfma_f32_32x32x16_bf16 v[176:191], v[104:107], v[136:139], v[176:191]
    ds_read_b64_tr_b16 a[172:173], v229 offset:3072
    ds_read_b64_tr_b16 a[174:175], v229 offset:3584
    ds_read_b64_tr_b16 v[132:133], v236 offset:4096
    ds_read_b64_tr_b16 v[134:135], v236 offset:5120
    v_mfma_f32_32x32x16_bf16 v[176:191], v[108:111], v[140:143], v[176:191]
    buffer_load_dwordx4 a[76:79], v240, s[28:31], s36 offen offset:3072 sc1
    ds_read_b64_tr_b16 a[176:177], v229 offset:4096
    ds_read_b64_tr_b16 a[178:179], v229 offset:4608
    ds_read_b64_tr_b16 v[136:137], v236 offset:8192
    ds_read_b64_tr_b16 v[138:139], v236 offset:9216
    s_waitcnt lgkmcnt(15)
    v_mfma_f32_32x32x16_bf16 v[176:191], v[112:115], v[144:147], v[176:191]
    ds_read_b64_tr_b16 a[180:181], v229 offset:5120
    ds_read_b64_tr_b16 a[182:183], v229 offset:5632
    ds_read_b64_tr_b16 v[140:141], v236 offset:12288
    ds_read_b64_tr_b16 v[142:143], v236 offset:13312
    v_mfma_f32_32x32x16_bf16 v[176:191], v[116:119], v[148:151], v[176:191]
    ds_read_b64_tr_b16 a[184:185], v229 offset:6144
    ds_read_b64_tr_b16 a[186:187], v229 offset:6656
    ds_read_b64_tr_b16 v[144:145], v236 offset:16384
    ds_read_b64_tr_b16 v[146:147], v236 offset:17408
    v_mfma_f32_32x32x16_bf16 v[176:191], v[120:123], v[152:155], v[176:191]
    buffer_load_dwordx4 a[80:83], v240, s[28:31], s37 offen offset:0 sc1
    ds_read_b64_tr_b16 a[188:189], v229 offset:7168
    ds_read_b64_tr_b16 a[190:191], v229 offset:7680
    ds_read_b64_tr_b16 v[148:149], v236 offset:20480
    ds_read_b64_tr_b16 v[150:151], v236 offset:21504
    s_waitcnt lgkmcnt(15)
    v_mfma_f32_32x32x16_bf16 v[176:191], v[124:127], v[156:159], v[176:191]
    ds_read_b64_tr_b16 v[152:153], v236 offset:24576
    ds_read_b64_tr_b16 v[154:155], v236 offset:25600
    v_mfma_f32_32x32x16_bf16 v[160:175], v[0:3], v[128:131], 0
    s_waitcnt lgkmcnt(4)
    s_add_u32 m0, s57, 0
    s_lshl_b32 s61, s82, 4
    s_add_u32 s61, s61, 0
    buffer_load_dwordx4 v228, s[72:75], s61 offen lds
    ds_read_b64_tr_b16 v[156:157], v236 offset:28672
    ds_read_b64_tr_b16 v[158:159], v236 offset:29696
    v_mfma_f32_32x32x16_bf16 v[160:175], v[4:7], v[132:135], v[160:175]
    buffer_load_dwordx4 a[84:87], v240, s[28:31], s37 offen offset:1024 sc1
    s_add_u32 m0, s57, 1024
    s_lshl_b32 s61, s82, 4
    s_add_u32 s61, s61, 16384
    buffer_load_dwordx4 v228, s[72:75], s61 offen lds
    ds_read_b64_tr_b16 v[128:129], v236 offset:32768
    ds_read_b64_tr_b16 v[130:131], v236 offset:33792
    v_mfma_f32_32x32x16_bf16 v[160:175], v[8:11], v[136:139], v[160:175]
    s_add_u32 m0, s57, 2048
    s_lshl_b32 s61, s82, 4
    s_add_u32 s61, s61, 32768
    buffer_load_dwordx4 v228, s[72:75], s61 offen lds
    ds_read_b64_tr_b16 v[132:133], v236 offset:36864
    ds_read_b64_tr_b16 v[134:135], v236 offset:37888
    v_mfma_f32_32x32x16_bf16 v[160:175], v[12:15], v[140:143], v[160:175]
    v_cvt_pk_bf16_f32 v200, v176, v177
    v_cvt_pk_bf16_f32 v201, v178, v179
    s_add_u32 m0, s57, 3072
    s_lshl_b32 s61, s82, 4
    s_add_u32 s61, s61, 49152
    buffer_load_dwordx4 v228, s[72:75], s61 offen lds
    ds_read_b64_tr_b16 v[136:137], v236 offset:40960
    ds_read_b64_tr_b16 v[138:139], v236 offset:41984
    v_mfma_f32_32x32x16_bf16 v[160:175], v[16:19], v[144:147], v[160:175]
    buffer_load_dwordx4 a[88:91], v240, s[28:31], s37 offen offset:2048 sc1
    v_cvt_pk_bf16_f32 v202, v180, v181
    v_cvt_pk_bf16_f32 v203, v182, v183
    s_add_u32 m0, s57, 4096
    s_lshl_b32 s61, s82, 4
    s_add_u32 s61, s61, 65536
    buffer_load_dwordx4 v228, s[72:75], s61 offen lds
    ds_read_b64_tr_b16 v[140:141], v236 offset:45056
    ds_read_b64_tr_b16 v[142:143], v236 offset:46080
    s_waitcnt lgkmcnt(12)
    v_mfma_f32_32x32x16_bf16 v[160:175], v[20:23], v[148:151], v[160:175]
    v_cvt_pk_bf16_f32 v204, v184, v185
    v_cvt_pk_bf16_f32 v205, v186, v187
    s_add_u32 m0, s57, 5120
    s_lshl_b32 s61, s82, 4
    s_add_u32 s61, s61, 81920
    buffer_load_dwordx4 v228, s[72:75], s61 offen lds
    ds_read_b64_tr_b16 v[144:145], v236 offset:49152
    ds_read_b64_tr_b16 v[146:147], v236 offset:50176
    s_waitcnt lgkmcnt(12)
    v_mfma_f32_32x32x16_bf16 v[160:175], v[24:27], v[152:155], v[160:175]
    v_cvt_pk_bf16_f32 v206, v188, v189
    v_cvt_pk_bf16_f32 v207, v190, v191
    buffer_store_dwordx4 v[200:203], v243, s[52:55], s33 offen offset:0 sc1
    s_add_u32 m0, s57, 6144
    s_lshl_b32 s61, s82, 4
    s_add_u32 s61, s61, 98304
    buffer_load_dwordx4 v228, s[72:75], s61 offen lds
    ds_read_b64_tr_b16 v[148:149], v236 offset:53248
    ds_read_b64_tr_b16 v[150:151], v236 offset:54272
    s_waitcnt lgkmcnt(12)
    v_mfma_f32_32x32x16_bf16 v[160:175], v[28:31], v[156:159], v[160:175]
    buffer_load_dwordx4 a[92:95], v240, s[28:31], s37 offen offset:3072 sc1
    s_add_u32 m0, s57, 7168
    s_lshl_b32 s61, s82, 4
    s_add_u32 s61, s61, 114688
    buffer_load_dwordx4 v228, s[72:75], s61 offen lds
    ds_read_b64_tr_b16 v[152:153], v236 offset:57344
    ds_read_b64_tr_b16 v[154:155], v236 offset:58368
    s_waitcnt lgkmcnt(12)
    v_mfma_f32_32x32x16_bf16 v[160:175], v[32:35], v[128:131], v[160:175]
    ds_read_b64_tr_b16 v[156:157], v236 offset:61440
    ds_read_b64_tr_b16 v[158:159], v236 offset:62464
    s_waitcnt lgkmcnt(12)
    v_mfma_f32_32x32x16_bf16 v[160:175], v[36:39], v[132:135], v[160:175]
    buffer_store_dwordx4 v[204:207], v243, s[52:55], s33 offen offset:512 sc1
    ds_read_b64_tr_b16 v[128:129], v237 offset:0
    ds_read_b64_tr_b16 v[130:131], v237 offset:1024
    s_waitcnt lgkmcnt(12)
    v_mfma_f32_32x32x16_bf16 v[160:175], v[40:43], v[136:139], v[160:175]
    buffer_load_dwordx4 a[96:99], v240, s[28:31], s38 offen offset:0 sc1
    ds_read_b64_tr_b16 v[132:133], v237 offset:4096
    ds_read_b64_tr_b16 v[134:135], v237 offset:5120
    s_waitcnt lgkmcnt(12)
    v_mfma_f32_32x32x16_bf16 v[160:175], v[44:47], v[140:143], v[160:175]
    ds_read_b64_tr_b16 v[136:137], v237 offset:8192
    ds_read_b64_tr_b16 v[138:139], v237 offset:9216
    s_waitcnt lgkmcnt(12)
    v_mfma_f32_32x32x16_bf16 v[160:175], v[48:51], v[144:147], v[160:175]
    ds_read_b64_tr_b16 v[140:141], v237 offset:12288
    ds_read_b64_tr_b16 v[142:143], v237 offset:13312
    s_waitcnt lgkmcnt(12)
    v_mfma_f32_32x32x16_bf16 v[160:175], v[52:55], v[148:151], v[160:175]
    buffer_load_dwordx4 a[100:103], v240, s[28:31], s38 offen offset:1024 sc1
    ds_read_b64_tr_b16 v[144:145], v237 offset:16384
    ds_read_b64_tr_b16 v[146:147], v237 offset:17408
    s_waitcnt lgkmcnt(12)
    v_mfma_f32_32x32x16_bf16 v[160:175], v[56:59], v[152:155], v[160:175]
    ds_read_b64_tr_b16 v[148:149], v237 offset:20480
    ds_read_b64_tr_b16 v[150:151], v237 offset:21504
    s_waitcnt lgkmcnt(12)
    v_mfma_f32_32x32x16_bf16 v[160:175], v[60:63], v[156:159], v[160:175]
    ds_read_b64_tr_b16 v[152:153], v237 offset:24576
    ds_read_b64_tr_b16 v[154:155], v237 offset:25600
    s_waitcnt lgkmcnt(12)
    v_mfma_f32_32x32x16_bf16 v[160:175], v[64:67], v[128:131], v[160:175]
    buffer_load_dwordx4 a[104:107], v240, s[28:31], s38 offen offset:2048 sc1
    ds_read_b64_tr_b16 v[156:157], v237 offset:28672
    ds_read_b64_tr_b16 v[158:159], v237 offset:29696
    s_waitcnt lgkmcnt(12)
    v_mfma_f32_32x32x16_bf16 v[160:175], v[68:71], v[132:135], v[160:175]
    ds_read_b64_tr_b16 v[128:129], v237 offset:32768
    ds_read_b64_tr_b16 v[130:131], v237 offset:33792
    s_waitcnt lgkmcnt(12)
    v_mfma_f32_32x32x16_bf16 v[160:175], v[72:75], v[136:139], v[160:175]
    ds_read_b64_tr_b16 v[132:133], v237 offset:36864
    ds_read_b64_tr_b16 v[134:135], v237 offset:37888
    s_waitcnt lgkmcnt(12)
    v_mfma_f32_32x32x16_bf16 v[160:175], v[76:79], v[140:143], v[160:175]
    buffer_load_dwordx4 a[108:111], v240, s[28:31], s38 offen offset:3072 sc1
    ds_read_b64_tr_b16 v[136:137], v237 offset:40960
    ds_read_b64_tr_b16 v[138:139], v237 offset:41984
    s_waitcnt lgkmcnt(12)
    v_mfma_f32_32x32x16_bf16 v[160:175], v[80:83], v[144:147], v[160:175]
    ds_read_b64_tr_b16 v[140:141], v237 offset:45056
    ds_read_b64_tr_b16 v[142:143], v237 offset:46080
    s_waitcnt lgkmcnt(12)
    v_mfma_f32_32x32x16_bf16 v[160:175], v[84:87], v[148:151], v[160:175]
    ds_read_b64_tr_b16 v[144:145], v237 offset:49152
    ds_read_b64_tr_b16 v[146:147], v237 offset:50176
    s_waitcnt lgkmcnt(12)
    v_mfma_f32_32x32x16_bf16 v[160:175], v[88:91], v[152:155], v[160:175]
    buffer_load_dwordx4 a[112:115], v240, s[28:31], s39 offen offset:0 sc1
    ds_read_b64_tr_b16 v[148:149], v237 offset:53248
    ds_read_b64_tr_b16 v[150:151], v237 offset:54272
    s_waitcnt lgkmcnt(12)
    v_mfma_f32_32x32x16_bf16 v[160:175], v[92:95], v[156:159], v[160:175]
    s_waitcnt vmcnt(6)
    ds_read_b64_tr_b16 a[192:193], v229 offset:0
    ds_read_b64_tr_b16 a[194:195], v229 offset:512
    ds_read_b64_tr_b16 v[152:153], v237 offset:57344
    ds_read_b64_tr_b16 v[154:155], v237 offset:58368
    s_waitcnt lgkmcnt(14)
    v_mfma_f32_32x32x16_bf16 v[160:175], v[96:99], v[128:131], v[160:175]
    ds_read_b64_tr_b16 a[196:197], v229 offset:1024
    ds_read_b64_tr_b16 a[198:199], v229 offset:1536
    ds_read_b64_tr_b16 v[156:157], v237 offset:61440
    ds_read_b64_tr_b16 v[158:159], v237 offset:62464
    s_waitcnt lgkmcnt(15)
    v_mfma_f32_32x32x16_bf16 v[160:175], v[100:103], v[132:135], v[160:175]
    buffer_load_dwordx4 a[116:119], v240, s[28:31], s39 offen offset:1024 sc1
    ds_read_b64_tr_b16 a[200:201], v229 offset:2048
    ds_read_b64_tr_b16 a[202:203], v229 offset:2560
    ds_read_b64_tr_b16 v[128:129], v238 offset:0
    ds_read_b64_tr_b16 v[130:131], v238 offset:1024
    s_waitcnt lgkmcnt(15)
    v_mfma_f32_32x32x16_bf16 v[160:175], v[104:107], v[136:139], v[160:175]
    ds_read_b64_tr_b16 a[204:205], v229 offset:3072
    ds_read_b64_tr_b16 a[206:207], v229 offset:3584
    ds_read_b64_tr_b16 v[132:133], v238 offset:4096
    ds_read_b64_tr_b16 v[134:135], v238 offset:5120
    v_mfma_f32_32x32x16_bf16 v[160:175], v[108:111], v[140:143], v[160:175]
    ds_read_b64_tr_b16 a[208:209], v229 offset:4096
    ds_read_b64_tr_b16 a[210:211], v229 offset:4608
    ds_read_b64_tr_b16 v[136:137], v238 offset:8192
    ds_read_b64_tr_b16 v[138:139], v238 offset:9216
    s_waitcnt lgkmcnt(15)
    v_mfma_f32_32x32x16_bf16 v[160:175], v[112:115], v[144:147], v[160:175]
    buffer_load_dwordx4 a[120:123], v240, s[28:31], s39 offen offset:2048 sc1
    ds_read_b64_tr_b16 a[212:213], v229 offset:5120
    ds_read_b64_tr_b16 a[214:215], v229 offset:5632
    ds_read_b64_tr_b16 v[140:141], v238 offset:12288
    ds_read_b64_tr_b16 v[142:143], v238 offset:13312
    v_mfma_f32_32x32x16_bf16 v[160:175], v[116:119], v[148:151], v[160:175]
    ds_read_b64_tr_b16 a[216:217], v229 offset:6144
    ds_read_b64_tr_b16 a[218:219], v229 offset:6656
    ds_read_b64_tr_b16 v[144:145], v238 offset:16384
    ds_read_b64_tr_b16 v[146:147], v238 offset:17408
    v_mfma_f32_32x32x16_bf16 v[160:175], v[120:123], v[152:155], v[160:175]
    ds_read_b64_tr_b16 a[220:221], v229 offset:7168
    ds_read_b64_tr_b16 a[222:223], v229 offset:7680
    ds_read_b64_tr_b16 v[148:149], v238 offset:20480
    ds_read_b64_tr_b16 v[150:151], v238 offset:21504
    s_waitcnt lgkmcnt(15)
    v_mfma_f32_32x32x16_bf16 v[160:175], v[124:127], v[156:159], v[160:175]
    buffer_load_dwordx4 a[124:127], v240, s[28:31], s39 offen offset:3072 sc1
    ds_read_b64_tr_b16 v[152:153], v238 offset:24576
    ds_read_b64_tr_b16 v[154:155], v238 offset:25600
    v_mfma_f32_32x32x16_bf16 v[176:191], v[0:3], v[128:131], 0
    s_waitcnt lgkmcnt(4)
    s_add_u32 m0, s57, 0
    s_lshl_b32 s61, s83, 4
    s_add_u32 s61, s61, 0
    buffer_load_dwordx4 v228, s[72:75], s61 offen lds
    ds_read_b64_tr_b16 v[156:157], v238 offset:28672
    ds_read_b64_tr_b16 v[158:159], v238 offset:29696
    v_mfma_f32_32x32x16_bf16 v[176:191], v[4:7], v[132:135], v[176:191]
    s_add_u32 m0, s57, 1024
    s_lshl_b32 s61, s83, 4
    s_add_u32 s61, s61, 16384
    buffer_load_dwordx4 v228, s[72:75], s61 offen lds
    ds_read_b64_tr_b16 v[128:129], v238 offset:32768
    ds_read_b64_tr_b16 v[130:131], v238 offset:33792
    v_mfma_f32_32x32x16_bf16 v[176:191], v[8:11], v[136:139], v[176:191]
    s_add_u32 m0, s57, 2048
    s_lshl_b32 s61, s83, 4
    s_add_u32 s61, s61, 32768
    buffer_load_dwordx4 v228, s[72:75], s61 offen lds
    ds_read_b64_tr_b16 v[132:133], v238 offset:36864
    ds_read_b64_tr_b16 v[134:135], v238 offset:37888
    v_mfma_f32_32x32x16_bf16 v[176:191], v[12:15], v[140:143], v[176:191]
    v_cvt_pk_bf16_f32 v192, v160, v161
    v_cvt_pk_bf16_f32 v193, v162, v163
    s_add_u32 m0, s57, 3072
    s_lshl_b32 s61, s83, 4
    s_add_u32 s61, s61, 49152
    buffer_load_dwordx4 v228, s[72:75], s61 offen lds
    ds_read_b64_tr_b16 v[136:137], v238 offset:40960
    ds_read_b64_tr_b16 v[138:139], v238 offset:41984
    v_mfma_f32_32x32x16_bf16 v[176:191], v[16:19], v[144:147], v[176:191]
    v_cvt_pk_bf16_f32 v194, v164, v165
    v_cvt_pk_bf16_f32 v195, v166, v167
    s_add_u32 m0, s57, 4096
    s_lshl_b32 s61, s83, 4
    s_add_u32 s61, s61, 65536
    buffer_load_dwordx4 v228, s[72:75], s61 offen lds
    ds_read_b64_tr_b16 v[140:141], v238 offset:45056
    ds_read_b64_tr_b16 v[142:143], v238 offset:46080
    s_waitcnt lgkmcnt(12)
    v_mfma_f32_32x32x16_bf16 v[176:191], v[20:23], v[148:151], v[176:191]
    v_cvt_pk_bf16_f32 v196, v168, v169
    v_cvt_pk_bf16_f32 v197, v170, v171
    s_add_u32 m0, s57, 5120
    s_lshl_b32 s61, s83, 4
    s_add_u32 s61, s61, 81920
    buffer_load_dwordx4 v228, s[72:75], s61 offen lds
    ds_read_b64_tr_b16 v[144:145], v238 offset:49152
    ds_read_b64_tr_b16 v[146:147], v238 offset:50176
    s_waitcnt lgkmcnt(12)
    v_mfma_f32_32x32x16_bf16 v[176:191], v[24:27], v[152:155], v[176:191]
    v_cvt_pk_bf16_f32 v198, v172, v173
    v_cvt_pk_bf16_f32 v199, v174, v175
    buffer_store_dwordx4 v[192:195], v243, s[52:55], s34 offen offset:0 sc1
    s_add_u32 m0, s57, 6144
    s_lshl_b32 s61, s83, 4
    s_add_u32 s61, s61, 98304
    buffer_load_dwordx4 v228, s[72:75], s61 offen lds
    ds_read_b64_tr_b16 v[148:149], v238 offset:53248
    ds_read_b64_tr_b16 v[150:151], v238 offset:54272
    s_waitcnt lgkmcnt(12)
    v_mfma_f32_32x32x16_bf16 v[176:191], v[28:31], v[156:159], v[176:191]
    s_add_u32 m0, s57, 7168
    s_lshl_b32 s61, s83, 4
    s_add_u32 s61, s61, 114688
    buffer_load_dwordx4 v228, s[72:75], s61 offen lds
    ds_read_b64_tr_b16 v[152:153], v238 offset:57344
    ds_read_b64_tr_b16 v[154:155], v238 offset:58368
    s_waitcnt lgkmcnt(12)
    v_mfma_f32_32x32x16_bf16 v[176:191], v[32:35], v[128:131], v[176:191]
    ds_read_b64_tr_b16 v[156:157], v238 offset:61440
    ds_read_b64_tr_b16 v[158:159], v238 offset:62464
    s_waitcnt lgkmcnt(12)
    v_mfma_f32_32x32x16_bf16 v[176:191], v[36:39], v[132:135], v[176:191]
    buffer_store_dwordx4 v[196:199], v243, s[52:55], s34 offen offset:512 sc1
    ds_read_b64_tr_b16 v[128:129], v239 offset:0
    ds_read_b64_tr_b16 v[130:131], v239 offset:1024
    s_waitcnt lgkmcnt(12)
    v_mfma_f32_32x32x16_bf16 v[176:191], v[40:43], v[136:139], v[176:191]
    ds_read_b64_tr_b16 v[132:133], v239 offset:4096
    ds_read_b64_tr_b16 v[134:135], v239 offset:5120
    s_waitcnt lgkmcnt(12)
    v_mfma_f32_32x32x16_bf16 v[176:191], v[44:47], v[140:143], v[176:191]
    ds_read_b64_tr_b16 v[136:137], v239 offset:8192
    ds_read_b64_tr_b16 v[138:139], v239 offset:9216
    s_waitcnt lgkmcnt(12)
    v_mfma_f32_32x32x16_bf16 v[176:191], v[48:51], v[144:147], v[176:191]
    ds_read_b64_tr_b16 v[140:141], v239 offset:12288
    ds_read_b64_tr_b16 v[142:143], v239 offset:13312
    s_waitcnt lgkmcnt(12)
    v_mfma_f32_32x32x16_bf16 v[176:191], v[52:55], v[148:151], v[176:191]
    ds_read_b64_tr_b16 v[144:145], v239 offset:16384
    ds_read_b64_tr_b16 v[146:147], v239 offset:17408
    s_waitcnt lgkmcnt(12)
    v_mfma_f32_32x32x16_bf16 v[176:191], v[56:59], v[152:155], v[176:191]
    ds_read_b64_tr_b16 v[148:149], v239 offset:20480
    ds_read_b64_tr_b16 v[150:151], v239 offset:21504
    s_waitcnt lgkmcnt(12)
    v_mfma_f32_32x32x16_bf16 v[176:191], v[60:63], v[156:159], v[176:191]
    ds_read_b64_tr_b16 v[152:153], v239 offset:24576
    ds_read_b64_tr_b16 v[154:155], v239 offset:25600
    s_waitcnt lgkmcnt(12)
    v_mfma_f32_32x32x16_bf16 v[176:191], v[64:67], v[128:131], v[176:191]
    ds_read_b64_tr_b16 v[156:157], v239 offset:28672
    ds_read_b64_tr_b16 v[158:159], v239 offset:29696
    s_waitcnt lgkmcnt(12)
    v_mfma_f32_32x32x16_bf16 v[176:191], v[68:71], v[132:135], v[176:191]
    ds_read_b64_tr_b16 v[128:129], v239 offset:32768
    ds_read_b64_tr_b16 v[130:131], v239 offset:33792
    s_waitcnt lgkmcnt(12)
    v_mfma_f32_32x32x16_bf16 v[176:191], v[72:75], v[136:139], v[176:191]
    ds_read_b64_tr_b16 v[132:133], v239 offset:36864
    ds_read_b64_tr_b16 v[134:135], v239 offset:37888
    s_waitcnt lgkmcnt(12)
    v_mfma_f32_32x32x16_bf16 v[176:191], v[76:79], v[140:143], v[176:191]
    ds_read_b64_tr_b16 v[136:137], v239 offset:40960
    ds_read_b64_tr_b16 v[138:139], v239 offset:41984
    s_waitcnt lgkmcnt(12)
    v_mfma_f32_32x32x16_bf16 v[176:191], v[80:83], v[144:147], v[176:191]
    ds_read_b64_tr_b16 v[140:141], v239 offset:45056
    ds_read_b64_tr_b16 v[142:143], v239 offset:46080
    s_waitcnt lgkmcnt(12)
    v_mfma_f32_32x32x16_bf16 v[176:191], v[84:87], v[148:151], v[176:191]
    ds_read_b64_tr_b16 v[144:145], v239 offset:49152
    ds_read_b64_tr_b16 v[146:147], v239 offset:50176
    s_waitcnt lgkmcnt(12)
    v_mfma_f32_32x32x16_bf16 v[176:191], v[88:91], v[152:155], v[176:191]
    ds_read_b64_tr_b16 v[148:149], v239 offset:53248
    ds_read_b64_tr_b16 v[150:151], v239 offset:54272
    s_waitcnt lgkmcnt(12)
    v_mfma_f32_32x32x16_bf16 v[176:191], v[92:95], v[156:159], v[176:191]
    s_waitcnt vmcnt(1)
    ds_read_b64_tr_b16 a[224:225], v229 offset:0
    ds_read_b64_tr_b16 a[226:227], v229 offset:512
    ds_read_b64_tr_b16 v[152:153], v239 offset:57344
    ds_read_b64_tr_b16 v[154:155], v239 offset:58368
    s_waitcnt lgkmcnt(14)
    v_mfma_f32_32x32x16_bf16 v[176:191], v[96:99], v[128:131], v[176:191]
    ds_read_b64_tr_b16 a[228:229], v229 offset:1024
    ds_read_b64_tr_b16 a[230:231], v229 offset:1536
    ds_read_b64_tr_b16 v[156:157], v239 offset:61440
    ds_read_b64_tr_b16 v[158:159], v239 offset:62464
    s_waitcnt lgkmcnt(15)
    v_mfma_f32_32x32x16_bf16 v[176:191], v[100:103], v[132:135], v[176:191]
    ds_read_b64_tr_b16 a[232:233], v229 offset:2048
    ds_read_b64_tr_b16 a[234:235], v229 offset:2560
    ds_read_b64_tr_b16 v[128:129], v232 offset:0
    ds_read_b64_tr_b16 v[130:131], v232 offset:1024
    s_waitcnt lgkmcnt(15)
    v_mfma_f32_32x32x16_bf16 v[176:191], v[104:107], v[136:139], v[176:191]
    ds_read_b64_tr_b16 a[236:237], v229 offset:3072
    ds_read_b64_tr_b16 a[238:239], v229 offset:3584
    ds_read_b64_tr_b16 v[132:133], v232 offset:4096
    ds_read_b64_tr_b16 v[134:135], v232 offset:5120
    v_mfma_f32_32x32x16_bf16 v[176:191], v[108:111], v[140:143], v[176:191]
    ds_read_b64_tr_b16 a[240:241], v229 offset:4096
    ds_read_b64_tr_b16 a[242:243], v229 offset:4608
    ds_read_b64_tr_b16 v[136:137], v232 offset:8192
    ds_read_b64_tr_b16 v[138:139], v232 offset:9216
    s_waitcnt lgkmcnt(15)
    v_mfma_f32_32x32x16_bf16 v[176:191], v[112:115], v[144:147], v[176:191]
    ds_read_b64_tr_b16 a[244:245], v229 offset:5120
    ds_read_b64_tr_b16 a[246:247], v229 offset:5632
    ds_read_b64_tr_b16 v[140:141], v232 offset:12288
    ds_read_b64_tr_b16 v[142:143], v232 offset:13312
    v_mfma_f32_32x32x16_bf16 v[176:191], v[116:119], v[148:151], v[176:191]
    ds_read_b64_tr_b16 a[248:249], v229 offset:6144
    ds_read_b64_tr_b16 a[250:251], v229 offset:6656
    ds_read_b64_tr_b16 v[144:145], v232 offset:16384
    ds_read_b64_tr_b16 v[146:147], v232 offset:17408
    v_mfma_f32_32x32x16_bf16 v[176:191], v[120:123], v[152:155], v[176:191]
    ds_read_b64_tr_b16 a[252:253], v229 offset:7168
    ds_read_b64_tr_b16 a[254:255], v229 offset:7680
    ds_read_b64_tr_b16 v[148:149], v232 offset:20480
    ds_read_b64_tr_b16 v[150:151], v232 offset:21504
    s_waitcnt lgkmcnt(15)
    v_mfma_f32_32x32x16_bf16 v[176:191], v[124:127], v[156:159], v[176:191]
    s_add_u32 s28, s28, 131072
    s_addc_u32 s29, s29, 0
    s_add_u32 s26, s26, 1
    ds_read_b64_tr_b16 v[152:153], v232 offset:24576
    ds_read_b64_tr_b16 v[154:155], v232 offset:25600
    v_mfma_f32_32x32x16_bf16 v[160:175], a[0:3], v[128:131], 0
    s_waitcnt lgkmcnt(4)
    s_add_u32 m0, s57, 0
    s_lshl_b32 s61, s84, 4
    s_add_u32 s61, s61, 0
    buffer_load_dwordx4 v228, s[72:75], s61 offen lds
    ds_read_b64_tr_b16 v[156:157], v232 offset:28672
    ds_read_b64_tr_b16 v[158:159], v232 offset:29696
    v_mfma_f32_32x32x16_bf16 v[160:175], a[4:7], v[132:135], v[160:175]
    s_add_u32 m0, s57, 1024
    s_lshl_b32 s61, s84, 4
    s_add_u32 s61, s61, 16384
    buffer_load_dwordx4 v228, s[72:75], s61 offen lds
    ds_read_b64_tr_b16 v[128:129], v232 offset:32768
    ds_read_b64_tr_b16 v[130:131], v232 offset:33792
    v_mfma_f32_32x32x16_bf16 v[160:175], a[8:11], v[136:139], v[160:175]
    s_add_u32 m0, s57, 2048
    s_lshl_b32 s61, s84, 4
    s_add_u32 s61, s61, 32768
    buffer_load_dwordx4 v228, s[72:75], s61 offen lds
    ds_read_b64_tr_b16 v[132:133], v232 offset:36864
    ds_read_b64_tr_b16 v[134:135], v232 offset:37888
    v_mfma_f32_32x32x16_bf16 v[160:175], a[12:15], v[140:143], v[160:175]
    v_cvt_pk_bf16_f32 v200, v176, v177
    v_cvt_pk_bf16_f32 v201, v178, v179
    s_add_u32 m0, s57, 3072
    s_lshl_b32 s61, s84, 4
    s_add_u32 s61, s61, 49152
    buffer_load_dwordx4 v228, s[72:75], s61 offen lds
    ds_read_b64_tr_b16 v[136:137], v232 offset:40960
    ds_read_b64_tr_b16 v[138:139], v232 offset:41984
    v_mfma_f32_32x32x16_bf16 v[160:175], a[16:19], v[144:147], v[160:175]
    v_cvt_pk_bf16_f32 v202, v180, v181
    v_cvt_pk_bf16_f32 v203, v182, v183
    s_add_u32 m0, s57, 4096
    s_lshl_b32 s61, s84, 4
    s_add_u32 s61, s61, 65536
    buffer_load_dwordx4 v228, s[72:75], s61 offen lds
    ds_read_b64_tr_b16 v[140:141], v232 offset:45056
    ds_read_b64_tr_b16 v[142:143], v232 offset:46080
    s_waitcnt lgkmcnt(12)
    v_mfma_f32_32x32x16_bf16 v[160:175], a[20:23], v[148:151], v[160:175]
    v_cvt_pk_bf16_f32 v204, v184, v185
    v_cvt_pk_bf16_f32 v205, v186, v187
    s_add_u32 m0, s57, 5120
    s_lshl_b32 s61, s84, 4
    s_add_u32 s61, s61, 81920
    buffer_load_dwordx4 v228, s[72:75], s61 offen lds
    ds_read_b64_tr_b16 v[144:145], v232 offset:49152
    ds_read_b64_tr_b16 v[146:147], v232 offset:50176
    s_waitcnt lgkmcnt(12)
    v_mfma_f32_32x32x16_bf16 v[160:175], a[24:27], v[152:155], v[160:175]
    v_cvt_pk_bf16_f32 v206, v188, v189
    v_cvt_pk_bf16_f32 v207, v190, v191
    buffer_store_dwordx4 v[200:203], v243, s[52:55], s35 offen offset:0 sc1
    s_add_u32 m0, s57, 6144
    s_lshl_b32 s61, s84, 4
    s_add_u32 s61, s61, 98304
    buffer_load_dwordx4 v228, s[72:75], s61 offen lds
    ds_read_b64_tr_b16 v[148:149], v232 offset:53248
    ds_read_b64_tr_b16 v[150:151], v232 offset:54272
    s_waitcnt lgkmcnt(12)
    v_mfma_f32_32x32x16_bf16 v[160:175], a[28:31], v[156:159], v[160:175]
    s_add_u32 m0, s57, 7168
    s_lshl_b32 s61, s84, 4
    s_add_u32 s61, s61, 114688
    buffer_load_dwordx4 v228, s[72:75], s61 offen lds
    ds_read_b64_tr_b16 v[152:153], v232 offset:57344
    ds_read_b64_tr_b16 v[154:155], v232 offset:58368
    s_waitcnt lgkmcnt(12)
    v_mfma_f32_32x32x16_bf16 v[160:175], a[32:35], v[128:131], v[160:175]
    ds_read_b64_tr_b16 v[156:157], v232 offset:61440
    ds_read_b64_tr_b16 v[158:159], v232 offset:62464
    s_waitcnt lgkmcnt(12)
    v_mfma_f32_32x32x16_bf16 v[160:175], a[36:39], v[132:135], v[160:175]
    buffer_store_dwordx4 v[204:207], v243, s[52:55], s35 offen offset:512 sc1
    s_add_u32 s52, s52, 2097152
    s_addc_u32 s53, s53, 0
    ds_read_b64_tr_b16 v[128:129], v233 offset:0
    ds_read_b64_tr_b16 v[130:131], v233 offset:1024
    s_waitcnt lgkmcnt(12)
    v_mfma_f32_32x32x16_bf16 v[160:175], a[40:43], v[136:139], v[160:175]
    ds_read_b64_tr_b16 v[132:133], v233 offset:4096
    ds_read_b64_tr_b16 v[134:135], v233 offset:5120
    s_waitcnt lgkmcnt(12)
    v_mfma_f32_32x32x16_bf16 v[160:175], a[44:47], v[140:143], v[160:175]
    ds_read_b64_tr_b16 v[136:137], v233 offset:8192
    ds_read_b64_tr_b16 v[138:139], v233 offset:9216
    s_waitcnt lgkmcnt(12)
    v_mfma_f32_32x32x16_bf16 v[160:175], a[48:51], v[144:147], v[160:175]
    ds_read_b64_tr_b16 v[140:141], v233 offset:12288
    ds_read_b64_tr_b16 v[142:143], v233 offset:13312
    s_waitcnt lgkmcnt(12)
    v_mfma_f32_32x32x16_bf16 v[160:175], a[52:55], v[148:151], v[160:175]
    ds_read_b64_tr_b16 v[144:145], v233 offset:16384
    ds_read_b64_tr_b16 v[146:147], v233 offset:17408
    s_waitcnt lgkmcnt(12)
    v_mfma_f32_32x32x16_bf16 v[160:175], a[56:59], v[152:155], v[160:175]
    ds_read_b64_tr_b16 v[148:149], v233 offset:20480
    ds_read_b64_tr_b16 v[150:151], v233 offset:21504
    s_waitcnt lgkmcnt(12)
    v_mfma_f32_32x32x16_bf16 v[160:175], a[60:63], v[156:159], v[160:175]
    ds_read_b64_tr_b16 v[152:153], v233 offset:24576
    ds_read_b64_tr_b16 v[154:155], v233 offset:25600
    s_waitcnt lgkmcnt(12)
    v_mfma_f32_32x32x16_bf16 v[160:175], a[64:67], v[128:131], v[160:175]
    ds_read_b64_tr_b16 v[156:157], v233 offset:28672
    ds_read_b64_tr_b16 v[158:159], v233 offset:29696
    s_waitcnt lgkmcnt(12)
    v_mfma_f32_32x32x16_bf16 v[160:175], a[68:71], v[132:135], v[160:175]
    ds_read_b64_tr_b16 v[128:129], v233 offset:32768
    ds_read_b64_tr_b16 v[130:131], v233 offset:33792
    s_waitcnt lgkmcnt(12)
    v_mfma_f32_32x32x16_bf16 v[160:175], a[72:75], v[136:139], v[160:175]
    ds_read_b64_tr_b16 v[132:133], v233 offset:36864
    ds_read_b64_tr_b16 v[134:135], v233 offset:37888
    s_waitcnt lgkmcnt(12)
    v_mfma_f32_32x32x16_bf16 v[160:175], a[76:79], v[140:143], v[160:175]
    ds_read_b64_tr_b16 v[136:137], v233 offset:40960
    ds_read_b64_tr_b16 v[138:139], v233 offset:41984
    s_waitcnt lgkmcnt(12)
    v_mfma_f32_32x32x16_bf16 v[160:175], a[80:83], v[144:147], v[160:175]
    ds_read_b64_tr_b16 v[140:141], v233 offset:45056
    ds_read_b64_tr_b16 v[142:143], v233 offset:46080
    s_waitcnt lgkmcnt(12)
    v_mfma_f32_32x32x16_bf16 v[160:175], a[84:87], v[148:151], v[160:175]
    ds_read_b64_tr_b16 v[144:145], v233 offset:49152
    ds_read_b64_tr_b16 v[146:147], v233 offset:50176
    s_waitcnt lgkmcnt(12)
    v_mfma_f32_32x32x16_bf16 v[160:175], a[88:91], v[152:155], v[160:175]
    ds_read_b64_tr_b16 v[148:149], v233 offset:53248
    ds_read_b64_tr_b16 v[150:151], v233 offset:54272
    s_waitcnt lgkmcnt(12)
    v_mfma_f32_32x32x16_bf16 v[160:175], a[92:95], v[156:159], v[160:175]
    s_waitcnt vmcnt(1)
    ds_read_b64_tr_b16 v[0:1], v229 offset:0
    ds_read_b64_tr_b16 v[2:3], v229 offset:512
    ds_read_b64_tr_b16 v[152:153], v233 offset:57344
    ds_read_b64_tr_b16 v[154:155], v233 offset:58368
    s_waitcnt lgkmcnt(14)
    v_mfma_f32_32x32x16_bf16 v[160:175], a[96:99], v[128:131], v[160:175]
    ds_read_b64_tr_b16 v[4:5], v229 offset:1024
    ds_read_b64_tr_b16 v[6:7], v229 offset:1536
    ds_read_b64_tr_b16 v[156:157], v233 offset:61440
    ds_read_b64_tr_b16 v[158:159], v233 offset:62464
    s_waitcnt lgkmcnt(15)
    v_mfma_f32_32x32x16_bf16 v[160:175], a[100:103], v[132:135], v[160:175]
    ds_read_b64_tr_b16 v[8:9], v229 offset:2048
    ds_read_b64_tr_b16 v[10:11], v229 offset:2560
    ds_read_b64_tr_b16 v[128:129], v234 offset:0
    ds_read_b64_tr_b16 v[130:131], v234 offset:1024
    s_waitcnt lgkmcnt(15)
    v_mfma_f32_32x32x16_bf16 v[160:175], a[104:107], v[136:139], v[160:175]
    ds_read_b64_tr_b16 v[12:13], v229 offset:3072
    ds_read_b64_tr_b16 v[14:15], v229 offset:3584
    ds_read_b64_tr_b16 v[132:133], v234 offset:4096
    ds_read_b64_tr_b16 v[134:135], v234 offset:5120
    v_mfma_f32_32x32x16_bf16 v[160:175], a[108:111], v[140:143], v[160:175]
    ds_read_b64_tr_b16 v[16:17], v229 offset:4096
    ds_read_b64_tr_b16 v[18:19], v229 offset:4608
    ds_read_b64_tr_b16 v[136:137], v234 offset:8192
    ds_read_b64_tr_b16 v[138:139], v234 offset:9216
    s_waitcnt lgkmcnt(15)
    v_mfma_f32_32x32x16_bf16 v[160:175], a[112:115], v[144:147], v[160:175]
    ds_read_b64_tr_b16 v[20:21], v229 offset:5120
    ds_read_b64_tr_b16 v[22:23], v229 offset:5632
    ds_read_b64_tr_b16 v[140:141], v234 offset:12288
    ds_read_b64_tr_b16 v[142:143], v234 offset:13312
    v_mfma_f32_32x32x16_bf16 v[160:175], a[116:119], v[148:151], v[160:175]
    ds_read_b64_tr_b16 v[24:25], v229 offset:6144
    ds_read_b64_tr_b16 v[26:27], v229 offset:6656
    ds_read_b64_tr_b16 v[144:145], v234 offset:16384
    ds_read_b64_tr_b16 v[146:147], v234 offset:17408
    v_mfma_f32_32x32x16_bf16 v[160:175], a[120:123], v[152:155], v[160:175]
    ds_read_b64_tr_b16 v[28:29], v229 offset:7168
    ds_read_b64_tr_b16 v[30:31], v229 offset:7680
    ds_read_b64_tr_b16 v[148:149], v234 offset:20480
    ds_read_b64_tr_b16 v[150:151], v234 offset:21504
    s_waitcnt lgkmcnt(15)
    v_mfma_f32_32x32x16_bf16 v[160:175], a[124:127], v[156:159], v[160:175]
    ds_read_b64_tr_b16 v[152:153], v234 offset:24576
    ds_read_b64_tr_b16 v[154:155], v234 offset:25600
    v_mfma_f32_32x32x16_bf16 v[176:191], a[0:3], v[128:131], 0
    s_waitcnt lgkmcnt(4)
    s_add_u32 m0, s57, 0
    s_lshl_b32 s61, s85, 4
    s_add_u32 s61, s61, 0
    buffer_load_dwordx4 v228, s[72:75], s61 offen lds
    ds_read_b64_tr_b16 v[156:157], v234 offset:28672
    ds_read_b64_tr_b16 v[158:159], v234 offset:29696
    v_mfma_f32_32x32x16_bf16 v[176:191], a[4:7], v[132:135], v[176:191]
    s_waitcnt vmcnt(1)
    s_lshl_b32 s58, s26, 2
    s_add_u32 s58, s58, s23
    v_mov_b32 v248, s58
    s_mov_b64 exec, 1
    global_store_dword v246, v248, s[42:43] sc1
    s_mov_b64 exec, -1
    s_add_u32 m0, s57, 1024
    s_lshl_b32 s61, s85, 4
    s_add_u32 s61, s61, 16384
    buffer_load_dwordx4 v228, s[72:75], s61 offen lds
    ds_read_b64_tr_b16 v[128:129], v234 offset:32768
    ds_read_b64_tr_b16 v[130:131], v234 offset:33792
    v_mfma_f32_32x32x16_bf16 v[176:191], a[8:11], v[136:139], v[176:191]
    s_add_u32 m0, s57, 2048
    s_lshl_b32 s61, s85, 4
    s_add_u32 s61, s61, 32768
    buffer_load_dwordx4 v228, s[72:75], s61 offen lds
    ds_read_b64_tr_b16 v[132:133], v234 offset:36864
    ds_read_b64_tr_b16 v[134:135], v234 offset:37888
    v_mfma_f32_32x32x16_bf16 v[176:191], a[12:15], v[140:143], v[176:191]
    v_cvt_pk_bf16_f32 v192, v160, v161
    v_cvt_pk_bf16_f32 v193, v162, v163
    s_add_u32 m0, s57, 3072
    s_lshl_b32 s61, s85, 4
    s_add_u32 s61, s61, 49152
    buffer_load_dwordx4 v228, s[72:75], s61 offen lds
    ds_read_b64_tr_b16 v[136:137], v234 offset:40960
    ds_read_b64_tr_b16 v[138:139], v234 offset:41984
    v_mfma_f32_32x32x16_bf16 v[176:191], a[16:19], v[144:147], v[176:191]
    v_cvt_pk_bf16_f32 v194, v164, v165
    v_cvt_pk_bf16_f32 v195, v166, v167
    s_add_u32 m0, s57, 4096
    s_lshl_b32 s61, s85, 4
    s_add_u32 s61, s61, 65536
    buffer_load_dwordx4 v228, s[72:75], s61 offen lds
    ds_read_b64_tr_b16 v[140:141], v234 offset:45056
    ds_read_b64_tr_b16 v[142:143], v234 offset:46080
    s_waitcnt lgkmcnt(12)
    v_mfma_f32_32x32x16_bf16 v[176:191], a[20:23], v[148:151], v[176:191]
    v_cvt_pk_bf16_f32 v196, v168, v169
    v_cvt_pk_bf16_f32 v197, v170, v171
    s_add_u32 m0, s57, 5120
    s_lshl_b32 s61, s85, 4
    s_add_u32 s61, s61, 81920
    buffer_load_dwordx4 v228, s[72:75], s61 offen lds
    ds_read_b64_tr_b16 v[144:145], v234 offset:49152
    ds_read_b64_tr_b16 v[146:147], v234 offset:50176
    s_waitcnt lgkmcnt(12)
    v_mfma_f32_32x32x16_bf16 v[176:191], a[24:27], v[152:155], v[176:191]
    v_cvt_pk_bf16_f32 v198, v172, v173
    v_cvt_pk_bf16_f32 v199, v174, v175
    buffer_store_dwordx4 v[192:195], v243, s[52:55], s32 offen offset:0 sc1
    s_add_u32 m0, s57, 6144
    s_lshl_b32 s61, s85, 4
    s_add_u32 s61, s61, 98304
    buffer_load_dwordx4 v228, s[72:75], s61 offen lds
    ds_read_b64_tr_b16 v[148:149], v234 offset:53248
    ds_read_b64_tr_b16 v[150:151], v234 offset:54272
    s_waitcnt lgkmcnt(12)
    v_mfma_f32_32x32x16_bf16 v[176:191], a[28:31], v[156:159], v[176:191]
    s_add_u32 m0, s57, 7168
    s_lshl_b32 s61, s85, 4
    s_add_u32 s61, s61, 114688
    buffer_load_dwordx4 v228, s[72:75], s61 offen lds
    ds_read_b64_tr_b16 v[152:153], v234 offset:57344
    ds_read_b64_tr_b16 v[154:155], v234 offset:58368
    s_waitcnt lgkmcnt(12)
    v_mfma_f32_32x32x16_bf16 v[176:191], a[32:35], v[128:131], v[176:191]
    ds_read_b64_tr_b16 v[156:157], v234 offset:61440
    ds_read_b64_tr_b16 v[158:159], v234 offset:62464
    s_waitcnt lgkmcnt(12)
    v_mfma_f32_32x32x16_bf16 v[176:191], a[36:39], v[132:135], v[176:191]
    buffer_store_dwordx4 v[196:199], v243, s[52:55], s32 offen offset:512 sc1
    ds_read_b64_tr_b16 v[128:129], v235 offset:0
    ds_read_b64_tr_b16 v[130:131], v235 offset:1024
    s_waitcnt lgkmcnt(12)
    v_mfma_f32_32x32x16_bf16 v[176:191], a[40:43], v[136:139], v[176:191]
    ds_read_b64_tr_b16 v[132:133], v235 offset:4096
    ds_read_b64_tr_b16 v[134:135], v235 offset:5120
    s_waitcnt lgkmcnt(12)
    v_mfma_f32_32x32x16_bf16 v[176:191], a[44:47], v[140:143], v[176:191]
    ds_read_b64_tr_b16 v[136:137], v235 offset:8192
    ds_read_b64_tr_b16 v[138:139], v235 offset:9216
    s_waitcnt lgkmcnt(12)
    v_mfma_f32_32x32x16_bf16 v[176:191], a[48:51], v[144:147], v[176:191]
    ds_read_b64_tr_b16 v[140:141], v235 offset:12288
    ds_read_b64_tr_b16 v[142:143], v235 offset:13312
    s_waitcnt lgkmcnt(12)
    v_mfma_f32_32x32x16_bf16 v[176:191], a[52:55], v[148:151], v[176:191]
    ds_read_b64_tr_b16 v[144:145], v235 offset:16384
    ds_read_b64_tr_b16 v[146:147], v235 offset:17408
    s_waitcnt lgkmcnt(12)
    v_mfma_f32_32x32x16_bf16 v[176:191], a[56:59], v[152:155], v[176:191]
    ds_read_b64_tr_b16 v[148:149], v235 offset:20480
    ds_read_b64_tr_b16 v[150:151], v235 offset:21504
    s_waitcnt lgkmcnt(12)
    v_mfma_f32_32x32x16_bf16 v[176:191], a[60:63], v[156:159], v[176:191]
    ds_read_b64_tr_b16 v[152:153], v235 offset:24576
    ds_read_b64_tr_b16 v[154:155], v235 offset:25600
    s_waitcnt lgkmcnt(12)
    v_mfma_f32_32x32x16_bf16 v[176:191], a[64:67], v[128:131], v[176:191]
    ds_read_b64_tr_b16 v[156:157], v235 offset:28672
    ds_read_b64_tr_b16 v[158:159], v235 offset:29696
    s_waitcnt lgkmcnt(12)
    v_mfma_f32_32x32x16_bf16 v[176:191], a[68:71], v[132:135], v[176:191]
    ds_read_b64_tr_b16 v[128:129], v235 offset:32768
    ds_read_b64_tr_b16 v[130:131], v235 offset:33792
    s_waitcnt lgkmcnt(12)
    v_mfma_f32_32x32x16_bf16 v[176:191], a[72:75], v[136:139], v[176:191]
    ds_read_b64_tr_b16 v[132:133], v235 offset:36864
    ds_read_b64_tr_b16 v[134:135], v235 offset:37888
    s_waitcnt lgkmcnt(12)
    v_mfma_f32_32x32x16_bf16 v[176:191], a[76:79], v[140:143], v[176:191]
    ds_read_b64_tr_b16 v[136:137], v235 offset:40960
    ds_read_b64_tr_b16 v[138:139], v235 offset:41984
    s_waitcnt lgkmcnt(12)
    v_mfma_f32_32x32x16_bf16 v[176:191], a[80:83], v[144:147], v[176:191]
    ds_read_b64_tr_b16 v[140:141], v235 offset:45056
    ds_read_b64_tr_b16 v[142:143], v235 offset:46080
    s_waitcnt lgkmcnt(12)
    v_mfma_f32_32x32x16_bf16 v[176:191], a[84:87], v[148:151], v[176:191]
    ds_read_b64_tr_b16 v[144:145], v235 offset:49152
    ds_read_b64_tr_b16 v[146:147], v235 offset:50176
    s_waitcnt lgkmcnt(12)
    v_mfma_f32_32x32x16_bf16 v[176:191], a[88:91], v[152:155], v[176:191]
    ds_read_b64_tr_b16 v[148:149], v235 offset:53248
    ds_read_b64_tr_b16 v[150:151], v235 offset:54272
    s_waitcnt lgkmcnt(12)
    v_mfma_f32_32x32x16_bf16 v[176:191], a[92:95], v[156:159], v[176:191]
    s_waitcnt vmcnt(1)
    ds_read_b64_tr_b16 v[32:33], v229 offset:0
    ds_read_b64_tr_b16 v[34:35], v229 offset:512
    ds_read_b64_tr_b16 v[152:153], v235 offset:57344
    ds_read_b64_tr_b16 v[154:155], v235 offset:58368
    s_waitcnt lgkmcnt(14)
    v_mfma_f32_32x32x16_bf16 v[176:191], a[96:99], v[128:131], v[176:191]
    ds_read_b64_tr_b16 v[36:37], v229 offset:1024
    ds_read_b64_tr_b16 v[38:39], v229 offset:1536
    ds_read_b64_tr_b16 v[156:157], v235 offset:61440
    ds_read_b64_tr_b16 v[158:159], v235 offset:62464
    s_waitcnt lgkmcnt(15)
    v_mfma_f32_32x32x16_bf16 v[176:191], a[100:103], v[132:135], v[176:191]
    ds_read_b64_tr_b16 v[40:41], v229 offset:2048
    ds_read_b64_tr_b16 v[42:43], v229 offset:2560
    ds_read_b64_tr_b16 v[128:129], v236 offset:0
    ds_read_b64_tr_b16 v[130:131], v236 offset:1024
    s_waitcnt lgkmcnt(15)
    v_mfma_f32_32x32x16_bf16 v[176:191], a[104:107], v[136:139], v[176:191]
    ds_read_b64_tr_b16 v[44:45], v229 offset:3072
    ds_read_b64_tr_b16 v[46:47], v229 offset:3584
    ds_read_b64_tr_b16 v[132:133], v236 offset:4096
    ds_read_b64_tr_b16 v[134:135], v236 offset:5120
    v_mfma_f32_32x32x16_bf16 v[176:191], a[108:111], v[140:143], v[176:191]
    ds_read_b64_tr_b16 v[48:49], v229 offset:4096
    ds_read_b64_tr_b16 v[50:51], v229 offset:4608
    ds_read_b64_tr_b16 v[136:137], v236 offset:8192
    ds_read_b64_tr_b16 v[138:139], v236 offset:9216
    s_waitcnt lgkmcnt(15)
    v_mfma_f32_32x32x16_bf16 v[176:191], a[112:115], v[144:147], v[176:191]
    ds_read_b64_tr_b16 v[52:53], v229 offset:5120
    ds_read_b64_tr_b16 v[54:55], v229 offset:5632
    ds_read_b64_tr_b16 v[140:141], v236 offset:12288
    ds_read_b64_tr_b16 v[142:143], v236 offset:13312
    v_mfma_f32_32x32x16_bf16 v[176:191], a[116:119], v[148:151], v[176:191]
    ds_read_b64_tr_b16 v[56:57], v229 offset:6144
    ds_read_b64_tr_b16 v[58:59], v229 offset:6656
    ds_read_b64_tr_b16 v[144:145], v236 offset:16384
    ds_read_b64_tr_b16 v[146:147], v236 offset:17408
    v_mfma_f32_32x32x16_bf16 v[176:191], a[120:123], v[152:155], v[176:191]
    ds_read_b64_tr_b16 v[60:61], v229 offset:7168
    ds_read_b64_tr_b16 v[62:63], v229 offset:7680
    ds_read_b64_tr_b16 v[148:149], v236 offset:20480
    ds_read_b64_tr_b16 v[150:151], v236 offset:21504
    s_waitcnt lgkmcnt(15)
    v_mfma_f32_32x32x16_bf16 v[176:191], a[124:127], v[156:159], v[176:191]
    ds_read_b64_tr_b16 v[152:153], v236 offset:24576
    ds_read_b64_tr_b16 v[154:155], v236 offset:25600
    v_mfma_f32_32x32x16_bf16 v[160:175], a[0:3], v[128:131], 0
    s_waitcnt lgkmcnt(4)
    s_add_u32 m0, s57, 0
    s_lshl_b32 s61, s86, 4
    s_add_u32 s61, s61, 0
    buffer_load_dwordx4 v228, s[72:75], s61 offen lds
    ds_read_b64_tr_b16 v[156:157], v236 offset:28672
    ds_read_b64_tr_b16 v[158:159], v236 offset:29696
    v_mfma_f32_32x32x16_bf16 v[160:175], a[4:7], v[132:135], v[160:175]
    s_add_u32 m0, s57, 1024
    s_lshl_b32 s61, s86, 4
    s_add_u32 s61, s61, 16384
    buffer_load_dwordx4 v228, s[72:75], s61 offen lds
    ds_read_b64_tr_b16 v[128:129], v236 offset:32768
    ds_read_b64_tr_b16 v[130:131], v236 offset:33792
    v_mfma_f32_32x32x16_bf16 v[160:175], a[8:11], v[136:139], v[160:175]
    s_add_u32 m0, s57, 2048
    s_lshl_b32 s61, s86, 4
    s_add_u32 s61, s61, 32768
    buffer_load_dwordx4 v228, s[72:75], s61 offen lds
    ds_read_b64_tr_b16 v[132:133], v236 offset:36864
    ds_read_b64_tr_b16 v[134:135], v236 offset:37888
    v_mfma_f32_32x32x16_bf16 v[160:175], a[12:15], v[140:143], v[160:175]
    v_cvt_pk_bf16_f32 v200, v176, v177
    v_cvt_pk_bf16_f32 v201, v178, v179
    s_add_u32 m0, s57, 3072
    s_lshl_b32 s61, s86, 4
    s_add_u32 s61, s61, 49152
    buffer_load_dwordx4 v228, s[72:75], s61 offen lds
    ds_read_b64_tr_b16 v[136:137], v236 offset:40960
    ds_read_b64_tr_b16 v[138:139], v236 offset:41984
    v_mfma_f32_32x32x16_bf16 v[160:175], a[16:19], v[144:147], v[160:175]
    v_cvt_pk_bf16_f32 v202, v180, v181
    v_cvt_pk_bf16_f32 v203, v182, v183
    s_add_u32 m0, s57, 4096
    s_lshl_b32 s61, s86, 4
    s_add_u32 s61, s61, 65536
    buffer_load_dwordx4 v228, s[72:75], s61 offen lds
    ds_read_b64_tr_b16 v[140:141], v236 offset:45056
    ds_read_b64_tr_b16 v[142:143], v236 offset:46080
    s_waitcnt lgkmcnt(12)
    v_mfma_f32_32x32x16_bf16 v[160:175], a[20:23], v[148:151], v[160:175]
    v_cvt_pk_bf16_f32 v204, v184, v185
    v_cvt_pk_bf16_f32 v205, v186, v187
    s_add_u32 m0, s57, 5120
    s_lshl_b32 s61, s86, 4
    s_add_u32 s61, s61, 81920
    buffer_load_dwordx4 v228, s[72:75], s61 offen lds
    ds_read_b64_tr_b16 v[144:145], v236 offset:49152
    ds_read_b64_tr_b16 v[146:147], v236 offset:50176
    s_waitcnt lgkmcnt(12)
    v_mfma_f32_32x32x16_bf16 v[160:175], a[24:27], v[152:155], v[160:175]
    v_cvt_pk_bf16_f32 v206, v188, v189
    v_cvt_pk_bf16_f32 v207, v190, v191
    buffer_store_dwordx4 v[200:203], v243, s[52:55], s33 offen offset:0 sc1
    s_add_u32 m0, s57, 6144
    s_lshl_b32 s61, s86, 4
    s_add_u32 s61, s61, 98304
    buffer_load_dwordx4 v228, s[72:75], s61 offen lds
    ds_read_b64_tr_b16 v[148:149], v236 offset:53248
    ds_read_b64_tr_b16 v[150:151], v236 offset:54272
    s_waitcnt lgkmcnt(12)
    v_mfma_f32_32x32x16_bf16 v[160:175], a[28:31], v[156:159], v[160:175]
    s_add_u32 m0, s57, 7168
    s_lshl_b32 s61, s86, 4
    s_add_u32 s61, s61, 114688
    buffer_load_dwordx4 v228, s[72:75], s61 offen lds
    ds_read_b64_tr_b16 v[152:153], v236 offset:57344
    ds_read_b64_tr_b16 v[154:155], v236 offset:58368
    s_waitcnt lgkmcnt(12)
    v_mfma_f32_32x32x16_bf16 v[160:175], a[32:35], v[128:131], v[160:175]
    ds_read_b64_tr_b16 v[156:157], v236 offset:61440
    ds_read_b64_tr_b16 v[158:159], v236 offset:62464
    s_waitcnt lgkmcnt(12)
    v_mfma_f32_32x32x16_bf16 v[160:175], a[36:39], v[132:135], v[160:175]
    buffer_store_dwordx4 v[204:207], v243, s[52:55], s33 offen offset:512 sc1
    ds_read_b64_tr_b16 v[128:129], v237 offset:0
    ds_read_b64_tr_b16 v[130:131], v237 offset:1024
    s_waitcnt lgkmcnt(12)
    v_mfma_f32_32x32x16_bf16 v[160:175], a[40:43], v[136:139], v[160:175]
    ds_read_b64_tr_b16 v[132:133], v237 offset:4096
    ds_read_b64_tr_b16 v[134:135], v237 offset:5120
    s_waitcnt lgkmcnt(12)
    v_mfma_f32_32x32x16_bf16 v[160:175], a[44:47], v[140:143], v[160:175]
    ds_read_b64_tr_b16 v[136:137], v237 offset:8192
    ds_read_b64_tr_b16 v[138:139], v237 offset:9216
    s_waitcnt lgkmcnt(12)
    v_mfma_f32_32x32x16_bf16 v[160:175], a[48:51], v[144:147], v[160:175]
    ds_read_b64_tr_b16 v[140:141], v237 offset:12288
    ds_read_b64_tr_b16 v[142:143], v237 offset:13312
    s_waitcnt lgkmcnt(12)
    v_mfma_f32_32x32x16_bf16 v[160:175], a[52:55], v[148:151], v[160:175]
    ds_read_b64_tr_b16 v[144:145], v237 offset:16384
    ds_read_b64_tr_b16 v[146:147], v237 offset:17408
    s_waitcnt lgkmcnt(12)
    v_mfma_f32_32x32x16_bf16 v[160:175], a[56:59], v[152:155], v[160:175]
    ds_read_b64_tr_b16 v[148:149], v237 offset:20480
    ds_read_b64_tr_b16 v[150:151], v237 offset:21504
    s_waitcnt lgkmcnt(12)
    v_mfma_f32_32x32x16_bf16 v[160:175], a[60:63], v[156:159], v[160:175]
    ds_read_b64_tr_b16 v[152:153], v237 offset:24576
    ds_read_b64_tr_b16 v[154:155], v237 offset:25600
    s_waitcnt lgkmcnt(12)
    v_mfma_f32_32x32x16_bf16 v[160:175], a[64:67], v[128:131], v[160:175]
    ds_read_b64_tr_b16 v[156:157], v237 offset:28672
    ds_read_b64_tr_b16 v[158:159], v237 offset:29696
    s_waitcnt lgkmcnt(12)
    v_mfma_f32_32x32x16_bf16 v[160:175], a[68:71], v[132:135], v[160:175]
    ds_read_b64_tr_b16 v[128:129], v237 offset:32768
    ds_read_b64_tr_b16 v[130:131], v237 offset:33792
    s_waitcnt lgkmcnt(12)
    v_mfma_f32_32x32x16_bf16 v[160:175], a[72:75], v[136:139], v[160:175]
    ds_read_b64_tr_b16 v[132:133], v237 offset:36864
    ds_read_b64_tr_b16 v[134:135], v237 offset:37888
    s_waitcnt lgkmcnt(12)
    v_mfma_f32_32x32x16_bf16 v[160:175], a[76:79], v[140:143], v[160:175]
    ds_read_b64_tr_b16 v[136:137], v237 offset:40960
    ds_read_b64_tr_b16 v[138:139], v237 offset:41984
    s_waitcnt lgkmcnt(12)
    v_mfma_f32_32x32x16_bf16 v[160:175], a[80:83], v[144:147], v[160:175]
    ds_read_b64_tr_b16 v[140:141], v237 offset:45056
    ds_read_b64_tr_b16 v[142:143], v237 offset:46080
    s_waitcnt lgkmcnt(12)
    v_mfma_f32_32x32x16_bf16 v[160:175], a[84:87], v[148:151], v[160:175]
    ds_read_b64_tr_b16 v[144:145], v237 offset:49152
    ds_read_b64_tr_b16 v[146:147], v237 offset:50176
    s_waitcnt lgkmcnt(12)
    v_mfma_f32_32x32x16_bf16 v[160:175], a[88:91], v[152:155], v[160:175]
    ds_read_b64_tr_b16 v[148:149], v237 offset:53248
    ds_read_b64_tr_b16 v[150:151], v237 offset:54272
    s_waitcnt lgkmcnt(12)
    v_mfma_f32_32x32x16_bf16 v[160:175], a[92:95], v[156:159], v[160:175]
    s_waitcnt vmcnt(1)
    ds_read_b64_tr_b16 v[64:65], v229 offset:0
    ds_read_b64_tr_b16 v[66:67], v229 offset:512
    ds_read_b64_tr_b16 v[152:153], v237 offset:57344
    ds_read_b64_tr_b16 v[154:155], v237 offset:58368
    s_waitcnt lgkmcnt(14)
    v_mfma_f32_32x32x16_bf16 v[160:175], a[96:99], v[128:131], v[160:175]
    ds_read_b64_tr_b16 v[68:69], v229 offset:1024
    ds_read_b64_tr_b16 v[70:71], v229 offset:1536
    ds_read_b64_tr_b16 v[156:157], v237 offset:61440
    ds_read_b64_tr_b16 v[158:159], v237 offset:62464
    s_waitcnt lgkmcnt(15)
    v_mfma_f32_32x32x16_bf16 v[160:175], a[100:103], v[132:135], v[160:175]
    ds_read_b64_tr_b16 v[72:73], v229 offset:2048
    ds_read_b64_tr_b16 v[74:75], v229 offset:2560
    ds_read_b64_tr_b16 v[128:129], v238 offset:0
    ds_read_b64_tr_b16 v[130:131], v238 offset:1024
    s_waitcnt lgkmcnt(15)
    v_mfma_f32_32x32x16_bf16 v[160:175], a[104:107], v[136:139], v[160:175]
    ds_read_b64_tr_b16 v[76:77], v229 offset:3072
    ds_read_b64_tr_b16 v[78:79], v229 offset:3584
    ds_read_b64_tr_b16 v[132:133], v238 offset:4096
    ds_read_b64_tr_b16 v[134:135], v238 offset:5120
    v_mfma_f32_32x32x16_bf16 v[160:175], a[108:111], v[140:143], v[160:175]
    ds_read_b64_tr_b16 v[80:81], v229 offset:4096
    ds_read_b64_tr_b16 v[82:83], v229 offset:4608
    ds_read_b64_tr_b16 v[136:137], v238 offset:8192
    ds_read_b64_tr_b16 v[138:139], v238 offset:9216
    s_waitcnt lgkmcnt(15)
    v_mfma_f32_32x32x16_bf16 v[160:175], a[112:115], v[144:147], v[160:175]
    ds_read_b64_tr_b16 v[84:85], v229 offset:5120
    ds_read_b64_tr_b16 v[86:87], v229 offset:5632
    ds_read_b64_tr_b16 v[140:141], v238 offset:12288
    ds_read_b64_tr_b16 v[142:143], v238 offset:13312
    v_mfma_f32_32x32x16_bf16 v[160:175], a[116:119], v[148:151], v[160:175]
    ds_read_b64_tr_b16 v[88:89], v229 offset:6144
    ds_read_b64_tr_b16 v[90:91], v229 offset:6656
    ds_read_b64_tr_b16 v[144:145], v238 offset:16384
    ds_read_b64_tr_b16 v[146:147], v238 offset:17408
    v_mfma_f32_32x32x16_bf16 v[160:175], a[120:123], v[152:155], v[160:175]
    ds_read_b64_tr_b16 v[92:93], v229 offset:7168
    ds_read_b64_tr_b16 v[94:95], v229 offset:7680
    ds_read_b64_tr_b16 v[148:149], v238 offset:20480
    ds_read_b64_tr_b16 v[150:151], v238 offset:21504
    s_waitcnt lgkmcnt(15)
    v_mfma_f32_32x32x16_bf16 v[160:175], a[124:127], v[156:159], v[160:175]
    ds_read_b64_tr_b16 v[152:153], v238 offset:24576
    ds_read_b64_tr_b16 v[154:155], v238 offset:25600
    v_mfma_f32_32x32x16_bf16 v[176:191], a[0:3], v[128:131], 0
    s_waitcnt lgkmcnt(4)
    s_add_u32 m0, s57, 0
    s_lshl_b32 s61, s87, 4
    s_add_u32 s61, s61, 0
    buffer_load_dwordx4 v228, s[72:75], s61 offen lds
    ds_read_b64_tr_b16 v[156:157], v238 offset:28672
    ds_read_b64_tr_b16 v[158:159], v238 offset:29696
    v_mfma_f32_32x32x16_bf16 v[176:191], a[4:7], v[132:135], v[176:191]
    s_add_u32 m0, s57, 1024
    s_lshl_b32 s61, s87, 4
    s_add_u32 s61, s61, 16384
    buffer_load_dwordx4 v228, s[72:75], s61 offen lds
    ds_read_b64_tr_b16 v[128:129], v238 offset:32768
    ds_read_b64_tr_b16 v[130:131], v238 offset:33792
    v_mfma_f32_32x32x16_bf16 v[176:191], a[8:11], v[136:139], v[176:191]
    s_add_u32 m0, s57, 2048
    s_lshl_b32 s61, s87, 4
    s_add_u32 s61, s61, 32768
    buffer_load_dwordx4 v228, s[72:75], s61 offen lds
    ds_read_b64_tr_b16 v[132:133], v238 offset:36864
    ds_read_b64_tr_b16 v[134:135], v238 offset:37888
    v_mfma_f32_32x32x16_bf16 v[176:191], a[12:15], v[140:143], v[176:191]
    v_cvt_pk_bf16_f32 v192, v160, v161
    v_cvt_pk_bf16_f32 v193, v162, v163
    s_add_u32 m0, s57, 3072
    s_lshl_b32 s61, s87, 4
    s_add_u32 s61, s61, 49152
    buffer_load_dwordx4 v228, s[72:75], s61 offen lds
    ds_read_b64_tr_b16 v[136:137], v238 offset:40960
    ds_read_b64_tr_b16 v[138:139], v238 offset:41984
    v_mfma_f32_32x32x16_bf16 v[176:191], a[16:19], v[144:147], v[176:191]
    v_cvt_pk_bf16_f32 v194, v164, v165
    v_cvt_pk_bf16_f32 v195, v166, v167
    s_add_u32 m0, s57, 4096
    s_lshl_b32 s61, s87, 4
    s_add_u32 s61, s61, 65536
    buffer_load_dwordx4 v228, s[72:75], s61 offen lds
    ds_read_b64_tr_b16 v[140:141], v238 offset:45056
    ds_read_b64_tr_b16 v[142:143], v238 offset:46080
    s_waitcnt lgkmcnt(12)
    v_mfma_f32_32x32x16_bf16 v[176:191], a[20:23], v[148:151], v[176:191]
    v_cvt_pk_bf16_f32 v196, v168, v169
    v_cvt_pk_bf16_f32 v197, v170, v171
    s_add_u32 m0, s57, 5120
    s_lshl_b32 s61, s87, 4
    s_add_u32 s61, s61, 81920
    buffer_load_dwordx4 v228, s[72:75], s61 offen lds
    ds_read_b64_tr_b16 v[144:145], v238 offset:49152
    ds_read_b64_tr_b16 v[146:147], v238 offset:50176
    s_waitcnt lgkmcnt(12)
    v_mfma_f32_32x32x16_bf16 v[176:191], a[24:27], v[152:155], v[176:191]
    v_cvt_pk_bf16_f32 v198, v172, v173
    v_cvt_pk_bf16_f32 v199, v174, v175
    buffer_store_dwordx4 v[192:195], v243, s[52:55], s34 offen offset:0 sc1
    s_add_u32 m0, s57, 6144
    s_lshl_b32 s61, s87, 4
    s_add_u32 s61, s61, 98304
    buffer_load_dwordx4 v228, s[72:75], s61 offen lds
    ds_read_b64_tr_b16 v[148:149], v238 offset:53248
    ds_read_b64_tr_b16 v[150:151], v238 offset:54272
    s_waitcnt lgkmcnt(12)
    v_mfma_f32_32x32x16_bf16 v[176:191], a[28:31], v[156:159], v[176:191]
    s_add_u32 m0, s57, 7168
    s_lshl_b32 s61, s87, 4
    s_add_u32 s61, s61, 114688
    buffer_load_dwordx4 v228, s[72:75], s61 offen lds
    ds_read_b64_tr_b16 v[152:153], v238 offset:57344
    ds_read_b64_tr_b16 v[154:155], v238 offset:58368
    s_waitcnt lgkmcnt(12)
    v_mfma_f32_32x32x16_bf16 v[176:191], a[32:35], v[128:131], v[176:191]
    ds_read_b64_tr_b16 v[156:157], v238 offset:61440
    ds_read_b64_tr_b16 v[158:159], v238 offset:62464
    s_waitcnt lgkmcnt(12)
    v_mfma_f32_32x32x16_bf16 v[176:191], a[36:39], v[132:135], v[176:191]
    buffer_store_dwordx4 v[196:199], v243, s[52:55], s34 offen offset:512 sc1
    ds_read_b64_tr_b16 v[128:129], v239 offset:0
    ds_read_b64_tr_b16 v[130:131], v239 offset:1024
    s_waitcnt lgkmcnt(12)
    v_mfma_f32_32x32x16_bf16 v[176:191], a[40:43], v[136:139], v[176:191]
    ds_read_b64_tr_b16 v[132:133], v239 offset:4096
    ds_read_b64_tr_b16 v[134:135], v239 offset:5120
    s_waitcnt lgkmcnt(12)
    v_mfma_f32_32x32x16_bf16 v[176:191], a[44:47], v[140:143], v[176:191]
    ds_read_b64_tr_b16 v[136:137], v239 offset:8192
    ds_read_b64_tr_b16 v[138:139], v239 offset:9216
    s_waitcnt lgkmcnt(12)
    v_mfma_f32_32x32x16_bf16 v[176:191], a[48:51], v[144:147], v[176:191]
    ds_read_b64_tr_b16 v[140:141], v239 offset:12288
    ds_read_b64_tr_b16 v[142:143], v239 offset:13312
    s_waitcnt lgkmcnt(12)
    v_mfma_f32_32x32x16_bf16 v[176:191], a[52:55], v[148:151], v[176:191]
    ds_read_b64_tr_b16 v[144:145], v239 offset:16384
    ds_read_b64_tr_b16 v[146:147], v239 offset:17408
    s_waitcnt lgkmcnt(12)
    v_mfma_f32_32x32x16_bf16 v[176:191], a[56:59], v[152:155], v[176:191]
    ds_read_b64_tr_b16 v[148:149], v239 offset:20480
    ds_read_b64_tr_b16 v[150:151], v239 offset:21504
    s_waitcnt lgkmcnt(12)
    v_mfma_f32_32x32x16_bf16 v[176:191], a[60:63], v[156:159], v[176:191]
    ds_read_b64_tr_b16 v[152:153], v239 offset:24576
    ds_read_b64_tr_b16 v[154:155], v239 offset:25600
    s_waitcnt lgkmcnt(12)
    v_mfma_f32_32x32x16_bf16 v[176:191], a[64:67], v[128:131], v[176:191]
    ds_read_b64_tr_b16 v[156:157], v239 offset:28672
    ds_read_b64_tr_b16 v[158:159], v239 offset:29696
    s_waitcnt lgkmcnt(12)
    v_mfma_f32_32x32x16_bf16 v[176:191], a[68:71], v[132:135], v[176:191]
    ds_read_b64_tr_b16 v[128:129], v239 offset:32768
    ds_read_b64_tr_b16 v[130:131], v239 offset:33792
    s_waitcnt lgkmcnt(12)
    v_mfma_f32_32x32x16_bf16 v[176:191], a[72:75], v[136:139], v[176:191]
    ds_read_b64_tr_b16 v[132:133], v239 offset:36864
    ds_read_b64_tr_b16 v[134:135], v239 offset:37888
    s_waitcnt lgkmcnt(12)
    v_mfma_f32_32x32x16_bf16 v[176:191], a[76:79], v[140:143], v[176:191]
    ds_read_b64_tr_b16 v[136:137], v239 offset:40960
    ds_read_b64_tr_b16 v[138:139], v239 offset:41984
    s_waitcnt lgkmcnt(12)
    v_mfma_f32_32x32x16_bf16 v[176:191], a[80:83], v[144:147], v[176:191]
    ds_read_b64_tr_b16 v[140:141], v239 offset:45056
    ds_read_b64_tr_b16 v[142:143], v239 offset:46080
    s_waitcnt lgkmcnt(12)
    v_mfma_f32_32x32x16_bf16 v[176:191], a[84:87], v[148:151], v[176:191]
    ds_read_b64_tr_b16 v[144:145], v239 offset:49152
    ds_read_b64_tr_b16 v[146:147], v239 offset:50176
    s_waitcnt lgkmcnt(12)
    v_mfma_f32_32x32x16_bf16 v[176:191], a[88:91], v[152:155], v[176:191]
    ds_read_b64_tr_b16 v[148:149], v239 offset:53248
    ds_read_b64_tr_b16 v[150:151], v239 offset:54272
    s_waitcnt lgkmcnt(12)
    v_mfma_f32_32x32x16_bf16 v[176:191], a[92:95], v[156:159], v[176:191]
    s_waitcnt vmcnt(1)
    ds_read_b64_tr_b16 v[96:97], v229 offset:0
    ds_read_b64_tr_b16 v[98:99], v229 offset:512
    ds_read_b64_tr_b16 v[152:153], v239 offset:57344
    ds_read_b64_tr_b16 v[154:155], v239 offset:58368
    s_waitcnt lgkmcnt(14)
    v_mfma_f32_32x32x16_bf16 v[176:191], a[96:99], v[128:131], v[176:191]
    ds_read_b64_tr_b16 v[100:101], v229 offset:1024
    ds_read_b64_tr_b16 v[102:103], v229 offset:1536
    ds_read_b64_tr_b16 v[156:157], v239 offset:61440
    ds_read_b64_tr_b16 v[158:159], v239 offset:62464
    s_waitcnt lgkmcnt(15)
    v_mfma_f32_32x32x16_bf16 v[176:191], a[100:103], v[132:135], v[176:191]
    ds_read_b64_tr_b16 v[104:105], v229 offset:2048
    ds_read_b64_tr_b16 v[106:107], v229 offset:2560
    s_waitcnt lgkmcnt(15)
    v_mfma_f32_32x32x16_bf16 v[176:191], a[104:107], v[136:139], v[176:191]
    ds_read_b64_tr_b16 v[108:109], v229 offset:3072
    ds_read_b64_tr_b16 v[110:111], v229 offset:3584
    s_waitcnt lgkmcnt(15)
    v_mfma_f32_32x32x16_bf16 v[176:191], a[108:111], v[140:143], v[176:191]
    ds_read_b64_tr_b16 v[112:113], v229 offset:4096
    ds_read_b64_tr_b16 v[114:115], v229 offset:4608
    s_waitcnt lgkmcnt(15)
    v_mfma_f32_32x32x16_bf16 v[176:191], a[112:115], v[144:147], v[176:191]
    ds_read_b64_tr_b16 v[116:117], v229 offset:5120
    ds_read_b64_tr_b16 v[118:119], v229 offset:5632
    s_waitcnt lgkmcnt(15)
    v_mfma_f32_32x32x16_bf16 v[176:191], a[116:119], v[148:151], v[176:191]
    ds_read_b64_tr_b16 v[120:121], v229 offset:6144
    ds_read_b64_tr_b16 v[122:123], v229 offset:6656
    s_waitcnt lgkmcnt(14)
    v_mfma_f32_32x32x16_bf16 v[176:191], a[120:123], v[152:155], v[176:191]
    ds_read_b64_tr_b16 v[124:125], v229 offset:7168
    ds_read_b64_tr_b16 v[126:127], v229 offset:7680
    s_waitcnt lgkmcnt(12)
    v_mfma_f32_32x32x16_bf16 v[176:191], a[124:127], v[156:159], v[176:191]
    s_add_u32 s26, s26, 1
    s_nop 10
    v_cvt_pk_bf16_f32 v200, v176, v177
    v_cvt_pk_bf16_f32 v201, v178, v179
    v_cvt_pk_bf16_f32 v202, v180, v181
    v_cvt_pk_bf16_f32 v203, v182, v183
    v_cvt_pk_bf16_f32 v204, v184, v185
    v_cvt_pk_bf16_f32 v205, v186, v187
    v_cvt_pk_bf16_f32 v206, v188, v189
    v_cvt_pk_bf16_f32 v207, v190, v191
    buffer_store_dwordx4 v[200:203], v243, s[52:55], s35 offen offset:0 sc1
    buffer_store_dwordx4 v[204:207], v243, s[52:55], s35 offen offset:512 sc1
    s_waitcnt vmcnt(0)
    s_lshl_b32 s58, s26, 2
    s_add_u32 s58, s58, s23
    v_mov_b32 v248, s58
    s_mov_b64 exec, 1
    global_store_dword v246, v248, s[42:43] sc1
    s_mov_b64 exec, -1
    s_mov_b32 s24, s56
    s_waitcnt lgkmcnt(0)
L_ow:
    s_barrier
    s_lshr_b32 s60, s24, 4
    s_lshl_b32 s58, s60, 18
    s_lshl_b32 s59, s23, 16
    s_add_u32 s58, s58, s59
    s_add_u32 s58, s58, 33554432
    s_add_u32 s28, s20, s58
    s_addc_u32 s29, s21, 0
    s_mov_b32 s30, 0x10000
    s_mov_b32 s31, 0x20000
    s_lshl_b32 s58, s60, 12
    s_lshl_b32 s59, s23, 10
    s_add_u32 s58, s58, s59
    s_add_u32 s58, s58, 61915136
    s_add_u32 s48, s20, s58
    s_addc_u32 s49, s21, 0
    v_and_b32 v244, 7, v249
    v_lshlrev_b32 v244, 7, v244
    s_lshl_b32 s58, s60, 16
    s_lshl_b32 s59, s25, 10
    s_add_u32 s58, s58, s59
    s_and_b32 s59, s24, 15
    s_lshl_b32 s59, s59, 6
    s_add_u32 s58, s58, s59
    s_lshl_b32 s59, s23, 4
    s_add_u32 s58, s58, s59
    s_add_u32 s46, s16, s58
    s_addc_u32 s47, s17, 0
    v_and_b32 v224, 31, v249
    v_lshlrev_b32 v224, 11, v224
    v_lshrrev_b32 v225, 5, v249
    v_lshl_add_u32 v245, v225, 3, v224
    v_add_u32 v241, 0x1000, v240
    s_lshl_b32 s58, s23, 12
    v_add_u32 v242, s58, v240
    s_lshl_b32 s58, s23, 10
    v_add_u32 v243, s58, v240
    s_mov_b32 s26, 0
    s_mov_b32 s26, 1
L_o_cold:
L_o_pf:
    global_load_dword v248, v244, s[48:49] sc1
    s_waitcnt vmcnt(0)
L_o_pf_c:
    v_cmp_gt_u32 vcc, s26, v248
    s_cbranch_vccz L_o_pf_ok
    s_sleep 2
    s_sub_u32 s27, s27, 1
    s_cbranch_scc0 L_o_pf
    s_branch L_end
L_o_pf_ok:
    buffer_load_dwordx4 a[0:3], v240, s[28:31], s80 offen offset:0 sc1
    buffer_load_dwordx4 a[4:7], v240, s[28:31], s80 offen offset:1024 sc1
    buffer_load_dwordx4 a[8:11], v240, s[28:31], s80 offen offset:2048 sc1
    buffer_load_dwordx4 a[12:15], v240, s[28:31], s80 offen offset:3072 sc1
    buffer_load_dwordx4 a[16:19], v241, s[28:31], s80 offen offset:0 sc1
    buffer_load_dwordx4 a[20:23], v241, s[28:31], s80 offen offset:1024 sc1
    buffer_load_dwordx4 a[24:27], v241, s[28:31], s80 offen offset:2048 sc1
    buffer_load_dwordx4 a[28:31], v241, s[28:31], s80 offen offset:3072 sc1
    buffer_load_dwordx4 a[32:35], v240, s[28:31], s81 offen offset:0 sc1
    buffer_load_dwordx4 a[36:39], v240, s[28:31], s81 offen offset:1024 sc1
    buffer_load_dwordx4 a[40:43], v240, s[28:31], s81 offen offset:2048 sc1
    buffer_load_dwordx4 a[44:47], v240, s[28:31], s81 offen offset:3072 sc1
    buffer_load_dwordx4 a[48:51], v241, s[28:31], s81 offen offset:0 sc1
    buffer_load_dwordx4 a[52:55], v241, s[28:31], s81 offen offset:1024 sc1
    buffer_load_dwordx4 a[56:59], v241, s[28:31], s81 offen offset:2048 sc1
    buffer_load_dwordx4 a[60:63], v241, s[28:31], s81 offen offset:3072 sc1
    buffer_load_dwordx4 a[64:67], v240, s[28:31], s82 offen offset:0 sc1
    buffer_load_dwordx4 a[68:71], v240, s[28:31], s82 offen offset:1024 sc1
    buffer_load_dwordx4 a[72:75], v240, s[28:31], s82 offen offset:2048 sc1
    buffer_load_dwordx4 a[76:79], v240, s[28:31], s82 offen offset:3072 sc1
    buffer_load_dwordx4 a[80:83], v241, s[28:31], s82 offen offset:0 sc1
    buffer_load_dwordx4 a[84:87], v241, s[28:31], s82 offen offset:1024 sc1
    buffer_load_dwordx4 a[88:91], v241, s[28:31], s82 offen offset:2048 sc1
    buffer_load_dwordx4 a[92:95], v241, s[28:31], s82 offen offset:3072 sc1
    buffer_load_dwordx4 a[96:99], v240, s[28:31], s83 offen offset:0 sc1
    buffer_load_dwordx4 a[100:103], v240, s[28:31], s83 offen offset:1024 sc1
    buffer_load_dwordx4 a[104:107], v240, s[28:31], s83 offen offset:2048 sc1
    buffer_load_dwordx4 a[108:111], v240, s[28:31], s83 offen offset:3072 sc1
    buffer_load_dwordx4 a[112:115], v241, s[28:31], s83 offen offset:0 sc1
    buffer_load_dwordx4 a[116:119], v241, s[28:31], s83 offen offset:1024 sc1
    buffer_load_dwordx4 a[120:123], v241, s[28:31], s83 offen offset:2048 sc1
    buffer_load_dwordx4 a[124:127], v241, s[28:31], s83 offen offset:3072 sc1
    s_nop 0
L_o_run:
    global_load_dword v248, v244, s[48:49] sc1
    s_waitcnt vmcnt(32)
    v_mfma_f32_32x32x16_bf16 v[128:143], a[128:131], a[0:3], 0
    buffer_load_dwordx4 a[0:3], v240, s[28:31], s84 offen offset:0 sc1
    s_waitcnt vmcnt(32)
    v_mfma_f32_32x32x16_bf16 v[128:143], a[132:135], a[4:7], v[128:143]
    buffer_load_dwordx4 a[4:7], v240, s[28:31], s84 offen offset:1024 sc1
    s_waitcnt vmcnt(32)
    v_mfma_f32_32x32x16_bf16 v[128:143], a[136:139], a[8:11], v[128:143]
    buffer_load_dwordx4 a[8:11], v240, s[28:31], s84 offen offset:2048 sc1
    s_waitcnt vmcnt(32)
    v_mfma_f32_32x32x16_bf16 v[128:143], a[140:143], a[12:15], v[128:143]
    buffer_load_dwordx4 a[12:15], v240, s[28:31], s84 offen offset:3072 sc1
    s_waitcnt vmcnt(32)
    v_mfma_f32_32x32x16_bf16 v[128:143], a[144:147], a[16:19], v[128:143]
    buffer_load_dwordx4 a[16:19], v241, s[28:31], s84 offen offset:0 sc1
    s_waitcnt vmcnt(32)
    v_mfma_f32_32x32x16_bf16 v[128:143], a[148:151], a[20:23], v[128:143]
    buffer_load_dwordx4 a[20:23], v241, s[28:31], s84 offen offset:1024 sc1
    s_waitcnt vmcnt(32)
    v_mfma_f32_32x32x16_bf16 v[128:143], a[152:155], a[24:27], v[128:143]
    buffer_load_dwordx4 a[24:27], v241, s[28:31], s84 offen offset:2048 sc1
    s_waitcnt vmcnt(32)
    v_mfma_f32_32x32x16_bf16 v[128:143], a[156:159], a[28:31], v[128:143]
    buffer_load_dwordx4 a[28:31], v241, s[28:31], s84 offen offset:3072 sc1
    s_waitcnt vmcnt(32)
    v_mfma_f32_32x32x16_bf16 v[128:143], a[160:163], a[32:35], v[128:143]
    buffer_load_dwordx4 a[32:35], v240, s[28:31], s85 offen offset:0 sc1
    s_waitcnt vmcnt(32)
    v_mfma_f32_32x32x16_bf16 v[128:143], a[164:167], a[36:39], v[128:143]
    buffer_load_dwordx4 a[36:39], v240, s[28:31], s85 offen offset:1024 sc1
    s_waitcnt vmcnt(32)
    v_mfma_f32_32x32x16_bf16 v[128:143], a[168:171], a[40:43], v[128:143]
    buffer_load_dwordx4 a[40:43], v240, s[28:31], s85 offen offset:2048 sc1
    s_waitcnt vmcnt(32)
    v_mfma_f32_32x32x16_bf16 v[128:143], a[172:175], a[44:47], v[128:143]
    buffer_load_dwordx4 a[44:47], v240, s[28:31], s85 offen offset:3072 sc1
    s_waitcnt vmcnt(32)
    v_mfma_f32_32x32x16_bf16 v[128:143], a[176:179], a[48:51], v[128:143]
    buffer_load_dwordx4 a[48:51], v241, s[28:31], s85 offen offset:0 sc1
    s_waitcnt vmcnt(32)
    v_mfma_f32_32x32x16_bf16 v[128:143], a[180:183], a[52:55], v[128:143]
    buffer_load_dwordx4 a[52:55], v241, s[28:31], s85 offen offset:1024 sc1
    s_waitcnt vmcnt(32)
    v_mfma_f32_32x32x16_bf16 v[128:143], a[184:187], a[56:59], v[128:143]
    buffer_load_dwordx4 a[56:59], v241, s[28:31], s85 offen offset:2048 sc1
    s_waitcnt vmcnt(32)
    v_mfma_f32_32x32x16_bf16 v[128:143], a[188:191], a[60:63], v[128:143]
    buffer_load_dwordx4 a[60:63], v241, s[28:31], s85 offen offset:3072 sc1
    s_waitcnt vmcnt(32)
    v_mfma_f32_32x32x16_bf16 v[128:143], a[192:195], a[64:67], v[128:143]
    buffer_load_dwordx4 a[64:67], v240, s[28:31], s86 offen offset:0 sc1
    s_waitcnt vmcnt(32)
    v_mfma_f32_32x32x16_bf16 v[128:143], a[196:199], a[68:71], v[128:143]
    buffer_load_dwordx4 a[68:71], v240, s[28:31], s86 offen offset:1024 sc1
    s_waitcnt vmcnt(32)
    v_mfma_f32_32x32x16_bf16 v[128:143], a[200:203], a[72:75], v[128:143]
    buffer_load_dwordx4 a[72:75], v240, s[28:31], s86 offen offset:2048 sc1
    s_waitcnt vmcnt(32)
    v_mfma_f32_32x32x16_bf16 v[128:143], a[204:207], a[76:79], v[128:143]
    buffer_load_dwordx4 a[76:79], v240, s[28:31], s86 offen offset:3072 sc1
    s_waitcnt vmcnt(32)
    v_mfma_f32_32x32x16_bf16 v[128:143], a[208:211], a[80:83], v[128:143]
    buffer_load_dwordx4 a[80:83], v241, s[28:31], s86 offen offset:0 sc1
    s_waitcnt vmcnt(32)
    v_mfma_f32_32x32x16_bf16 v[128:143], a[212:215], a[84:87], v[128:143]
    buffer_load_dwordx4 a[84:87], v241, s[28:31], s86 offen offset:1024 sc1
    s_waitcnt vmcnt(32)
    v_mfma_f32_32x32x16_bf16 v[128:143], a[216:219], a[88:91], v[128:143]
    buffer_load_dwordx4 a[88:91], v241, s[28:31], s86 offen offset:2048 sc1
    s_waitcnt vmcnt(32)
    v_mfma_f32_32x32x16_bf16 v[128:143], a[220:223], a[92:95], v[128:143]
    buffer_load_dwordx4 a[92:95], v241, s[28:31], s86 offen offset:3072 sc1
    s_waitcnt vmcnt(32)
    v_mfma_f32_32x32x16_bf16 v[128:143], a[224:227], a[96:99], v[128:143]
    buffer_load_dwordx4 a[96:99], v240, s[28:31], s87 offen offset:0 sc1
    s_waitcnt vmcnt(32)
    v_mfma_f32_32x32x16_bf16 v[128:143], a[228:231], a[100:103], v[128:143]
    buffer_load_dwordx4 a[100:103], v240, s[28:31], s87 offen offset:1024 sc1
    s_waitcnt vmcnt(32)
    v_mfma_f32_32x32x16_bf16 v[128:143], a[232:235], a[104:107], v[128:143]
    buffer_load_dwordx4 a[104:107], v240, s[28:31], s87 offen offset:2048 sc1
    s_waitcnt vmcnt(32)
    v_mfma_f32_32x32x16_bf16 v[128:143], a[236:239], a[108:111], v[128:143]
    buffer_load_dwordx4 a[108:111], v240, s[28:31], s87 offen offset:3072 sc1
    s_waitcnt vmcnt(32)
    v_mfma_f32_32x32x16_bf16 v[128:143], a[240:243], a[112:115], v[128:143]
    buffer_load_dwordx4 a[112:115], v241, s[28:31], s87 offen offset:0 sc1
    s_waitcnt vmcnt(32)
    v_mfma_f32_32x32x16_bf16 v[128:143], a[244:247], a[116:119], v[128:143]
    buffer_load_dwordx4 a[116:119], v241, s[28:31], s87 offen offset:1024 sc1
    s_waitcnt vmcnt(32)
    v_mfma_f32_32x32x16_bf16 v[128:143], a[248:251], a[120:123], v[128:143]
    buffer_load_dwordx4 a[120:123], v241, s[28:31], s87 offen offset:2048 sc1
    s_waitcnt vmcnt(32)
    v_mfma_f32_32x32x16_bf16 v[128:143], a[252:255], a[124:127], v[128:143]
    buffer_load_dwordx4 a[124:127], v241, s[28:31], s87 offen offset:3072 sc1
    s_add_u32 s28, s28, 1048576
    s_addc_u32 s29, s29, 0
    s_waitcnt vmcnt(32)
    v_cmp_ge_u32 vcc, s26, v248
    s_cmp_ge_u32 s26, 16
    s_cbranch_scc1 L_o_drain
    s_cbranch_vccnz L_o_drain
    s_waitcnt vmcnt(31)
    v_mfma_f32_32x32x16_bf16 v[128:143], v[0:3], a[0:3], v[128:143]
    buffer_load_dwordx4 a[0:3], v240, s[28:31], s80 offen offset:0 sc1
    s_waitcnt vmcnt(31)
    v_mfma_f32_32x32x16_bf16 v[128:143], v[4:7], a[4:7], v[128:143]
    buffer_load_dwordx4 a[4:7], v240, s[28:31], s80 offen offset:1024 sc1
    s_waitcnt vmcnt(31)
    v_mfma_f32_32x32x16_bf16 v[128:143], v[8:11], a[8:11], v[128:143]
    buffer_load_dwordx4 a[8:11], v240, s[28:31], s80 offen offset:2048 sc1
    s_waitcnt vmcnt(31)
    v_mfma_f32_32x32x16_bf16 v[128:143], v[12:15], a[12:15], v[128:143]
    buffer_load_dwordx4 a[12:15], v240, s[28:31], s80 offen offset:3072 sc1
    s_waitcnt vmcnt(31)
    v_mfma_f32_32x32x16_bf16 v[128:143], v[16:19], a[16:19], v[128:143]
    buffer_load_dwordx4 a[16:19], v241, s[28:31], s80 offen offset:0 sc1
    s_waitcnt vmcnt(31)
    v_mfma_f32_32x32x16_bf16 v[128:143], v[20:23], a[20:23], v[128:143]
    buffer_load_dwordx4 a[20:23], v241, s[28:31], s80 offen offset:1024 sc1
    s_waitcnt vmcnt(31)
    v_mfma_f32_32x32x16_bf16 v[128:143], v[24:27], a[24:27], v[128:143]
    buffer_load_dwordx4 a[24:27], v241, s[28:31], s80 offen offset:2048 sc1
    s_waitcnt vmcnt(31)
    v_mfma_f32_32x32x16_bf16 v[128:143], v[28:31], a[28:31], v[128:143]
    buffer_load_dwordx4 a[28:31], v241, s[28:31], s80 offen offset:3072 sc1
    s_waitcnt vmcnt(31)
    v_mfma_f32_32x32x16_bf16 v[128:143], v[32:35], a[32:35], v[128:143]
    buffer_load_dwordx4 a[32:35], v240, s[28:31], s81 offen offset:0 sc1
    s_waitcnt vmcnt(31)
    v_mfma_f32_32x32x16_bf16 v[128:143], v[36:39], a[36:39], v[128:143]
    buffer_load_dwordx4 a[36:39], v240, s[28:31], s81 offen offset:1024 sc1
    s_waitcnt vmcnt(31)
    v_mfma_f32_32x32x16_bf16 v[128:143], v[40:43], a[40:43], v[128:143]
    buffer_load_dwordx4 a[40:43], v240, s[28:31], s81 offen offset:2048 sc1
    s_waitcnt vmcnt(31)
    v_mfma_f32_32x32x16_bf16 v[128:143], v[44:47], a[44:47], v[128:143]
    buffer_load_dwordx4 a[44:47], v240, s[28:31], s81 offen offset:3072 sc1
    s_waitcnt vmcnt(31)
    v_mfma_f32_32x32x16_bf16 v[128:143], v[48:51], a[48:51], v[128:143]
    buffer_load_dwordx4 a[48:51], v241, s[28:31], s81 offen offset:0 sc1
    s_waitcnt vmcnt(31)
    v_mfma_f32_32x32x16_bf16 v[128:143], v[52:55], a[52:55], v[128:143]
    buffer_load_dwordx4 a[52:55], v241, s[28:31], s81 offen offset:1024 sc1
    s_waitcnt vmcnt(31)
    v_mfma_f32_32x32x16_bf16 v[128:143], v[56:59], a[56:59], v[128:143]
    buffer_load_dwordx4 a[56:59], v241, s[28:31], s81 offen offset:2048 sc1
    s_waitcnt vmcnt(31)
    v_mfma_f32_32x32x16_bf16 v[128:143], v[60:63], a[60:63], v[128:143]
    buffer_load_dwordx4 a[60:63], v241, s[28:31], s81 offen offset:3072 sc1
    s_waitcnt vmcnt(31)
    v_mfma_f32_32x32x16_bf16 v[128:143], v[64:67], a[64:67], v[128:143]
    buffer_load_dwordx4 a[64:67], v240, s[28:31], s82 offen offset:0 sc1
    s_waitcnt vmcnt(31)
    v_mfma_f32_32x32x16_bf16 v[128:143], v[68:71], a[68:71], v[128:143]
    buffer_load_dwordx4 a[68:71], v240, s[28:31], s82 offen offset:1024 sc1
    s_waitcnt vmcnt(31)
    v_mfma_f32_32x32x16_bf16 v[128:143], v[72:75], a[72:75], v[128:143]
    buffer_load_dwordx4 a[72:75], v240, s[28:31], s82 offen offset:2048 sc1
    s_waitcnt vmcnt(31)
    v_mfma_f32_32x32x16_bf16 v[128:143], v[76:79], a[76:79], v[128:143]
    buffer_load_dwordx4 a[76:79], v240, s[28:31], s82 offen offset:3072 sc1
    s_waitcnt vmcnt(31)
    v_mfma_f32_32x32x16_bf16 v[128:143], v[80:83], a[80:83], v[128:143]
    buffer_load_dwordx4 a[80:83], v241, s[28:31], s82 offen offset:0 sc1
    s_waitcnt vmcnt(31)
    v_mfma_f32_32x32x16_bf16 v[128:143], v[84:87], a[84:87], v[128:143]
    buffer_load_dwordx4 a[84:87], v241, s[28:31], s82 offen offset:1024 sc1
    s_waitcnt vmcnt(31)
    v_mfma_f32_32x32x16_bf16 v[128:143], v[88:91], a[88:91], v[128:143]
    buffer_load_dwordx4 a[88:91], v241, s[28:31], s82 offen offset:2048 sc1
    s_waitcnt vmcnt(31)
    v_mfma_f32_32x32x16_bf16 v[128:143], v[92:95], a[92:95], v[128:143]
    buffer_load_dwordx4 a[92:95], v241, s[28:31], s82 offen offset:3072 sc1
    s_waitcnt vmcnt(31)
    v_mfma_f32_32x32x16_bf16 v[128:143], v[96:99], a[96:99], v[128:143]
    buffer_load_dwordx4 a[96:99], v240, s[28:31], s83 offen offset:0 sc1
    s_waitcnt vmcnt(31)
    v_mfma_f32_32x32x16_bf16 v[128:143], v[100:103], a[100:103], v[128:143]
    buffer_load_dwordx4 a[100:103], v240, s[28:31], s83 offen offset:1024 sc1
    s_waitcnt vmcnt(31)
    v_mfma_f32_32x32x16_bf16 v[128:143], v[104:107], a[104:107], v[128:143]
    buffer_load_dwordx4 a[104:107], v240, s[28:31], s83 offen offset:2048 sc1
    s_waitcnt vmcnt(31)
    v_mfma_f32_32x32x16_bf16 v[128:143], v[108:111], a[108:111], v[128:143]
    buffer_load_dwordx4 a[108:111], v240, s[28:31], s83 offen offset:3072 sc1
    s_waitcnt vmcnt(31)
    v_mfma_f32_32x32x16_bf16 v[128:143], v[112:115], a[112:115], v[128:143]
    buffer_load_dwordx4 a[112:115], v241, s[28:31], s83 offen offset:0 sc1
    s_waitcnt vmcnt(31)
    v_mfma_f32_32x32x16_bf16 v[128:143], v[116:119], a[116:119], v[128:143]
    buffer_load_dwordx4 a[116:119], v241, s[28:31], s83 offen offset:1024 sc1
    s_waitcnt vmcnt(31)
    v_mfma_f32_32x32x16_bf16 v[128:143], v[120:123], a[120:123], v[128:143]
    buffer_load_dwordx4 a[120:123], v241, s[28:31], s83 offen offset:2048 sc1
    s_waitcnt vmcnt(31)
    v_mfma_f32_32x32x16_bf16 v[128:143], v[124:127], a[124:127], v[128:143]
    buffer_load_dwordx4 a[124:127], v241, s[28:31], s83 offen offset:3072 sc1
    s_nop 10
    ds_write_b128 v242, v[128:131] offset:0
    ds_write_b128 v242, v[132:135] offset:1024
    ds_write_b128 v242, v[136:139] offset:2048
    ds_write_b128 v242, v[140:143] offset:3072
    s_waitcnt lgkmcnt(0)
    s_barrier
    ds_read_b128 v[144:147], v243 offset:0
    ds_read_b128 v[148:151], v243 offset:4096
    ds_read_b128 v[152:155], v243 offset:8192
    ds_read_b128 v[156:159], v243 offset:12288
    v_xor_b32 v242, 0x4000, v242
    v_xor_b32 v243, 0x4000, v243
    s_waitcnt lgkmcnt(0)
    v_pk_add_f32 v[144:145], v[144:145], v[148:149]
    v_pk_add_f32 v[146:147], v[146:147], v[150:151]
    v_pk_add_f32 v[152:153], v[152:153], v[156:157]
    v_pk_add_f32 v[154:155], v[154:155], v[158:159]
    v_pk_add_f32 v[144:145], v[144:145], v[152:153]
    v_pk_add_f32 v[146:147], v[146:147], v[154:155]
    v_cvt_pk_bf16_f32 v160, v144, v145
    v_cvt_pk_bf16_f32 v161, v146, v147
    global_store_dwordx2 v245, v[160:161], s[46:47]
    s_add_u32 s46, s46, 262144
    s_addc_u32 s47, s47, 0
    s_add_u32 s26, s26, 1
    s_branch L_o_run
L_o_drain:
    s_waitcnt vmcnt(31)
    v_mfma_f32_32x32x16_bf16 v[128:143], v[0:3], a[0:3], v[128:143]
    s_waitcnt vmcnt(30)
    v_mfma_f32_32x32x16_bf16 v[128:143], v[4:7], a[4:7], v[128:143]
    s_waitcnt vmcnt(29)
    v_mfma_f32_32x32x16_bf16 v[128:143], v[8:11], a[8:11], v[128:143]
    s_waitcnt vmcnt(28)
    v_mfma_f32_32x32x16_bf16 v[128:143], v[12:15], a[12:15], v[128:143]
    s_waitcnt vmcnt(27)
    v_mfma_f32_32x32x16_bf16 v[128:143], v[16:19], a[16:19], v[128:143]
    s_waitcnt vmcnt(26)
    v_mfma_f32_32x32x16_bf16 v[128:143], v[20:23], a[20:23], v[128:143]
    s_waitcnt vmcnt(25)
    v_mfma_f32_32x32x16_bf16 v[128:143], v[24:27], a[24:27], v[128:143]
    s_waitcnt vmcnt(24)
    v_mfma_f32_32x32x16_bf16 v[128:143], v[28:31], a[28:31], v[128:143]
    s_waitcnt vmcnt(23)
    v_mfma_f32_32x32x16_bf16 v[128:143], v[32:35], a[32:35], v[128:143]
    s_waitcnt vmcnt(22)
    v_mfma_f32_32x32x16_bf16 v[128:143], v[36:39], a[36:39], v[128:143]
    s_waitcnt vmcnt(21)
    v_mfma_f32_32x32x16_bf16 v[128:143], v[40:43], a[40:43], v[128:143]
    s_waitcnt vmcnt(20)
    v_mfma_f32_32x32x16_bf16 v[128:143], v[44:47], a[44:47], v[128:143]
    s_waitcnt vmcnt(19)
    v_mfma_f32_32x32x16_bf16 v[128:143], v[48:51], a[48:51], v[128:143]
    s_waitcnt vmcnt(18)
    v_mfma_f32_32x32x16_bf16 v[128:143], v[52:55], a[52:55], v[128:143]
    s_waitcnt vmcnt(17)
    v_mfma_f32_32x32x16_bf16 v[128:143], v[56:59], a[56:59], v[128:143]
    s_waitcnt vmcnt(16)
    v_mfma_f32_32x32x16_bf16 v[128:143], v[60:63], a[60:63], v[128:143]
    s_waitcnt vmcnt(15)
    v_mfma_f32_32x32x16_bf16 v[128:143], v[64:67], a[64:67], v[128:143]
    s_waitcnt vmcnt(14)
    v_mfma_f32_32x32x16_bf16 v[128:143], v[68:71], a[68:71], v[128:143]
    s_waitcnt vmcnt(13)
    v_mfma_f32_32x32x16_bf16 v[128:143], v[72:75], a[72:75], v[128:143]
    s_waitcnt vmcnt(12)
    v_mfma_f32_32x32x16_bf16 v[128:143], v[76:79], a[76:79], v[128:143]
    s_waitcnt vmcnt(11)
    v_mfma_f32_32x32x16_bf16 v[128:143], v[80:83], a[80:83], v[128:143]
    s_waitcnt vmcnt(10)
    v_mfma_f32_32x32x16_bf16 v[128:143], v[84:87], a[84:87], v[128:143]
    s_waitcnt vmcnt(9)
    v_mfma_f32_32x32x16_bf16 v[128:143], v[88:91], a[88:91], v[128:143]
    s_waitcnt vmcnt(8)
    v_mfma_f32_32x32x16_bf16 v[128:143], v[92:95], a[92:95], v[128:143]
    s_waitcnt vmcnt(7)
    v_mfma_f32_32x32x16_bf16 v[128:143], v[96:99], a[96:99], v[128:143]
    s_waitcnt vmcnt(6)
    v_mfma_f32_32x32x16_bf16 v[128:143], v[100:103], a[100:103], v[128:143]
    s_waitcnt vmcnt(5)
    v_mfma_f32_32x32x16_bf16 v[128:143], v[104:107], a[104:107], v[128:143]
    s_waitcnt vmcnt(4)
    v_mfma_f32_32x32x16_bf16 v[128:143], v[108:111], a[108:111], v[128:143]
    s_waitcnt vmcnt(3)
    v_mfma_f32_32x32x16_bf16 v[128:143], v[112:115], a[112:115], v[128:143]
    s_waitcnt vmcnt(2)
    v_mfma_f32_32x32x16_bf16 v[128:143], v[116:119], a[116:119], v[128:143]
    s_waitcnt vmcnt(1)
    v_mfma_f32_32x32x16_bf16 v[128:143], v[120:123], a[120:123], v[128:143]
    s_waitcnt vmcnt(0)
    v_mfma_f32_32x32x16_bf16 v[128:143], v[124:127], a[124:127], v[128:143]
    s_nop 11
    ds_write_b128 v242, v[128:131] offset:0
    ds_write_b128 v242, v[132:135] offset:1024
    ds_write_b128 v242, v[136:139] offset:2048
    ds_write_b128 v242, v[140:143] offset:3072
    s_waitcnt lgkmcnt(0)
    s_barrier
    ds_read_b128 v[144:147], v243 offset:0
    ds_read_b128 v[148:151], v243 offset:4096
    ds_read_b128 v[152:155], v243 offset:8192
    ds_read_b128 v[156:159], v243 offset:12288
    v_xor_b32 v242, 0x4000, v242
    v_xor_b32 v243, 0x4000, v243
    s_waitcnt lgkmcnt(0)
    v_pk_add_f32 v[144:145], v[144:145], v[148:149]
    v_pk_add_f32 v[146:147], v[146:147], v[150:151]
    v_pk_add_f32 v[152:153], v[152:153], v[156:157]
    v_pk_add_f32 v[154:155], v[154:155], v[158:159]
    v_pk_add_f32 v[144:145], v[144:145], v[152:153]
    v_pk_add_f32 v[146:147], v[146:147], v[154:155]
    v_cvt_pk_bf16_f32 v160, v144, v145
    v_cvt_pk_bf16_f32 v161, v146, v147
    global_store_dwordx2 v245, v[160:161], s[46:47]
    s_add_u32 s46, s46, 262144
    s_addc_u32 s47, s47, 0
    s_add_u32 s26, s26, 1
    s_cmp_le_u32 s26, 16
    s_cbranch_scc1 L_o_cold
    s_endpgm
L_qw:
    v_lshlrev_b32 v240, 4, v0
    v_add_u32 v241, 0x10000, v240
    v_mov_b32 v246, 0
    s_mov_b32 s68, 0x05040100
    s_mov_b32 s69, 0x07060302
    s_mov_b32 s32, 0
    s_mov_b32 s33, 4096
    s_mov_b32 s34, 8192
    s_mov_b32 s35, 12288
    s_mov_b32 s36, 16384
    s_mov_b32 s37, 20480
    s_mov_b32 s38, 24576
    s_mov_b32 s39, 28672
    v_lshrrev_b32 v1, 5, v0
    v_lshlrev_b32 v1, 8, v1
    v_and_b32 v2, 8, v0
    v_lshl_add_u32 v2, v2, 7, v1
    v_and_b32 v3, 16, v0
    v_lshl_add_u32 v2, v3, 3, v2
    v_and_b32 v3, 7, v0
    v_lshl_add_u32 v242, v3, 4, v2
    v_and_b32 v3, 16, v0
    v_lshl_add_u32 v2, v3, 6, v1
    v_and_b32 v3, 15, v0
    v_lshl_add_u32 v2, v3, 4, v2
    v_add_u32 v243, 0x800, v2
L_q_c1:
    s_lshl_b32 s58, s23, 12
    s_lshl_b32 s59, s24, 7
    s_add_u32 s58, s58, s59
    s_add_u32 s58, s58, 61915136
    s_add_u32 s42, s20, s58
    s_addc_u32 s43, s21, 0
    s_mov_b64 exec, 1
    global_store_dword v246, v246, s[42:43] sc1
    s_mov_b64 exec, -1
    s_mov_b32 s52, s4
    s_and_b32 s53, s5, 0xffff
    s_mov_b32 s54, 2097152
    s_mov_b32 s55, 0x20000
    s_lshr_b32 s58, s23, 1
    s_lshl_b32 s58, s58, 5
    s_add_u32 s58, s58, s24
    s_lshl_b32 s58, s58, 15
    s_and_b32 s59, s23, 1
    s_lshl_b32 s60, s59, 9
    s_add_u32 s40, s58, s60
    s_lshl_b32 s59, s59, 14
    s_add_u32 s58, s58, s59
    s_add_u32 s58, s58, 58720256
    s_add_u32 s28, s20, s58
    s_addc_u32 s29, s21, 0
    s_mov_b32 s30, 0x4000
    s_mov_b32 s31, 0x20000
    s_lshl_b32 s60, s23, 14
    v_lshrrev_b32 v1, 5, v0
    v_and_b32 v2, 31, v0
    v_xor_b32 v3, v2, v1
    v_lshlrev_b32 v3, 4, v3
    v_lshl_add_u32 v3, v1, 10, v3
    v_xor_b32 v8, 0, v3
    s_add_u32 m0, s60, 0
    s_add_u32 s61, s40, 0
    buffer_load_dwordx4 v8, s[52:55], s61 offen  lds
    v_xor_b32 v9, 32, v3
    s_add_u32 m0, s60, 1024
    s_add_u32 s61, s40, 2048
    buffer_load_dwordx4 v9, s[52:55], s61 offen  lds
    v_xor_b32 v10, 64, v3
    s_add_u32 m0, s60, 2048
    s_add_u32 s61, s40, 4096
    buffer_load_dwordx4 v10, s[52:55], s61 offen  lds
    v_xor_b32 v11, 96, v3
    s_add_u32 m0, s60, 3072
    s_add_u32 s61, s40, 6144
    buffer_load_dwordx4 v11, s[52:55], s61 offen  lds
    v_xor_b32 v12, 128, v3
    s_add_u32 m0, s60, 4096
    s_add_u32 s61, s40, 8192
    buffer_load_dwordx4 v12, s[52:55], s61 offen  lds
    v_xor_b32 v13, 160, v3
    s_add_u32 m0, s60, 5120
    s_add_u32 s61, s40, 10240
    buffer_load_dwordx4 v13, s[52:55], s61 offen  lds
    v_xor_b32 v14, 192, v3
    s_add_u32 m0, s60, 6144
    s_add_u32 s61, s40, 12288
    buffer_load_dwordx4 v14, s[52:55], s61 offen  lds
    v_xor_b32 v15, 224, v3
    s_add_u32 m0, s60, 7168
    s_add_u32 s61, s40, 14336
    buffer_load_dwordx4 v15, s[52:55], s61 offen  lds
    s_nop 0
    s_add_u32 m0, s60, 8192
    s_add_u32 s61, s40, 16384
    buffer_load_dwordx4 v8, s[52:55], s61 offen  lds
    s_nop 0
    s_add_u32 m0, s60, 9216
    s_add_u32 s61, s40, 18432
    buffer_load_dwordx4 v9, s[52:55], s61 offen  lds
    s_nop 0
    s_add_u32 m0, s60, 10240
    s_add_u32 s61, s40, 20480
    buffer_load_dwordx4 v10, s[52:55], s61 offen  lds
    s_nop 0
    s_add_u32 m0, s60, 11264
    s_add_u32 s61, s40, 22528
    buffer_load_dwordx4 v11, s[52:55], s61 offen  lds
    s_nop 0
    s_add_u32 m0, s60, 12288
    s_add_u32 s61, s40, 24576
    buffer_load_dwordx4 v12, s[52:55], s61 offen  lds
    s_nop 0
    s_add_u32 m0, s60, 13312
    s_add_u32 s61, s40, 26624
    buffer_load_dwordx4 v13, s[52:55], s61 offen  lds
    s_nop 0
    s_add_u32 m0, s60, 14336
    s_add_u32 s61, s40, 28672
    buffer_load_dwordx4 v14, s[52:55], s61 offen  lds
    s_nop 0
    s_add_u32 m0, s60, 15360
    s_add_u32 s61, s40, 30720
    buffer_load_dwordx4 v15, s[52:55], s61 offen  lds
    v_and_b32 v4, 15, v0
    v_xor_b32 v4, v4, v1
    v_lshlrev_b32 v4, 4, v4
    v_lshl_add_u32 v4, v2, 9, v4
    v_add_u32 v4, s60, v4
    v_xor_b32 v16, 0, v4
    v_xor_b32 v17, 32, v4
    v_xor_b32 v18, 64, v4
    v_xor_b32 v19, 96, v4
    v_xor_b32 v20, 128, v4
    v_xor_b32 v21, 160, v4
    v_xor_b32 v22, 192, v4
    v_xor_b32 v23, 224, v4
    s_waitcnt vmcnt(0)
    ds_read_b128 v[32:35], v16 offset:0
    ds_read_b128 v[36:39], v17 offset:0
    ds_read_b128 v[40:43], v18 offset:0
    ds_read_b128 v[44:47], v19 offset:0
    ds_read_b128 v[48:51], v20 offset:0
    ds_read_b128 v[52:55], v21 offset:0
    ds_read_b128 v[56:59], v22 offset:0
    ds_read_b128 v[60:63], v23 offset:0
    s_waitcnt lgkmcnt(7)
    ds_read_b128 v[64:67], v16 offset:256
    ds_read_b128 v[68:71], v17 offset:256
    ds_read_b128 v[72:75], v18 offset:256
    ds_read_b128 v[76:79], v19 offset:256
    ds_read_b128 v[80:83], v20 offset:256
    ds_read_b128 v[84:87], v21 offset:256
    ds_read_b128 v[88:91], v22 offset:256
    ds_read_b128 v[92:95], v23 offset:256
    buffer_store_dwordx4 v[32:35], v240, s[28:31], s32 offen offset:0 sc1
    s_waitcnt lgkmcnt(14)
    buffer_store_dwordx4 v[36:39], v240, s[28:31], s32 offen offset:1024 sc1
    s_waitcnt lgkmcnt(13)
    buffer_store_dwordx4 v[40:43], v240, s[28:31], s32 offen offset:2048 sc1
    s_waitcnt lgkmcnt(12)
    buffer_store_dwordx4 v[44:47], v240, s[28:31], s32 offen offset:3072 sc1
    s_waitcnt lgkmcnt(11)
    buffer_store_dwordx4 v[48:51], v240, s[28:31], s33 offen offset:0 sc1
    s_waitcnt lgkmcnt(10)
    buffer_store_dwordx4 v[52:55], v240, s[28:31], s33 offen offset:1024 sc1
    s_waitcnt lgkmcnt(9)
    buffer_store_dwordx4 v[56:59], v240, s[28:31], s33 offen offset:2048 sc1
    s_waitcnt lgkmcnt(8)
    buffer_store_dwordx4 v[60:63], v240, s[28:31], s33 offen offset:3072 sc1
    s_waitcnt lgkmcnt(7)
    buffer_store_dwordx4 v[64:67], v240, s[28:31], s34 offen offset:0 sc1
    s_waitcnt lgkmcnt(6)
    buffer_store_dwordx4 v[68:71], v240, s[28:31], s34 offen offset:1024 sc1
    s_waitcnt lgkmcnt(5)
    buffer_store_dwordx4 v[72:75], v240, s[28:31], s34 offen offset:2048 sc1
    s_waitcnt lgkmcnt(4)
    buffer_store_dwordx4 v[76:79], v240, s[28:31], s34 offen offset:3072 sc1
    s_waitcnt lgkmcnt(3)
    buffer_store_dwordx4 v[80:83], v240, s[28:31], s35 offen offset:0 sc1
    s_waitcnt lgkmcnt(2)
    buffer_store_dwordx4 v[84:87], v240, s[28:31], s35 offen offset:1024 sc1
    s_waitcnt lgkmcnt(1)
    buffer_store_dwordx4 v[88:91], v240, s[28:31], s35 offen offset:2048 sc1
    s_waitcnt lgkmcnt(0)
    buffer_store_dwordx4 v[92:95], v240, s[28:31], s35 offen offset:3072 sc1
    s_waitcnt vmcnt(0) lgkmcnt(0)
    s_barrier
    s_cmp_eq_u32 s23, 0
    s_cbranch_scc0 L_q_noarr
    s_mov_b64 exec, 1
    s_lshl_b32 s58, s3, 5
    s_add_u32 s58, s58, 208
    v_mov_b32 v252, s58
    v_mov_b32 v253, 1
    global_atomic_add v252, v253, s[18:19]
    s_mov_b64 exec, -1
L_q_noarr:
    v_mov_b32 v249, v0
    v_mov_b32 v249, v0
    v_lshrrev_b32 v2, 4, v0
    v_lshlrev_b32 v3, 2, v2
    v_and_b32 v1, 15, v0
    v_xor_b32 v1, v1, v3
    v_lshlrev_b32 v3, 13, v2
    v_lshl_add_u32 v3, v1, 4, v3
    s_lshl_b32 s58, s23, 15
    s_lshl_b32 s59, s24, 8
    s_add_u32 s58, s58, s59
    v_add_u32 v248, s58, v3
    s_lshl_b32 s60, s23, 10
    v_lshrrev_b32 v1, 5, v0
    v_lshlrev_b32 v1, 11, v1
    v_and_b32 v2, 12, v0
    v_lshl_add_u32 v1, v2, 6, v1
    v_lshl_add_u32 v1, v2, 4, v1
    v_and_b32 v2, 1, v0
    v_lshl_add_u32 v1, v2, 3, v1
    v_and_b32 v2, 2, v0
    v_and_b32 v3, 16, v0
    v_lshl_add_u32 v1, v2, 4, v1
    v_add_u32 v1, v3, v1
    v_xor_b32 v120, 0, v1
    v_add_u32 v121, 0x10000, v120
    v_xor_b32 v122, 64, v1
    v_add_u32 v123, 0x10000, v122
    v_xor_b32 v124, 128, v1
    v_add_u32 v125, 0x10000, v124
    v_xor_b32 v126, 192, v1
    v_add_u32 v127, 0x10000, v126
    s_mov_b32 s28, s8
    s_and_b32 s29, s9, 0xffff
    s_mov_b32 s30, 4194304
    s_mov_b32 s31, 0x20000
    s_add_u32 m0, s60, 0
    s_mov_b32 s61, 0
    buffer_load_dwordx4 v248, s[28:31], s61 offen  lds
    s_add_u32 m0, s60, 4096
    s_mov_b32 s61, 131072
    buffer_load_dwordx4 v248, s[28:31], s61 offen  lds
    s_add_u32 m0, s60, 8192
    s_mov_b32 s61, 262144
    buffer_load_dwordx4 v248, s[28:31], s61 offen  lds
    s_add_u32 m0, s60, 12288
    s_mov_b32 s61, 393216
    buffer_load_dwordx4 v248, s[28:31], s61 offen  lds
    s_add_u32 m0, s60, 16384
    s_mov_b32 s61, 524288
    buffer_load_dwordx4 v248, s[28:31], s61 offen  lds
    s_add_u32 m0, s60, 20480
    s_mov_b32 s61, 655360
    buffer_load_dwordx4 v248, s[28:31], s61 offen  lds
    s_add_u32 m0, s60, 24576
    s_mov_b32 s61, 786432
    buffer_load_dwordx4 v248, s[28:31], s61 offen  lds
    s_add_u32 m0, s60, 28672
    s_mov_b32 s61, 917504
    buffer_load_dwordx4 v248, s[28:31], s61 offen  lds
    s_add_u32 m0, s60, 32768
    s_mov_b32 s61, 1048576
    buffer_load_dwordx4 v248, s[28:31], s61 offen  lds
    s_add_u32 m0, s60, 36864
    s_mov_b32 s61, 1179648
    buffer_load_dwordx4 v248, s[28:31], s61 offen  lds
    s_add_u32 m0, s60, 40960
    s_mov_b32 s61, 1310720
    buffer_load_dwordx4 v248, s[28:31], s61 offen  lds
    s_add_u32 m0, s60, 45056
    s_mov_b32 s61, 1441792
    buffer_load_dwordx4 v248, s[28:31], s61 offen  lds
    s_add_u32 m0, s60, 49152
    s_mov_b32 s61, 1572864
    buffer_load_dwordx4 v248, s[28:31], s61 offen  lds
    s_add_u32 m0, s60, 53248
    s_mov_b32 s61, 1703936
    buffer_load_dwordx4 v248, s[28:31], s61 offen  lds
    s_add_u32 m0, s60, 57344
    s_mov_b32 s61, 1835008
    buffer_load_dwordx4 v248, s[28:31], s61 offen  lds
    s_add_u32 m0, s60, 61440
    s_mov_b32 s61, 1966080
    buffer_load_dwordx4 v248, s[28:31], s61 offen  lds
    s_add_u32 m0, s60, 65536
    s_mov_b32 s61, 2097152
    buffer_load_dwordx4 v248, s[28:31], s61 offen  lds
    s_add_u32 m0, s60, 69632
    s_mov_b32 s61, 2228224
    buffer_load_dwordx4 v248, s[28:31], s61 offen  lds
    s_add_u32 m0, s60, 73728
    s_mov_b32 s61, 2359296
    buffer_load_dwordx4 v248, s[28:31], s61 offen  lds
    s_add_u32 m0, s60, 77824
    s_mov_b32 s61, 2490368
    buffer_load_dwordx4 v248, s[28:31], s61 offen  lds
    s_add_u32 m0, s60, 81920
    s_mov_b32 s61, 2621440
    buffer_load_dwordx4 v248, s[28:31], s61 offen  lds
    s_add_u32 m0, s60, 86016
    s_mov_b32 s61, 2752512
    buffer_load_dwordx4 v248, s[28:31], s61 offen  lds
    s_add_u32 m0, s60, 90112
    s_mov_b32 s61, 2883584
    buffer_load_dwordx4 v248, s[28:31], s61 offen  lds
    s_add_u32 m0, s60, 94208
    s_mov_b32 s61, 3014656
    buffer_load_dwordx4 v248, s[28:31], s61 offen  lds
    s_add_u32 m0, s60, 98304
    s_mov_b32 s61, 3145728
    buffer_load_dwordx4 v248, s[28:31], s61 offen  lds
    s_add_u32 m0, s60, 102400
    s_mov_b32 s61, 3276800
    buffer_load_dwordx4 v248, s[28:31], s61 offen  lds
    s_add_u32 m0, s60, 106496
    s_mov_b32 s61, 3407872
    buffer_load_dwordx4 v248, s[28:31], s61 offen  lds
    s_add_u32 m0, s60, 110592
    s_mov_b32 s61, 3538944
    buffer_load_dwordx4 v248, s[28:31], s61 offen  lds
    s_add_u32 m0, s60, 114688
    s_mov_b32 s61, 3670016
    buffer_load_dwordx4 v248, s[28:31], s61 offen  lds
    s_add_u32 m0, s60, 118784
    s_mov_b32 s61, 3801088
    buffer_load_dwordx4 v248, s[28:31], s61 offen  lds
    s_add_u32 m0, s60, 122880
    s_mov_b32 s61, 3932160
    buffer_load_dwordx4 v248, s[28:31], s61 offen  lds
    s_add_u32 m0, s60, 126976
    s_mov_b32 s61, 4063232
    buffer_load_dwordx4 v248, s[28:31], s61 offen  lds
    s_lshl_b32 s58, s24, 9
    s_add_u32 s60, s58, 61898752
    s_lshl_b32 s59, s23, 7
    s_add_u32 s58, s58, s59
    s_add_u32 s58, s58, 61865984
    s_add_u32 s48, s20, s58
    s_addc_u32 s49, s21, 0
    s_add_u32 s50, s20, s60
    s_addc_u32 s51, s21, 0
    v_and_b32 v254, 1, v249
    v_mul_u32_u24 v254, 16384, v254
    v_mov_b32 v255, 0
    v_lshrrev_b32 v250, 5, v249
    v_lshlrev_b32 v251, 8, v250
    v_and_b32 v252, 6, v249
    v_lshl_add_u32 v251, v252, 5, v251
    v_and_b32 v252, 1, v249
    v_lshl_add_u32 v244, v252, 4, v251
    v_lshlrev_b32 v251, 9, v250
    v_and_b32 v252, 15, v249
    v_or_b32 v252, 2, v252
    v_lshl_add_u32 v251, v252, 4, v251
    v_and_b32 v252, 16, v249
    v_lshrrev_b32 v252, 2, v252
    v_add_u32 v251, v251, v252
    v_and_b32 v252, 2, v249
    v_xor_b32 v252, 2, v252
    v_lshl_add_u32 v245, v252, 2, v251
    v_and_b32 v251, 31, v249
    v_lshlrev_b32 v250, 2, v250
    v_sub_u32 v251, v251, v250
    v_mov_b32 v252, 0xf149f2ca
    s_mov_b32 s67, 0x3e0293ee
    v_cmp_gt_i32 vcc, 0, v251
    s_nop 1
    v_cndmask_b32 v224, 0, v252, vcc
    v_cmp_gt_i32 vcc, 1, v251
    s_nop 1
    v_cndmask_b32 v225, 0, v252, vcc
    v_cmp_gt_i32 vcc, 2, v251
    s_nop 1
    v_cndmask_b32 v226, 0, v252, vcc
    v_cmp_gt_i32 vcc, 3, v251
    s_nop 1
    v_cndmask_b32 v227, 0, v252, vcc
    v_cmp_gt_i32 vcc, 8, v251
    s_nop 1
    v_cndmask_b32 v228, 0, v252, vcc
    v_cmp_gt_i32 vcc, 9, v251
    s_nop 1
    v_cndmask_b32 v229, 0, v252, vcc
    v_cmp_gt_i32 vcc, 10, v251
    s_nop 1
    v_cndmask_b32 v230, 0, v252, vcc
    v_cmp_gt_i32 vcc, 11, v251
    s_nop 1
    v_cndmask_b32 v231, 0, v252, vcc
    v_cmp_gt_i32 vcc, 16, v251
    s_nop 1
    v_cndmask_b32 v232, 0, v252, vcc
    v_cmp_gt_i32 vcc, 17, v251
    s_nop 1
    v_cndmask_b32 v233, 0, v252, vcc
    v_cmp_gt_i32 vcc, 18, v251
    s_nop 1
    v_cndmask_b32 v234, 0, v252, vcc
    v_cmp_gt_i32 vcc, 19, v251
    s_nop 1
    v_cndmask_b32 v235, 0, v252, vcc
    v_cmp_gt_i32 vcc, 24, v251
    s_nop 1
    v_cndmask_b32 v236, 0, v252, vcc
    v_cmp_gt_i32 vcc, 25, v251
    s_nop 1
    v_cndmask_b32 v237, 0, v252, vcc
    v_cmp_gt_i32 vcc, 26, v251
    s_nop 1
    v_cndmask_b32 v238, 0, v252, vcc
    v_cmp_gt_i32 vcc, 27, v251
    s_nop 1
    v_cndmask_b32 v239, 0, v252, vcc
    s_waitcnt vmcnt(0)
    s_barrier
    v_mbcnt_lo_u32_b32 v252, -1, 0
    v_and_b32 v252, 15, v252
    v_lshlrev_b32 v252, 4, v252
    s_lshl_b32 s59, s3, 1
    s_add_u32 s59, s59, 13
L_q_wa:
    global_load_dword v253, v252, s[18:19] sc1
    s_waitcnt vmcnt(0)
L_q_w0:
    v_readlane_b32 s58, v253, s59
    s_cmp_ge_u32 s58, 256
    s_cbranch_scc1 L_q_wb
    s_sleep 16
    s_sub_u32 s27, s27, 1
    s_cbranch_scc0 L_q_wa
    s_branch L_end
L_q_wb:
    s_cmp_eq_u32 s3, 1
    s_cbranch_scc1 L_q_wc
    v_cmp_ne_u32 vcc, 32, v253
    s_and_b32 s58, vcc_lo, 0x5555
    s_cbranch_scc0 L_q_wc
    global_load_dword v253, v252, s[18:19] sc1
    s_waitcnt vmcnt(0)
    v_cmp_ne_u32 vcc, 32, v253
    s_and_b32 s58, vcc_lo, 0x5555
    s_cbranch_scc1 L_safe
L_q_wc:
    s_lshl_b32 s58, s23, 15
    s_add_u32 s58, s58, 58720256
    s_add_u32 s28, s20, s58
    s_addc_u32 s29, s21, 0
    s_mov_b32 s30, 0x8000
    s_mov_b32 s31, 0x20000
    s_add_u32 s28, s28, 131072
    s_addc_u32 s29, s29, 0
    s_lshl_b32 s58, s23, 19
    s_lshl_b32 s59, s24, 14
    s_add_u32 s58, s58, s59
    s_add_u32 s52, s20, s58
    s_addc_u32 s53, s21, 0
    s_mov_b32 s54, 0x4000
    s_mov_b32 s55, 0x20000
    s_mov_b32 s26, 0
    s_sub_u32 s28, s28, 131072
    s_subb_u32 s29, s29, 0
    buffer_load_dwordx4 a[0:3], v240, s[28:31], s32 offen offset:0 sc1
    buffer_load_dwordx4 a[4:7], v240, s[28:31], s32 offen offset:1024 sc1
    buffer_load_dwordx4 a[8:11], v240, s[28:31], s32 offen offset:2048 sc1
    buffer_load_dwordx4 a[12:15], v240, s[28:31], s32 offen offset:3072 sc1
    buffer_load_dwordx4 a[16:19], v240, s[28:31], s33 offen offset:0 sc1
    buffer_load_dwordx4 a[20:23], v240, s[28:31], s33 offen offset:1024 sc1
    buffer_load_dwordx4 a[24:27], v240, s[28:31], s33 offen offset:2048 sc1
    buffer_load_dwordx4 a[28:31], v240, s[28:31], s33 offen offset:3072 sc1
    buffer_load_dwordx4 a[32:35], v240, s[28:31], s34 offen offset:0 sc1
    buffer_load_dwordx4 a[36:39], v240, s[28:31], s34 offen offset:1024 sc1
    buffer_load_dwordx4 a[40:43], v240, s[28:31], s34 offen offset:2048 sc1
    buffer_load_dwordx4 a[44:47], v240, s[28:31], s34 offen offset:3072 sc1
    buffer_load_dwordx4 a[48:51], v240, s[28:31], s35 offen offset:0 sc1
    buffer_load_dwordx4 a[52:55], v240, s[28:31], s35 offen offset:1024 sc1
    buffer_load_dwordx4 a[56:59], v240, s[28:31], s35 offen offset:2048 sc1
    buffer_load_dwordx4 a[60:63], v240, s[28:31], s35 offen offset:3072 sc1
    buffer_load_dwordx4 a[64:67], v240, s[28:31], s36 offen offset:0 sc1
    buffer_load_dwordx4 a[68:71], v240, s[28:31], s36 offen offset:1024 sc1
    buffer_load_dwordx4 a[72:75], v240, s[28:31], s36 offen offset:2048 sc1
    buffer_load_dwordx4 a[76:79], v240, s[28:31], s36 offen offset:3072 sc1
    buffer_load_dwordx4 a[80:83], v240, s[28:31], s37 offen offset:0 sc1
    buffer_load_dwordx4 a[84:87], v240, s[28:31], s37 offen offset:1024 sc1
    buffer_load_dwordx4 a[88:91], v240, s[28:31], s37 offen offset:2048 sc1
    buffer_load_dwordx4 a[92:95], v240, s[28:31], s37 offen offset:3072 sc1
    buffer_load_dwordx4 a[96:99], v240, s[28:31], s38 offen offset:0 sc1
    buffer_load_dwordx4 a[100:103], v240, s[28:31], s38 offen offset:1024 sc1
    buffer_load_dwordx4 a[104:107], v240, s[28:31], s38 offen offset:2048 sc1
    buffer_load_dwordx4 a[108:111], v240, s[28:31], s38 offen offset:3072 sc1
    buffer_load_dwordx4 a[112:115], v240, s[28:31], s39 offen offset:0 sc1
    buffer_load_dwordx4 a[116:119], v240, s[28:31], s39 offen offset:1024 sc1
    buffer_load_dwordx4 a[120:123], v240, s[28:31], s39 offen offset:2048 sc1
    buffer_load_dwordx4 a[124:127], v240, s[28:31], s39 offen offset:3072 sc1
    s_add_u32 s28, s28, 131072
    s_addc_u32 s29, s29, 0
    s_lshl_b32 s58, s23, 17
    s_lshl_b32 s59, s24, 12
    s_add_u32 s58, s58, s59
    s_add_u32 s59, s58, 50331648
    s_lshl_b32 s58, s58, 1
    s_add_u32 s58, s58, 33558528
    s_add_u32 s44, s20, s59
    s_addc_u32 s45, s21, 0
    s_add_u32 s46, s20, s58
    s_addc_u32 s47, s21, 0
    s_waitcnt vmcnt(0)
    s_branch L_q_first
L_q_loop:
    s_lshl_b32 s60, s26, 2
    s_add_u32 s60, s60, s23
    s_add_u32 s60, s60, 1
L_q_pk0:
    global_load_dword v248, v254, s[48:49] sc1
    s_waitcnt vmcnt(0)
L_q_pk0_c:
    v_cmp_gt_u32 vcc, s60, v248
    s_cbranch_vccz L_q_pk0_ok
    s_sleep 2
    s_sub_u32 s27, s27, 1
    s_cbranch_scc0 L_q_pk0
    s_branch L_end
L_q_pk0_ok:
    v_mov_b32 v248, s26
    s_mov_b64 exec, 1
    global_store_dword v246, v248, s[42:43] sc1
    s_mov_b64 exec, -1
    buffer_load_dwordx4 a[128:131], v242, s[52:55], s32 offen offset:0 sc1
    buffer_load_dwordx4 a[132:135], v242, s[52:55], s32 offen offset:512 sc1
    buffer_load_dwordx4 a[136:139], v242, s[52:55], s33 offen offset:0 sc1
    buffer_load_dwordx4 a[140:143], v242, s[52:55], s33 offen offset:512 sc1
    buffer_load_dwordx4 a[144:147], v242, s[52:55], s34 offen offset:0 sc1
    buffer_load_dwordx4 a[148:151], v242, s[52:55], s34 offen offset:512 sc1
    buffer_load_dwordx4 a[152:155], v242, s[52:55], s35 offen offset:0 sc1
    buffer_load_dwordx4 a[156:159], v242, s[52:55], s35 offen offset:512 sc1
    buffer_load_dwordx4 a[160:163], v243, s[52:55], s32 offen offset:0 sc1
    buffer_load_dwordx4 a[164:167], v243, s[52:55], s32 offen offset:512 sc1
    buffer_load_dwordx4 a[168:171], v243, s[52:55], s33 offen offset:0 sc1
    buffer_load_dwordx4 a[172:175], v243, s[52:55], s33 offen offset:512 sc1
    buffer_load_dwordx4 a[176:179], v243, s[52:55], s34 offen offset:0 sc1
    buffer_load_dwordx4 a[180:183], v243, s[52:55], s34 offen offset:512 sc1
    buffer_load_dwordx4 a[184:187], v243, s[52:55], s35 offen offset:0 sc1
    buffer_load_dwordx4 a[188:191], v243, s[52:55], s35 offen offset:512 sc1
    s_add_u32 s52, s52, 2097152
    s_addc_u32 s53, s53, 0
    ds_read_b64_tr_b16 v[128:129], v120 offset:0
    ds_read_b64_tr_b16 v[130:131], v120 offset:1024
    ds_read_b64_tr_b16 v[132:133], v120 offset:4096
    ds_read_b64_tr_b16 v[134:135], v120 offset:5120
    ds_read_b64_tr_b16 v[136:137], v120 offset:8192
    ds_read_b64_tr_b16 v[138:139], v120 offset:9216
    ds_read_b64_tr_b16 v[140:141], v120 offset:12288
    ds_read_b64_tr_b16 v[142:143], v120 offset:13312
    ds_read_b64_tr_b16 v[144:145], v120 offset:16384
    ds_read_b64_tr_b16 v[146:147], v120 offset:17408
    ds_read_b64_tr_b16 v[148:149], v120 offset:20480
    ds_read_b64_tr_b16 v[150:151], v120 offset:21504
    ds_read_b64_tr_b16 v[152:153], v120 offset:24576
    ds_read_b64_tr_b16 v[154:155], v120 offset:25600
    s_waitcnt lgkmcnt(12)
    v_mfma_f32_32x32x16_bf16 v[160:175], v[128:131], a[0:3], 0
    ds_read_b64_tr_b16 v[156:157], v120 offset:28672
    ds_read_b64_tr_b16 v[158:159], v120 offset:29696
    s_waitcnt lgkmcnt(12)
    v_mfma_f32_32x32x16_bf16 v[160:175], v[132:135], a[4:7], v[160:175]
    ds_read_b64_tr_b16 v[128:129], v120 offset:32768
    ds_read_b64_tr_b16 v[130:131], v120 offset:33792
    s_waitcnt lgkmcnt(12)
    v_mfma_f32_32x32x16_bf16 v[160:175], v[136:139], a[8:11], v[160:175]
    ds_read_b64_tr_b16 v[132:133], v120 offset:36864
    ds_read_b64_tr_b16 v[134:135], v120 offset:37888
    s_waitcnt lgkmcnt(12)
    v_mfma_f32_32x32x16_bf16 v[160:175], v[140:143], a[12:15], v[160:175]
    ds_read_b64_tr_b16 v[136:137], v120 offset:40960
    ds_read_b64_tr_b16 v[138:139], v120 offset:41984
    s_waitcnt lgkmcnt(12)
    v_mfma_f32_32x32x16_bf16 v[160:175], v[144:147], a[16:19], v[160:175]
    ds_read_b64_tr_b16 v[140:141], v120 offset:45056
    ds_read_b64_tr_b16 v[142:143], v120 offset:46080
    s_waitcnt lgkmcnt(12)
    v_mfma_f32_32x32x16_bf16 v[160:175], v[148:151], a[20:23], v[160:175]
    ds_read_b64_tr_b16 v[144:145], v120 offset:49152
    ds_read_b64_tr_b16 v[146:147], v120 offset:50176
    s_waitcnt lgkmcnt(12)
    v_mfma_f32_32x32x16_bf16 v[160:175], v[152:155], a[24:27], v[160:175]
    ds_read_b64_tr_b16 v[148:149], v120 offset:53248
    ds_read_b64_tr_b16 v[150:151], v120 offset:54272
    s_waitcnt lgkmcnt(12)
    v_mfma_f32_32x32x16_bf16 v[160:175], v[156:159], a[28:31], v[160:175]
    ds_read_b64_tr_b16 v[152:153], v120 offset:57344
    ds_read_b64_tr_b16 v[154:155], v120 offset:58368
    s_waitcnt lgkmcnt(12)
    v_mfma_f32_32x32x16_bf16 v[160:175], v[128:131], a[32:35], v[160:175]
    ds_read_b64_tr_b16 v[156:157], v120 offset:61440
    ds_read_b64_tr_b16 v[158:159], v120 offset:62464
    s_waitcnt lgkmcnt(12)
    v_mfma_f32_32x32x16_bf16 v[160:175], v[132:135], a[36:39], v[160:175]
    ds_read_b64_tr_b16 v[128:129], v121 offset:0
    ds_read_b64_tr_b16 v[130:131], v121 offset:1024
    s_waitcnt lgkmcnt(12)
    v_mfma_f32_32x32x16_bf16 v[160:175], v[136:139], a[40:43], v[160:175]
    ds_read_b64_tr_b16 v[132:133], v121 offset:4096
    ds_read_b64_tr_b16 v[134:135], v121 offset:5120
    s_waitcnt lgkmcnt(12)
    v_mfma_f32_32x32x16_bf16 v[160:175], v[140:143], a[44:47], v[160:175]
    ds_read_b64_tr_b16 v[136:137], v121 offset:8192
    ds_read_b64_tr_b16 v[138:139], v121 offset:9216
    s_waitcnt lgkmcnt(12)
    v_mfma_f32_32x32x16_bf16 v[160:175], v[144:147], a[48:51], v[160:175]
    ds_read_b64_tr_b16 v[140:141], v121 offset:12288
    ds_read_b64_tr_b16 v[142:143], v121 offset:13312
    s_waitcnt lgkmcnt(12)
    v_mfma_f32_32x32x16_bf16 v[160:175], v[148:151], a[52:55], v[160:175]
    ds_read_b64_tr_b16 v[144:145], v121 offset:16384
    ds_read_b64_tr_b16 v[146:147], v121 offset:17408
    s_waitcnt lgkmcnt(12)
    v_mfma_f32_32x32x16_bf16 v[160:175], v[152:155], a[56:59], v[160:175]
    ds_read_b64_tr_b16 v[148:149], v121 offset:20480
    ds_read_b64_tr_b16 v[150:151], v121 offset:21504
    s_waitcnt lgkmcnt(12)
    v_mfma_f32_32x32x16_bf16 v[160:175], v[156:159], a[60:63], v[160:175]
    ds_read_b64_tr_b16 v[152:153], v121 offset:24576
    ds_read_b64_tr_b16 v[154:155], v121 offset:25600
    s_waitcnt lgkmcnt(12)
    v_mfma_f32_32x32x16_bf16 v[160:175], v[128:131], a[64:67], v[160:175]
    ds_read_b64_tr_b16 v[156:157], v121 offset:28672
    ds_read_b64_tr_b16 v[158:159], v121 offset:29696
    s_waitcnt lgkmcnt(12)
    v_mfma_f32_32x32x16_bf16 v[160:175], v[132:135], a[68:71], v[160:175]
    ds_read_b64_tr_b16 v[128:129], v121 offset:32768
    ds_read_b64_tr_b16 v[130:131], v121 offset:33792
    s_waitcnt lgkmcnt(12)
    v_mfma_f32_32x32x16_bf16 v[160:175], v[136:139], a[72:75], v[160:175]
    ds_read_b64_tr_b16 v[132:133], v121 offset:36864
    ds_read_b64_tr_b16 v[134:135], v121 offset:37888
    s_waitcnt lgkmcnt(12)
    v_mfma_f32_32x32x16_bf16 v[160:175], v[140:143], a[76:79], v[160:175]
    ds_read_b64_tr_b16 v[136:137], v121 offset:40960
    ds_read_b64_tr_b16 v[138:139], v121 offset:41984
    s_waitcnt lgkmcnt(12)
    v_mfma_f32_32x32x16_bf16 v[160:175], v[144:147], a[80:83], v[160:175]
    ds_read_b64_tr_b16 v[140:141], v121 offset:45056
    ds_read_b64_tr_b16 v[142:143], v121 offset:46080
    s_waitcnt lgkmcnt(12)
    v_mfma_f32_32x32x16_bf16 v[160:175], v[148:151], a[84:87], v[160:175]
    ds_read_b64_tr_b16 v[144:145], v121 offset:49152
    ds_read_b64_tr_b16 v[146:147], v121 offset:50176
    s_waitcnt lgkmcnt(12)
    v_mfma_f32_32x32x16_bf16 v[160:175], v[152:155], a[88:91], v[160:175]
    ds_read_b64_tr_b16 v[148:149], v121 offset:53248
    ds_read_b64_tr_b16 v[150:151], v121 offset:54272
    s_waitcnt lgkmcnt(12)
    v_mfma_f32_32x32x16_bf16 v[160:175], v[156:159], a[92:95], v[160:175]
    ds_read_b64_tr_b16 v[152:153], v121 offset:57344
    ds_read_b64_tr_b16 v[154:155], v121 offset:58368
    s_waitcnt lgkmcnt(12)
    v_mfma_f32_32x32x16_bf16 v[160:175], v[128:131], a[96:99], v[160:175]
    ds_read_b64_tr_b16 v[156:157], v121 offset:61440
    ds_read_b64_tr_b16 v[158:159], v121 offset:62464
    s_waitcnt lgkmcnt(12)
    v_mfma_f32_32x32x16_bf16 v[160:175], v[132:135], a[100:103], v[160:175]
    ds_read_b64_tr_b16 v[128:129], v122 offset:0
    ds_read_b64_tr_b16 v[130:131], v122 offset:1024
    s_waitcnt lgkmcnt(12)
    v_mfma_f32_32x32x16_bf16 v[160:175], v[136:139], a[104:107], v[160:175]
    ds_read_b64_tr_b16 v[132:133], v122 offset:4096
    ds_read_b64_tr_b16 v[134:135], v122 offset:5120
    s_waitcnt lgkmcnt(12)
    v_mfma_f32_32x32x16_bf16 v[160:175], v[140:143], a[108:111], v[160:175]
    ds_read_b64_tr_b16 v[136:137], v122 offset:8192
    ds_read_b64_tr_b16 v[138:139], v122 offset:9216
    s_waitcnt lgkmcnt(12)
    v_mfma_f32_32x32x16_bf16 v[160:175], v[144:147], a[112:115], v[160:175]
    ds_read_b64_tr_b16 v[140:141], v122 offset:12288
    ds_read_b64_tr_b16 v[142:143], v122 offset:13312
    s_waitcnt lgkmcnt(12)
    v_mfma_f32_32x32x16_bf16 v[160:175], v[148:151], a[116:119], v[160:175]
    ds_read_b64_tr_b16 v[144:145], v122 offset:16384
    ds_read_b64_tr_b16 v[146:147], v122 offset:17408
    s_waitcnt lgkmcnt(12)
    v_mfma_f32_32x32x16_bf16 v[160:175], v[152:155], a[120:123], v[160:175]
    ds_read_b64_tr_b16 v[148:149], v122 offset:20480
    ds_read_b64_tr_b16 v[150:151], v122 offset:21504
    s_waitcnt lgkmcnt(12)
    v_mfma_f32_32x32x16_bf16 v[160:175], v[156:159], a[124:127], v[160:175]
    ds_read_b64_tr_b16 v[152:153], v122 offset:24576
    ds_read_b64_tr_b16 v[154:155], v122 offset:25600
    s_waitcnt lgkmcnt(12)
    v_mfma_f32_32x32x16_bf16 v[176:191], v[128:131], a[0:3], 0
    ds_read_b64_tr_b16 v[156:157], v122 offset:28672
    ds_read_b64_tr_b16 v[158:159], v122 offset:29696
    s_waitcnt lgkmcnt(12)
    v_mfma_f32_32x32x16_bf16 v[176:191], v[132:135], a[4:7], v[176:191]
    ds_read_b64_tr_b16 v[128:129], v122 offset:32768
    ds_read_b64_tr_b16 v[130:131], v122 offset:33792
    s_waitcnt lgkmcnt(12)
    v_mfma_f32_32x32x16_bf16 v[176:191], v[136:139], a[8:11], v[176:191]
    ds_read_b64_tr_b16 v[132:133], v122 offset:36864
    ds_read_b64_tr_b16 v[134:135], v122 offset:37888
    s_waitcnt lgkmcnt(12)
    v_mfma_f32_32x32x16_bf16 v[176:191], v[140:143], a[12:15], v[176:191]
    v_cvt_pk_bf16_f32 v0, v160, v161
    v_cvt_pk_bf16_f32 v1, v162, v163
    ds_read_b64_tr_b16 v[136:137], v122 offset:40960
    ds_read_b64_tr_b16 v[138:139], v122 offset:41984
    s_waitcnt lgkmcnt(12)
    v_mfma_f32_32x32x16_bf16 v[176:191], v[144:147], a[16:19], v[176:191]
    v_cvt_pk_bf16_f32 v2, v164, v165
    v_cvt_pk_bf16_f32 v3, v166, v167
    ds_read_b64_tr_b16 v[140:141], v122 offset:45056
    ds_read_b64_tr_b16 v[142:143], v122 offset:46080
    s_waitcnt lgkmcnt(12)
    v_mfma_f32_32x32x16_bf16 v[176:191], v[148:151], a[20:23], v[176:191]
    v_cvt_pk_bf16_f32 v4, v168, v169
    v_cvt_pk_bf16_f32 v5, v170, v171
    ds_read_b64_tr_b16 v[144:145], v122 offset:49152
    ds_read_b64_tr_b16 v[146:147], v122 offset:50176
    s_waitcnt lgkmcnt(12)
    v_mfma_f32_32x32x16_bf16 v[176:191], v[152:155], a[24:27], v[176:191]
    v_cvt_pk_bf16_f32 v6, v172, v173
    v_cvt_pk_bf16_f32 v7, v174, v175
    ds_read_b64_tr_b16 v[148:149], v122 offset:53248
    ds_read_b64_tr_b16 v[150:151], v122 offset:54272
    s_waitcnt lgkmcnt(12)
    v_mfma_f32_32x32x16_bf16 v[176:191], v[156:159], a[28:31], v[176:191]
    ds_read_b64_tr_b16 v[152:153], v122 offset:57344
    ds_read_b64_tr_b16 v[154:155], v122 offset:58368
    s_waitcnt lgkmcnt(12)
    v_mfma_f32_32x32x16_bf16 v[176:191], v[128:131], a[32:35], v[176:191]
    ds_read_b64_tr_b16 v[156:157], v122 offset:61440
    ds_read_b64_tr_b16 v[158:159], v122 offset:62464
    s_waitcnt lgkmcnt(12)
    v_mfma_f32_32x32x16_bf16 v[176:191], v[132:135], a[36:39], v[176:191]
    ds_read_b64_tr_b16 v[128:129], v123 offset:0
    ds_read_b64_tr_b16 v[130:131], v123 offset:1024
    s_waitcnt lgkmcnt(12)
    v_mfma_f32_32x32x16_bf16 v[176:191], v[136:139], a[40:43], v[176:191]
    ds_read_b64_tr_b16 v[132:133], v123 offset:4096
    ds_read_b64_tr_b16 v[134:135], v123 offset:5120
    s_waitcnt lgkmcnt(12)
    v_mfma_f32_32x32x16_bf16 v[176:191], v[140:143], a[44:47], v[176:191]
    ds_read_b64_tr_b16 v[136:137], v123 offset:8192
    ds_read_b64_tr_b16 v[138:139], v123 offset:9216
    s_waitcnt lgkmcnt(12)
    v_mfma_f32_32x32x16_bf16 v[176:191], v[144:147], a[48:51], v[176:191]
    ds_read_b64_tr_b16 v[140:141], v123 offset:12288
    ds_read_b64_tr_b16 v[142:143], v123 offset:13312
    s_waitcnt lgkmcnt(12)
    v_mfma_f32_32x32x16_bf16 v[176:191], v[148:151], a[52:55], v[176:191]
    ds_read_b64_tr_b16 v[144:145], v123 offset:16384
    ds_read_b64_tr_b16 v[146:147], v123 offset:17408
    s_waitcnt lgkmcnt(12)
    v_mfma_f32_32x32x16_bf16 v[176:191], v[152:155], a[56:59], v[176:191]
    ds_read_b64_tr_b16 v[148:149], v123 offset:20480
    ds_read_b64_tr_b16 v[150:151], v123 offset:21504
    s_waitcnt lgkmcnt(12)
    v_mfma_f32_32x32x16_bf16 v[176:191], v[156:159], a[60:63], v[176:191]
    ds_read_b64_tr_b16 v[152:153], v123 offset:24576
    ds_read_b64_tr_b16 v[154:155], v123 offset:25600
    s_waitcnt lgkmcnt(12)
    v_mfma_f32_32x32x16_bf16 v[176:191], v[128:131], a[64:67], v[176:191]
    ds_read_b64_tr_b16 v[156:157], v123 offset:28672
    ds_read_b64_tr_b16 v[158:159], v123 offset:29696
    s_waitcnt lgkmcnt(12)
    v_mfma_f32_32x32x16_bf16 v[176:191], v[132:135], a[68:71], v[176:191]
    ds_read_b64_tr_b16 v[128:129], v123 offset:32768
    ds_read_b64_tr_b16 v[130:131], v123 offset:33792
    s_waitcnt lgkmcnt(12)
    v_mfma_f32_32x32x16_bf16 v[176:191], v[136:139], a[72:75], v[176:191]
    ds_read_b64_tr_b16 v[132:133], v123 offset:36864
    ds_read_b64_tr_b16 v[134:135], v123 offset:37888
    s_waitcnt lgkmcnt(12)
    v_mfma_f32_32x32x16_bf16 v[176:191], v[140:143], a[76:79], v[176:191]
    ds_read_b64_tr_b16 v[136:137], v123 offset:40960
    ds_read_b64_tr_b16 v[138:139], v123 offset:41984
    s_waitcnt lgkmcnt(12)
    v_mfma_f32_32x32x16_bf16 v[176:191], v[144:147], a[80:83], v[176:191]
    ds_read_b64_tr_b16 v[140:141], v123 offset:45056
    ds_read_b64_tr_b16 v[142:143], v123 offset:46080
    s_waitcnt lgkmcnt(12)
    v_mfma_f32_32x32x16_bf16 v[176:191], v[148:151], a[84:87], v[176:191]
    ds_read_b64_tr_b16 v[144:145], v123 offset:49152
    ds_read_b64_tr_b16 v[146:147], v123 offset:50176
    s_waitcnt lgkmcnt(12)
    v_mfma_f32_32x32x16_bf16 v[176:191], v[152:155], a[88:91], v[176:191]
    ds_read_b64_tr_b16 v[148:149], v123 offset:53248
    ds_read_b64_tr_b16 v[150:151], v123 offset:54272
    s_waitcnt lgkmcnt(12)
    v_mfma_f32_32x32x16_bf16 v[176:191], v[156:159], a[92:95], v[176:191]
    ds_read_b64_tr_b16 v[152:153], v123 offset:57344
    ds_read_b64_tr_b16 v[154:155], v123 offset:58368
    s_waitcnt lgkmcnt(12)
    v_mfma_f32_32x32x16_bf16 v[176:191], v[128:131], a[96:99], v[176:191]
    ds_read_b64_tr_b16 v[156:157], v123 offset:61440
    ds_read_b64_tr_b16 v[158:159], v123 offset:62464
    s_waitcnt lgkmcnt(12)
    v_mfma_f32_32x32x16_bf16 v[176:191], v[132:135], a[100:103], v[176:191]
    ds_read_b64_tr_b16 v[128:129], v124 offset:0
    ds_read_b64_tr_b16 v[130:131], v124 offset:1024
    s_waitcnt lgkmcnt(12)
    v_mfma_f32_32x32x16_bf16 v[176:191], v[136:139], a[104:107], v[176:191]
    ds_read_b64_tr_b16 v[132:133], v124 offset:4096
    ds_read_b64_tr_b16 v[134:135], v124 offset:5120
    s_waitcnt lgkmcnt(12)
    v_mfma_f32_32x32x16_bf16 v[176:191], v[140:143], a[108:111], v[176:191]
    ds_read_b64_tr_b16 v[136:137], v124 offset:8192
    ds_read_b64_tr_b16 v[138:139], v124 offset:9216
    s_waitcnt lgkmcnt(12)
    v_mfma_f32_32x32x16_bf16 v[176:191], v[144:147], a[112:115], v[176:191]
    ds_read_b64_tr_b16 v[140:141], v124 offset:12288
    ds_read_b64_tr_b16 v[142:143], v124 offset:13312
    s_waitcnt lgkmcnt(12)
    v_mfma_f32_32x32x16_bf16 v[176:191], v[148:151], a[116:119], v[176:191]
    ds_read_b64_tr_b16 v[144:145], v124 offset:16384
    ds_read_b64_tr_b16 v[146:147], v124 offset:17408
    s_waitcnt lgkmcnt(12)
    v_mfma_f32_32x32x16_bf16 v[176:191], v[152:155], a[120:123], v[176:191]
    ds_read_b64_tr_b16 v[148:149], v124 offset:20480
    ds_read_b64_tr_b16 v[150:151], v124 offset:21504
    s_waitcnt lgkmcnt(12)
    v_mfma_f32_32x32x16_bf16 v[176:191], v[156:159], a[124:127], v[176:191]
    ds_read_b64_tr_b16 v[152:153], v124 offset:24576
    ds_read_b64_tr_b16 v[154:155], v124 offset:25600
    s_waitcnt lgkmcnt(12)
    v_mfma_f32_32x32x16_bf16 v[160:175], v[128:131], a[0:3], 0
    ds_read_b64_tr_b16 v[156:157], v124 offset:28672
    ds_read_b64_tr_b16 v[158:159], v124 offset:29696
    s_waitcnt lgkmcnt(12)
    v_mfma_f32_32x32x16_bf16 v[160:175], v[132:135], a[4:7], v[160:175]
    ds_read_b64_tr_b16 v[128:129], v124 offset:32768
    ds_read_b64_tr_b16 v[130:131], v124 offset:33792
    s_waitcnt lgkmcnt(12)
    v_mfma_f32_32x32x16_bf16 v[160:175], v[136:139], a[8:11], v[160:175]
    ds_read_b64_tr_b16 v[132:133], v124 offset:36864
    ds_read_b64_tr_b16 v[134:135], v124 offset:37888
    s_waitcnt lgkmcnt(12)
    v_mfma_f32_32x32x16_bf16 v[160:175], v[140:143], a[12:15], v[160:175]
    v_cvt_pk_bf16_f32 v8, v176, v177
    v_cvt_pk_bf16_f32 v9, v178, v179
    ds_read_b64_tr_b16 v[136:137], v124 offset:40960
    ds_read_b64_tr_b16 v[138:139], v124 offset:41984
    s_waitcnt lgkmcnt(12)
    v_mfma_f32_32x32x16_bf16 v[160:175], v[144:147], a[16:19], v[160:175]
    v_cvt_pk_bf16_f32 v10, v180, v181
    v_cvt_pk_bf16_f32 v11, v182, v183
    ds_read_b64_tr_b16 v[140:141], v124 offset:45056
    ds_read_b64_tr_b16 v[142:143], v124 offset:46080
    s_waitcnt lgkmcnt(12)
    v_mfma_f32_32x32x16_bf16 v[160:175], v[148:151], a[20:23], v[160:175]
    v_cvt_pk_bf16_f32 v12, v184, v185
    v_cvt_pk_bf16_f32 v13, v186, v187
    ds_read_b64_tr_b16 v[144:145], v124 offset:49152
    ds_read_b64_tr_b16 v[146:147], v124 offset:50176
    s_waitcnt lgkmcnt(12)
    v_mfma_f32_32x32x16_bf16 v[160:175], v[152:155], a[24:27], v[160:175]
    v_cvt_pk_bf16_f32 v14, v188, v189
    v_cvt_pk_bf16_f32 v15, v190, v191
    ds_read_b64_tr_b16 v[148:149], v124 offset:53248
    ds_read_b64_tr_b16 v[150:151], v124 offset:54272
    s_waitcnt lgkmcnt(12)
    v_mfma_f32_32x32x16_bf16 v[160:175], v[156:159], a[28:31], v[160:175]
    ds_read_b64_tr_b16 v[152:153], v124 offset:57344
    ds_read_b64_tr_b16 v[154:155], v124 offset:58368
    s_waitcnt lgkmcnt(12)
    v_mfma_f32_32x32x16_bf16 v[160:175], v[128:131], a[32:35], v[160:175]
    ds_read_b64_tr_b16 v[156:157], v124 offset:61440
    ds_read_b64_tr_b16 v[158:159], v124 offset:62464
    s_waitcnt lgkmcnt(12)
    v_mfma_f32_32x32x16_bf16 v[160:175], v[132:135], a[36:39], v[160:175]
    ds_read_b64_tr_b16 v[128:129], v125 offset:0
    ds_read_b64_tr_b16 v[130:131], v125 offset:1024
    s_waitcnt lgkmcnt(12)
    v_mfma_f32_32x32x16_bf16 v[160:175], v[136:139], a[40:43], v[160:175]
    ds_read_b64_tr_b16 v[132:133], v125 offset:4096
    ds_read_b64_tr_b16 v[134:135], v125 offset:5120
    s_waitcnt lgkmcnt(12)
    v_mfma_f32_32x32x16_bf16 v[160:175], v[140:143], a[44:47], v[160:175]
    ds_read_b64_tr_b16 v[136:137], v125 offset:8192
    ds_read_b64_tr_b16 v[138:139], v125 offset:9216
    s_waitcnt lgkmcnt(12)
    v_mfma_f32_32x32x16_bf16 v[160:175], v[144:147], a[48:51], v[160:175]
    ds_read_b64_tr_b16 v[140:141], v125 offset:12288
    ds_read_b64_tr_b16 v[142:143], v125 offset:13312
    s_waitcnt lgkmcnt(12)
    v_mfma_f32_32x32x16_bf16 v[160:175], v[148:151], a[52:55], v[160:175]
    ds_read_b64_tr_b16 v[144:145], v125 offset:16384
    ds_read_b64_tr_b16 v[146:147], v125 offset:17408
    s_waitcnt lgkmcnt(12)
    v_mfma_f32_32x32x16_bf16 v[160:175], v[152:155], a[56:59], v[160:175]
    ds_read_b64_tr_b16 v[148:149], v125 offset:20480
    ds_read_b64_tr_b16 v[150:151], v125 offset:21504
    s_waitcnt lgkmcnt(12)
    v_mfma_f32_32x32x16_bf16 v[160:175], v[156:159], a[60:63], v[160:175]
    ds_read_b64_tr_b16 v[152:153], v125 offset:24576
    ds_read_b64_tr_b16 v[154:155], v125 offset:25600
    s_waitcnt lgkmcnt(12)
    v_mfma_f32_32x32x16_bf16 v[160:175], v[128:131], a[64:67], v[160:175]
    ds_read_b64_tr_b16 v[156:157], v125 offset:28672
    ds_read_b64_tr_b16 v[158:159], v125 offset:29696
    s_waitcnt lgkmcnt(12)
    v_mfma_f32_32x32x16_bf16 v[160:175], v[132:135], a[68:71], v[160:175]
    ds_read_b64_tr_b16 v[128:129], v125 offset:32768
    ds_read_b64_tr_b16 v[130:131], v125 offset:33792
    s_waitcnt lgkmcnt(12)
    v_mfma_f32_32x32x16_bf16 v[160:175], v[136:139], a[72:75], v[160:175]
    ds_read_b64_tr_b16 v[132:133], v125 offset:36864
    ds_read_b64_tr_b16 v[134:135], v125 offset:37888
    s_waitcnt lgkmcnt(12)
    v_mfma_f32_32x32x16_bf16 v[160:175], v[140:143], a[76:79], v[160:175]
    ds_read_b64_tr_b16 v[136:137], v125 offset:40960
    ds_read_b64_tr_b16 v[138:139], v125 offset:41984
    s_waitcnt lgkmcnt(12)
    v_mfma_f32_32x32x16_bf16 v[160:175], v[144:147], a[80:83], v[160:175]
    ds_read_b64_tr_b16 v[140:141], v125 offset:45056
    ds_read_b64_tr_b16 v[142:143], v125 offset:46080
    s_waitcnt lgkmcnt(12)
    v_mfma_f32_32x32x16_bf16 v[160:175], v[148:151], a[84:87], v[160:175]
    ds_read_b64_tr_b16 v[144:145], v125 offset:49152
    ds_read_b64_tr_b16 v[146:147], v125 offset:50176
    s_waitcnt lgkmcnt(12)
    v_mfma_f32_32x32x16_bf16 v[160:175], v[152:155], a[88:91], v[160:175]
    ds_read_b64_tr_b16 v[148:149], v125 offset:53248
    ds_read_b64_tr_b16 v[150:151], v125 offset:54272
    s_waitcnt lgkmcnt(12)
    v_mfma_f32_32x32x16_bf16 v[160:175], v[156:159], a[92:95], v[160:175]
    ds_read_b64_tr_b16 v[152:153], v125 offset:57344
    ds_read_b64_tr_b16 v[154:155], v125 offset:58368
    s_waitcnt lgkmcnt(12)
    v_mfma_f32_32x32x16_bf16 v[160:175], v[128:131], a[96:99], v[160:175]
    ds_read_b64_tr_b16 v[156:157], v125 offset:61440
    ds_read_b64_tr_b16 v[158:159], v125 offset:62464
    s_waitcnt lgkmcnt(12)
    v_mfma_f32_32x32x16_bf16 v[160:175], v[132:135], a[100:103], v[160:175]
    ds_read_b64_tr_b16 v[128:129], v126 offset:0
    ds_read_b64_tr_b16 v[130:131], v126 offset:1024
    s_waitcnt lgkmcnt(12)
    v_mfma_f32_32x32x16_bf16 v[160:175], v[136:139], a[104:107], v[160:175]
    ds_read_b64_tr_b16 v[132:133], v126 offset:4096
    ds_read_b64_tr_b16 v[134:135], v126 offset:5120
    s_waitcnt lgkmcnt(12)
    v_mfma_f32_32x32x16_bf16 v[160:175], v[140:143], a[108:111], v[160:175]
    ds_read_b64_tr_b16 v[136:137], v126 offset:8192
    ds_read_b64_tr_b16 v[138:139], v126 offset:9216
    s_waitcnt lgkmcnt(12)
    v_mfma_f32_32x32x16_bf16 v[160:175], v[144:147], a[112:115], v[160:175]
    ds_read_b64_tr_b16 v[140:141], v126 offset:12288
    ds_read_b64_tr_b16 v[142:143], v126 offset:13312
    s_waitcnt lgkmcnt(12)
    v_mfma_f32_32x32x16_bf16 v[160:175], v[148:151], a[116:119], v[160:175]
    ds_read_b64_tr_b16 v[144:145], v126 offset:16384
    ds_read_b64_tr_b16 v[146:147], v126 offset:17408
    s_waitcnt lgkmcnt(12)
    v_mfma_f32_32x32x16_bf16 v[160:175], v[152:155], a[120:123], v[160:175]
    ds_read_b64_tr_b16 v[148:149], v126 offset:20480
    ds_read_b64_tr_b16 v[150:151], v126 offset:21504
    s_waitcnt lgkmcnt(12)
    v_mfma_f32_32x32x16_bf16 v[160:175], v[156:159], a[124:127], v[160:175]
    ds_read_b64_tr_b16 v[152:153], v126 offset:24576
    ds_read_b64_tr_b16 v[154:155], v126 offset:25600
    s_waitcnt lgkmcnt(12)
    v_mfma_f32_32x32x16_bf16 v[176:191], v[128:131], a[0:3], 0
    ds_read_b64_tr_b16 v[156:157], v126 offset:28672
    ds_read_b64_tr_b16 v[158:159], v126 offset:29696
    s_waitcnt lgkmcnt(12)
    v_mfma_f32_32x32x16_bf16 v[176:191], v[132:135], a[4:7], v[176:191]
    ds_read_b64_tr_b16 v[128:129], v126 offset:32768
    ds_read_b64_tr_b16 v[130:131], v126 offset:33792
    s_waitcnt lgkmcnt(12)
    v_mfma_f32_32x32x16_bf16 v[176:191], v[136:139], a[8:11], v[176:191]
    ds_read_b64_tr_b16 v[132:133], v126 offset:36864
    ds_read_b64_tr_b16 v[134:135], v126 offset:37888
    s_waitcnt lgkmcnt(12)
    v_mfma_f32_32x32x16_bf16 v[176:191], v[140:143], a[12:15], v[176:191]
    v_cvt_pk_bf16_f32 v16, v160, v161
    v_cvt_pk_bf16_f32 v17, v162, v163
    ds_read_b64_tr_b16 v[136:137], v126 offset:40960
    ds_read_b64_tr_b16 v[138:139], v126 offset:41984
    s_waitcnt lgkmcnt(12)
    v_mfma_f32_32x32x16_bf16 v[176:191], v[144:147], a[16:19], v[176:191]
    v_cvt_pk_bf16_f32 v18, v164, v165
    v_cvt_pk_bf16_f32 v19, v166, v167
    ds_read_b64_tr_b16 v[140:141], v126 offset:45056
    ds_read_b64_tr_b16 v[142:143], v126 offset:46080
    s_waitcnt lgkmcnt(12)
    v_mfma_f32_32x32x16_bf16 v[176:191], v[148:151], a[20:23], v[176:191]
    v_cvt_pk_bf16_f32 v20, v168, v169
    v_cvt_pk_bf16_f32 v21, v170, v171
    ds_read_b64_tr_b16 v[144:145], v126 offset:49152
    ds_read_b64_tr_b16 v[146:147], v126 offset:50176
    s_waitcnt lgkmcnt(12)
    v_mfma_f32_32x32x16_bf16 v[176:191], v[152:155], a[24:27], v[176:191]
    v_cvt_pk_bf16_f32 v22, v172, v173
    v_cvt_pk_bf16_f32 v23, v174, v175
    ds_read_b64_tr_b16 v[148:149], v126 offset:53248
    ds_read_b64_tr_b16 v[150:151], v126 offset:54272
    s_waitcnt lgkmcnt(12)
    v_mfma_f32_32x32x16_bf16 v[176:191], v[156:159], a[28:31], v[176:191]
    ds_read_b64_tr_b16 v[152:153], v126 offset:57344
    ds_read_b64_tr_b16 v[154:155], v126 offset:58368
    s_waitcnt lgkmcnt(12)
    v_mfma_f32_32x32x16_bf16 v[176:191], v[128:131], a[32:35], v[176:191]
    ds_read_b64_tr_b16 v[156:157], v126 offset:61440
    ds_read_b64_tr_b16 v[158:159], v126 offset:62464
    s_waitcnt lgkmcnt(12)
    v_mfma_f32_32x32x16_bf16 v[176:191], v[132:135], a[36:39], v[176:191]
    ds_read_b64_tr_b16 v[128:129], v127 offset:0
    ds_read_b64_tr_b16 v[130:131], v127 offset:1024
    s_waitcnt lgkmcnt(12)
    v_mfma_f32_32x32x16_bf16 v[176:191], v[136:139], a[40:43], v[176:191]
    ds_read_b64_tr_b16 v[132:133], v127 offset:4096
    ds_read_b64_tr_b16 v[134:135], v127 offset:5120
    s_waitcnt lgkmcnt(12)
    v_mfma_f32_32x32x16_bf16 v[176:191], v[140:143], a[44:47], v[176:191]
    ds_read_b64_tr_b16 v[136:137], v127 offset:8192
    ds_read_b64_tr_b16 v[138:139], v127 offset:9216
    s_waitcnt lgkmcnt(12)
    v_mfma_f32_32x32x16_bf16 v[176:191], v[144:147], a[48:51], v[176:191]
    ds_read_b64_tr_b16 v[140:141], v127 offset:12288
    ds_read_b64_tr_b16 v[142:143], v127 offset:13312
    s_waitcnt lgkmcnt(12)
    v_mfma_f32_32x32x16_bf16 v[176:191], v[148:151], a[52:55], v[176:191]
    ds_read_b64_tr_b16 v[144:145], v127 offset:16384
    ds_read_b64_tr_b16 v[146:147], v127 offset:17408
    s_waitcnt lgkmcnt(12)
    v_mfma_f32_32x32x16_bf16 v[176:191], v[152:155], a[56:59], v[176:191]
    ds_read_b64_tr_b16 v[148:149], v127 offset:20480
    ds_read_b64_tr_b16 v[150:151], v127 offset:21504
    s_waitcnt lgkmcnt(12)
    v_mfma_f32_32x32x16_bf16 v[176:191], v[156:159], a[60:63], v[176:191]
    ds_read_b64_tr_b16 v[152:153], v127 offset:24576
    ds_read_b64_tr_b16 v[154:155], v127 offset:25600
    s_waitcnt lgkmcnt(12)
    v_mfma_f32_32x32x16_bf16 v[176:191], v[128:131], a[64:67], v[176:191]
    ds_read_b64_tr_b16 v[156:157], v127 offset:28672
    ds_read_b64_tr_b16 v[158:159], v127 offset:29696
    s_waitcnt lgkmcnt(12)
    v_mfma_f32_32x32x16_bf16 v[176:191], v[132:135], a[68:71], v[176:191]
    ds_read_b64_tr_b16 v[128:129], v127 offset:32768
    ds_read_b64_tr_b16 v[130:131], v127 offset:33792
    s_waitcnt lgkmcnt(12)
    v_mfma_f32_32x32x16_bf16 v[176:191], v[136:139], a[72:75], v[176:191]
    ds_read_b64_tr_b16 v[132:133], v127 offset:36864
    ds_read_b64_tr_b16 v[134:135], v127 offset:37888
    s_waitcnt lgkmcnt(12)
    v_mfma_f32_32x32x16_bf16 v[176:191], v[140:143], a[76:79], v[176:191]
    ds_read_b64_tr_b16 v[136:137], v127 offset:40960
    ds_read_b64_tr_b16 v[138:139], v127 offset:41984
    s_waitcnt lgkmcnt(12)
    v_mfma_f32_32x32x16_bf16 v[176:191], v[144:147], a[80:83], v[176:191]
    ds_read_b64_tr_b16 v[140:141], v127 offset:45056
    ds_read_b64_tr_b16 v[142:143], v127 offset:46080
    s_waitcnt lgkmcnt(12)
    v_mfma_f32_32x32x16_bf16 v[176:191], v[148:151], a[84:87], v[176:191]
    ds_read_b64_tr_b16 v[144:145], v127 offset:49152
    ds_read_b64_tr_b16 v[146:147], v127 offset:50176
    s_waitcnt lgkmcnt(12)
    v_mfma_f32_32x32x16_bf16 v[176:191], v[152:155], a[88:91], v[176:191]
    ds_read_b64_tr_b16 v[148:149], v127 offset:53248
    ds_read_b64_tr_b16 v[150:151], v127 offset:54272
    s_waitcnt lgkmcnt(12)
    v_mfma_f32_32x32x16_bf16 v[176:191], v[156:159], a[92:95], v[176:191]
    ds_read_b64_tr_b16 v[152:153], v127 offset:57344
    ds_read_b64_tr_b16 v[154:155], v127 offset:58368
    s_waitcnt lgkmcnt(12)
    v_mfma_f32_32x32x16_bf16 v[176:191], v[128:131], a[96:99], v[176:191]
    ds_read_b64_tr_b16 v[156:157], v127 offset:61440
    ds_read_b64_tr_b16 v[158:159], v127 offset:62464
    s_waitcnt lgkmcnt(12)
    v_mfma_f32_32x32x16_bf16 v[176:191], v[132:135], a[100:103], v[176:191]
    s_waitcnt lgkmcnt(10)
    v_mfma_f32_32x32x16_bf16 v[176:191], v[136:139], a[104:107], v[176:191]
    s_waitcnt lgkmcnt(8)
    v_mfma_f32_32x32x16_bf16 v[176:191], v[140:143], a[108:111], v[176:191]
    s_waitcnt lgkmcnt(6)
    v_mfma_f32_32x32x16_bf16 v[176:191], v[144:147], a[112:115], v[176:191]
    s_waitcnt lgkmcnt(4)
    v_mfma_f32_32x32x16_bf16 v[176:191], v[148:151], a[116:119], v[176:191]
    s_waitcnt lgkmcnt(2)
    v_mfma_f32_32x32x16_bf16 v[176:191], v[152:155], a[120:123], v[176:191]
    s_waitcnt lgkmcnt(0)
    v_mfma_f32_32x32x16_bf16 v[176:191], v[156:159], a[124:127], v[176:191]
    s_waitcnt vmcnt(0)
    buffer_load_dwordx4 a[0:3], v240, s[28:31], s32 offen offset:0 sc1
    buffer_load_dwordx4 a[4:7], v240, s[28:31], s32 offen offset:1024 sc1
    buffer_load_dwordx4 a[8:11], v240, s[28:31], s32 offen offset:2048 sc1
    buffer_load_dwordx4 a[12:15], v240, s[28:31], s32 offen offset:3072 sc1
    buffer_load_dwordx4 a[16:19], v240, s[28:31], s33 offen offset:0 sc1
    buffer_load_dwordx4 a[20:23], v240, s[28:31], s33 offen offset:1024 sc1
    buffer_load_dwordx4 a[24:27], v240, s[28:31], s33 offen offset:2048 sc1
    buffer_load_dwordx4 a[28:31], v240, s[28:31], s33 offen offset:3072 sc1
    buffer_load_dwordx4 a[32:35], v240, s[28:31], s34 offen offset:0 sc1
    buffer_load_dwordx4 a[36:39], v240, s[28:31], s34 offen offset:1024 sc1
    buffer_load_dwordx4 a[40:43], v240, s[28:31], s34 offen offset:2048 sc1
    buffer_load_dwordx4 a[44:47], v240, s[28:31], s34 offen offset:3072 sc1
    buffer_load_dwordx4 a[48:51], v240, s[28:31], s35 offen offset:0 sc1
    buffer_load_dwordx4 a[52:55], v240, s[28:31], s35 offen offset:1024 sc1
    buffer_load_dwordx4 a[56:59], v240, s[28:31], s35 offen offset:2048 sc1
    buffer_load_dwordx4 a[60:63], v240, s[28:31], s35 offen offset:3072 sc1
    buffer_load_dwordx4 a[64:67], v240, s[28:31], s36 offen offset:0 sc1
    buffer_load_dwordx4 a[68:71], v240, s[28:31], s36 offen offset:1024 sc1
    buffer_load_dwordx4 a[72:75], v240, s[28:31], s36 offen offset:2048 sc1
    buffer_load_dwordx4 a[76:79], v240, s[28:31], s36 offen offset:3072 sc1
    buffer_load_dwordx4 a[80:83], v240, s[28:31], s37 offen offset:0 sc1
    buffer_load_dwordx4 a[84:87], v240, s[28:31], s37 offen offset:1024 sc1
    buffer_load_dwordx4 a[88:91], v240, s[28:31], s37 offen offset:2048 sc1
    buffer_load_dwordx4 a[92:95], v240, s[28:31], s37 offen offset:3072 sc1
    buffer_load_dwordx4 a[96:99], v240, s[28:31], s38 offen offset:0 sc1
    buffer_load_dwordx4 a[100:103], v240, s[28:31], s38 offen offset:1024 sc1
    buffer_load_dwordx4 a[104:107], v240, s[28:31], s38 offen offset:2048 sc1
    buffer_load_dwordx4 a[108:111], v240, s[28:31], s38 offen offset:3072 sc1
    buffer_load_dwordx4 a[112:115], v240, s[28:31], s39 offen offset:0 sc1
    buffer_load_dwordx4 a[116:119], v240, s[28:31], s39 offen offset:1024 sc1
    buffer_load_dwordx4 a[120:123], v240, s[28:31], s39 offen offset:2048 sc1
    buffer_load_dwordx4 a[124:127], v240, s[28:31], s39 offen offset:3072 sc1
    s_add_u32 s28, s28, 131072
    s_addc_u32 s29, s29, 0
    v_cvt_pk_bf16_f32 v24, v176, v177
    v_cvt_pk_bf16_f32 v25, v178, v179
    v_cvt_pk_bf16_f32 v26, v180, v181
    v_cvt_pk_bf16_f32 v27, v182, v183
    v_cvt_pk_bf16_f32 v28, v184, v185
    v_cvt_pk_bf16_f32 v29, v186, v187
    v_cvt_pk_bf16_f32 v30, v188, v189
    v_cvt_pk_bf16_f32 v31, v190, v191
    s_add_u32 s26, s26, 1
    v_mfma_f32_32x32x16_bf16 v[160:175], a[128:131], v[192:195], v[224:239]
    v_mfma_f32_32x32x16_bf16 v[160:175], a[132:135], v[196:199], v[160:175]
    v_mfma_f32_32x32x16_bf16 v[160:175], a[136:139], v[200:203], v[160:175]
    v_mfma_f32_32x32x16_bf16 v[160:175], a[140:143], v[204:207], v[160:175]
    v_mfma_f32_32x32x16_bf16 v[160:175], a[144:147], v[208:211], v[160:175]
    v_mfma_f32_32x32x16_bf16 v[160:175], a[148:151], v[212:215], v[160:175]
    v_mfma_f32_32x32x16_bf16 v[160:175], a[152:155], v[216:219], v[160:175]
    v_mfma_f32_32x32x16_bf16 v[160:175], a[156:159], v[220:223], v[160:175]
    s_nop 11
    v_max3_f32 v96, v160, v161, v162
    v_max3_f32 v96, v96, v163, v164
    v_max3_f32 v96, v96, v165, v166
    v_max3_f32 v96, v96, v167, v168
    v_max3_f32 v96, v96, v169, v170
    v_max3_f32 v96, v96, v171, v172
    v_max3_f32 v96, v96, v173, v174
    v_max_f32 v96, v96, v175
    v_mov_b32 v97, v96
    s_nop 1
    v_permlane32_swap_b32 v96, v97
    v_max_f32 v96, v96, v97
    v_sub_f32 v160, v160, v96
    v_sub_f32 v161, v161, v96
    v_sub_f32 v162, v162, v96
    v_sub_f32 v163, v163, v96
    v_sub_f32 v164, v164, v96
    v_sub_f32 v165, v165, v96
    v_sub_f32 v166, v166, v96
    v_sub_f32 v167, v167, v96
    v_sub_f32 v168, v168, v96
    v_sub_f32 v169, v169, v96
    v_sub_f32 v170, v170, v96
    v_sub_f32 v171, v171, v96
    v_sub_f32 v172, v172, v96
    v_sub_f32 v173, v173, v96
    v_sub_f32 v174, v174, v96
    v_sub_f32 v175, v175, v96
    v_mul_f32 v160, s67, v160
    v_mul_f32 v161, s67, v161
    v_mul_f32 v162, s67, v162
    v_mul_f32 v163, s67, v163
    v_mul_f32 v164, s67, v164
    v_mul_f32 v165, s67, v165
    v_mul_f32 v166, s67, v166
    v_mul_f32 v167, s67, v167
    v_mul_f32 v168, s67, v168
    v_mul_f32 v169, s67, v169
    v_mul_f32 v170, s67, v170
    v_mul_f32 v171, s67, v171
    v_mul_f32 v172, s67, v172
    v_mul_f32 v173, s67, v173
    v_mul_f32 v174, s67, v174
    v_mul_f32 v175, s67, v175
    v_exp_f32 v160, v160
    v_exp_f32 v161, v161
    v_exp_f32 v162, v162
    v_exp_f32 v163, v163
    v_exp_f32 v164, v164
    v_exp_f32 v165, v165
    v_exp_f32 v166, v166
    v_exp_f32 v167, v167
    v_exp_f32 v168, v168
    v_exp_f32 v169, v169
    v_exp_f32 v170, v170
    v_exp_f32 v171, v171
    v_exp_f32 v172, v172
    v_exp_f32 v173, v173
    v_exp_f32 v174, v174
    v_exp_f32 v175, v175
    v_cvt_pk_bf16_f32 v128, v160, v161
    v_cvt_pk_bf16_f32 v129, v162, v163
    v_cvt_pk_bf16_f32 v130, v164, v165
    v_cvt_pk_bf16_f32 v131, v166, v167
    v_cvt_pk_bf16_f32 v132, v168, v169
    v_cvt_pk_bf16_f32 v133, v170, v171
    v_cvt_pk_bf16_f32 v134, v172, v173
    v_cvt_pk_bf16_f32 v135, v174, v175
    v_pk_add_f32 v[160:161], v[160:161], v[162:163]
    v_pk_add_f32 v[164:165], v[164:165], v[166:167]
    v_pk_add_f32 v[168:169], v[168:169], v[170:171]
    v_pk_add_f32 v[172:173], v[172:173], v[174:175]
    v_pk_add_f32 v[160:161], v[160:161], v[164:165]
    v_pk_add_f32 v[168:169], v[168:169], v[172:173]
    v_pk_add_f32 v[160:161], v[160:161], v[168:169]
    v_add_f32 v98, v160, v161
    v_mfma_f32_32x32x16_bf16 v[32:47], a[160:163], v[128:131], 0
    v_mfma_f32_32x32x16_bf16 v[32:47], a[164:167], v[132:135], v[32:47]
    v_mfma_f32_32x32x16_bf16 v[48:63], a[168:171], v[128:131], 0
    v_mfma_f32_32x32x16_bf16 v[48:63], a[172:175], v[132:135], v[48:63]
    v_mfma_f32_32x32x16_bf16 v[64:79], a[176:179], v[128:131], 0
    v_mfma_f32_32x32x16_bf16 v[64:79], a[180:183], v[132:135], v[64:79]
    v_mfma_f32_32x32x16_bf16 v[80:95], a[184:187], v[128:131], 0
    v_mfma_f32_32x32x16_bf16 v[80:95], a[188:191], v[132:135], v[80:95]
    s_add_u32 s60, s60, 1
L_q_pc0:
    global_load_dword v248, v255, s[50:51] sc1
    s_waitcnt vmcnt(0)
L_q_pc0_c:
    v_cmp_gt_u32 vcc, s60, v248
    s_cbranch_vccz L_q_pc0_ok
    s_sleep 1
    s_sub_u32 s27, s27, 1
    s_cbranch_scc0 L_q_pc0
    s_branch L_end
L_q_pc0_ok:
    global_load_dwordx4 a[192:195], v244, s[44:45] offset:0 sc1
    global_load_dwordx4 a[196:199], v244, s[44:45] offset:512 sc1
    global_load_dwordx4 a[200:203], v244, s[44:45] offset:1024 sc1
    global_load_dwordx4 a[204:207], v244, s[44:45] offset:1536 sc1
    global_load_dwordx4 a[208:211], v244, s[44:45] offset:2048 sc1
    global_load_dwordx4 a[212:215], v244, s[44:45] offset:2560 sc1
    global_load_dwordx4 a[216:219], v244, s[44:45] offset:3072 sc1
    global_load_dwordx4 a[220:223], v244, s[44:45] offset:3584 sc1
    global_load_dword a224, v245, s[44:45] offset:0 sc1
    global_load_dword a225, v245, s[44:45] offset:256 sc1
    global_load_dword a226, v245, s[44:45] offset:1024 sc1
    global_load_dword a227, v245, s[44:45] offset:1280 sc1
    global_load_dword a228, v245, s[44:45] offset:2048 sc1
    global_load_dword a229, v245, s[44:45] offset:2304 sc1
    global_load_dword a230, v245, s[44:45] offset:3072 sc1
    global_load_dword a231, v245, s[44:45] offset:3328 sc1
    s_add_u32 s44, s44, 524288
    s_addc_u32 s45, s45, 0
    s_waitcnt vmcnt(15)
    v_mfma_f32_32x32x16_bf16 v[176:191], a[192:195], v[192:195], 0
    s_waitcnt vmcnt(14)
    v_mfma_f32_32x32x16_bf16 v[176:191], a[196:199], v[196:199], v[176:191]
    s_waitcnt vmcnt(13)
    v_mfma_f32_32x32x16_bf16 v[176:191], a[200:203], v[200:203], v[176:191]
    s_waitcnt vmcnt(12)
    v_mfma_f32_32x32x16_bf16 v[176:191], a[204:207], v[204:207], v[176:191]
    s_waitcnt vmcnt(11)
    v_mfma_f32_32x32x16_bf16 v[176:191], a[208:211], v[208:211], v[176:191]
    s_waitcnt vmcnt(10)
    v_mfma_f32_32x32x16_bf16 v[176:191], a[212:215], v[212:215], v[176:191]
    s_waitcnt vmcnt(9)
    v_mfma_f32_32x32x16_bf16 v[176:191], a[216:219], v[216:219], v[176:191]
    s_waitcnt vmcnt(8)
    v_mfma_f32_32x32x16_bf16 v[176:191], a[220:223], v[220:223], v[176:191]
    s_nop 11
    v_max3_f32 v100, v176, v177, v178
    v_max_f32 v100, v100, v179
    v_mov_b32 v97, v100
    s_nop 1
    v_permlane32_swap_b32 v100, v97
    v_max3_f32 v97, v100, v97, v96
    v_sub_f32 v100, v96, v97
    v_sub_f32 v176, v176, v97
    v_sub_f32 v177, v177, v97
    v_sub_f32 v178, v178, v97
    v_sub_f32 v179, v179, v97
    v_mul_f32 v100, s67, v100
    v_mul_f32 v176, s67, v176
    v_mul_f32 v177, s67, v177
    v_mul_f32 v178, s67, v178
    v_mul_f32 v179, s67, v179
    v_exp_f32 v100, v100
    v_exp_f32 v176, v176
    v_exp_f32 v177, v177
    v_exp_f32 v178, v178
    v_exp_f32 v179, v179
    v_fma_f32 v98, v98, v100, v176
    v_add_f32 v98, v98, v177
    v_add_f32 v98, v98, v178
    v_add_f32 v98, v98, v179
    v_mov_b32 v97, v98
    s_nop 1
    v_permlane32_swap_b32 v98, v97
    v_add_f32 v98, v98, v97
    v_rcp_f32 v98, v98
    s_nop 0
    v_mul_f32 v100, v100, v98
    v_pk_mul_f32 v[176:177], v[176:177], v[98:99] op_sel_hi:[1,0]
    v_pk_mul_f32 v[178:179], v[178:179], v[98:99] op_sel_hi:[1,0]
    v_cvt_pk_bf16_f32 v136, v176, v177
    v_cvt_pk_bf16_f32 v137, v178, v179
    v_pk_mul_f32 v[32:33], v[32:33], v[100:101] op_sel_hi:[1,0]
    v_pk_mul_f32 v[34:35], v[34:35], v[100:101] op_sel_hi:[1,0]
    v_pk_mul_f32 v[36:37], v[36:37], v[100:101] op_sel_hi:[1,0]
    v_pk_mul_f32 v[38:39], v[38:39], v[100:101] op_sel_hi:[1,0]
    v_pk_mul_f32 v[40:41], v[40:41], v[100:101] op_sel_hi:[1,0]
    v_pk_mul_f32 v[42:43], v[42:43], v[100:101] op_sel_hi:[1,0]
    v_pk_mul_f32 v[44:45], v[44:45], v[100:101] op_sel_hi:[1,0]
    v_pk_mul_f32 v[46:47], v[46:47], v[100:101] op_sel_hi:[1,0]
    v_pk_mul_f32 v[48:49], v[48:49], v[100:101] op_sel_hi:[1,0]
    v_pk_mul_f32 v[50:51], v[50:51], v[100:101] op_sel_hi:[1,0]
    v_pk_mul_f32 v[52:53], v[52:53], v[100:101] op_sel_hi:[1,0]
    v_pk_mul_f32 v[54:55], v[54:55], v[100:101] op_sel_hi:[1,0]
    v_pk_mul_f32 v[56:57], v[56:57], v[100:101] op_sel_hi:[1,0]
    v_pk_mul_f32 v[58:59], v[58:59], v[100:101] op_sel_hi:[1,0]
    v_pk_mul_f32 v[60:61], v[60:61], v[100:101] op_sel_hi:[1,0]
    v_pk_mul_f32 v[62:63], v[62:63], v[100:101] op_sel_hi:[1,0]
    v_pk_mul_f32 v[64:65], v[64:65], v[100:101] op_sel_hi:[1,0]
    v_pk_mul_f32 v[66:67], v[66:67], v[100:101] op_sel_hi:[1,0]
    v_pk_mul_f32 v[68:69], v[68:69], v[100:101] op_sel_hi:[1,0]
    v_pk_mul_f32 v[70:71], v[70:71], v[100:101] op_sel_hi:[1,0]
    v_pk_mul_f32 v[72:73], v[72:73], v[100:101] op_sel_hi:[1,0]
    v_pk_mul_f32 v[74:75], v[74:75], v[100:101] op_sel_hi:[1,0]
    v_pk_mul_f32 v[76:77], v[76:77], v[100:101] op_sel_hi:[1,0]
    v_pk_mul_f32 v[78:79], v[78:79], v[100:101] op_sel_hi:[1,0]
    v_pk_mul_f32 v[80:81], v[80:81], v[100:101] op_sel_hi:[1,0]
    v_pk_mul_f32 v[82:83], v[82:83], v[100:101] op_sel_hi:[1,0]
    v_pk_mul_f32 v[84:85], v[84:85], v[100:101] op_sel_hi:[1,0]
    v_pk_mul_f32 v[86:87], v[86:87], v[100:101] op_sel_hi:[1,0]
    v_pk_mul_f32 v[88:89], v[88:89], v[100:101] op_sel_hi:[1,0]
    v_pk_mul_f32 v[90:91], v[90:91], v[100:101] op_sel_hi:[1,0]
    v_pk_mul_f32 v[92:93], v[92:93], v[100:101] op_sel_hi:[1,0]
    v_pk_mul_f32 v[94:95], v[94:95], v[100:101] op_sel_hi:[1,0]
    s_waitcnt vmcnt(0)
    v_mfma_f32_32x32x8_bf16 v[32:47], a[224:225], v[136:137], v[32:47]
    v_mfma_f32_32x32x8_bf16 v[48:63], a[226:227], v[136:137], v[48:63]
    v_mfma_f32_32x32x8_bf16 v[64:79], a[228:229], v[136:137], v[64:79]
    v_cvt_pk_bf16_f32 v140, v32, v33
    v_cvt_pk_bf16_f32 v141, v34, v35
    v_cvt_pk_bf16_f32 v142, v36, v37
    v_cvt_pk_bf16_f32 v143, v38, v39
    v_cvt_pk_bf16_f32 v144, v40, v41
    v_cvt_pk_bf16_f32 v145, v42, v43
    v_cvt_pk_bf16_f32 v146, v44, v45
    v_cvt_pk_bf16_f32 v147, v46, v47
    global_store_dwordx4 v240, v[140:143], s[46:47] offset:-4096 sc1
    global_store_dwordx4 v240, v[144:147], s[46:47] offset:-3072 sc1
    v_mfma_f32_32x32x8_bf16 v[80:95], a[230:231], v[136:137], v[80:95]
    v_cvt_pk_bf16_f32 v148, v48, v49
    v_cvt_pk_bf16_f32 v149, v50, v51
    v_cvt_pk_bf16_f32 v150, v52, v53
    v_cvt_pk_bf16_f32 v151, v54, v55
    v_cvt_pk_bf16_f32 v152, v56, v57
    v_cvt_pk_bf16_f32 v153, v58, v59
    v_cvt_pk_bf16_f32 v154, v60, v61
    v_cvt_pk_bf16_f32 v155, v62, v63
    global_store_dwordx4 v240, v[148:151], s[46:47] offset:-2048 sc1
    global_store_dwordx4 v240, v[152:155], s[46:47] offset:-1024 sc1
    v_cvt_pk_bf16_f32 v140, v64, v65
    v_cvt_pk_bf16_f32 v141, v66, v67
    v_cvt_pk_bf16_f32 v142, v68, v69
    v_cvt_pk_bf16_f32 v143, v70, v71
    v_cvt_pk_bf16_f32 v144, v72, v73
    v_cvt_pk_bf16_f32 v145, v74, v75
    v_cvt_pk_bf16_f32 v146, v76, v77
    v_cvt_pk_bf16_f32 v147, v78, v79
    global_store_dwordx4 v240, v[140:143], s[46:47] offset:0 sc1
    global_store_dwordx4 v240, v[144:147], s[46:47] offset:1024 sc1
    v_cvt_pk_bf16_f32 v148, v80, v81
    v_cvt_pk_bf16_f32 v149, v82, v83
    v_cvt_pk_bf16_f32 v150, v84, v85
    v_cvt_pk_bf16_f32 v151, v86, v87
    v_cvt_pk_bf16_f32 v152, v88, v89
    v_cvt_pk_bf16_f32 v153, v90, v91
    v_cvt_pk_bf16_f32 v154, v92, v93
    v_cvt_pk_bf16_f32 v155, v94, v95
    global_store_dwordx4 v240, v[148:151], s[46:47] offset:2048 sc1
    global_store_dwordx4 v240, v[152:155], s[46:47] offset:3072 sc1
    s_add_u32 s46, s46, 1048576
    s_addc_u32 s47, s47, 0
    s_lshl_b32 s60, s26, 2
    s_add_u32 s60, s60, s23
    s_add_u32 s60, s60, 1
L_q_pk1:
    global_load_dword v248, v254, s[48:49] sc1
    s_waitcnt vmcnt(0)
L_q_pk1_c:
    v_cmp_gt_u32 vcc, s60, v248
    s_cbranch_vccz L_q_pk1_ok
    s_sleep 2
    s_sub_u32 s27, s27, 1
    s_cbranch_scc0 L_q_pk1
    s_branch L_end
L_q_pk1_ok:
    v_mov_b32 v248, s26
    s_mov_b64 exec, 1
    global_store_dword v246, v248, s[42:43] sc1
    s_mov_b64 exec, -1
    buffer_load_dwordx4 a[128:131], v242, s[52:55], s32 offen offset:0 sc1
    buffer_load_dwordx4 a[132:135], v242, s[52:55], s32 offen offset:512 sc1
    buffer_load_dwordx4 a[136:139], v242, s[52:55], s33 offen offset:0 sc1
    buffer_load_dwordx4 a[140:143], v242, s[52:55], s33 offen offset:512 sc1
    buffer_load_dwordx4 a[144:147], v242, s[52:55], s34 offen offset:0 sc1
    buffer_load_dwordx4 a[148:151], v242, s[52:55], s34 offen offset:512 sc1
    buffer_load_dwordx4 a[152:155], v242, s[52:55], s35 offen offset:0 sc1
    buffer_load_dwordx4 a[156:159], v242, s[52:55], s35 offen offset:512 sc1
    buffer_load_dwordx4 a[160:163], v243, s[52:55], s32 offen offset:0 sc1
    buffer_load_dwordx4 a[164:167], v243, s[52:55], s32 offen offset:512 sc1
    buffer_load_dwordx4 a[168:171], v243, s[52:55], s33 offen offset:0 sc1
    buffer_load_dwordx4 a[172:175], v243, s[52:55], s33 offen offset:512 sc1
    buffer_load_dwordx4 a[176:179], v243, s[52:55], s34 offen offset:0 sc1
    buffer_load_dwordx4 a[180:183], v243, s[52:55], s34 offen offset:512 sc1
    buffer_load_dwordx4 a[184:187], v243, s[52:55], s35 offen offset:0 sc1
    buffer_load_dwordx4 a[188:191], v243, s[52:55], s35 offen offset:512 sc1
    s_add_u32 s52, s52, 2097152
    s_addc_u32 s53, s53, 0
    s_cmp_ge_u32 s26, 15
    s_cbranch_scc1 L_q_skip
L_q_first:
    ds_read_b64_tr_b16 v[128:129], v120 offset:0
    ds_read_b64_tr_b16 v[130:131], v120 offset:1024
    ds_read_b64_tr_b16 v[132:133], v120 offset:4096
    ds_read_b64_tr_b16 v[134:135], v120 offset:5120
    ds_read_b64_tr_b16 v[136:137], v120 offset:8192
    ds_read_b64_tr_b16 v[138:139], v120 offset:9216
    ds_read_b64_tr_b16 v[140:141], v120 offset:12288
    ds_read_b64_tr_b16 v[142:143], v120 offset:13312
    ds_read_b64_tr_b16 v[144:145], v120 offset:16384
    ds_read_b64_tr_b16 v[146:147], v120 offset:17408
    ds_read_b64_tr_b16 v[148:149], v120 offset:20480
    ds_read_b64_tr_b16 v[150:151], v120 offset:21504
    ds_read_b64_tr_b16 v[152:153], v120 offset:24576
    ds_read_b64_tr_b16 v[154:155], v120 offset:25600
    s_waitcnt lgkmcnt(12)
    v_mfma_f32_32x32x16_bf16 v[160:175], v[128:131], a[0:3], 0
    ds_read_b64_tr_b16 v[156:157], v120 offset:28672
    ds_read_b64_tr_b16 v[158:159], v120 offset:29696
    s_waitcnt lgkmcnt(12)
    v_mfma_f32_32x32x16_bf16 v[160:175], v[132:135], a[4:7], v[160:175]
    ds_read_b64_tr_b16 v[128:129], v120 offset:32768
    ds_read_b64_tr_b16 v[130:131], v120 offset:33792
    s_waitcnt lgkmcnt(12)
    v_mfma_f32_32x32x16_bf16 v[160:175], v[136:139], a[8:11], v[160:175]
    ds_read_b64_tr_b16 v[132:133], v120 offset:36864
    ds_read_b64_tr_b16 v[134:135], v120 offset:37888
    s_waitcnt lgkmcnt(12)
    v_mfma_f32_32x32x16_bf16 v[160:175], v[140:143], a[12:15], v[160:175]
    ds_read_b64_tr_b16 v[136:137], v120 offset:40960
    ds_read_b64_tr_b16 v[138:139], v120 offset:41984
    s_waitcnt lgkmcnt(12)
    v_mfma_f32_32x32x16_bf16 v[160:175], v[144:147], a[16:19], v[160:175]
    ds_read_b64_tr_b16 v[140:141], v120 offset:45056
    ds_read_b64_tr_b16 v[142:143], v120 offset:46080
    s_waitcnt lgkmcnt(12)
    v_mfma_f32_32x32x16_bf16 v[160:175], v[148:151], a[20:23], v[160:175]
    ds_read_b64_tr_b16 v[144:145], v120 offset:49152
    ds_read_b64_tr_b16 v[146:147], v120 offset:50176
    s_waitcnt lgkmcnt(12)
    v_mfma_f32_32x32x16_bf16 v[160:175], v[152:155], a[24:27], v[160:175]
    ds_read_b64_tr_b16 v[148:149], v120 offset:53248
    ds_read_b64_tr_b16 v[150:151], v120 offset:54272
    s_waitcnt lgkmcnt(12)
    v_mfma_f32_32x32x16_bf16 v[160:175], v[156:159], a[28:31], v[160:175]
    ds_read_b64_tr_b16 v[152:153], v120 offset:57344
    ds_read_b64_tr_b16 v[154:155], v120 offset:58368
    s_waitcnt lgkmcnt(12)
    v_mfma_f32_32x32x16_bf16 v[160:175], v[128:131], a[32:35], v[160:175]
    ds_read_b64_tr_b16 v[156:157], v120 offset:61440
    ds_read_b64_tr_b16 v[158:159], v120 offset:62464
    s_waitcnt lgkmcnt(12)
    v_mfma_f32_32x32x16_bf16 v[160:175], v[132:135], a[36:39], v[160:175]
    ds_read_b64_tr_b16 v[128:129], v121 offset:0
    ds_read_b64_tr_b16 v[130:131], v121 offset:1024
    s_waitcnt lgkmcnt(12)
    v_mfma_f32_32x32x16_bf16 v[160:175], v[136:139], a[40:43], v[160:175]
    ds_read_b64_tr_b16 v[132:133], v121 offset:4096
    ds_read_b64_tr_b16 v[134:135], v121 offset:5120
    s_waitcnt lgkmcnt(12)
    v_mfma_f32_32x32x16_bf16 v[160:175], v[140:143], a[44:47], v[160:175]
    ds_read_b64_tr_b16 v[136:137], v121 offset:8192
    ds_read_b64_tr_b16 v[138:139], v121 offset:9216
    s_waitcnt lgkmcnt(12)
    v_mfma_f32_32x32x16_bf16 v[160:175], v[144:147], a[48:51], v[160:175]
    ds_read_b64_tr_b16 v[140:141], v121 offset:12288
    ds_read_b64_tr_b16 v[142:143], v121 offset:13312
    s_waitcnt lgkmcnt(12)
    v_mfma_f32_32x32x16_bf16 v[160:175], v[148:151], a[52:55], v[160:175]
    ds_read_b64_tr_b16 v[144:145], v121 offset:16384
    ds_read_b64_tr_b16 v[146:147], v121 offset:17408
    s_waitcnt lgkmcnt(12)
    v_mfma_f32_32x32x16_bf16 v[160:175], v[152:155], a[56:59], v[160:175]
    ds_read_b64_tr_b16 v[148:149], v121 offset:20480
    ds_read_b64_tr_b16 v[150:151], v121 offset:21504
    s_waitcnt lgkmcnt(12)
    v_mfma_f32_32x32x16_bf16 v[160:175], v[156:159], a[60:63], v[160:175]
    ds_read_b64_tr_b16 v[152:153], v121 offset:24576
    ds_read_b64_tr_b16 v[154:155], v121 offset:25600
    s_waitcnt lgkmcnt(12)
    v_mfma_f32_32x32x16_bf16 v[160:175], v[128:131], a[64:67], v[160:175]
    ds_read_b64_tr_b16 v[156:157], v121 offset:28672
    ds_read_b64_tr_b16 v[158:159], v121 offset:29696
    s_waitcnt lgkmcnt(12)
    v_mfma_f32_32x32x16_bf16 v[160:175], v[132:135], a[68:71], v[160:175]
    ds_read_b64_tr_b16 v[128:129], v121 offset:32768
    ds_read_b64_tr_b16 v[130:131], v121 offset:33792
    s_waitcnt lgkmcnt(12)
    v_mfma_f32_32x32x16_bf16 v[160:175], v[136:139], a[72:75], v[160:175]
    ds_read_b64_tr_b16 v[132:133], v121 offset:36864
    ds_read_b64_tr_b16 v[134:135], v121 offset:37888
    s_waitcnt lgkmcnt(12)
    v_mfma_f32_32x32x16_bf16 v[160:175], v[140:143], a[76:79], v[160:175]
    ds_read_b64_tr_b16 v[136:137], v121 offset:40960
    ds_read_b64_tr_b16 v[138:139], v121 offset:41984
    s_waitcnt lgkmcnt(12)
    v_mfma_f32_32x32x16_bf16 v[160:175], v[144:147], a[80:83], v[160:175]
    ds_read_b64_tr_b16 v[140:141], v121 offset:45056
    ds_read_b64_tr_b16 v[142:143], v121 offset:46080
    s_waitcnt lgkmcnt(12)
    v_mfma_f32_32x32x16_bf16 v[160:175], v[148:151], a[84:87], v[160:175]
    ds_read_b64_tr_b16 v[144:145], v121 offset:49152
    ds_read_b64_tr_b16 v[146:147], v121 offset:50176
    s_waitcnt lgkmcnt(12)
    v_mfma_f32_32x32x16_bf16 v[160:175], v[152:155], a[88:91], v[160:175]
    ds_read_b64_tr_b16 v[148:149], v121 offset:53248
    ds_read_b64_tr_b16 v[150:151], v121 offset:54272
    s_waitcnt lgkmcnt(12)
    v_mfma_f32_32x32x16_bf16 v[160:175], v[156:159], a[92:95], v[160:175]
    ds_read_b64_tr_b16 v[152:153], v121 offset:57344
    ds_read_b64_tr_b16 v[154:155], v121 offset:58368
    s_waitcnt lgkmcnt(12)
    v_mfma_f32_32x32x16_bf16 v[160:175], v[128:131], a[96:99], v[160:175]
    ds_read_b64_tr_b16 v[156:157], v121 offset:61440
    ds_read_b64_tr_b16 v[158:159], v121 offset:62464
    s_waitcnt lgkmcnt(12)
    v_mfma_f32_32x32x16_bf16 v[160:175], v[132:135], a[100:103], v[160:175]
    ds_read_b64_tr_b16 v[128:129], v122 offset:0
    ds_read_b64_tr_b16 v[130:131], v122 offset:1024
    s_waitcnt lgkmcnt(12)
    v_mfma_f32_32x32x16_bf16 v[160:175], v[136:139], a[104:107], v[160:175]
    ds_read_b64_tr_b16 v[132:133], v122 offset:4096
    ds_read_b64_tr_b16 v[134:135], v122 offset:5120
    s_waitcnt lgkmcnt(12)
    v_mfma_f32_32x32x16_bf16 v[160:175], v[140:143], a[108:111], v[160:175]
    ds_read_b64_tr_b16 v[136:137], v122 offset:8192
    ds_read_b64_tr_b16 v[138:139], v122 offset:9216
    s_waitcnt lgkmcnt(12)
    v_mfma_f32_32x32x16_bf16 v[160:175], v[144:147], a[112:115], v[160:175]
    ds_read_b64_tr_b16 v[140:141], v122 offset:12288
    ds_read_b64_tr_b16 v[142:143], v122 offset:13312
    s_waitcnt lgkmcnt(12)
    v_mfma_f32_32x32x16_bf16 v[160:175], v[148:151], a[116:119], v[160:175]
    ds_read_b64_tr_b16 v[144:145], v122 offset:16384
    ds_read_b64_tr_b16 v[146:147], v122 offset:17408
    s_waitcnt lgkmcnt(12)
    v_mfma_f32_32x32x16_bf16 v[160:175], v[152:155], a[120:123], v[160:175]
    ds_read_b64_tr_b16 v[148:149], v122 offset:20480
    ds_read_b64_tr_b16 v[150:151], v122 offset:21504
    s_waitcnt lgkmcnt(12)
    v_mfma_f32_32x32x16_bf16 v[160:175], v[156:159], a[124:127], v[160:175]
    ds_read_b64_tr_b16 v[152:153], v122 offset:24576
    ds_read_b64_tr_b16 v[154:155], v122 offset:25600
    s_waitcnt lgkmcnt(12)
    v_mfma_f32_32x32x16_bf16 v[176:191], v[128:131], a[0:3], 0
    ds_read_b64_tr_b16 v[156:157], v122 offset:28672
    ds_read_b64_tr_b16 v[158:159], v122 offset:29696
    s_waitcnt lgkmcnt(12)
    v_mfma_f32_32x32x16_bf16 v[176:191], v[132:135], a[4:7], v[176:191]
    ds_read_b64_tr_b16 v[128:129], v122 offset:32768
    ds_read_b64_tr_b16 v[130:131], v122 offset:33792
    s_waitcnt lgkmcnt(12)
    v_mfma_f32_32x32x16_bf16 v[176:191], v[136:139], a[8:11], v[176:191]
    ds_read_b64_tr_b16 v[132:133], v122 offset:36864
    ds_read_b64_tr_b16 v[134:135], v122 offset:37888
    s_waitcnt lgkmcnt(12)
    v_mfma_f32_32x32x16_bf16 v[176:191], v[140:143], a[12:15], v[176:191]
    v_cvt_pk_bf16_f32 v192, v160, v161
    v_cvt_pk_bf16_f32 v193, v162, v163
    ds_read_b64_tr_b16 v[136:137], v122 offset:40960
    ds_read_b64_tr_b16 v[138:139], v122 offset:41984
    s_waitcnt lgkmcnt(12)
    v_mfma_f32_32x32x16_bf16 v[176:191], v[144:147], a[16:19], v[176:191]
    v_cvt_pk_bf16_f32 v194, v164, v165
    v_cvt_pk_bf16_f32 v195, v166, v167
    ds_read_b64_tr_b16 v[140:141], v122 offset:45056
    ds_read_b64_tr_b16 v[142:143], v122 offset:46080
    s_waitcnt lgkmcnt(12)
    v_mfma_f32_32x32x16_bf16 v[176:191], v[148:151], a[20:23], v[176:191]
    v_cvt_pk_bf16_f32 v196, v168, v169
    v_cvt_pk_bf16_f32 v197, v170, v171
    ds_read_b64_tr_b16 v[144:145], v122 offset:49152
    ds_read_b64_tr_b16 v[146:147], v122 offset:50176
    s_waitcnt lgkmcnt(12)
    v_mfma_f32_32x32x16_bf16 v[176:191], v[152:155], a[24:27], v[176:191]
    v_cvt_pk_bf16_f32 v198, v172, v173
    v_cvt_pk_bf16_f32 v199, v174, v175
    ds_read_b64_tr_b16 v[148:149], v122 offset:53248
    ds_read_b64_tr_b16 v[150:151], v122 offset:54272
    s_waitcnt lgkmcnt(12)
    v_mfma_f32_32x32x16_bf16 v[176:191], v[156:159], a[28:31], v[176:191]
    ds_read_b64_tr_b16 v[152:153], v122 offset:57344
    ds_read_b64_tr_b16 v[154:155], v122 offset:58368
    s_waitcnt lgkmcnt(12)
    v_mfma_f32_32x32x16_bf16 v[176:191], v[128:131], a[32:35], v[176:191]
    ds_read_b64_tr_b16 v[156:157], v122 offset:61440
    ds_read_b64_tr_b16 v[158:159], v122 offset:62464
    s_waitcnt lgkmcnt(12)
    v_mfma_f32_32x32x16_bf16 v[176:191], v[132:135], a[36:39], v[176:191]
    ds_read_b64_tr_b16 v[128:129], v123 offset:0
    ds_read_b64_tr_b16 v[130:131], v123 offset:1024
    s_waitcnt lgkmcnt(12)
    v_mfma_f32_32x32x16_bf16 v[176:191], v[136:139], a[40:43], v[176:191]
    ds_read_b64_tr_b16 v[132:133], v123 offset:4096
    ds_read_b64_tr_b16 v[134:135], v123 offset:5120
    s_waitcnt lgkmcnt(12)
    v_mfma_f32_32x32x16_bf16 v[176:191], v[140:143], a[44:47], v[176:191]
    ds_read_b64_tr_b16 v[136:137], v123 offset:8192
    ds_read_b64_tr_b16 v[138:139], v123 offset:9216
    s_waitcnt lgkmcnt(12)
    v_mfma_f32_32x32x16_bf16 v[176:191], v[144:147], a[48:51], v[176:191]
    ds_read_b64_tr_b16 v[140:141], v123 offset:12288
    ds_read_b64_tr_b16 v[142:143], v123 offset:13312
    s_waitcnt lgkmcnt(12)
    v_mfma_f32_32x32x16_bf16 v[176:191], v[148:151], a[52:55], v[176:191]
    ds_read_b64_tr_b16 v[144:145], v123 offset:16384
    ds_read_b64_tr_b16 v[146:147], v123 offset:17408
    s_waitcnt lgkmcnt(12)
    v_mfma_f32_32x32x16_bf16 v[176:191], v[152:155], a[56:59], v[176:191]
    ds_read_b64_tr_b16 v[148:149], v123 offset:20480
    ds_read_b64_tr_b16 v[150:151], v123 offset:21504
    s_waitcnt lgkmcnt(12)
    v_mfma_f32_32x32x16_bf16 v[176:191], v[156:159], a[60:63], v[176:191]
    ds_read_b64_tr_b16 v[152:153], v123 offset:24576
    ds_read_b64_tr_b16 v[154:155], v123 offset:25600
    s_waitcnt lgkmcnt(12)
    v_mfma_f32_32x32x16_bf16 v[176:191], v[128:131], a[64:67], v[176:191]
    ds_read_b64_tr_b16 v[156:157], v123 offset:28672
    ds_read_b64_tr_b16 v[158:159], v123 offset:29696
    s_waitcnt lgkmcnt(12)
    v_mfma_f32_32x32x16_bf16 v[176:191], v[132:135], a[68:71], v[176:191]
    ds_read_b64_tr_b16 v[128:129], v123 offset:32768
    ds_read_b64_tr_b16 v[130:131], v123 offset:33792
    s_waitcnt lgkmcnt(12)
    v_mfma_f32_32x32x16_bf16 v[176:191], v[136:139], a[72:75], v[176:191]
    ds_read_b64_tr_b16 v[132:133], v123 offset:36864
    ds_read_b64_tr_b16 v[134:135], v123 offset:37888
    s_waitcnt lgkmcnt(12)
    v_mfma_f32_32x32x16_bf16 v[176:191], v[140:143], a[76:79], v[176:191]
    ds_read_b64_tr_b16 v[136:137], v123 offset:40960
    ds_read_b64_tr_b16 v[138:139], v123 offset:41984
    s_waitcnt lgkmcnt(12)
    v_mfma_f32_32x32x16_bf16 v[176:191], v[144:147], a[80:83], v[176:191]
    ds_read_b64_tr_b16 v[140:141], v123 offset:45056
    ds_read_b64_tr_b16 v[142:143], v123 offset:46080
    s_waitcnt lgkmcnt(12)
    v_mfma_f32_32x32x16_bf16 v[176:191], v[148:151], a[84:87], v[176:191]
    ds_read_b64_tr_b16 v[144:145], v123 offset:49152
    ds_read_b64_tr_b16 v[146:147], v123 offset:50176
    s_waitcnt lgkmcnt(12)
    v_mfma_f32_32x32x16_bf16 v[176:191], v[152:155], a[88:91], v[176:191]
    ds_read_b64_tr_b16 v[148:149], v123 offset:53248
    ds_read_b64_tr_b16 v[150:151], v123 offset:54272
    s_waitcnt lgkmcnt(12)
    v_mfma_f32_32x32x16_bf16 v[176:191], v[156:159], a[92:95], v[176:191]
    ds_read_b64_tr_b16 v[152:153], v123 offset:57344
    ds_read_b64_tr_b16 v[154:155], v123 offset:58368
    s_waitcnt lgkmcnt(12)
    v_mfma_f32_32x32x16_bf16 v[176:191], v[128:131], a[96:99], v[176:191]
    ds_read_b64_tr_b16 v[156:157], v123 offset:61440
    ds_read_b64_tr_b16 v[158:159], v123 offset:62464
    s_waitcnt lgkmcnt(12)
    v_mfma_f32_32x32x16_bf16 v[176:191], v[132:135], a[100:103], v[176:191]
    ds_read_b64_tr_b16 v[128:129], v124 offset:0
    ds_read_b64_tr_b16 v[130:131], v124 offset:1024
    s_waitcnt lgkmcnt(12)
    v_mfma_f32_32x32x16_bf16 v[176:191], v[136:139], a[104:107], v[176:191]
    ds_read_b64_tr_b16 v[132:133], v124 offset:4096
    ds_read_b64_tr_b16 v[134:135], v124 offset:5120
    s_waitcnt lgkmcnt(12)
    v_mfma_f32_32x32x16_bf16 v[176:191], v[140:143], a[108:111], v[176:191]
    ds_read_b64_tr_b16 v[136:137], v124 offset:8192
    ds_read_b64_tr_b16 v[138:139], v124 offset:9216
    s_waitcnt lgkmcnt(12)
    v_mfma_f32_32x32x16_bf16 v[176:191], v[144:147], a[112:115], v[176:191]
    ds_read_b64_tr_b16 v[140:141], v124 offset:12288
    ds_read_b64_tr_b16 v[142:143], v124 offset:13312
    s_waitcnt lgkmcnt(12)
    v_mfma_f32_32x32x16_bf16 v[176:191], v[148:151], a[116:119], v[176:191]
    ds_read_b64_tr_b16 v[144:145], v124 offset:16384
    ds_read_b64_tr_b16 v[146:147], v124 offset:17408
    s_waitcnt lgkmcnt(12)
    v_mfma_f32_32x32x16_bf16 v[176:191], v[152:155], a[120:123], v[176:191]
    ds_read_b64_tr_b16 v[148:149], v124 offset:20480
    ds_read_b64_tr_b16 v[150:151], v124 offset:21504
    s_waitcnt lgkmcnt(12)
    v_mfma_f32_32x32x16_bf16 v[176:191], v[156:159], a[124:127], v[176:191]
    ds_read_b64_tr_b16 v[152:153], v124 offset:24576
    ds_read_b64_tr_b16 v[154:155], v124 offset:25600
    s_waitcnt lgkmcnt(12)
    v_mfma_f32_32x32x16_bf16 v[160:175], v[128:131], a[0:3], 0
    ds_read_b64_tr_b16 v[156:157], v124 offset:28672
    ds_read_b64_tr_b16 v[158:159], v124 offset:29696
    s_waitcnt lgkmcnt(12)
    v_mfma_f32_32x32x16_bf16 v[160:175], v[132:135], a[4:7], v[160:175]
    ds_read_b64_tr_b16 v[128:129], v124 offset:32768
    ds_read_b64_tr_b16 v[130:131], v124 offset:33792
    s_waitcnt lgkmcnt(12)
    v_mfma_f32_32x32x16_bf16 v[160:175], v[136:139], a[8:11], v[160:175]
    ds_read_b64_tr_b16 v[132:133], v124 offset:36864
    ds_read_b64_tr_b16 v[134:135], v124 offset:37888
    s_waitcnt lgkmcnt(12)
    v_mfma_f32_32x32x16_bf16 v[160:175], v[140:143], a[12:15], v[160:175]
    v_cvt_pk_bf16_f32 v200, v176, v177
    v_cvt_pk_bf16_f32 v201, v178, v179
    ds_read_b64_tr_b16 v[136:137], v124 offset:40960
    ds_read_b64_tr_b16 v[138:139], v124 offset:41984
    s_waitcnt lgkmcnt(12)
    v_mfma_f32_32x32x16_bf16 v[160:175], v[144:147], a[16:19], v[160:175]
    v_cvt_pk_bf16_f32 v202, v180, v181
    v_cvt_pk_bf16_f32 v203, v182, v183
    ds_read_b64_tr_b16 v[140:141], v124 offset:45056
    ds_read_b64_tr_b16 v[142:143], v124 offset:46080
    s_waitcnt lgkmcnt(12)
    v_mfma_f32_32x32x16_bf16 v[160:175], v[148:151], a[20:23], v[160:175]
    v_cvt_pk_bf16_f32 v204, v184, v185
    v_cvt_pk_bf16_f32 v205, v186, v187
    ds_read_b64_tr_b16 v[144:145], v124 offset:49152
    ds_read_b64_tr_b16 v[146:147], v124 offset:50176
    s_waitcnt lgkmcnt(12)
    v_mfma_f32_32x32x16_bf16 v[160:175], v[152:155], a[24:27], v[160:175]
    v_cvt_pk_bf16_f32 v206, v188, v189
    v_cvt_pk_bf16_f32 v207, v190, v191
    ds_read_b64_tr_b16 v[148:149], v124 offset:53248
    ds_read_b64_tr_b16 v[150:151], v124 offset:54272
    s_waitcnt lgkmcnt(12)
    v_mfma_f32_32x32x16_bf16 v[160:175], v[156:159], a[28:31], v[160:175]
    ds_read_b64_tr_b16 v[152:153], v124 offset:57344
    ds_read_b64_tr_b16 v[154:155], v124 offset:58368
    s_waitcnt lgkmcnt(12)
    v_mfma_f32_32x32x16_bf16 v[160:175], v[128:131], a[32:35], v[160:175]
    ds_read_b64_tr_b16 v[156:157], v124 offset:61440
    ds_read_b64_tr_b16 v[158:159], v124 offset:62464
    s_waitcnt lgkmcnt(12)
    v_mfma_f32_32x32x16_bf16 v[160:175], v[132:135], a[36:39], v[160:175]
    ds_read_b64_tr_b16 v[128:129], v125 offset:0
    ds_read_b64_tr_b16 v[130:131], v125 offset:1024
    s_waitcnt lgkmcnt(12)
    v_mfma_f32_32x32x16_bf16 v[160:175], v[136:139], a[40:43], v[160:175]
    ds_read_b64_tr_b16 v[132:133], v125 offset:4096
    ds_read_b64_tr_b16 v[134:135], v125 offset:5120
    s_waitcnt lgkmcnt(12)
    v_mfma_f32_32x32x16_bf16 v[160:175], v[140:143], a[44:47], v[160:175]
    ds_read_b64_tr_b16 v[136:137], v125 offset:8192
    ds_read_b64_tr_b16 v[138:139], v125 offset:9216
    s_waitcnt lgkmcnt(12)
    v_mfma_f32_32x32x16_bf16 v[160:175], v[144:147], a[48:51], v[160:175]
    ds_read_b64_tr_b16 v[140:141], v125 offset:12288
    ds_read_b64_tr_b16 v[142:143], v125 offset:13312
    s_waitcnt lgkmcnt(12)
    v_mfma_f32_32x32x16_bf16 v[160:175], v[148:151], a[52:55], v[160:175]
    ds_read_b64_tr_b16 v[144:145], v125 offset:16384
    ds_read_b64_tr_b16 v[146:147], v125 offset:17408
    s_waitcnt lgkmcnt(12)
    v_mfma_f32_32x32x16_bf16 v[160:175], v[152:155], a[56:59], v[160:175]
    ds_read_b64_tr_b16 v[148:149], v125 offset:20480
    ds_read_b64_tr_b16 v[150:151], v125 offset:21504
    s_waitcnt lgkmcnt(12)
    v_mfma_f32_32x32x16_bf16 v[160:175], v[156:159], a[60:63], v[160:175]
    ds_read_b64_tr_b16 v[152:153], v125 offset:24576
    ds_read_b64_tr_b16 v[154:155], v125 offset:25600
    s_waitcnt lgkmcnt(12)
    v_mfma_f32_32x32x16_bf16 v[160:175], v[128:131], a[64:67], v[160:175]
    ds_read_b64_tr_b16 v[156:157], v125 offset:28672
    ds_read_b64_tr_b16 v[158:159], v125 offset:29696
    s_waitcnt lgkmcnt(12)
    v_mfma_f32_32x32x16_bf16 v[160:175], v[132:135], a[68:71], v[160:175]
    ds_read_b64_tr_b16 v[128:129], v125 offset:32768
    ds_read_b64_tr_b16 v[130:131], v125 offset:33792
    s_waitcnt lgkmcnt(12)
    v_mfma_f32_32x32x16_bf16 v[160:175], v[136:139], a[72:75], v[160:175]
    ds_read_b64_tr_b16 v[132:133], v125 offset:36864
    ds_read_b64_tr_b16 v[134:135], v125 offset:37888
    s_waitcnt lgkmcnt(12)
    v_mfma_f32_32x32x16_bf16 v[160:175], v[140:143], a[76:79], v[160:175]
    ds_read_b64_tr_b16 v[136:137], v125 offset:40960
    ds_read_b64_tr_b16 v[138:139], v125 offset:41984
    s_waitcnt lgkmcnt(12)
    v_mfma_f32_32x32x16_bf16 v[160:175], v[144:147], a[80:83], v[160:175]
    ds_read_b64_tr_b16 v[140:141], v125 offset:45056
    ds_read_b64_tr_b16 v[142:143], v125 offset:46080
    s_waitcnt lgkmcnt(12)
    v_mfma_f32_32x32x16_bf16 v[160:175], v[148:151], a[84:87], v[160:175]
    ds_read_b64_tr_b16 v[144:145], v125 offset:49152
    ds_read_b64_tr_b16 v[146:147], v125 offset:50176
    s_waitcnt lgkmcnt(12)
    v_mfma_f32_32x32x16_bf16 v[160:175], v[152:155], a[88:91], v[160:175]
    ds_read_b64_tr_b16 v[148:149], v125 offset:53248
    ds_read_b64_tr_b16 v[150:151], v125 offset:54272
    s_waitcnt lgkmcnt(12)
    v_mfma_f32_32x32x16_bf16 v[160:175], v[156:159], a[92:95], v[160:175]
    ds_read_b64_tr_b16 v[152:153], v125 offset:57344
    ds_read_b64_tr_b16 v[154:155], v125 offset:58368
    s_waitcnt lgkmcnt(12)
    v_mfma_f32_32x32x16_bf16 v[160:175], v[128:131], a[96:99], v[160:175]
    ds_read_b64_tr_b16 v[156:157], v125 offset:61440
    ds_read_b64_tr_b16 v[158:159], v125 offset:62464
    s_waitcnt lgkmcnt(12)
    v_mfma_f32_32x32x16_bf16 v[160:175], v[132:135], a[100:103], v[160:175]
    ds_read_b64_tr_b16 v[128:129], v126 offset:0
    ds_read_b64_tr_b16 v[130:131], v126 offset:1024
    s_waitcnt lgkmcnt(12)
    v_mfma_f32_32x32x16_bf16 v[160:175], v[136:139], a[104:107], v[160:175]
    ds_read_b64_tr_b16 v[132:133], v126 offset:4096
    ds_read_b64_tr_b16 v[134:135], v126 offset:5120
    s_waitcnt lgkmcnt(12)
    v_mfma_f32_32x32x16_bf16 v[160:175], v[140:143], a[108:111], v[160:175]
    ds_read_b64_tr_b16 v[136:137], v126 offset:8192
    ds_read_b64_tr_b16 v[138:139], v126 offset:9216
    s_waitcnt lgkmcnt(12)
    v_mfma_f32_32x32x16_bf16 v[160:175], v[144:147], a[112:115], v[160:175]
    ds_read_b64_tr_b16 v[140:141], v126 offset:12288
    ds_read_b64_tr_b16 v[142:143], v126 offset:13312
    s_waitcnt lgkmcnt(12)
    v_mfma_f32_32x32x16_bf16 v[160:175], v[148:151], a[116:119], v[160:175]
    ds_read_b64_tr_b16 v[144:145], v126 offset:16384
    ds_read_b64_tr_b16 v[146:147], v126 offset:17408
    s_waitcnt lgkmcnt(12)
    v_mfma_f32_32x32x16_bf16 v[160:175], v[152:155], a[120:123], v[160:175]
    ds_read_b64_tr_b16 v[148:149], v126 offset:20480
    ds_read_b64_tr_b16 v[150:151], v126 offset:21504
    s_waitcnt lgkmcnt(12)
    v_mfma_f32_32x32x16_bf16 v[160:175], v[156:159], a[124:127], v[160:175]
    ds_read_b64_tr_b16 v[152:153], v126 offset:24576
    ds_read_b64_tr_b16 v[154:155], v126 offset:25600
    s_waitcnt lgkmcnt(12)
    v_mfma_f32_32x32x16_bf16 v[176:191], v[128:131], a[0:3], 0
    ds_read_b64_tr_b16 v[156:157], v126 offset:28672
    ds_read_b64_tr_b16 v[158:159], v126 offset:29696
    s_waitcnt lgkmcnt(12)
    v_mfma_f32_32x32x16_bf16 v[176:191], v[132:135], a[4:7], v[176:191]
    ds_read_b64_tr_b16 v[128:129], v126 offset:32768
    ds_read_b64_tr_b16 v[130:131], v126 offset:33792
    s_waitcnt lgkmcnt(12)
    v_mfma_f32_32x32x16_bf16 v[176:191], v[136:139], a[8:11], v[176:191]
    ds_read_b64_tr_b16 v[132:133], v126 offset:36864
    ds_read_b64_tr_b16 v[134:135], v126 offset:37888
    s_waitcnt lgkmcnt(12)
    v_mfma_f32_32x32x16_bf16 v[176:191], v[140:143], a[12:15], v[176:191]
    v_cvt_pk_bf16_f32 v208, v160, v161
    v_cvt_pk_bf16_f32 v209, v162, v163
    ds_read_b64_tr_b16 v[136:137], v126 offset:40960
    ds_read_b64_tr_b16 v[138:139], v126 offset:41984
    s_waitcnt lgkmcnt(12)
    v_mfma_f32_32x32x16_bf16 v[176:191], v[144:147], a[16:19], v[176:191]
    v_cvt_pk_bf16_f32 v210, v164, v165
    v_cvt_pk_bf16_f32 v211, v166, v167
    ds_read_b64_tr_b16 v[140:141], v126 offset:45056
    ds_read_b64_tr_b16 v[142:143], v126 offset:46080
    s_waitcnt lgkmcnt(12)
    v_mfma_f32_32x32x16_bf16 v[176:191], v[148:151], a[20:23], v[176:191]
    v_cvt_pk_bf16_f32 v212, v168, v169
    v_cvt_pk_bf16_f32 v213, v170, v171
    ds_read_b64_tr_b16 v[144:145], v126 offset:49152
    ds_read_b64_tr_b16 v[146:147], v126 offset:50176
    s_waitcnt lgkmcnt(12)
    v_mfma_f32_32x32x16_bf16 v[176:191], v[152:155], a[24:27], v[176:191]
    v_cvt_pk_bf16_f32 v214, v172, v173
    v_cvt_pk_bf16_f32 v215, v174, v175
    ds_read_b64_tr_b16 v[148:149], v126 offset:53248
    ds_read_b64_tr_b16 v[150:151], v126 offset:54272
    s_waitcnt lgkmcnt(12)
    v_mfma_f32_32x32x16_bf16 v[176:191], v[156:159], a[28:31], v[176:191]
    ds_read_b64_tr_b16 v[152:153], v126 offset:57344
    ds_read_b64_tr_b16 v[154:155], v126 offset:58368
    s_waitcnt lgkmcnt(12)
    v_mfma_f32_32x32x16_bf16 v[176:191], v[128:131], a[32:35], v[176:191]
    ds_read_b64_tr_b16 v[156:157], v126 offset:61440
    ds_read_b64_tr_b16 v[158:159], v126 offset:62464
    s_waitcnt lgkmcnt(12)
    v_mfma_f32_32x32x16_bf16 v[176:191], v[132:135], a[36:39], v[176:191]
    ds_read_b64_tr_b16 v[128:129], v127 offset:0
    ds_read_b64_tr_b16 v[130:131], v127 offset:1024
    s_waitcnt lgkmcnt(12)
    v_mfma_f32_32x32x16_bf16 v[176:191], v[136:139], a[40:43], v[176:191]
    ds_read_b64_tr_b16 v[132:133], v127 offset:4096
    ds_read_b64_tr_b16 v[134:135], v127 offset:5120
    s_waitcnt lgkmcnt(12)
    v_mfma_f32_32x32x16_bf16 v[176:191], v[140:143], a[44:47], v[176:191]
    ds_read_b64_tr_b16 v[136:137], v127 offset:8192
    ds_read_b64_tr_b16 v[138:139], v127 offset:9216
    s_waitcnt lgkmcnt(12)
    v_mfma_f32_32x32x16_bf16 v[176:191], v[144:147], a[48:51], v[176:191]
    ds_read_b64_tr_b16 v[140:141], v127 offset:12288
    ds_read_b64_tr_b16 v[142:143], v127 offset:13312
    s_waitcnt lgkmcnt(12)
    v_mfma_f32_32x32x16_bf16 v[176:191], v[148:151], a[52:55], v[176:191]
    ds_read_b64_tr_b16 v[144:145], v127 offset:16384
    ds_read_b64_tr_b16 v[146:147], v127 offset:17408
    s_waitcnt lgkmcnt(12)
    v_mfma_f32_32x32x16_bf16 v[176:191], v[152:155], a[56:59], v[176:191]
    ds_read_b64_tr_b16 v[148:149], v127 offset:20480
    ds_read_b64_tr_b16 v[150:151], v127 offset:21504
    s_waitcnt lgkmcnt(12)
    v_mfma_f32_32x32x16_bf16 v[176:191], v[156:159], a[60:63], v[176:191]
    ds_read_b64_tr_b16 v[152:153], v127 offset:24576
    ds_read_b64_tr_b16 v[154:155], v127 offset:25600
    s_waitcnt lgkmcnt(12)
    v_mfma_f32_32x32x16_bf16 v[176:191], v[128:131], a[64:67], v[176:191]
    ds_read_b64_tr_b16 v[156:157], v127 offset:28672
    ds_read_b64_tr_b16 v[158:159], v127 offset:29696
    s_waitcnt lgkmcnt(12)
    v_mfma_f32_32x32x16_bf16 v[176:191], v[132:135], a[68:71], v[176:191]
    ds_read_b64_tr_b16 v[128:129], v127 offset:32768
    ds_read_b64_tr_b16 v[130:131], v127 offset:33792
    s_waitcnt lgkmcnt(12)
    v_mfma_f32_32x32x16_bf16 v[176:191], v[136:139], a[72:75], v[176:191]
    ds_read_b64_tr_b16 v[132:133], v127 offset:36864
    ds_read_b64_tr_b16 v[134:135], v127 offset:37888
    s_waitcnt lgkmcnt(12)
    v_mfma_f32_32x32x16_bf16 v[176:191], v[140:143], a[76:79], v[176:191]
    ds_read_b64_tr_b16 v[136:137], v127 offset:40960
    ds_read_b64_tr_b16 v[138:139], v127 offset:41984
    s_waitcnt lgkmcnt(12)
    v_mfma_f32_32x32x16_bf16 v[176:191], v[144:147], a[80:83], v[176:191]
    ds_read_b64_tr_b16 v[140:141], v127 offset:45056
    ds_read_b64_tr_b16 v[142:143], v127 offset:46080
    s_waitcnt lgkmcnt(12)
    v_mfma_f32_32x32x16_bf16 v[176:191], v[148:151], a[84:87], v[176:191]
    ds_read_b64_tr_b16 v[144:145], v127 offset:49152
    ds_read_b64_tr_b16 v[146:147], v127 offset:50176
    s_waitcnt lgkmcnt(12)
    v_mfma_f32_32x32x16_bf16 v[176:191], v[152:155], a[88:91], v[176:191]
    ds_read_b64_tr_b16 v[148:149], v127 offset:53248
    ds_read_b64_tr_b16 v[150:151], v127 offset:54272
    s_waitcnt lgkmcnt(12)
    v_mfma_f32_32x32x16_bf16 v[176:191], v[156:159], a[92:95], v[176:191]
    ds_read_b64_tr_b16 v[152:153], v127 offset:57344
    ds_read_b64_tr_b16 v[154:155], v127 offset:58368
    s_waitcnt lgkmcnt(12)
    v_mfma_f32_32x32x16_bf16 v[176:191], v[128:131], a[96:99], v[176:191]
    ds_read_b64_tr_b16 v[156:157], v127 offset:61440
    ds_read_b64_tr_b16 v[158:159], v127 offset:62464
    s_waitcnt lgkmcnt(12)
    v_mfma_f32_32x32x16_bf16 v[176:191], v[132:135], a[100:103], v[176:191]
    s_waitcnt lgkmcnt(10)
    v_mfma_f32_32x32x16_bf16 v[176:191], v[136:139], a[104:107], v[176:191]
    s_waitcnt lgkmcnt(8)
    v_mfma_f32_32x32x16_bf16 v[176:191], v[140:143], a[108:111], v[176:191]
    s_waitcnt lgkmcnt(6)
    v_mfma_f32_32x32x16_bf16 v[176:191], v[144:147], a[112:115], v[176:191]
    s_waitcnt lgkmcnt(4)
    v_mfma_f32_32x32x16_bf16 v[176:191], v[148:151], a[116:119], v[176:191]
    s_waitcnt lgkmcnt(2)
    v_mfma_f32_32x32x16_bf16 v[176:191], v[152:155], a[120:123], v[176:191]
    s_waitcnt lgkmcnt(0)
    v_mfma_f32_32x32x16_bf16 v[176:191], v[156:159], a[124:127], v[176:191]
    s_waitcnt vmcnt(0)
    buffer_load_dwordx4 a[0:3], v240, s[28:31], s32 offen offset:0 sc1
    buffer_load_dwordx4 a[4:7], v240, s[28:31], s32 offen offset:1024 sc1
    buffer_load_dwordx4 a[8:11], v240, s[28:31], s32 offen offset:2048 sc1
    buffer_load_dwordx4 a[12:15], v240, s[28:31], s32 offen offset:3072 sc1
    buffer_load_dwordx4 a[16:19], v240, s[28:31], s33 offen offset:0 sc1
    buffer_load_dwordx4 a[20:23], v240, s[28:31], s33 offen offset:1024 sc1
    buffer_load_dwordx4 a[24:27], v240, s[28:31], s33 offen offset:2048 sc1
    buffer_load_dwordx4 a[28:31], v240, s[28:31], s33 offen offset:3072 sc1
    buffer_load_dwordx4 a[32:35], v240, s[28:31], s34 offen offset:0 sc1
    buffer_load_dwordx4 a[36:39], v240, s[28:31], s34 offen offset:1024 sc1
    buffer_load_dwordx4 a[40:43], v240, s[28:31], s34 offen offset:2048 sc1
    buffer_load_dwordx4 a[44:47], v240, s[28:31], s34 offen offset:3072 sc1
    buffer_load_dwordx4 a[48:51], v240, s[28:31], s35 offen offset:0 sc1
    buffer_load_dwordx4 a[52:55], v240, s[28:31], s35 offen offset:1024 sc1
    buffer_load_dwordx4 a[56:59], v240, s[28:31], s35 offen offset:2048 sc1
    buffer_load_dwordx4 a[60:63], v240, s[28:31], s35 offen offset:3072 sc1
    buffer_load_dwordx4 a[64:67], v240, s[28:31], s36 offen offset:0 sc1
    buffer_load_dwordx4 a[68:71], v240, s[28:31], s36 offen offset:1024 sc1
    buffer_load_dwordx4 a[72:75], v240, s[28:31], s36 offen offset:2048 sc1
    buffer_load_dwordx4 a[76:79], v240, s[28:31], s36 offen offset:3072 sc1
    buffer_load_dwordx4 a[80:83], v240, s[28:31], s37 offen offset:0 sc1
    buffer_load_dwordx4 a[84:87], v240, s[28:31], s37 offen offset:1024 sc1
    buffer_load_dwordx4 a[88:91], v240, s[28:31], s37 offen offset:2048 sc1
    buffer_load_dwordx4 a[92:95], v240, s[28:31], s37 offen offset:3072 sc1
    buffer_load_dwordx4 a[96:99], v240, s[28:31], s38 offen offset:0 sc1
    buffer_load_dwordx4 a[100:103], v240, s[28:31], s38 offen offset:1024 sc1
    buffer_load_dwordx4 a[104:107], v240, s[28:31], s38 offen offset:2048 sc1
    buffer_load_dwordx4 a[108:111], v240, s[28:31], s38 offen offset:3072 sc1
    buffer_load_dwordx4 a[112:115], v240, s[28:31], s39 offen offset:0 sc1
    buffer_load_dwordx4 a[116:119], v240, s[28:31], s39 offen offset:1024 sc1
    buffer_load_dwordx4 a[120:123], v240, s[28:31], s39 offen offset:2048 sc1
    buffer_load_dwordx4 a[124:127], v240, s[28:31], s39 offen offset:3072 sc1
    s_add_u32 s28, s28, 131072
    s_addc_u32 s29, s29, 0
    v_cvt_pk_bf16_f32 v216, v176, v177
    v_cvt_pk_bf16_f32 v217, v178, v179
    v_cvt_pk_bf16_f32 v218, v180, v181
    v_cvt_pk_bf16_f32 v219, v182, v183
    v_cvt_pk_bf16_f32 v220, v184, v185
    v_cvt_pk_bf16_f32 v221, v186, v187
    v_cvt_pk_bf16_f32 v222, v188, v189
    v_cvt_pk_bf16_f32 v223, v190, v191
    s_cmp_eq_u32 s26, 0
    s_cbranch_scc1 L_q_loop
    s_branch L_q_go
L_q_skip:
    s_waitcnt vmcnt(0)
L_q_go:
    s_add_u32 s26, s26, 1
    v_mfma_f32_32x32x16_bf16 v[160:175], a[128:131], v[0:3], v[224:239]
    v_mfma_f32_32x32x16_bf16 v[160:175], a[132:135], v[4:7], v[160:175]
    v_mfma_f32_32x32x16_bf16 v[160:175], a[136:139], v[8:11], v[160:175]
    v_mfma_f32_32x32x16_bf16 v[160:175], a[140:143], v[12:15], v[160:175]
    v_mfma_f32_32x32x16_bf16 v[160:175], a[144:147], v[16:19], v[160:175]
    v_mfma_f32_32x32x16_bf16 v[160:175], a[148:151], v[20:23], v[160:175]
    v_mfma_f32_32x32x16_bf16 v[160:175], a[152:155], v[24:27], v[160:175]
    v_mfma_f32_32x32x16_bf16 v[160:175], a[156:159], v[28:31], v[160:175]
    s_nop 11
    v_max3_f32 v96, v160, v161, v162
    v_max3_f32 v96, v96, v163, v164
    v_max3_f32 v96, v96, v165, v166
    v_max3_f32 v96, v96, v167, v168
    v_max3_f32 v96, v96, v169, v170
    v_max3_f32 v96, v96, v171, v172
    v_max3_f32 v96, v96, v173, v174
    v_max_f32 v96, v96, v175
    v_mov_b32 v97, v96
    s_nop 1
    v_permlane32_swap_b32 v96, v97
    v_max_f32 v96, v96, v97
    v_sub_f32 v160, v160, v96
    v_sub_f32 v161, v161, v96
    v_sub_f32 v162, v162, v96
    v_sub_f32 v163, v163, v96
    v_sub_f32 v164, v164, v96
    v_sub_f32 v165, v165, v96
    v_sub_f32 v166, v166, v96
    v_sub_f32 v167, v167, v96
    v_sub_f32 v168, v168, v96
    v_sub_f32 v169, v169, v96
    v_sub_f32 v170, v170, v96
    v_sub_f32 v171, v171, v96
    v_sub_f32 v172, v172, v96
    v_sub_f32 v173, v173, v96
    v_sub_f32 v174, v174, v96
    v_sub_f32 v175, v175, v96
    v_mul_f32 v160, s67, v160
    v_mul_f32 v161, s67, v161
    v_mul_f32 v162, s67, v162
    v_mul_f32 v163, s67, v163
    v_mul_f32 v164, s67, v164
    v_mul_f32 v165, s67, v165
    v_mul_f32 v166, s67, v166
    v_mul_f32 v167, s67, v167
    v_mul_f32 v168, s67, v168
    v_mul_f32 v169, s67, v169
    v_mul_f32 v170, s67, v170
    v_mul_f32 v171, s67, v171
    v_mul_f32 v172, s67, v172
    v_mul_f32 v173, s67, v173
    v_mul_f32 v174, s67, v174
    v_mul_f32 v175, s67, v175
    v_exp_f32 v160, v160
    v_exp_f32 v161, v161
    v_exp_f32 v162, v162
    v_exp_f32 v163, v163
    v_exp_f32 v164, v164
    v_exp_f32 v165, v165
    v_exp_f32 v166, v166
    v_exp_f32 v167, v167
    v_exp_f32 v168, v168
    v_exp_f32 v169, v169
    v_exp_f32 v170, v170
    v_exp_f32 v171, v171
    v_exp_f32 v172, v172
    v_exp_f32 v173, v173
    v_exp_f32 v174, v174
    v_exp_f32 v175, v175
    v_cvt_pk_bf16_f32 v128, v160, v161
    v_cvt_pk_bf16_f32 v129, v162, v163
    v_cvt_pk_bf16_f32 v130, v164, v165
    v_cvt_pk_bf16_f32 v131, v166, v167
    v_cvt_pk_bf16_f32 v132, v168, v169
    v_cvt_pk_bf16_f32 v133, v170, v171
    v_cvt_pk_bf16_f32 v134, v172, v173
    v_cvt_pk_bf16_f32 v135, v174, v175
    v_pk_add_f32 v[160:161], v[160:161], v[162:163]
    v_pk_add_f32 v[164:165], v[164:165], v[166:167]
    v_pk_add_f32 v[168:169], v[168:169], v[170:171]
    v_pk_add_f32 v[172:173], v[172:173], v[174:175]
    v_pk_add_f32 v[160:161], v[160:161], v[164:165]
    v_pk_add_f32 v[168:169], v[168:169], v[172:173]
    v_pk_add_f32 v[160:161], v[160:161], v[168:169]
    v_add_f32 v98, v160, v161
    v_mfma_f32_32x32x16_bf16 v[32:47], a[160:163], v[128:131], 0
    v_mfma_f32_32x32x16_bf16 v[32:47], a[164:167], v[132:135], v[32:47]
    v_mfma_f32_32x32x16_bf16 v[48:63], a[168:171], v[128:131], 0
    v_mfma_f32_32x32x16_bf16 v[48:63], a[172:175], v[132:135], v[48:63]
    v_mfma_f32_32x32x16_bf16 v[64:79], a[176:179], v[128:131], 0
    v_mfma_f32_32x32x16_bf16 v[64:79], a[180:183], v[132:135], v[64:79]
    v_mfma_f32_32x32x16_bf16 v[80:95], a[184:187], v[128:131], 0
    v_mfma_f32_32x32x16_bf16 v[80:95], a[188:191], v[132:135], v[80:95]
    s_add_u32 s60, s60, 1
L_q_pc1:
    global_load_dword v248, v255, s[50:51] sc1
    s_waitcnt vmcnt(0)
L_q_pc1_c:
    v_cmp_gt_u32 vcc, s60, v248
    s_cbranch_vccz L_q_pc1_ok
    s_sleep 1
    s_sub_u32 s27, s27, 1
    s_cbranch_scc0 L_q_pc1
    s_branch L_end
L_q_pc1_ok:
    global_load_dwordx4 a[192:195], v244, s[44:45] offset:0 sc1
    global_load_dwordx4 a[196:199], v244, s[44:45] offset:512 sc1
    global_load_dwordx4 a[200:203], v244, s[44:45] offset:1024 sc1
    global_load_dwordx4 a[204:207], v244, s[44:45] offset:1536 sc1
    global_load_dwordx4 a[208:211], v244, s[44:45] offset:2048 sc1
    global_load_dwordx4 a[212:215], v244, s[44:45] offset:2560 sc1
    global_load_dwordx4 a[216:219], v244, s[44:45] offset:3072 sc1
    global_load_dwordx4 a[220:223], v244, s[44:45] offset:3584 sc1
    global_load_dword a224, v245, s[44:45] offset:0 sc1
    global_load_dword a225, v245, s[44:45] offset:256 sc1
    global_load_dword a226, v245, s[44:45] offset:1024 sc1
    global_load_dword a227, v245, s[44:45] offset:1280 sc1
    global_load_dword a228, v245, s[44:45] offset:2048 sc1
    global_load_dword a229, v245, s[44:45] offset:2304 sc1
    global_load_dword a230, v245, s[44:45] offset:3072 sc1
    global_load_dword a231, v245, s[44:45] offset:3328 sc1
    s_add_u32 s44, s44, 524288
    s_addc_u32 s45, s45, 0
    s_waitcnt vmcnt(15)
    v_mfma_f32_32x32x16_bf16 v[176:191], a[192:195], v[0:3], 0
    s_waitcnt vmcnt(14)
    v_mfma_f32_32x32x16_bf16 v[176:191], a[196:199], v[4:7], v[176:191]
    s_waitcnt vmcnt(13)
    v_mfma_f32_32x32x16_bf16 v[176:191], a[200:203], v[8:11], v[176:191]
    s_waitcnt vmcnt(12)
    v_mfma_f32_32x32x16_bf16 v[176:191], a[204:207], v[12:15], v[176:191]
    s_waitcnt vmcnt(11)
    v_mfma_f32_32x32x16_bf16 v[176:191], a[208:211], v[16:19], v[176:191]
    s_waitcnt vmcnt(10)
    v_mfma_f32_32x32x16_bf16 v[176:191], a[212:215], v[20:23], v[176:191]
    s_waitcnt vmcnt(9)
    v_mfma_f32_32x32x16_bf16 v[176:191], a[216:219], v[24:27], v[176:191]
    s_waitcnt vmcnt(8)
    v_mfma_f32_32x32x16_bf16 v[176:191], a[220:223], v[28:31], v[176:191]
    s_nop 11
    v_max3_f32 v100, v176, v177, v178
    v_max_f32 v100, v100, v179
    v_mov_b32 v97, v100
    s_nop 1
    v_permlane32_swap_b32 v100, v97
    v_max3_f32 v97, v100, v97, v96
    v_sub_f32 v100, v96, v97
    v_sub_f32 v176, v176, v97
    v_sub_f32 v177, v177, v97
    v_sub_f32 v178, v178, v97
    v_sub_f32 v179, v179, v97
    v_mul_f32 v100, s67, v100
    v_mul_f32 v176, s67, v176
    v_mul_f32 v177, s67, v177
    v_mul_f32 v178, s67, v178
    v_mul_f32 v179, s67, v179
    v_exp_f32 v100, v100
    v_exp_f32 v176, v176
    v_exp_f32 v177, v177
    v_exp_f32 v178, v178
    v_exp_f32 v179, v179
    v_fma_f32 v98, v98, v100, v176
    v_add_f32 v98, v98, v177
    v_add_f32 v98, v98, v178
    v_add_f32 v98, v98, v179
    v_mov_b32 v97, v98
    s_nop 1
    v_permlane32_swap_b32 v98, v97
    v_add_f32 v98, v98, v97
    v_rcp_f32 v98, v98
    s_nop 0
    v_mul_f32 v100, v100, v98
    v_pk_mul_f32 v[176:177], v[176:177], v[98:99] op_sel_hi:[1,0]
    v_pk_mul_f32 v[178:179], v[178:179], v[98:99] op_sel_hi:[1,0]
    v_cvt_pk_bf16_f32 v136, v176, v177
    v_cvt_pk_bf16_f32 v137, v178, v179
    v_pk_mul_f32 v[32:33], v[32:33], v[100:101] op_sel_hi:[1,0]
    v_pk_mul_f32 v[34:35], v[34:35], v[100:101] op_sel_hi:[1,0]
    v_pk_mul_f32 v[36:37], v[36:37], v[100:101] op_sel_hi:[1,0]
    v_pk_mul_f32 v[38:39], v[38:39], v[100:101] op_sel_hi:[1,0]
    v_pk_mul_f32 v[40:41], v[40:41], v[100:101] op_sel_hi:[1,0]
    v_pk_mul_f32 v[42:43], v[42:43], v[100:101] op_sel_hi:[1,0]
    v_pk_mul_f32 v[44:45], v[44:45], v[100:101] op_sel_hi:[1,0]
    v_pk_mul_f32 v[46:47], v[46:47], v[100:101] op_sel_hi:[1,0]
    v_pk_mul_f32 v[48:49], v[48:49], v[100:101] op_sel_hi:[1,0]
    v_pk_mul_f32 v[50:51], v[50:51], v[100:101] op_sel_hi:[1,0]
    v_pk_mul_f32 v[52:53], v[52:53], v[100:101] op_sel_hi:[1,0]
    v_pk_mul_f32 v[54:55], v[54:55], v[100:101] op_sel_hi:[1,0]
    v_pk_mul_f32 v[56:57], v[56:57], v[100:101] op_sel_hi:[1,0]
    v_pk_mul_f32 v[58:59], v[58:59], v[100:101] op_sel_hi:[1,0]
    v_pk_mul_f32 v[60:61], v[60:61], v[100:101] op_sel_hi:[1,0]
    v_pk_mul_f32 v[62:63], v[62:63], v[100:101] op_sel_hi:[1,0]
    v_pk_mul_f32 v[64:65], v[64:65], v[100:101] op_sel_hi:[1,0]
    v_pk_mul_f32 v[66:67], v[66:67], v[100:101] op_sel_hi:[1,0]
    v_pk_mul_f32 v[68:69], v[68:69], v[100:101] op_sel_hi:[1,0]
    v_pk_mul_f32 v[70:71], v[70:71], v[100:101] op_sel_hi:[1,0]
    v_pk_mul_f32 v[72:73], v[72:73], v[100:101] op_sel_hi:[1,0]
    v_pk_mul_f32 v[74:75], v[74:75], v[100:101] op_sel_hi:[1,0]
    v_pk_mul_f32 v[76:77], v[76:77], v[100:101] op_sel_hi:[1,0]
    v_pk_mul_f32 v[78:79], v[78:79], v[100:101] op_sel_hi:[1,0]
    v_pk_mul_f32 v[80:81], v[80:81], v[100:101] op_sel_hi:[1,0]
    v_pk_mul_f32 v[82:83], v[82:83], v[100:101] op_sel_hi:[1,0]
    v_pk_mul_f32 v[84:85], v[84:85], v[100:101] op_sel_hi:[1,0]
    v_pk_mul_f32 v[86:87], v[86:87], v[100:101] op_sel_hi:[1,0]
    v_pk_mul_f32 v[88:89], v[88:89], v[100:101] op_sel_hi:[1,0]
    v_pk_mul_f32 v[90:91], v[90:91], v[100:101] op_sel_hi:[1,0]
    v_pk_mul_f32 v[92:93], v[92:93], v[100:101] op_sel_hi:[1,0]
    v_pk_mul_f32 v[94:95], v[94:95], v[100:101] op_sel_hi:[1,0]
    s_waitcnt vmcnt(0)
    v_mfma_f32_32x32x8_bf16 v[32:47], a[224:225], v[136:137], v[32:47]
    v_mfma_f32_32x32x8_bf16 v[48:63], a[226:227], v[136:137], v[48:63]
    v_mfma_f32_32x32x8_bf16 v[64:79], a[228:229], v[136:137], v[64:79]
    v_cvt_pk_bf16_f32 v140, v32, v33
    v_cvt_pk_bf16_f32 v141, v34, v35
    v_cvt_pk_bf16_f32 v142, v36, v37
    v_cvt_pk_bf16_f32 v143, v38, v39
    v_cvt_pk_bf16_f32 v144, v40, v41
    v_cvt_pk_bf16_f32 v145, v42, v43
    v_cvt_pk_bf16_f32 v146, v44, v45
    v_cvt_pk_bf16_f32 v147, v46, v47
    global_store_dwordx4 v240, v[140:143], s[46:47] offset:-4096 sc1
    global_store_dwordx4 v240, v[144:147], s[46:47] offset:-3072 sc1
    v_mfma_f32_32x32x8_bf16 v[80:95], a[230:231], v[136:137], v[80:95]
    v_cvt_pk_bf16_f32 v148, v48, v49
    v_cvt_pk_bf16_f32 v149, v50, v51
    v_cvt_pk_bf16_f32 v150, v52, v53
    v_cvt_pk_bf16_f32 v151, v54, v55
    v_cvt_pk_bf16_f32 v152, v56, v57
    v_cvt_pk_bf16_f32 v153, v58, v59
    v_cvt_pk_bf16_f32 v154, v60, v61
    v_cvt_pk_bf16_f32 v155, v62, v63
    global_store_dwordx4 v240, v[148:151], s[46:47] offset:-2048 sc1
    global_store_dwordx4 v240, v[152:155], s[46:47] offset:-1024 sc1
    v_cvt_pk_bf16_f32 v140, v64, v65
    v_cvt_pk_bf16_f32 v141, v66, v67
    v_cvt_pk_bf16_f32 v142, v68, v69
    v_cvt_pk_bf16_f32 v143, v70, v71
    v_cvt_pk_bf16_f32 v144, v72, v73
    v_cvt_pk_bf16_f32 v145, v74, v75
    v_cvt_pk_bf16_f32 v146, v76, v77
    v_cvt_pk_bf16_f32 v147, v78, v79
    global_store_dwordx4 v240, v[140:143], s[46:47] offset:0 sc1
    global_store_dwordx4 v240, v[144:147], s[46:47] offset:1024 sc1
    v_cvt_pk_bf16_f32 v148, v80, v81
    v_cvt_pk_bf16_f32 v149, v82, v83
    v_cvt_pk_bf16_f32 v150, v84, v85
    v_cvt_pk_bf16_f32 v151, v86, v87
    v_cvt_pk_bf16_f32 v152, v88, v89
    v_cvt_pk_bf16_f32 v153, v90, v91
    v_cvt_pk_bf16_f32 v154, v92, v93
    v_cvt_pk_bf16_f32 v155, v94, v95
    global_store_dwordx4 v240, v[148:151], s[46:47] offset:2048 sc1
    global_store_dwordx4 v240, v[152:155], s[46:47] offset:3072 sc1
    s_add_u32 s46, s46, 1048576
    s_addc_u32 s47, s47, 0
    s_cmp_lt_u32 s26, 16
    s_cbranch_scc1 L_q_loop
    s_waitcnt vmcnt(0)
    v_mov_b32 v248, s26
    s_mov_b64 exec, 1
    global_store_dword v246, v248, s[42:43] sc1
    s_mov_b64 exec, -1
    s_endpgm
L_norole:
    s_waitcnt vmcnt(0) lgkmcnt(0)
    s_barrier
    s_cmp_eq_u32 s23, 0
    s_cbranch_scc0 L_n_noarr
    s_mov_b64 exec, 1
    s_lshl_b32 s58, s3, 5
    s_add_u32 s58, s58, 208
    v_mov_b32 v252, s58
    v_mov_b32 v253, 1
    global_atomic_add v252, v253, s[18:19]
    s_mov_b64 exec, -1
L_n_noarr:
    v_mbcnt_lo_u32_b32 v252, -1, 0
    v_and_b32 v252, 15, v252
    v_lshlrev_b32 v252, 4, v252
    s_lshl_b32 s59, s3, 1
    s_add_u32 s59, s59, 13
L_n_wa:
    global_load_dword v253, v252, s[18:19] sc1
    s_waitcnt vmcnt(0)
L_n_w0:
    v_readlane_b32 s58, v253, s59
    s_cmp_ge_u32 s58, 256
    s_cbranch_scc1 L_n_wb
    s_sleep 16
    s_sub_u32 s27, s27, 1
    s_cbranch_scc0 L_n_wa
    s_branch L_end
L_n_wb:
    s_cmp_eq_u32 s3, 1
    s_cbranch_scc1 L_n_wc
    v_cmp_ne_u32 vcc, 32, v253
    s_and_b32 s58, vcc_lo, 0x5555
    s_cbranch_scc0 L_n_wc
    global_load_dword v253, v252, s[18:19] sc1
    s_waitcnt vmcnt(0)
    v_cmp_ne_u32 vcc, 32, v253
    s_and_b32 s58, vcc_lo, 0x5555
    s_cbranch_scc1 L_safe
L_n_wc:
    s_branch L_end
L_safe:
    s_load_dwordx4 s[4:7], s[0:1], 0
    s_load_dwordx4 s[8:11], s[0:1], 16
    s_load_dwordx4 s[12:15], s[0:1], 32
    s_load_dwordx2 s[32:33], s[0:1], 56
    s_load_dwordx4 s[36:39], s[0:1], 64
    s_load_dwordx4 s[40:43], s[0:1], 80
    s_load_dwordx2 s[44:45], s[0:1], 96
    s_load_dwordx4 s[16:19], s[0:1], 112
    s_load_dwordx2 s[20:21], s[0:1], 128
    s_mov_b32 s3, 1
    s_and_b32 s22, s2, 7
    s_lshr_b32 s24, s2, 3
    v_mbcnt_lo_u32_b32 v0, -1, 0
    v_mbcnt_hi_u32_b32 v0, -1, v0
    s_waitcnt vmcnt(0) lgkmcnt(0)
    s_barrier
    s_branch L_role
L_chain_safe:
    v_and_b32 v1, 15, v0
    v_lshrrev_b32 v2, 4, v0
    v_lshlrev_b32 v2, 10, v2
    v_and_b32 v8, 16, v0
    v_lshl_add_u32 v2, v1, 4, v2
    s_lshl_b32 s58, s24, 17
    s_lshl_b32 s59, s23, 8
    s_add_u32 s58, s58, s59
    v_add_u32 v4, s58, v2
    s_mul_i32 s72, s23, 36864
    s_add_u32 s72, s72, 16384
    s_mov_b32 s88, s14
    s_and_b32 s89, s15, 0xffff
    s_mov_b32 s90, 4194304
    s_mov_b32 s91, 0x20000
    s_mov_b32 s60, 0
    s_add_u32 m0, s72, 0
    s_add_u32 s61, s60, 0
    buffer_load_dwordx4 v4, s[88:91], s61 offen  lds
    s_add_u32 m0, s72, 1024
    s_add_u32 s61, s60, 4096
    buffer_load_dwordx4 v4, s[88:91], s61 offen  lds
    s_add_u32 m0, s72, 2048
    s_add_u32 s61, s60, 8192
    buffer_load_dwordx4 v4, s[88:91], s61 offen  lds
    s_add_u32 m0, s72, 3072
    s_add_u32 s61, s60, 12288
    buffer_load_dwordx4 v4, s[88:91], s61 offen  lds
    s_mov_b32 s60, 0
    s_add_u32 m0, s72, 4096
    s_add_u32 s61, s60, 16384
    buffer_load_dwordx4 v4, s[88:91], s61 offen  lds
    s_add_u32 m0, s72, 5120
    s_add_u32 s61, s60, 20480
    buffer_load_dwordx4 v4, s[88:91], s61 offen  lds
    s_add_u32 m0, s72, 6144
    s_add_u32 s61, s60, 24576
    buffer_load_dwordx4 v4, s[88:91], s61 offen  lds
    s_add_u32 m0, s72, 7168
    s_add_u32 s61, s60, 28672
    buffer_load_dwordx4 v4, s[88:91], s61 offen  lds
    s_mov_b32 s60, 32768
    s_add_u32 m0, s72, 8192
    s_add_u32 s61, s60, 0
    buffer_load_dwordx4 v4, s[88:91], s61 offen  lds
    s_add_u32 m0, s72, 9216
    s_add_u32 s61, s60, 4096
    buffer_load_dwordx4 v4, s[88:91], s61 offen  lds
    s_add_u32 m0, s72, 10240
    s_add_u32 s61, s60, 8192
    buffer_load_dwordx4 v4, s[88:91], s61 offen  lds
    s_add_u32 m0, s72, 11264
    s_add_u32 s61, s60, 12288
    buffer_load_dwordx4 v4, s[88:91], s61 offen  lds
    s_mov_b32 s60, 32768
    s_add_u32 m0, s72, 12288
    s_add_u32 s61, s60, 16384
    buffer_load_dwordx4 v4, s[88:91], s61 offen  lds
    s_add_u32 m0, s72, 13312
    s_add_u32 s61, s60, 20480
    buffer_load_dwordx4 v4, s[88:91], s61 offen  lds
    s_add_u32 m0, s72, 14336
    s_add_u32 s61, s60, 24576
    buffer_load_dwordx4 v4, s[88:91], s61 offen  lds
    s_add_u32 m0, s72, 15360
    s_add_u32 s61, s60, 28672
    buffer_load_dwordx4 v4, s[88:91], s61 offen  lds
L_cs_c0:
L_cs_c1:
    s_mov_b32 s67, s23
    v_and_b32 v61, 15, v0
    v_lshrrev_b32 v62, 4, v0
    v_lshlrev_b32 v105, 4, v0
    s_mov_b32 s48, 0xcccccccc
    s_mov_b32 s49, 0xcccccccc
    s_mov_b32 s98, 0x3e0293ee
    s_mov_b32 s68, 0x05040100
    s_mov_b32 s69, 0x07060302
    s_mov_b32 s70, 4290838464
    s_mov_b32 s71, 0xffc00000
    s_mov_b32 s99, 0x3e0293ee
    v_mov_b32 v124, s70
    v_mov_b32 v125, s70
    v_mov_b32 v126, s70
    v_mov_b32 v127, s70
    v_mov_b32 v64, 0xeeee
    v_mov_b32 v65, 0x4444
    v_cndmask_b32 v104, v65, v64, s[48:49]
    v_and_b32 v63, 1, v61
    v_lshlrev_b32 v63, 4, v63
    v_mov_b32 v64, 0x3f80
    v_lshlrev_b32 v64, v63, v64
    v_lshrrev_b32 v65, 2, v61
    v_cmp_eq_u32 vcc, v65, v62
    s_nop 1
    v_cndmask_b32 v64, 0, v64, vcc
    v_mov_b32 v65, 0
    v_cndmask_b32 v106, v65, v64, s[48:49]
    v_cndmask_b32 v107, v64, v65, s[48:49]
    v_lshrrev_b32 v63, 2, v61
    v_and_b32 v63, 1, v63
    v_lshlrev_b32 v63, 4, v63
    v_mov_b32 v64, 0x3f80
    v_lshlrev_b32 v64, v63, v64
    v_and_b32 v65, 11, v61
    v_cmp_eq_u32 vcc, 0, v65
    s_nop 1
    v_cndmask_b32 v108, 0, v64, vcc
    v_cmp_eq_u32 vcc, 1, v65
    s_nop 1
    v_cndmask_b32 v109, 0, v64, vcc
    v_cmp_eq_u32 vcc, 8, v65
    s_nop 1
    v_cndmask_b32 v110, 0, v64, vcc
    v_cmp_eq_u32 vcc, 9, v65
    s_nop 1
    v_cndmask_b32 v111, 0, v64, vcc
    v_lshrrev_b32 v63, 1, v62
    v_lshlrev_b32 v63, 13, v63
    v_and_b32 v64, 1, v62
    v_lshl_add_u32 v63, v64, 11, v63
    v_lshl_add_u32 v63, v61, 2, v63
    s_lshl_b32 s58, s23, 16
    s_lshl_b32 s59, s24, 6
    s_add_u32 s58, s58, s59
    v_add_u32 v112, s58, v63
    s_lshl_b32 s58, s23, 9
    v_lshrrev_b32 v63, 1, v62
    v_lshlrev_b32 v63, 8, v63
    v_or_b32 v63, s58, v63
    v_xor_b32 v112, v112, v63
    s_mov_b32 s50, 0
    s_mov_b32 s51, 16384
    s_mov_b32 s52, 32768
    s_mov_b32 s53, 49152
    s_mov_b32 s54, 4096
    s_mov_b32 s55, 20480
    s_mov_b32 s56, 36864
    s_mov_b32 s57, 53248
    v_and_b32 v63, 2, v0
    v_lshlrev_b32 v63, 4, v63
    v_and_b32 v64, 1, v62
    v_lshl_add_u32 v63, v64, 4, v63
    v_and_b32 v64, 1, v0
    v_lshl_add_u32 v63, v64, 3, v63
    v_lshrrev_b32 v64, 1, v62
    v_lshl_add_u32 v63, v64, 2, v63
    s_lshr_b32 s32, s23, 1
    s_lshr_b32 s60, s24, 1
    s_and_b32 s60, s60, 3
    s_lshl_b32 s58, s32, 2
    s_add_u32 s60, s60, s58
    s_and_b32 s61, s24, 1
    s_lshl_b32 s61, s61, 1
    s_and_b32 s58, s23, 1
    s_add_u32 s61, s61, s58
    s_lshl_b32 s58, s60, 10
    s_lshr_b32 s59, s24, 3
    s_lshl_b32 s59, s59, 8
    s_add_u32 s58, s58, s59
    s_lshl_b32 s59, s61, 6
    s_add_u32 s58, s58, s59
    v_add_u32 v113, s58, v63
    v_and_b32 v63, 1, v62
    v_lshlrev_b32 v63, 10, v63
    v_lshrrev_b32 v64, 1, v62
    v_lshl_add_u32 v63, v64, 2, v63
    v_and_b32 v64, 3, v0
    v_lshl_add_u32 v63, v64, 3, v63
    s_lshl_b32 s58, s61, 11
    s_lshr_b32 s59, s24, 3
    s_lshl_b32 s59, s59, 8
    s_add_u32 s58, s58, s59
    s_lshl_b32 s59, s60, 5
    s_add_u32 s58, s58, s59
    v_add_u32 v70, s58, v63
    s_lshl_b32 s58, s67, 11
    v_add_u32 v114, s58, v105
    v_xor_b32 v115, 0x800, v114
    v_xor_b32 v116, 0x1000, v114
    v_xor_b32 v117, 0x1800, v114
    s_mul_i32 s58, s23, 36864
    s_add_u32 s58, s58, 16384
    v_add_u32 v118, s58, v105
    s_lshl_b32 s58, s23, 2
    v_add_u32 v119, s58, v105
    s_lshl_b32 s60, s24, 2
    s_add_u32 s60, s60, s23
    s_lshl_b32 s65, s60, 11
    s_add_u32 s65, s65, 63963136
    s_lshl_b32 s66, s67, 10
    s_add_u32 s66, s66, 64489472
    s_lshl_b32 s58, s60, 12
    s_add_u32 s42, s20, s58
    s_addc_u32 s43, s21, 0
    s_lshl_b32 s58, s60, 10
    s_add_u32 s58, s58, 50331648
    s_add_u32 s44, s20, s58
    s_addc_u32 s45, s21, 0
    v_and_b32 v63, 3, v0
    v_lshlrev_b32 v63, 7, v63
    v_and_b32 v64, 4, v0
    v_lshl_add_u32 v122, v64, 12, v63
    s_lshl_b32 s58, s24, 9
    s_add_u32 s58, s58, 61865984
    s_add_u32 s96, s20, s58
    s_addc_u32 s97, s21, 0
    s_lshl_b32 s58, s23, 7
    s_add_u32 s58, s58, 32768
    s_add_u32 s4, s96, s58
    s_addc_u32 s5, s97, 0
    v_mov_b32 v64, 0
    s_mov_b64 exec, 1
    global_store_dword v105, v64, s[4:5] sc1
    s_mov_b64 exec, -1
    s_mov_b32 s62, 0
    s_mov_b32 s63, 0
    s_add_u32 s58, s62, 63963136
    s_add_u32 s28, s20, s58
    s_addc_u32 s29, s21, 0
    s_add_u32 s58, s65, s62
    s_add_u32 s34, s20, s58
    s_addc_u32 s35, s21, 0
    s_add_u32 s58, s63, 64487424
    s_add_u32 s36, s20, s58
    s_addc_u32 s37, s21, 0
    s_xor_b32 s58, s63, 0x2000
    s_add_u32 s58, s58, 64487424
    s_add_u32 s38, s20, s58
    s_addc_u32 s39, s21, 0
    s_add_u32 s58, s66, s63
    s_add_u32 s40, s20, s58
    s_addc_u32 s41, s21, 0
    global_store_dwordx4 v105, v[124:127], s[34:35] sc1
    global_store_dwordx4 v105, v[124:127], s[34:35] offset:1024 sc1
    s_add_u32 s46, s34, 0x40000
    s_addc_u32 s47, s35, 0
    global_store_dwordx4 v105, v[124:127], s[46:47] sc1
    global_store_dwordx4 v105, v[124:127], s[46:47] offset:1024 sc1
    global_store_dword v113, v124, s[38:39] sc1
    global_store_dword v113, v124, s[36:37] sc1
    global_load_dword v123, v70, s[6:7]
    s_mov_b32 s60, 65536
    s_add_u32 m0, s72, 16384
    s_add_u32 s61, s60, 0
    buffer_load_dwordx4 v4, s[88:91], s61 offen  lds
    s_add_u32 m0, s72, 17408
    s_add_u32 s61, s60, 4096
    buffer_load_dwordx4 v4, s[88:91], s61 offen  lds
    s_add_u32 m0, s72, 18432
    s_add_u32 s61, s60, 8192
    buffer_load_dwordx4 v4, s[88:91], s61 offen  lds
    s_add_u32 m0, s72, 19456
    s_add_u32 s61, s60, 12288
    buffer_load_dwordx4 v4, s[88:91], s61 offen  lds
    s_mov_b32 s60, 65536
    s_add_u32 m0, s72, 20480
    s_add_u32 s61, s60, 16384
    buffer_load_dwordx4 v4, s[88:91], s61 offen  lds
    s_add_u32 m0, s72, 21504
    s_add_u32 s61, s60, 20480
    buffer_load_dwordx4 v4, s[88:91], s61 offen  lds
    s_add_u32 m0, s72, 22528
    s_add_u32 s61, s60, 24576
    buffer_load_dwordx4 v4, s[88:91], s61 offen  lds
    s_add_u32 m0, s72, 23552
    s_add_u32 s61, s60, 28672
    buffer_load_dwordx4 v4, s[88:91], s61 offen  lds
    s_mov_b32 s60, 98304
    s_add_u32 m0, s72, 24576
    s_add_u32 s61, s60, 0
    buffer_load_dwordx4 v4, s[88:91], s61 offen  lds
    s_add_u32 m0, s72, 25600
    s_add_u32 s61, s60, 4096
    buffer_load_dwordx4 v4, s[88:91], s61 offen  lds
    s_add_u32 m0, s72, 26624
    s_add_u32 s61, s60, 8192
    buffer_load_dwordx4 v4, s[88:91], s61 offen  lds
    s_add_u32 m0, s72, 27648
    s_add_u32 s61, s60, 12288
    buffer_load_dwordx4 v4, s[88:91], s61 offen  lds
    s_mov_b32 s60, 98304
    s_add_u32 m0, s72, 28672
    s_add_u32 s61, s60, 16384
    buffer_load_dwordx4 v4, s[88:91], s61 offen  lds
    s_add_u32 m0, s72, 29696
    s_add_u32 s61, s60, 20480
    buffer_load_dwordx4 v4, s[88:91], s61 offen  lds
    s_add_u32 m0, s72, 30720
    s_add_u32 s61, s60, 24576
    buffer_load_dwordx4 v4, s[88:91], s61 offen  lds
    s_add_u32 m0, s72, 31744
    s_add_u32 s61, s60, 28672
    buffer_load_dwordx4 v4, s[88:91], s61 offen  lds
    v_lshrrev_b32 v2, 5, v0
    v_lshlrev_b32 v2, 16, v2
    v_lshl_add_u32 v2, v8, 9, v2
    v_lshrrev_b32 v9, 2, v0
    v_and_b32 v9, 12, v9
    v_xor_b32 v9, v9, v1
    v_lshl_add_u32 v2, v9, 4, v2
    s_lshr_b32 s58, s23, 1
    s_lshl_b32 s58, s58, 21
    s_and_b32 s59, s23, 1
    s_lshl_b32 s59, s59, 14
    s_add_u32 s58, s58, s59
    s_lshl_b32 s59, s24, 8
    s_add_u32 s58, s58, s59
    v_add_u32 v3, s58, v2
    v_lshrrev_b32 v2, 2, v0
    v_lshlrev_b32 v2, 8, v2
    v_and_b32 v1, 3, v0
    v_lshl_add_u32 v2, v1, 3, v2
    v_lshlrev_b32 v9, 3, v1
    v_and_b32 v10, 4, v0
    v_lshl_add_u32 v9, v10, 6, v9
    v_and_b32 v10, 8, v0
    v_lshl_add_u32 v9, v10, 2, v9
    v_and_b32 v10, 16, v0
    v_lshl_add_u32 v9, v10, 8, v9
    v_and_b32 v10, 32, v0
    v_lshl_add_u32 v9, v10, 5, v9
    v_add_u32 v5, s72, v9
    v_and_b32 v9, 12, v0
    v_lshlrev_b32 v9, 4, v9
    s_lshl_b32 s58, s23, 6
    v_xor_b32 v9, s58, v9
    v_add_u32 v2, v2, v9
    v_add_u32 v6, 16384, v2
    v_add_u32 v7, 73728, v6
    s_mov_b32 s76, s8
    s_and_b32 s77, s9, 0xffff
    s_mov_b32 s78, 4194304
    s_mov_b32 s79, 0x20000
    s_mov_b32 s80, s10
    s_and_b32 s81, s11, 0xffff
    s_mov_b32 s82, 4194304
    s_mov_b32 s83, 0x20000
    s_mov_b32 s84, s12
    s_and_b32 s85, s13, 0xffff
    s_mov_b32 s86, 4194304
    s_mov_b32 s87, 0x20000
    s_waitcnt vmcnt(16) lgkmcnt(0)
    s_barrier
    s_cmp_eq_u32 s23, 0
    s_cbranch_scc0 L_cs_noarr
    s_mov_b64 exec, 1
    s_lshl_b32 s58, s3, 5
    s_add_u32 s58, s58, 208
    v_mov_b32 v1, s58
    v_mov_b32 v2, 1
    global_atomic_add v1, v2, s[18:19]
    s_mov_b64 exec, -1
L_cs_noarr:
    s_add_u32 m0, s72, 32768
    s_mov_b32 s61, 0
    buffer_load_dwordx4 v3, s[80:83], s61 offen  lds
    s_add_u32 m0, s72, 33792
    s_mov_b32 s61, 32768
    buffer_load_dwordx4 v3, s[80:83], s61 offen  lds
    s_add_u32 m0, s72, 34816
    s_mov_b32 s61, 1048576
    buffer_load_dwordx4 v3, s[80:83], s61 offen  lds
    s_add_u32 m0, s72, 35840
    s_mov_b32 s61, 1081344
    buffer_load_dwordx4 v3, s[80:83], s61 offen  lds
    s_cmp_eq_u32 s67, 0
    s_cbranch_scc0 L_cs_wv1
    ds_read_b64_tr_b16 a[16:17], v5 offset:0
    ds_read_b64_tr_b16 a[18:19], v5 offset:512
    ds_read_b64_tr_b16 a[20:21], v5 offset:2048
    ds_read_b64_tr_b16 a[22:23], v5 offset:2560
    ds_read_b64_tr_b16 a[24:25], v5 offset:64
    ds_read_b64_tr_b16 a[26:27], v5 offset:576
    ds_read_b64_tr_b16 a[28:29], v5 offset:2112
    ds_read_b64_tr_b16 a[30:31], v5 offset:2624
    s_waitcnt lgkmcnt(0)
    ds_read_b64_tr_b16 a[48:49], v5 offset:128
    ds_read_b64_tr_b16 a[50:51], v5 offset:640
    ds_read_b64_tr_b16 a[52:53], v5 offset:2176
    ds_read_b64_tr_b16 a[54:55], v5 offset:2688
    ds_read_b64_tr_b16 a[56:57], v5 offset:192
    ds_read_b64_tr_b16 a[58:59], v5 offset:704
    ds_read_b64_tr_b16 a[60:61], v5 offset:2240
    ds_read_b64_tr_b16 a[62:63], v5 offset:2752
    s_waitcnt lgkmcnt(0)
    s_add_u32 m0, s72, 0
    s_mov_b32 s61, 131072
    buffer_load_dwordx4 v3, s[80:83], s61 offen  lds
    s_add_u32 m0, s72, 1024
    s_mov_b32 s61, 163840
    buffer_load_dwordx4 v3, s[80:83], s61 offen  lds
    s_add_u32 m0, s72, 2048
    s_mov_b32 s61, 1179648
    buffer_load_dwordx4 v3, s[80:83], s61 offen  lds
    s_add_u32 m0, s72, 3072
    s_mov_b32 s61, 1212416
    buffer_load_dwordx4 v3, s[80:83], s61 offen  lds
    s_add_u32 m0, s72, 4096
    s_mov_b32 s61, 262144
    buffer_load_dwordx4 v3, s[80:83], s61 offen  lds
    s_add_u32 m0, s72, 5120
    s_mov_b32 s61, 294912
    buffer_load_dwordx4 v3, s[80:83], s61 offen  lds
    s_add_u32 m0, s72, 6144
    s_mov_b32 s61, 1310720
    buffer_load_dwordx4 v3, s[80:83], s61 offen  lds
    s_add_u32 m0, s72, 7168
    s_mov_b32 s61, 1343488
    buffer_load_dwordx4 v3, s[80:83], s61 offen  lds
    ds_read_b64_tr_b16 v[128:129], v5 offset:8192
    ds_read_b64_tr_b16 v[130:131], v5 offset:8704
    ds_read_b64_tr_b16 v[132:133], v5 offset:10240
    ds_read_b64_tr_b16 v[134:135], v5 offset:10752
    ds_read_b64_tr_b16 v[152:153], v5 offset:8256
    ds_read_b64_tr_b16 v[154:155], v5 offset:8768
    ds_read_b64_tr_b16 v[156:157], v5 offset:10304
    ds_read_b64_tr_b16 v[158:159], v5 offset:10816
    s_waitcnt lgkmcnt(0)
    ds_read_b64_tr_b16 v[176:177], v5 offset:8320
    ds_read_b64_tr_b16 v[178:179], v5 offset:8832
    ds_read_b64_tr_b16 v[180:181], v5 offset:10368
    ds_read_b64_tr_b16 v[182:183], v5 offset:10880
    ds_read_b64_tr_b16 v[200:201], v5 offset:8384
    ds_read_b64_tr_b16 v[202:203], v5 offset:8896
    ds_read_b64_tr_b16 v[204:205], v5 offset:10432
    ds_read_b64_tr_b16 v[206:207], v5 offset:10944
    s_waitcnt lgkmcnt(0)
    s_add_u32 m0, s72, 8192
    s_mov_b32 s61, 393216
    buffer_load_dwordx4 v3, s[80:83], s61 offen  lds
    s_add_u32 m0, s72, 9216
    s_mov_b32 s61, 425984
    buffer_load_dwordx4 v3, s[80:83], s61 offen  lds
    s_add_u32 m0, s72, 10240
    s_mov_b32 s61, 1441792
    buffer_load_dwordx4 v3, s[80:83], s61 offen  lds
    s_add_u32 m0, s72, 11264
    s_mov_b32 s61, 1474560
    buffer_load_dwordx4 v3, s[80:83], s61 offen  lds
    s_waitcnt vmcnt(24)
    ds_read_b64_tr_b16 v[136:137], v5 offset:16384
    ds_read_b64_tr_b16 v[138:139], v5 offset:16896
    ds_read_b64_tr_b16 v[140:141], v5 offset:18432
    ds_read_b64_tr_b16 v[142:143], v5 offset:18944
    ds_read_b64_tr_b16 v[160:161], v5 offset:16448
    ds_read_b64_tr_b16 v[162:163], v5 offset:16960
    ds_read_b64_tr_b16 v[164:165], v5 offset:18496
    ds_read_b64_tr_b16 v[166:167], v5 offset:19008
    s_waitcnt lgkmcnt(0)
    ds_read_b64_tr_b16 v[184:185], v5 offset:16512
    ds_read_b64_tr_b16 v[186:187], v5 offset:17024
    ds_read_b64_tr_b16 v[188:189], v5 offset:18560
    ds_read_b64_tr_b16 v[190:191], v5 offset:19072
    ds_read_b64_tr_b16 a[80:81], v5 offset:16576
    ds_read_b64_tr_b16 a[82:83], v5 offset:17088
    ds_read_b64_tr_b16 a[84:85], v5 offset:18624
    ds_read_b64_tr_b16 a[86:87], v5 offset:19136
    s_waitcnt lgkmcnt(0)
    s_waitcnt vmcnt(16)
    ds_read_b64_tr_b16 v[144:145], v5 offset:24576
    ds_read_b64_tr_b16 v[146:147], v5 offset:25088
    ds_read_b64_tr_b16 v[148:149], v5 offset:26624
    ds_read_b64_tr_b16 v[150:151], v5 offset:27136
    ds_read_b64_tr_b16 v[168:169], v5 offset:24640
    ds_read_b64_tr_b16 v[170:171], v5 offset:25152
    ds_read_b64_tr_b16 v[172:173], v5 offset:26688
    ds_read_b64_tr_b16 v[174:175], v5 offset:27200
    s_waitcnt lgkmcnt(0)
    ds_read_b64_tr_b16 v[192:193], v5 offset:24704
    ds_read_b64_tr_b16 v[194:195], v5 offset:25216
    ds_read_b64_tr_b16 v[196:197], v5 offset:26752
    ds_read_b64_tr_b16 v[198:199], v5 offset:27264
    ds_read_b64_tr_b16 a[88:89], v5 offset:24768
    ds_read_b64_tr_b16 a[90:91], v5 offset:25280
    ds_read_b64_tr_b16 a[92:93], v5 offset:26816
    ds_read_b64_tr_b16 a[94:95], v5 offset:27328
    s_waitcnt lgkmcnt(0)
    v_add_u32 v4, 36864, v6
    v_add_u32 v5, 36864, v7
    s_waitcnt vmcnt(12)
    s_barrier
    ds_read_b64_tr_b16 v[8:9], v6 offset:32768
    ds_read_b64_tr_b16 v[10:11], v4 offset:32768
    ds_read_b64_tr_b16 v[12:13], v7 offset:32768
    ds_read_b64_tr_b16 v[14:15], v5 offset:32768
    ds_read_b64_tr_b16 v[16:17], v6 offset:32800
    ds_read_b64_tr_b16 v[18:19], v4 offset:32800
    ds_read_b64_tr_b16 v[20:21], v7 offset:32800
    ds_read_b64_tr_b16 v[22:23], v5 offset:32800
    ds_write_b128 v118, a[48:51] offset:28672
    ds_write_b128 v118, a[52:55] offset:29696
    ds_write_b128 v118, a[56:59] offset:30720
    ds_write_b128 v118, a[60:63] offset:31744
    s_add_u32 m0, s72, 20480
    s_mov_b32 s61, 524288
    buffer_load_dwordx4 v3, s[80:83], s61 offen  lds
    s_add_u32 m0, s72, 21504
    s_mov_b32 s61, 557056
    buffer_load_dwordx4 v3, s[80:83], s61 offen  lds
    s_add_u32 m0, s72, 22528
    s_mov_b32 s61, 1572864
    buffer_load_dwordx4 v3, s[80:83], s61 offen  lds
    s_add_u32 m0, s72, 23552
    s_mov_b32 s61, 1605632
    buffer_load_dwordx4 v3, s[80:83], s61 offen  lds
    s_waitcnt lgkmcnt(0)
    s_waitcnt vmcnt(12)
    s_barrier
    ds_read_b64_tr_b16 v[24:25], v6 offset:0
    ds_read_b64_tr_b16 v[26:27], v4 offset:0
    ds_read_b64_tr_b16 v[28:29], v7 offset:0
    ds_read_b64_tr_b16 v[30:31], v5 offset:0
    ds_read_b64_tr_b16 v[32:33], v6 offset:32
    ds_read_b64_tr_b16 v[34:35], v4 offset:32
    ds_read_b64_tr_b16 v[36:37], v7 offset:32
    ds_read_b64_tr_b16 v[38:39], v5 offset:32
    ds_write_b128 v118, a[80:83] offset:32768
    ds_write_b128 v118, a[84:87] offset:33792
    ds_write_b128 v118, a[88:91] offset:34816
    ds_write_b128 v118, a[92:95] offset:35840
    s_add_u32 m0, s72, 16384
    s_mov_b32 s61, 655360
    buffer_load_dwordx4 v3, s[80:83], s61 offen  lds
    s_add_u32 m0, s72, 17408
    s_mov_b32 s61, 688128
    buffer_load_dwordx4 v3, s[80:83], s61 offen  lds
    s_add_u32 m0, s72, 18432
    s_mov_b32 s61, 1703936
    buffer_load_dwordx4 v3, s[80:83], s61 offen  lds
    s_add_u32 m0, s72, 19456
    s_mov_b32 s61, 1736704
    buffer_load_dwordx4 v3, s[80:83], s61 offen  lds
    s_waitcnt lgkmcnt(0)
    s_waitcnt vmcnt(12)
    s_barrier
    ds_read_b64_tr_b16 v[208:209], v6 offset:4096
    ds_read_b64_tr_b16 v[210:211], v4 offset:4096
    ds_read_b64_tr_b16 v[212:213], v7 offset:4096
    ds_read_b64_tr_b16 v[214:215], v5 offset:4096
    ds_read_b64_tr_b16 v[216:217], v6 offset:4128
    ds_read_b64_tr_b16 v[218:219], v4 offset:4128
    ds_read_b64_tr_b16 v[220:221], v7 offset:4128
    ds_read_b64_tr_b16 v[222:223], v5 offset:4128
    ds_write_b128 v118, a[16:19] offset:24576
    ds_write_b128 v118, a[20:23] offset:25600
    ds_write_b128 v118, a[24:27] offset:26624
    ds_write_b128 v118, a[28:31] offset:27648
    s_add_u32 m0, s72, 12288
    s_mov_b32 s61, 786432
    buffer_load_dwordx4 v3, s[80:83], s61 offen  lds
    s_add_u32 m0, s72, 13312
    s_mov_b32 s61, 819200
    buffer_load_dwordx4 v3, s[80:83], s61 offen  lds
    s_add_u32 m0, s72, 14336
    s_mov_b32 s61, 1835008
    buffer_load_dwordx4 v3, s[80:83], s61 offen  lds
    s_add_u32 m0, s72, 15360
    s_mov_b32 s61, 1867776
    buffer_load_dwordx4 v3, s[80:83], s61 offen  lds
    s_waitcnt lgkmcnt(0)
    s_waitcnt vmcnt(12)
    s_barrier
    ds_read_b64_tr_b16 v[240:241], v6 offset:8192
    ds_read_b64_tr_b16 v[242:243], v4 offset:8192
    ds_read_b64_tr_b16 v[244:245], v7 offset:8192
    ds_read_b64_tr_b16 v[246:247], v5 offset:8192
    ds_read_b64_tr_b16 v[248:249], v6 offset:8224
    ds_read_b64_tr_b16 v[250:251], v4 offset:8224
    ds_read_b64_tr_b16 v[252:253], v7 offset:8224
    ds_read_b64_tr_b16 v[254:255], v5 offset:8224
    s_add_u32 m0, s72, 4096
    s_mov_b32 s61, 917504
    buffer_load_dwordx4 v3, s[80:83], s61 offen  lds
    s_add_u32 m0, s72, 5120
    s_mov_b32 s61, 950272
    buffer_load_dwordx4 v3, s[80:83], s61 offen  lds
    s_add_u32 m0, s72, 6144
    s_mov_b32 s61, 1966080
    buffer_load_dwordx4 v3, s[80:83], s61 offen  lds
    s_add_u32 m0, s72, 7168
    s_mov_b32 s61, 1998848
    buffer_load_dwordx4 v3, s[80:83], s61 offen  lds
    s_waitcnt lgkmcnt(0)
    s_waitcnt vmcnt(12)
    s_barrier
    ds_read_b64_tr_b16 v[40:41], v6 offset:20480
    ds_read_b64_tr_b16 v[42:43], v4 offset:20480
    ds_read_b64_tr_b16 v[44:45], v7 offset:20480
    ds_read_b64_tr_b16 v[46:47], v5 offset:20480
    ds_read_b64_tr_b16 v[48:49], v6 offset:20512
    ds_read_b64_tr_b16 v[50:51], v4 offset:20512
    ds_read_b64_tr_b16 v[52:53], v7 offset:20512
    ds_read_b64_tr_b16 v[54:55], v5 offset:20512
    s_add_u32 m0, s72, 8192
    s_mov_b32 s61, 0
    buffer_load_dwordx4 v3, s[84:87], s61 offen  lds
    s_add_u32 m0, s72, 9216
    s_mov_b32 s61, 32768
    buffer_load_dwordx4 v3, s[84:87], s61 offen  lds
    s_add_u32 m0, s72, 10240
    s_mov_b32 s61, 1048576
    buffer_load_dwordx4 v3, s[84:87], s61 offen  lds
    s_add_u32 m0, s72, 11264
    s_mov_b32 s61, 1081344
    buffer_load_dwordx4 v3, s[84:87], s61 offen  lds
    s_waitcnt lgkmcnt(0)
    s_waitcnt vmcnt(12)
    s_barrier
    ds_read_b64_tr_b16 v[56:57], v6 offset:16384
    ds_read_b64_tr_b16 v[58:59], v4 offset:16384
    ds_read_b64_tr_b16 v[60:61], v7 offset:16384
    ds_read_b64_tr_b16 v[62:63], v5 offset:16384
    ds_read_b64_tr_b16 v[64:65], v6 offset:16416
    ds_read_b64_tr_b16 v[66:67], v4 offset:16416
    ds_read_b64_tr_b16 v[68:69], v7 offset:16416
    ds_read_b64_tr_b16 v[70:71], v5 offset:16416
    s_add_u32 m0, s72, 20480
    s_mov_b32 s61, 131072
    buffer_load_dwordx4 v3, s[84:87], s61 offen  lds
    s_add_u32 m0, s72, 21504
    s_mov_b32 s61, 163840
    buffer_load_dwordx4 v3, s[84:87], s61 offen  lds
    s_add_u32 m0, s72, 22528
    s_mov_b32 s61, 1179648
    buffer_load_dwordx4 v3, s[84:87], s61 offen  lds
    s_add_u32 m0, s72, 23552
    s_mov_b32 s61, 1212416
    buffer_load_dwordx4 v3, s[84:87], s61 offen  lds
    s_waitcnt lgkmcnt(0)
    s_waitcnt vmcnt(12)
    s_barrier
    ds_read_b64_tr_b16 v[224:225], v6 offset:12288
    ds_read_b64_tr_b16 v[226:227], v4 offset:12288
    ds_read_b64_tr_b16 v[228:229], v7 offset:12288
    ds_read_b64_tr_b16 v[230:231], v5 offset:12288
    ds_read_b64_tr_b16 v[232:233], v6 offset:12320
    ds_read_b64_tr_b16 v[234:235], v4 offset:12320
    ds_read_b64_tr_b16 v[236:237], v7 offset:12320
    ds_read_b64_tr_b16 v[238:239], v5 offset:12320
    s_add_u32 m0, s72, 16384
    s_mov_b32 s61, 262144
    buffer_load_dwordx4 v3, s[84:87], s61 offen  lds
    s_add_u32 m0, s72, 17408
    s_mov_b32 s61, 294912
    buffer_load_dwordx4 v3, s[84:87], s61 offen  lds
    s_add_u32 m0, s72, 18432
    s_mov_b32 s61, 1310720
    buffer_load_dwordx4 v3, s[84:87], s61 offen  lds
    s_add_u32 m0, s72, 19456
    s_mov_b32 s61, 1343488
    buffer_load_dwordx4 v3, s[84:87], s61 offen  lds
    s_waitcnt lgkmcnt(0)
    s_waitcnt vmcnt(12)
    s_barrier
    ds_read_b64_tr_b16 a[224:225], v6 offset:4096
    ds_read_b64_tr_b16 a[226:227], v4 offset:4096
    ds_read_b64_tr_b16 a[228:229], v7 offset:4096
    ds_read_b64_tr_b16 a[230:231], v5 offset:4096
    ds_read_b64_tr_b16 a[232:233], v6 offset:4128
    ds_read_b64_tr_b16 a[234:235], v4 offset:4128
    ds_read_b64_tr_b16 a[236:237], v7 offset:4128
    ds_read_b64_tr_b16 a[238:239], v5 offset:4128
    s_add_u32 m0, s72, 12288
    s_mov_b32 s61, 393216
    buffer_load_dwordx4 v3, s[84:87], s61 offen  lds
    s_add_u32 m0, s72, 13312
    s_mov_b32 s61, 425984
    buffer_load_dwordx4 v3, s[84:87], s61 offen  lds
    s_add_u32 m0, s72, 14336
    s_mov_b32 s61, 1441792
    buffer_load_dwordx4 v3, s[84:87], s61 offen  lds
    s_add_u32 m0, s72, 15360
    s_mov_b32 s61, 1474560
    buffer_load_dwordx4 v3, s[84:87], s61 offen  lds
    s_waitcnt lgkmcnt(0)
    s_waitcnt vmcnt(12)
    s_barrier
    ds_read_b64_tr_b16 a[128:129], v6 offset:8192
    ds_read_b64_tr_b16 a[130:131], v4 offset:8192
    ds_read_b64_tr_b16 a[132:133], v7 offset:8192
    ds_read_b64_tr_b16 a[134:135], v5 offset:8192
    ds_read_b64_tr_b16 a[136:137], v6 offset:8224
    ds_read_b64_tr_b16 a[138:139], v4 offset:8224
    ds_read_b64_tr_b16 a[140:141], v7 offset:8224
    ds_read_b64_tr_b16 a[142:143], v5 offset:8224
    ds_write_b128 v118, v[8:11] offset:0
    ds_write_b128 v118, v[12:15] offset:1024
    ds_write_b128 v118, v[16:19] offset:2048
    ds_write_b128 v118, v[20:23] offset:3072
    s_add_u32 m0, s72, 4096
    s_mov_b32 s61, 524288
    buffer_load_dwordx4 v3, s[84:87], s61 offen  lds
    s_add_u32 m0, s72, 5120
    s_mov_b32 s61, 557056
    buffer_load_dwordx4 v3, s[84:87], s61 offen  lds
    s_add_u32 m0, s72, 6144
    s_mov_b32 s61, 1572864
    buffer_load_dwordx4 v3, s[84:87], s61 offen  lds
    s_add_u32 m0, s72, 7168
    s_mov_b32 s61, 1605632
    buffer_load_dwordx4 v3, s[84:87], s61 offen  lds
    s_waitcnt lgkmcnt(0)
    s_waitcnt vmcnt(12)
    s_barrier
    ds_read_b64_tr_b16 a[160:161], v6 offset:20480
    ds_read_b64_tr_b16 a[162:163], v4 offset:20480
    ds_read_b64_tr_b16 a[164:165], v7 offset:20480
    ds_read_b64_tr_b16 a[166:167], v5 offset:20480
    ds_read_b64_tr_b16 a[168:169], v6 offset:20512
    ds_read_b64_tr_b16 a[170:171], v4 offset:20512
    ds_read_b64_tr_b16 a[172:173], v7 offset:20512
    ds_read_b64_tr_b16 a[174:175], v5 offset:20512
    s_add_u32 m0, s72, 8192
    s_mov_b32 s61, 655360
    buffer_load_dwordx4 v3, s[84:87], s61 offen  lds
    s_add_u32 m0, s72, 9216
    s_mov_b32 s61, 688128
    buffer_load_dwordx4 v3, s[84:87], s61 offen  lds
    s_add_u32 m0, s72, 10240
    s_mov_b32 s61, 1703936
    buffer_load_dwordx4 v3, s[84:87], s61 offen  lds
    s_add_u32 m0, s72, 11264
    s_mov_b32 s61, 1736704
    buffer_load_dwordx4 v3, s[84:87], s61 offen  lds
    s_waitcnt lgkmcnt(0)
    s_waitcnt vmcnt(12)
    s_barrier
    ds_read_b64_tr_b16 a[192:193], v6 offset:16384
    ds_read_b64_tr_b16 a[194:195], v4 offset:16384
    ds_read_b64_tr_b16 a[196:197], v7 offset:16384
    ds_read_b64_tr_b16 a[198:199], v5 offset:16384
    ds_read_b64_tr_b16 a[200:201], v6 offset:16416
    ds_read_b64_tr_b16 a[202:203], v4 offset:16416
    ds_read_b64_tr_b16 a[204:205], v7 offset:16416
    ds_read_b64_tr_b16 a[206:207], v5 offset:16416
    s_add_u32 m0, s72, 20480
    s_mov_b32 s61, 786432
    buffer_load_dwordx4 v3, s[84:87], s61 offen  lds
    s_add_u32 m0, s72, 21504
    s_mov_b32 s61, 819200
    buffer_load_dwordx4 v3, s[84:87], s61 offen  lds
    s_add_u32 m0, s72, 22528
    s_mov_b32 s61, 1835008
    buffer_load_dwordx4 v3, s[84:87], s61 offen  lds
    s_add_u32 m0, s72, 23552
    s_mov_b32 s61, 1867776
    buffer_load_dwordx4 v3, s[84:87], s61 offen  lds
    s_waitcnt lgkmcnt(0)
    s_waitcnt vmcnt(12)
    s_barrier
    ds_read_b64_tr_b16 a[208:209], v6 offset:12288
    ds_read_b64_tr_b16 a[210:211], v4 offset:12288
    ds_read_b64_tr_b16 a[212:213], v7 offset:12288
    ds_read_b64_tr_b16 a[214:215], v5 offset:12288
    ds_read_b64_tr_b16 a[216:217], v6 offset:12320
    ds_read_b64_tr_b16 a[218:219], v4 offset:12320
    ds_read_b64_tr_b16 a[220:221], v7 offset:12320
    ds_read_b64_tr_b16 a[222:223], v5 offset:12320
    s_add_u32 m0, s72, 16384
    s_mov_b32 s61, 917504
    buffer_load_dwordx4 v3, s[84:87], s61 offen  lds
    s_add_u32 m0, s72, 17408
    s_mov_b32 s61, 950272
    buffer_load_dwordx4 v3, s[84:87], s61 offen  lds
    s_add_u32 m0, s72, 18432
    s_mov_b32 s61, 1966080
    buffer_load_dwordx4 v3, s[84:87], s61 offen  lds
    s_add_u32 m0, s72, 19456
    s_mov_b32 s61, 1998848
    buffer_load_dwordx4 v3, s[84:87], s61 offen  lds
    s_waitcnt lgkmcnt(0)
    s_waitcnt vmcnt(12)
    s_barrier
    ds_read_b64_tr_b16 a[144:145], v6 offset:4096
    ds_read_b64_tr_b16 a[146:147], v4 offset:4096
    ds_read_b64_tr_b16 a[148:149], v7 offset:4096
    ds_read_b64_tr_b16 a[150:151], v5 offset:4096
    ds_read_b64_tr_b16 a[152:153], v6 offset:4128
    ds_read_b64_tr_b16 a[154:155], v4 offset:4128
    ds_read_b64_tr_b16 a[156:157], v7 offset:4128
    ds_read_b64_tr_b16 a[158:159], v5 offset:4128
    s_add_u32 m0, s72, 12288
    s_mov_b32 s61, 0
    buffer_load_dwordx4 v3, s[76:79], s61 offen  lds
    s_add_u32 m0, s72, 13312
    s_mov_b32 s61, 32768
    buffer_load_dwordx4 v3, s[76:79], s61 offen  lds
    s_add_u32 m0, s72, 14336
    s_mov_b32 s61, 1048576
    buffer_load_dwordx4 v3, s[76:79], s61 offen  lds
    s_add_u32 m0, s72, 15360
    s_mov_b32 s61, 1081344
    buffer_load_dwordx4 v3, s[76:79], s61 offen  lds
    s_waitcnt lgkmcnt(0)
    s_waitcnt vmcnt(12)
    s_barrier
    ds_read_b64_tr_b16 a[176:177], v6 offset:8192
    ds_read_b64_tr_b16 a[178:179], v4 offset:8192
    ds_read_b64_tr_b16 a[180:181], v7 offset:8192
    ds_read_b64_tr_b16 a[182:183], v5 offset:8192
    ds_read_b64_tr_b16 a[184:185], v6 offset:8224
    ds_read_b64_tr_b16 a[186:187], v4 offset:8224
    ds_read_b64_tr_b16 a[188:189], v7 offset:8224
    ds_read_b64_tr_b16 a[190:191], v5 offset:8224
    s_add_u32 m0, s72, 4096
    s_mov_b32 s61, 131072
    buffer_load_dwordx4 v3, s[76:79], s61 offen  lds
    s_add_u32 m0, s72, 5120
    s_mov_b32 s61, 163840
    buffer_load_dwordx4 v3, s[76:79], s61 offen  lds
    s_add_u32 m0, s72, 6144
    s_mov_b32 s61, 1179648
    buffer_load_dwordx4 v3, s[76:79], s61 offen  lds
    s_add_u32 m0, s72, 7168
    s_mov_b32 s61, 1212416
    buffer_load_dwordx4 v3, s[76:79], s61 offen  lds
    s_waitcnt lgkmcnt(0)
    s_waitcnt vmcnt(12)
    s_barrier
    ds_read_b64_tr_b16 v[72:73], v6 offset:20480
    ds_read_b64_tr_b16 v[74:75], v4 offset:20480
    ds_read_b64_tr_b16 v[76:77], v7 offset:20480
    ds_read_b64_tr_b16 v[78:79], v5 offset:20480
    ds_read_b64_tr_b16 v[80:81], v6 offset:20512
    ds_read_b64_tr_b16 v[82:83], v4 offset:20512
    ds_read_b64_tr_b16 v[84:85], v7 offset:20512
    ds_read_b64_tr_b16 v[86:87], v5 offset:20512
    s_add_u32 m0, s72, 8192
    s_mov_b32 s61, 262144
    buffer_load_dwordx4 v3, s[76:79], s61 offen  lds
    s_add_u32 m0, s72, 9216
    s_mov_b32 s61, 294912
    buffer_load_dwordx4 v3, s[76:79], s61 offen  lds
    s_add_u32 m0, s72, 10240
    s_mov_b32 s61, 1310720
    buffer_load_dwordx4 v3, s[76:79], s61 offen  lds
    s_add_u32 m0, s72, 11264
    s_mov_b32 s61, 1343488
    buffer_load_dwordx4 v3, s[76:79], s61 offen  lds
    global_store_dword v113, v123, s[36:37] sc1
    v_mbcnt_lo_u32_b32 v1, -1, 0
    v_and_b32 v1, 15, v1
    v_lshlrev_b32 v1, 4, v1
    global_load_dword v2, v1, s[18:19] sc1
    s_waitcnt lgkmcnt(0)
    s_waitcnt vmcnt(14)
    s_barrier
    ds_read_b64_tr_b16 v[88:89], v6 offset:16384
    ds_read_b64_tr_b16 v[90:91], v4 offset:16384
    ds_read_b64_tr_b16 v[92:93], v7 offset:16384
    ds_read_b64_tr_b16 v[94:95], v5 offset:16384
    ds_read_b64_tr_b16 v[96:97], v6 offset:16416
    ds_read_b64_tr_b16 v[98:99], v4 offset:16416
    ds_read_b64_tr_b16 v[100:101], v7 offset:16416
    ds_read_b64_tr_b16 v[102:103], v5 offset:16416
    s_add_u32 m0, s72, 20480
    s_mov_b32 s61, 393216
    buffer_load_dwordx4 v3, s[76:79], s61 offen  lds
    s_add_u32 m0, s72, 21504
    s_mov_b32 s61, 425984
    buffer_load_dwordx4 v3, s[76:79], s61 offen  lds
    s_add_u32 m0, s72, 22528
    s_mov_b32 s61, 1441792
    buffer_load_dwordx4 v3, s[76:79], s61 offen  lds
    s_add_u32 m0, s72, 23552
    s_mov_b32 s61, 1474560
    buffer_load_dwordx4 v3, s[76:79], s61 offen  lds
    s_waitcnt lgkmcnt(0)
    s_waitcnt vmcnt(14)
    s_barrier
    ds_read_b64_tr_b16 a[0:1], v6 offset:12288
    ds_read_b64_tr_b16 a[2:3], v4 offset:12288
    ds_read_b64_tr_b16 a[4:5], v7 offset:12288
    ds_read_b64_tr_b16 a[6:7], v5 offset:12288
    ds_read_b64_tr_b16 a[8:9], v6 offset:12320
    ds_read_b64_tr_b16 a[10:11], v4 offset:12320
    ds_read_b64_tr_b16 a[12:13], v7 offset:12320
    ds_read_b64_tr_b16 a[14:15], v5 offset:12320
    s_add_u32 m0, s72, 16384
    s_mov_b32 s61, 524288
    buffer_load_dwordx4 v3, s[76:79], s61 offen  lds
    s_add_u32 m0, s72, 17408
    s_mov_b32 s61, 557056
    buffer_load_dwordx4 v3, s[76:79], s61 offen  lds
    s_add_u32 m0, s72, 18432
    s_mov_b32 s61, 1572864
    buffer_load_dwordx4 v3, s[76:79], s61 offen  lds
    s_add_u32 m0, s72, 19456
    s_mov_b32 s61, 1605632
    buffer_load_dwordx4 v3, s[76:79], s61 offen  lds
    s_waitcnt lgkmcnt(0)
    s_waitcnt vmcnt(14)
    s_barrier
    ds_read_b64_tr_b16 a[32:33], v6 offset:4096
    ds_read_b64_tr_b16 a[34:35], v4 offset:4096
    ds_read_b64_tr_b16 a[36:37], v7 offset:4096
    ds_read_b64_tr_b16 a[38:39], v5 offset:4096
    ds_read_b64_tr_b16 a[40:41], v6 offset:4128
    ds_read_b64_tr_b16 a[42:43], v4 offset:4128
    ds_read_b64_tr_b16 a[44:45], v7 offset:4128
    ds_read_b64_tr_b16 a[46:47], v5 offset:4128
    s_add_u32 m0, s72, 12288
    s_mov_b32 s61, 655360
    buffer_load_dwordx4 v3, s[76:79], s61 offen  lds
    s_add_u32 m0, s72, 13312
    s_mov_b32 s61, 688128
    buffer_load_dwordx4 v3, s[76:79], s61 offen  lds
    s_add_u32 m0, s72, 14336
    s_mov_b32 s61, 1703936
    buffer_load_dwordx4 v3, s[76:79], s61 offen  lds
    s_add_u32 m0, s72, 15360
    s_mov_b32 s61, 1736704
    buffer_load_dwordx4 v3, s[76:79], s61 offen  lds
    s_waitcnt lgkmcnt(0)
    s_waitcnt vmcnt(14)
    s_barrier
    ds_read_b64_tr_b16 a[64:65], v6 offset:8192
    ds_read_b64_tr_b16 a[66:67], v4 offset:8192
    ds_read_b64_tr_b16 a[68:69], v7 offset:8192
    ds_read_b64_tr_b16 a[70:71], v5 offset:8192
    ds_read_b64_tr_b16 a[72:73], v6 offset:8224
    ds_read_b64_tr_b16 a[74:75], v4 offset:8224
    ds_read_b64_tr_b16 a[76:77], v7 offset:8224
    ds_read_b64_tr_b16 a[78:79], v5 offset:8224
    s_add_u32 m0, s72, 4096
    s_mov_b32 s61, 786432
    buffer_load_dwordx4 v3, s[76:79], s61 offen  lds
    s_add_u32 m0, s72, 5120
    s_mov_b32 s61, 819200
    buffer_load_dwordx4 v3, s[76:79], s61 offen  lds
    s_add_u32 m0, s72, 6144
    s_mov_b32 s61, 1835008
    buffer_load_dwordx4 v3, s[76:79], s61 offen  lds
    s_add_u32 m0, s72, 7168
    s_mov_b32 s61, 1867776
    buffer_load_dwordx4 v3, s[76:79], s61 offen  lds
    s_waitcnt lgkmcnt(0)
    s_waitcnt vmcnt(12)
    s_barrier
    ds_read_b64_tr_b16 a[96:97], v6 offset:20480
    ds_read_b64_tr_b16 a[98:99], v4 offset:20480
    ds_read_b64_tr_b16 a[100:101], v7 offset:20480
    ds_read_b64_tr_b16 a[102:103], v5 offset:20480
    ds_read_b64_tr_b16 a[104:105], v6 offset:20512
    ds_read_b64_tr_b16 a[106:107], v4 offset:20512
    ds_read_b64_tr_b16 a[108:109], v7 offset:20512
    ds_read_b64_tr_b16 a[110:111], v5 offset:20512
    s_add_u32 m0, s72, 8192
    s_mov_b32 s61, 917504
    buffer_load_dwordx4 v3, s[76:79], s61 offen  lds
    s_add_u32 m0, s72, 9216
    s_mov_b32 s61, 950272
    buffer_load_dwordx4 v3, s[76:79], s61 offen  lds
    s_add_u32 m0, s72, 10240
    s_mov_b32 s61, 1966080
    buffer_load_dwordx4 v3, s[76:79], s61 offen  lds
    s_add_u32 m0, s72, 11264
    s_mov_b32 s61, 1998848
    buffer_load_dwordx4 v3, s[76:79], s61 offen  lds
    s_waitcnt lgkmcnt(0)
    s_waitcnt vmcnt(12)
    s_barrier
    ds_read_b64_tr_b16 a[16:17], v6 offset:16384
    ds_read_b64_tr_b16 a[18:19], v4 offset:16384
    ds_read_b64_tr_b16 a[20:21], v7 offset:16384
    ds_read_b64_tr_b16 a[22:23], v5 offset:16384
    ds_read_b64_tr_b16 a[24:25], v6 offset:16416
    ds_read_b64_tr_b16 a[26:27], v4 offset:16416
    ds_read_b64_tr_b16 a[28:29], v7 offset:16416
    ds_read_b64_tr_b16 a[30:31], v5 offset:16416
    ds_write_b128 v118, v[88:91] offset:20480
    ds_write_b128 v118, v[92:95] offset:21504
    ds_write_b128 v118, v[96:99] offset:22528
    ds_write_b128 v118, v[100:103] offset:23552
    global_load_dword v123, v122, s[96:97] sc1
    s_waitcnt lgkmcnt(0)
    s_waitcnt vmcnt(9)
    s_barrier
    ds_read_b64_tr_b16 a[48:49], v6 offset:12288
    ds_read_b64_tr_b16 a[50:51], v4 offset:12288
    ds_read_b64_tr_b16 a[52:53], v7 offset:12288
    ds_read_b64_tr_b16 a[54:55], v5 offset:12288
    ds_read_b64_tr_b16 a[56:57], v6 offset:12320
    ds_read_b64_tr_b16 a[58:59], v4 offset:12320
    ds_read_b64_tr_b16 a[60:61], v7 offset:12320
    ds_read_b64_tr_b16 a[62:63], v5 offset:12320
    ds_write_b128 v118, v[72:75] offset:16384
    ds_write_b128 v118, v[76:79] offset:17408
    ds_write_b128 v118, v[80:83] offset:18432
    ds_write_b128 v118, v[84:87] offset:19456
    s_waitcnt lgkmcnt(0)
    s_waitcnt vmcnt(5)
    s_barrier
    ds_read_b64_tr_b16 a[80:81], v6 offset:4096
    ds_read_b64_tr_b16 a[82:83], v4 offset:4096
    ds_read_b64_tr_b16 a[84:85], v7 offset:4096
    ds_read_b64_tr_b16 a[86:87], v5 offset:4096
    ds_read_b64_tr_b16 a[88:89], v6 offset:4128
    ds_read_b64_tr_b16 a[90:91], v4 offset:4128
    ds_read_b64_tr_b16 a[92:93], v7 offset:4128
    ds_read_b64_tr_b16 a[94:95], v5 offset:4128
    ds_write_b128 v118, v[56:59] offset:12288
    ds_write_b128 v118, v[60:63] offset:13312
    ds_write_b128 v118, v[64:67] offset:14336
    ds_write_b128 v118, v[68:71] offset:15360
    s_waitcnt lgkmcnt(0)
    s_waitcnt vmcnt(1)
    s_barrier
    ds_read_b64_tr_b16 a[112:113], v6 offset:8192
    ds_read_b64_tr_b16 a[114:115], v4 offset:8192
    ds_read_b64_tr_b16 a[116:117], v7 offset:8192
    ds_read_b64_tr_b16 a[118:119], v5 offset:8192
    ds_read_b64_tr_b16 a[120:121], v6 offset:8224
    ds_read_b64_tr_b16 a[122:123], v4 offset:8224
    ds_read_b64_tr_b16 a[124:125], v7 offset:8224
    ds_read_b64_tr_b16 a[126:127], v5 offset:8224
    ds_write_b128 v118, v[24:27] offset:4096
    ds_write_b128 v118, v[28:31] offset:5120
    ds_write_b128 v118, v[32:35] offset:6144
    ds_write_b128 v118, v[36:39] offset:7168
    s_waitcnt vmcnt(0)
    global_load_dwordx4 a[240:243], v105, s[42:43] offset:0 sc1
    global_load_dwordx4 a[244:247], v105, s[42:43] offset:1024 sc1
    global_load_dwordx4 a[248:251], v105, s[42:43] offset:2048 sc1
    global_load_dwordx4 a[252:255], v105, s[42:43] offset:3072 sc1
    s_waitcnt lgkmcnt(0)
    s_barrier
    ds_write_b128 v118, v[40:43] offset:8192
    ds_write_b128 v118, v[44:47] offset:9216
    ds_write_b128 v118, v[48:51] offset:10240
    ds_write_b128 v118, v[52:55] offset:11264
    s_branch L_cs_wdone
L_cs_wv1:
    s_cmp_eq_u32 s67, 1
    s_cbranch_scc0 L_cs_wv2
    ds_read_b64_tr_b16 v[128:129], v5 offset:0
    ds_read_b64_tr_b16 v[130:131], v5 offset:512
    ds_read_b64_tr_b16 v[132:133], v5 offset:2048
    ds_read_b64_tr_b16 v[134:135], v5 offset:2560
    ds_read_b64_tr_b16 v[152:153], v5 offset:64
    ds_read_b64_tr_b16 v[154:155], v5 offset:576
    ds_read_b64_tr_b16 v[156:157], v5 offset:2112
    ds_read_b64_tr_b16 v[158:159], v5 offset:2624
    s_waitcnt lgkmcnt(0)
    ds_read_b64_tr_b16 v[176:177], v5 offset:128
    ds_read_b64_tr_b16 v[178:179], v5 offset:640
    ds_read_b64_tr_b16 v[180:181], v5 offset:2176
    ds_read_b64_tr_b16 v[182:183], v5 offset:2688
    ds_read_b64_tr_b16 v[200:201], v5 offset:192
    ds_read_b64_tr_b16 v[202:203], v5 offset:704
    ds_read_b64_tr_b16 v[204:205], v5 offset:2240
    ds_read_b64_tr_b16 v[206:207], v5 offset:2752
    s_waitcnt lgkmcnt(0)
    s_add_u32 m0, s72, 0
    s_mov_b32 s61, 131072
    buffer_load_dwordx4 v3, s[80:83], s61 offen  lds
    s_add_u32 m0, s72, 1024
    s_mov_b32 s61, 163840
    buffer_load_dwordx4 v3, s[80:83], s61 offen  lds
    s_add_u32 m0, s72, 2048
    s_mov_b32 s61, 1179648
    buffer_load_dwordx4 v3, s[80:83], s61 offen  lds
    s_add_u32 m0, s72, 3072
    s_mov_b32 s61, 1212416
    buffer_load_dwordx4 v3, s[80:83], s61 offen  lds
    s_add_u32 m0, s72, 4096
    s_mov_b32 s61, 262144
    buffer_load_dwordx4 v3, s[80:83], s61 offen  lds
    s_add_u32 m0, s72, 5120
    s_mov_b32 s61, 294912
    buffer_load_dwordx4 v3, s[80:83], s61 offen  lds
    s_add_u32 m0, s72, 6144
    s_mov_b32 s61, 1310720
    buffer_load_dwordx4 v3, s[80:83], s61 offen  lds
    s_add_u32 m0, s72, 7168
    s_mov_b32 s61, 1343488
    buffer_load_dwordx4 v3, s[80:83], s61 offen  lds
    ds_read_b64_tr_b16 a[16:17], v5 offset:8192
    ds_read_b64_tr_b16 a[18:19], v5 offset:8704
    ds_read_b64_tr_b16 a[20:21], v5 offset:10240
    ds_read_b64_tr_b16 a[22:23], v5 offset:10752
    ds_read_b64_tr_b16 a[24:25], v5 offset:8256
    ds_read_b64_tr_b16 a[26:27], v5 offset:8768
    ds_read_b64_tr_b16 a[28:29], v5 offset:10304
    ds_read_b64_tr_b16 a[30:31], v5 offset:10816
    s_waitcnt lgkmcnt(0)
    ds_read_b64_tr_b16 a[48:49], v5 offset:8320
    ds_read_b64_tr_b16 a[50:51], v5 offset:8832
    ds_read_b64_tr_b16 a[52:53], v5 offset:10368
    ds_read_b64_tr_b16 a[54:55], v5 offset:10880
    ds_read_b64_tr_b16 a[56:57], v5 offset:8384
    ds_read_b64_tr_b16 a[58:59], v5 offset:8896
    ds_read_b64_tr_b16 a[60:61], v5 offset:10432
    ds_read_b64_tr_b16 a[62:63], v5 offset:10944
    s_waitcnt lgkmcnt(0)
    s_add_u32 m0, s72, 8192
    s_mov_b32 s61, 393216
    buffer_load_dwordx4 v3, s[80:83], s61 offen  lds
    s_add_u32 m0, s72, 9216
    s_mov_b32 s61, 425984
    buffer_load_dwordx4 v3, s[80:83], s61 offen  lds
    s_add_u32 m0, s72, 10240
    s_mov_b32 s61, 1441792
    buffer_load_dwordx4 v3, s[80:83], s61 offen  lds
    s_add_u32 m0, s72, 11264
    s_mov_b32 s61, 1474560
    buffer_load_dwordx4 v3, s[80:83], s61 offen  lds
    s_waitcnt vmcnt(24)
    ds_read_b64_tr_b16 v[144:145], v5 offset:16384
    ds_read_b64_tr_b16 v[146:147], v5 offset:16896
    ds_read_b64_tr_b16 v[148:149], v5 offset:18432
    ds_read_b64_tr_b16 v[150:151], v5 offset:18944
    ds_read_b64_tr_b16 v[168:169], v5 offset:16448
    ds_read_b64_tr_b16 v[170:171], v5 offset:16960
    ds_read_b64_tr_b16 v[172:173], v5 offset:18496
    ds_read_b64_tr_b16 v[174:175], v5 offset:19008
    s_waitcnt lgkmcnt(0)
    ds_read_b64_tr_b16 v[192:193], v5 offset:16512
    ds_read_b64_tr_b16 v[194:195], v5 offset:17024
    ds_read_b64_tr_b16 v[196:197], v5 offset:18560
    ds_read_b64_tr_b16 v[198:199], v5 offset:19072
    ds_read_b64_tr_b16 a[88:89], v5 offset:16576
    ds_read_b64_tr_b16 a[90:91], v5 offset:17088
    ds_read_b64_tr_b16 a[92:93], v5 offset:18624
    ds_read_b64_tr_b16 a[94:95], v5 offset:19136
    s_waitcnt lgkmcnt(0)
    s_waitcnt vmcnt(16)
    ds_read_b64_tr_b16 v[136:137], v5 offset:24576
    ds_read_b64_tr_b16 v[138:139], v5 offset:25088
    ds_read_b64_tr_b16 v[140:141], v5 offset:26624
    ds_read_b64_tr_b16 v[142:143], v5 offset:27136
    ds_read_b64_tr_b16 v[160:161], v5 offset:24640
    ds_read_b64_tr_b16 v[162:163], v5 offset:25152
    ds_read_b64_tr_b16 v[164:165], v5 offset:26688
    ds_read_b64_tr_b16 v[166:167], v5 offset:27200
    s_waitcnt lgkmcnt(0)
    ds_read_b64_tr_b16 v[184:185], v5 offset:24704
    ds_read_b64_tr_b16 v[186:187], v5 offset:25216
    ds_read_b64_tr_b16 v[188:189], v5 offset:26752
    ds_read_b64_tr_b16 v[190:191], v5 offset:27264
    ds_read_b64_tr_b16 a[80:81], v5 offset:24768
    ds_read_b64_tr_b16 a[82:83], v5 offset:25280
    ds_read_b64_tr_b16 a[84:85], v5 offset:26816
    ds_read_b64_tr_b16 a[86:87], v5 offset:27328
    s_waitcnt lgkmcnt(0)
    v_add_u32 v4, 36864, v6
    v_add_u32 v5, 36864, v7
    s_waitcnt vmcnt(12)
    s_barrier
    ds_read_b64_tr_b16 v[24:25], v6 offset:32768
    ds_read_b64_tr_b16 v[26:27], v4 offset:32768
    ds_read_b64_tr_b16 v[28:29], v7 offset:32768
    ds_read_b64_tr_b16 v[30:31], v5 offset:32768
    ds_read_b64_tr_b16 v[32:33], v6 offset:32800
    ds_read_b64_tr_b16 v[34:35], v4 offset:32800
    ds_read_b64_tr_b16 v[36:37], v7 offset:32800
    ds_read_b64_tr_b16 v[38:39], v5 offset:32800
    ds_write_b128 v118, a[48:51] offset:28672
    ds_write_b128 v118, a[52:55] offset:29696
    ds_write_b128 v118, a[56:59] offset:30720
    ds_write_b128 v118, a[60:63] offset:31744
    s_add_u32 m0, s72, 20480
    s_mov_b32 s61, 524288
    buffer_load_dwordx4 v3, s[80:83], s61 offen  lds
    s_add_u32 m0, s72, 21504
    s_mov_b32 s61, 557056
    buffer_load_dwordx4 v3, s[80:83], s61 offen  lds
    s_add_u32 m0, s72, 22528
    s_mov_b32 s61, 1572864
    buffer_load_dwordx4 v3, s[80:83], s61 offen  lds
    s_add_u32 m0, s72, 23552
    s_mov_b32 s61, 1605632
    buffer_load_dwordx4 v3, s[80:83], s61 offen  lds
    s_waitcnt lgkmcnt(0)
    s_waitcnt vmcnt(12)
    s_barrier
    ds_read_b64_tr_b16 v[8:9], v6 offset:0
    ds_read_b64_tr_b16 v[10:11], v4 offset:0
    ds_read_b64_tr_b16 v[12:13], v7 offset:0
    ds_read_b64_tr_b16 v[14:15], v5 offset:0
    ds_read_b64_tr_b16 v[16:17], v6 offset:32
    ds_read_b64_tr_b16 v[18:19], v4 offset:32
    ds_read_b64_tr_b16 v[20:21], v7 offset:32
    ds_read_b64_tr_b16 v[22:23], v5 offset:32
    ds_write_b128 v118, a[80:83] offset:32768
    ds_write_b128 v118, a[84:87] offset:33792
    ds_write_b128 v118, a[88:91] offset:34816
    ds_write_b128 v118, a[92:95] offset:35840
    s_add_u32 m0, s72, 16384
    s_mov_b32 s61, 655360
    buffer_load_dwordx4 v3, s[80:83], s61 offen  lds
    s_add_u32 m0, s72, 17408
    s_mov_b32 s61, 688128
    buffer_load_dwordx4 v3, s[80:83], s61 offen  lds
    s_add_u32 m0, s72, 18432
    s_mov_b32 s61, 1703936
    buffer_load_dwordx4 v3, s[80:83], s61 offen  lds
    s_add_u32 m0, s72, 19456
    s_mov_b32 s61, 1736704
    buffer_load_dwordx4 v3, s[80:83], s61 offen  lds
    s_waitcnt lgkmcnt(0)
    s_waitcnt vmcnt(12)
    s_barrier
    ds_read_b64_tr_b16 v[240:241], v6 offset:4096
    ds_read_b64_tr_b16 v[242:243], v4 offset:4096
    ds_read_b64_tr_b16 v[244:245], v7 offset:4096
    ds_read_b64_tr_b16 v[246:247], v5 offset:4096
    ds_read_b64_tr_b16 v[248:249], v6 offset:4128
    ds_read_b64_tr_b16 v[250:251], v4 offset:4128
    ds_read_b64_tr_b16 v[252:253], v7 offset:4128
    ds_read_b64_tr_b16 v[254:255], v5 offset:4128
    ds_write_b128 v118, a[16:19] offset:24576
    ds_write_b128 v118, a[20:23] offset:25600
    ds_write_b128 v118, a[24:27] offset:26624
    ds_write_b128 v118, a[28:31] offset:27648
    s_add_u32 m0, s72, 12288
    s_mov_b32 s61, 786432
    buffer_load_dwordx4 v3, s[80:83], s61 offen  lds
    s_add_u32 m0, s72, 13312
    s_mov_b32 s61, 819200
    buffer_load_dwordx4 v3, s[80:83], s61 offen  lds
    s_add_u32 m0, s72, 14336
    s_mov_b32 s61, 1835008
    buffer_load_dwordx4 v3, s[80:83], s61 offen  lds
    s_add_u32 m0, s72, 15360
    s_mov_b32 s61, 1867776
    buffer_load_dwordx4 v3, s[80:83], s61 offen  lds
    s_waitcnt lgkmcnt(0)
    s_waitcnt vmcnt(12)
    s_barrier
    ds_read_b64_tr_b16 v[208:209], v6 offset:8192
    ds_read_b64_tr_b16 v[210:211], v4 offset:8192
    ds_read_b64_tr_b16 v[212:213], v7 offset:8192
    ds_read_b64_tr_b16 v[214:215], v5 offset:8192
    ds_read_b64_tr_b16 v[216:217], v6 offset:8224
    ds_read_b64_tr_b16 v[218:219], v4 offset:8224
    ds_read_b64_tr_b16 v[220:221], v7 offset:8224
    ds_read_b64_tr_b16 v[222:223], v5 offset:8224
    s_add_u32 m0, s72, 4096
    s_mov_b32 s61, 917504
    buffer_load_dwordx4 v3, s[80:83], s61 offen  lds
    s_add_u32 m0, s72, 5120
    s_mov_b32 s61, 950272
    buffer_load_dwordx4 v3, s[80:83], s61 offen  lds
    s_add_u32 m0, s72, 6144
    s_mov_b32 s61, 1966080
    buffer_load_dwordx4 v3, s[80:83], s61 offen  lds
    s_add_u32 m0, s72, 7168
    s_mov_b32 s61, 1998848
    buffer_load_dwordx4 v3, s[80:83], s61 offen  lds
    s_waitcnt lgkmcnt(0)
    s_waitcnt vmcnt(12)
    s_barrier
    ds_read_b64_tr_b16 v[56:57], v6 offset:20480
    ds_read_b64_tr_b16 v[58:59], v4 offset:20480
    ds_read_b64_tr_b16 v[60:61], v7 offset:20480
    ds_read_b64_tr_b16 v[62:63], v5 offset:20480
    ds_read_b64_tr_b16 v[64:65], v6 offset:20512
    ds_read_b64_tr_b16 v[66:67], v4 offset:20512
    ds_read_b64_tr_b16 v[68:69], v7 offset:20512
    ds_read_b64_tr_b16 v[70:71], v5 offset:20512
    s_add_u32 m0, s72, 8192
    s_mov_b32 s61, 0
    buffer_load_dwordx4 v3, s[84:87], s61 offen  lds
    s_add_u32 m0, s72, 9216
    s_mov_b32 s61, 32768
    buffer_load_dwordx4 v3, s[84:87], s61 offen  lds
    s_add_u32 m0, s72, 10240
    s_mov_b32 s61, 1048576
    buffer_load_dwordx4 v3, s[84:87], s61 offen  lds
    s_add_u32 m0, s72, 11264
    s_mov_b32 s61, 1081344
    buffer_load_dwordx4 v3, s[84:87], s61 offen  lds
    s_waitcnt lgkmcnt(0)
    s_waitcnt vmcnt(12)
    s_barrier
    ds_read_b64_tr_b16 v[40:41], v6 offset:16384
    ds_read_b64_tr_b16 v[42:43], v4 offset:16384
    ds_read_b64_tr_b16 v[44:45], v7 offset:16384
    ds_read_b64_tr_b16 v[46:47], v5 offset:16384
    ds_read_b64_tr_b16 v[48:49], v6 offset:16416
    ds_read_b64_tr_b16 v[50:51], v4 offset:16416
    ds_read_b64_tr_b16 v[52:53], v7 offset:16416
    ds_read_b64_tr_b16 v[54:55], v5 offset:16416
    s_add_u32 m0, s72, 20480
    s_mov_b32 s61, 131072
    buffer_load_dwordx4 v3, s[84:87], s61 offen  lds
    s_add_u32 m0, s72, 21504
    s_mov_b32 s61, 163840
    buffer_load_dwordx4 v3, s[84:87], s61 offen  lds
    s_add_u32 m0, s72, 22528
    s_mov_b32 s61, 1179648
    buffer_load_dwordx4 v3, s[84:87], s61 offen  lds
    s_add_u32 m0, s72, 23552
    s_mov_b32 s61, 1212416
    buffer_load_dwordx4 v3, s[84:87], s61 offen  lds
    s_waitcnt lgkmcnt(0)
    s_waitcnt vmcnt(12)
    s_barrier
    ds_read_b64_tr_b16 a[224:225], v6 offset:12288
    ds_read_b64_tr_b16 a[226:227], v4 offset:12288
    ds_read_b64_tr_b16 a[228:229], v7 offset:12288
    ds_read_b64_tr_b16 a[230:231], v5 offset:12288
    ds_read_b64_tr_b16 a[232:233], v6 offset:12320
    ds_read_b64_tr_b16 a[234:235], v4 offset:12320
    ds_read_b64_tr_b16 a[236:237], v7 offset:12320
    ds_read_b64_tr_b16 a[238:239], v5 offset:12320
    s_add_u32 m0, s72, 16384
    s_mov_b32 s61, 262144
    buffer_load_dwordx4 v3, s[84:87], s61 offen  lds
    s_add_u32 m0, s72, 17408
    s_mov_b32 s61, 294912
    buffer_load_dwordx4 v3, s[84:87], s61 offen  lds
    s_add_u32 m0, s72, 18432
    s_mov_b32 s61, 1310720
    buffer_load_dwordx4 v3, s[84:87], s61 offen  lds
    s_add_u32 m0, s72, 19456
    s_mov_b32 s61, 1343488
    buffer_load_dwordx4 v3, s[84:87], s61 offen  lds
    s_waitcnt lgkmcnt(0)
    s_waitcnt vmcnt(12)
    s_barrier
    ds_read_b64_tr_b16 v[224:225], v6 offset:4096
    ds_read_b64_tr_b16 v[226:227], v4 offset:4096
    ds_read_b64_tr_b16 v[228:229], v7 offset:4096
    ds_read_b64_tr_b16 v[230:231], v5 offset:4096
    ds_read_b64_tr_b16 v[232:233], v6 offset:4128
    ds_read_b64_tr_b16 v[234:235], v4 offset:4128
    ds_read_b64_tr_b16 v[236:237], v7 offset:4128
    ds_read_b64_tr_b16 v[238:239], v5 offset:4128
    s_add_u32 m0, s72, 12288
    s_mov_b32 s61, 393216
    buffer_load_dwordx4 v3, s[84:87], s61 offen  lds
    s_add_u32 m0, s72, 13312
    s_mov_b32 s61, 425984
    buffer_load_dwordx4 v3, s[84:87], s61 offen  lds
    s_add_u32 m0, s72, 14336
    s_mov_b32 s61, 1441792
    buffer_load_dwordx4 v3, s[84:87], s61 offen  lds
    s_add_u32 m0, s72, 15360
    s_mov_b32 s61, 1474560
    buffer_load_dwordx4 v3, s[84:87], s61 offen  lds
    s_waitcnt lgkmcnt(0)
    s_waitcnt vmcnt(12)
    s_barrier
    ds_read_b64_tr_b16 a[160:161], v6 offset:8192
    ds_read_b64_tr_b16 a[162:163], v4 offset:8192
    ds_read_b64_tr_b16 a[164:165], v7 offset:8192
    ds_read_b64_tr_b16 a[166:167], v5 offset:8192
    ds_read_b64_tr_b16 a[168:169], v6 offset:8224
    ds_read_b64_tr_b16 a[170:171], v4 offset:8224
    ds_read_b64_tr_b16 a[172:173], v7 offset:8224
    ds_read_b64_tr_b16 a[174:175], v5 offset:8224
    ds_write_b128 v118, v[8:11] offset:0
    ds_write_b128 v118, v[12:15] offset:1024
    ds_write_b128 v118, v[16:19] offset:2048
    ds_write_b128 v118, v[20:23] offset:3072
    s_add_u32 m0, s72, 4096
    s_mov_b32 s61, 524288
    buffer_load_dwordx4 v3, s[84:87], s61 offen  lds
    s_add_u32 m0, s72, 5120
    s_mov_b32 s61, 557056
    buffer_load_dwordx4 v3, s[84:87], s61 offen  lds
    s_add_u32 m0, s72, 6144
    s_mov_b32 s61, 1572864
    buffer_load_dwordx4 v3, s[84:87], s61 offen  lds
    s_add_u32 m0, s72, 7168
    s_mov_b32 s61, 1605632
    buffer_load_dwordx4 v3, s[84:87], s61 offen  lds
    s_waitcnt lgkmcnt(0)
    s_waitcnt vmcnt(12)
    s_barrier
    ds_read_b64_tr_b16 a[128:129], v6 offset:20480
    ds_read_b64_tr_b16 a[130:131], v4 offset:20480
    ds_read_b64_tr_b16 a[132:133], v7 offset:20480
    ds_read_b64_tr_b16 a[134:135], v5 offset:20480
    ds_read_b64_tr_b16 a[136:137], v6 offset:20512
    ds_read_b64_tr_b16 a[138:139], v4 offset:20512
    ds_read_b64_tr_b16 a[140:141], v7 offset:20512
    ds_read_b64_tr_b16 a[142:143], v5 offset:20512
    s_add_u32 m0, s72, 8192
    s_mov_b32 s61, 655360
    buffer_load_dwordx4 v3, s[84:87], s61 offen  lds
    s_add_u32 m0, s72, 9216
    s_mov_b32 s61, 688128
    buffer_load_dwordx4 v3, s[84:87], s61 offen  lds
    s_add_u32 m0, s72, 10240
    s_mov_b32 s61, 1703936
    buffer_load_dwordx4 v3, s[84:87], s61 offen  lds
    s_add_u32 m0, s72, 11264
    s_mov_b32 s61, 1736704
    buffer_load_dwordx4 v3, s[84:87], s61 offen  lds
    s_waitcnt lgkmcnt(0)
    s_waitcnt vmcnt(12)
    s_barrier
    ds_read_b64_tr_b16 a[208:209], v6 offset:16384
    ds_read_b64_tr_b16 a[210:211], v4 offset:16384
    ds_read_b64_tr_b16 a[212:213], v7 offset:16384
    ds_read_b64_tr_b16 a[214:215], v5 offset:16384
    ds_read_b64_tr_b16 a[216:217], v6 offset:16416
    ds_read_b64_tr_b16 a[218:219], v4 offset:16416
    ds_read_b64_tr_b16 a[220:221], v7 offset:16416
    ds_read_b64_tr_b16 a[222:223], v5 offset:16416
    s_add_u32 m0, s72, 20480
    s_mov_b32 s61, 786432
    buffer_load_dwordx4 v3, s[84:87], s61 offen  lds
    s_add_u32 m0, s72, 21504
    s_mov_b32 s61, 819200
    buffer_load_dwordx4 v3, s[84:87], s61 offen  lds
    s_add_u32 m0, s72, 22528
    s_mov_b32 s61, 1835008
    buffer_load_dwordx4 v3, s[84:87], s61 offen  lds
    s_add_u32 m0, s72, 23552
    s_mov_b32 s61, 1867776
    buffer_load_dwordx4 v3, s[84:87], s61 offen  lds
    s_waitcnt lgkmcnt(0)
    s_waitcnt vmcnt(12)
    s_barrier
    ds_read_b64_tr_b16 a[192:193], v6 offset:12288
    ds_read_b64_tr_b16 a[194:195], v4 offset:12288
    ds_read_b64_tr_b16 a[196:197], v7 offset:12288
    ds_read_b64_tr_b16 a[198:199], v5 offset:12288
    ds_read_b64_tr_b16 a[200:201], v6 offset:12320
    ds_read_b64_tr_b16 a[202:203], v4 offset:12320
    ds_read_b64_tr_b16 a[204:205], v7 offset:12320
    ds_read_b64_tr_b16 a[206:207], v5 offset:12320
    s_add_u32 m0, s72, 16384
    s_mov_b32 s61, 917504
    buffer_load_dwordx4 v3, s[84:87], s61 offen  lds
    s_add_u32 m0, s72, 17408
    s_mov_b32 s61, 950272
    buffer_load_dwordx4 v3, s[84:87], s61 offen  lds
    s_add_u32 m0, s72, 18432
    s_mov_b32 s61, 1966080
    buffer_load_dwordx4 v3, s[84:87], s61 offen  lds
    s_add_u32 m0, s72, 19456
    s_mov_b32 s61, 1998848
    buffer_load_dwordx4 v3, s[84:87], s61 offen  lds
    s_waitcnt lgkmcnt(0)
    s_waitcnt vmcnt(12)
    s_barrier
    ds_read_b64_tr_b16 a[176:177], v6 offset:4096
    ds_read_b64_tr_b16 a[178:179], v4 offset:4096
    ds_read_b64_tr_b16 a[180:181], v7 offset:4096
    ds_read_b64_tr_b16 a[182:183], v5 offset:4096
    ds_read_b64_tr_b16 a[184:185], v6 offset:4128
    ds_read_b64_tr_b16 a[186:187], v4 offset:4128
    ds_read_b64_tr_b16 a[188:189], v7 offset:4128
    ds_read_b64_tr_b16 a[190:191], v5 offset:4128
    s_add_u32 m0, s72, 12288
    s_mov_b32 s61, 0
    buffer_load_dwordx4 v3, s[76:79], s61 offen  lds
    s_add_u32 m0, s72, 13312
    s_mov_b32 s61, 32768
    buffer_load_dwordx4 v3, s[76:79], s61 offen  lds
    s_add_u32 m0, s72, 14336
    s_mov_b32 s61, 1048576
    buffer_load_dwordx4 v3, s[76:79], s61 offen  lds
    s_add_u32 m0, s72, 15360
    s_mov_b32 s61, 1081344
    buffer_load_dwordx4 v3, s[76:79], s61 offen  lds
    s_waitcnt lgkmcnt(0)
    s_waitcnt vmcnt(12)
    s_barrier
    ds_read_b64_tr_b16 a[144:145], v6 offset:8192
    ds_read_b64_tr_b16 a[146:147], v4 offset:8192
    ds_read_b64_tr_b16 a[148:149], v7 offset:8192
    ds_read_b64_tr_b16 a[150:151], v5 offset:8192
    ds_read_b64_tr_b16 a[152:153], v6 offset:8224
    ds_read_b64_tr_b16 a[154:155], v4 offset:8224
    ds_read_b64_tr_b16 a[156:157], v7 offset:8224
    ds_read_b64_tr_b16 a[158:159], v5 offset:8224
    s_add_u32 m0, s72, 4096
    s_mov_b32 s61, 131072
    buffer_load_dwordx4 v3, s[76:79], s61 offen  lds
    s_add_u32 m0, s72, 5120
    s_mov_b32 s61, 163840
    buffer_load_dwordx4 v3, s[76:79], s61 offen  lds
    s_add_u32 m0, s72, 6144
    s_mov_b32 s61, 1179648
    buffer_load_dwordx4 v3, s[76:79], s61 offen  lds
    s_add_u32 m0, s72, 7168
    s_mov_b32 s61, 1212416
    buffer_load_dwordx4 v3, s[76:79], s61 offen  lds
    s_waitcnt lgkmcnt(0)
    s_waitcnt vmcnt(12)
    s_barrier
    ds_read_b64_tr_b16 v[88:89], v6 offset:20480
    ds_read_b64_tr_b16 v[90:91], v4 offset:20480
    ds_read_b64_tr_b16 v[92:93], v7 offset:20480
    ds_read_b64_tr_b16 v[94:95], v5 offset:20480
    ds_read_b64_tr_b16 v[96:97], v6 offset:20512
    ds_read_b64_tr_b16 v[98:99], v4 offset:20512
    ds_read_b64_tr_b16 v[100:101], v7 offset:20512
    ds_read_b64_tr_b16 v[102:103], v5 offset:20512
    s_add_u32 m0, s72, 8192
    s_mov_b32 s61, 262144
    buffer_load_dwordx4 v3, s[76:79], s61 offen  lds
    s_add_u32 m0, s72, 9216
    s_mov_b32 s61, 294912
    buffer_load_dwordx4 v3, s[76:79], s61 offen  lds
    s_add_u32 m0, s72, 10240
    s_mov_b32 s61, 1310720
    buffer_load_dwordx4 v3, s[76:79], s61 offen  lds
    s_add_u32 m0, s72, 11264
    s_mov_b32 s61, 1343488
    buffer_load_dwordx4 v3, s[76:79], s61 offen  lds
    global_store_dword v113, v123, s[36:37] sc1
    v_mbcnt_lo_u32_b32 v1, -1, 0
    v_and_b32 v1, 15, v1
    v_lshlrev_b32 v1, 4, v1
    global_load_dword v2, v1, s[18:19] sc1
    s_waitcnt lgkmcnt(0)
    s_waitcnt vmcnt(14)
    s_barrier
    ds_read_b64_tr_b16 v[72:73], v6 offset:16384
    ds_read_b64_tr_b16 v[74:75], v4 offset:16384
    ds_read_b64_tr_b16 v[76:77], v7 offset:16384
    ds_read_b64_tr_b16 v[78:79], v5 offset:16384
    ds_read_b64_tr_b16 v[80:81], v6 offset:16416
    ds_read_b64_tr_b16 v[82:83], v4 offset:16416
    ds_read_b64_tr_b16 v[84:85], v7 offset:16416
    ds_read_b64_tr_b16 v[86:87], v5 offset:16416
    s_add_u32 m0, s72, 20480
    s_mov_b32 s61, 393216
    buffer_load_dwordx4 v3, s[76:79], s61 offen  lds
    s_add_u32 m0, s72, 21504
    s_mov_b32 s61, 425984
    buffer_load_dwordx4 v3, s[76:79], s61 offen  lds
    s_add_u32 m0, s72, 22528
    s_mov_b32 s61, 1441792
    buffer_load_dwordx4 v3, s[76:79], s61 offen  lds
    s_add_u32 m0, s72, 23552
    s_mov_b32 s61, 1474560
    buffer_load_dwordx4 v3, s[76:79], s61 offen  lds
    s_waitcnt lgkmcnt(0)
    s_waitcnt vmcnt(14)
    s_barrier
    ds_read_b64_tr_b16 a[32:33], v6 offset:12288
    ds_read_b64_tr_b16 a[34:35], v4 offset:12288
    ds_read_b64_tr_b16 a[36:37], v7 offset:12288
    ds_read_b64_tr_b16 a[38:39], v5 offset:12288
    ds_read_b64_tr_b16 a[40:41], v6 offset:12320
    ds_read_b64_tr_b16 a[42:43], v4 offset:12320
    ds_read_b64_tr_b16 a[44:45], v7 offset:12320
    ds_read_b64_tr_b16 a[46:47], v5 offset:12320
    s_add_u32 m0, s72, 16384
    s_mov_b32 s61, 524288
    buffer_load_dwordx4 v3, s[76:79], s61 offen  lds
    s_add_u32 m0, s72, 17408
    s_mov_b32 s61, 557056
    buffer_load_dwordx4 v3, s[76:79], s61 offen  lds
    s_add_u32 m0, s72, 18432
    s_mov_b32 s61, 1572864
    buffer_load_dwordx4 v3, s[76:79], s61 offen  lds
    s_add_u32 m0, s72, 19456
    s_mov_b32 s61, 1605632
    buffer_load_dwordx4 v3, s[76:79], s61 offen  lds
    s_waitcnt lgkmcnt(0)
    s_waitcnt vmcnt(14)
    s_barrier
    ds_read_b64_tr_b16 a[0:1], v6 offset:4096
    ds_read_b64_tr_b16 a[2:3], v4 offset:4096
    ds_read_b64_tr_b16 a[4:5], v7 offset:4096
    ds_read_b64_tr_b16 a[6:7], v5 offset:4096
    ds_read_b64_tr_b16 a[8:9], v6 offset:4128
    ds_read_b64_tr_b16 a[10:11], v4 offset:4128
    ds_read_b64_tr_b16 a[12:13], v7 offset:4128
    ds_read_b64_tr_b16 a[14:15], v5 offset:4128
    s_add_u32 m0, s72, 12288
    s_mov_b32 s61, 655360
    buffer_load_dwordx4 v3, s[76:79], s61 offen  lds
    s_add_u32 m0, s72, 13312
    s_mov_b32 s61, 688128
    buffer_load_dwordx4 v3, s[76:79], s61 offen  lds
    s_add_u32 m0, s72, 14336
    s_mov_b32 s61, 1703936
    buffer_load_dwordx4 v3, s[76:79], s61 offen  lds
    s_add_u32 m0, s72, 15360
    s_mov_b32 s61, 1736704
    buffer_load_dwordx4 v3, s[76:79], s61 offen  lds
    s_waitcnt lgkmcnt(0)
    s_waitcnt vmcnt(14)
    s_barrier
    ds_read_b64_tr_b16 a[96:97], v6 offset:8192
    ds_read_b64_tr_b16 a[98:99], v4 offset:8192
    ds_read_b64_tr_b16 a[100:101], v7 offset:8192
    ds_read_b64_tr_b16 a[102:103], v5 offset:8192
    ds_read_b64_tr_b16 a[104:105], v6 offset:8224
    ds_read_b64_tr_b16 a[106:107], v4 offset:8224
    ds_read_b64_tr_b16 a[108:109], v7 offset:8224
    ds_read_b64_tr_b16 a[110:111], v5 offset:8224
    s_add_u32 m0, s72, 4096
    s_mov_b32 s61, 786432
    buffer_load_dwordx4 v3, s[76:79], s61 offen  lds
    s_add_u32 m0, s72, 5120
    s_mov_b32 s61, 819200
    buffer_load_dwordx4 v3, s[76:79], s61 offen  lds
    s_add_u32 m0, s72, 6144
    s_mov_b32 s61, 1835008
    buffer_load_dwordx4 v3, s[76:79], s61 offen  lds
    s_add_u32 m0, s72, 7168
    s_mov_b32 s61, 1867776
    buffer_load_dwordx4 v3, s[76:79], s61 offen  lds
    s_waitcnt lgkmcnt(0)
    s_waitcnt vmcnt(12)
    s_barrier
    ds_read_b64_tr_b16 a[64:65], v6 offset:20480
    ds_read_b64_tr_b16 a[66:67], v4 offset:20480
    ds_read_b64_tr_b16 a[68:69], v7 offset:20480
    ds_read_b64_tr_b16 a[70:71], v5 offset:20480
    ds_read_b64_tr_b16 a[72:73], v6 offset:20512
    ds_read_b64_tr_b16 a[74:75], v4 offset:20512
    ds_read_b64_tr_b16 a[76:77], v7 offset:20512
    ds_read_b64_tr_b16 a[78:79], v5 offset:20512
    s_add_u32 m0, s72, 8192
    s_mov_b32 s61, 917504
    buffer_load_dwordx4 v3, s[76:79], s61 offen  lds
    s_add_u32 m0, s72, 9216
    s_mov_b32 s61, 950272
    buffer_load_dwordx4 v3, s[76:79], s61 offen  lds
    s_add_u32 m0, s72, 10240
    s_mov_b32 s61, 1966080
    buffer_load_dwordx4 v3, s[76:79], s61 offen  lds
    s_add_u32 m0, s72, 11264
    s_mov_b32 s61, 1998848
    buffer_load_dwordx4 v3, s[76:79], s61 offen  lds
    s_waitcnt lgkmcnt(0)
    s_waitcnt vmcnt(12)
    s_barrier
    ds_read_b64_tr_b16 a[48:49], v6 offset:16384
    ds_read_b64_tr_b16 a[50:51], v4 offset:16384
    ds_read_b64_tr_b16 a[52:53], v7 offset:16384
    ds_read_b64_tr_b16 a[54:55], v5 offset:16384
    ds_read_b64_tr_b16 a[56:57], v6 offset:16416
    ds_read_b64_tr_b16 a[58:59], v4 offset:16416
    ds_read_b64_tr_b16 a[60:61], v7 offset:16416
    ds_read_b64_tr_b16 a[62:63], v5 offset:16416
    ds_write_b128 v118, v[88:91] offset:20480
    ds_write_b128 v118, v[92:95] offset:21504
    ds_write_b128 v118, v[96:99] offset:22528
    ds_write_b128 v118, v[100:103] offset:23552
    global_load_dword v123, v122, s[96:97] sc1
    s_waitcnt lgkmcnt(0)
    s_waitcnt vmcnt(9)
    s_barrier
    ds_read_b64_tr_b16 a[16:17], v6 offset:12288
    ds_read_b64_tr_b16 a[18:19], v4 offset:12288
    ds_read_b64_tr_b16 a[20:21], v7 offset:12288
    ds_read_b64_tr_b16 a[22:23], v5 offset:12288
    ds_read_b64_tr_b16 a[24:25], v6 offset:12320
    ds_read_b64_tr_b16 a[26:27], v4 offset:12320
    ds_read_b64_tr_b16 a[28:29], v7 offset:12320
    ds_read_b64_tr_b16 a[30:31], v5 offset:12320
    ds_write_b128 v118, v[72:75] offset:16384
    ds_write_b128 v118, v[76:79] offset:17408
    ds_write_b128 v118, v[80:83] offset:18432
    ds_write_b128 v118, v[84:87] offset:19456
    s_waitcnt lgkmcnt(0)
    s_waitcnt vmcnt(5)
    s_barrier
    ds_read_b64_tr_b16 a[112:113], v6 offset:4096
    ds_read_b64_tr_b16 a[114:115], v4 offset:4096
    ds_read_b64_tr_b16 a[116:117], v7 offset:4096
    ds_read_b64_tr_b16 a[118:119], v5 offset:4096
    ds_read_b64_tr_b16 a[120:121], v6 offset:4128
    ds_read_b64_tr_b16 a[122:123], v4 offset:4128
    ds_read_b64_tr_b16 a[124:125], v7 offset:4128
    ds_read_b64_tr_b16 a[126:127], v5 offset:4128
    ds_write_b128 v118, v[56:59] offset:12288
    ds_write_b128 v118, v[60:63] offset:13312
    ds_write_b128 v118, v[64:67] offset:14336
    ds_write_b128 v118, v[68:71] offset:15360
    s_waitcnt lgkmcnt(0)
    s_waitcnt vmcnt(1)
    s_barrier
    ds_read_b64_tr_b16 a[80:81], v6 offset:8192
    ds_read_b64_tr_b16 a[82:83], v4 offset:8192
    ds_read_b64_tr_b16 a[84:85], v7 offset:8192
    ds_read_b64_tr_b16 a[86:87], v5 offset:8192
    ds_read_b64_tr_b16 a[88:89], v6 offset:8224
    ds_read_b64_tr_b16 a[90:91], v4 offset:8224
    ds_read_b64_tr_b16 a[92:93], v7 offset:8224
    ds_read_b64_tr_b16 a[94:95], v5 offset:8224
    ds_write_b128 v118, v[24:27] offset:4096
    ds_write_b128 v118, v[28:31] offset:5120
    ds_write_b128 v118, v[32:35] offset:6144
    ds_write_b128 v118, v[36:39] offset:7168
    s_waitcnt vmcnt(0)
    global_load_dwordx4 a[240:243], v105, s[42:43] offset:0 sc1
    global_load_dwordx4 a[244:247], v105, s[42:43] offset:1024 sc1
    global_load_dwordx4 a[248:251], v105, s[42:43] offset:2048 sc1
    global_load_dwordx4 a[252:255], v105, s[42:43] offset:3072 sc1
    s_waitcnt lgkmcnt(0)
    s_barrier
    ds_write_b128 v118, v[40:43] offset:8192
    ds_write_b128 v118, v[44:47] offset:9216
    ds_write_b128 v118, v[48:51] offset:10240
    ds_write_b128 v118, v[52:55] offset:11264
    s_branch L_cs_wdone
L_cs_wv2:
    s_cmp_eq_u32 s67, 2
    s_cbranch_scc0 L_cs_wv3
    ds_read_b64_tr_b16 v[136:137], v5 offset:0
    ds_read_b64_tr_b16 v[138:139], v5 offset:512
    ds_read_b64_tr_b16 v[140:141], v5 offset:2048
    ds_read_b64_tr_b16 v[142:143], v5 offset:2560
    ds_read_b64_tr_b16 v[160:161], v5 offset:64
    ds_read_b64_tr_b16 v[162:163], v5 offset:576
    ds_read_b64_tr_b16 v[164:165], v5 offset:2112
    ds_read_b64_tr_b16 v[166:167], v5 offset:2624
    s_waitcnt lgkmcnt(0)
    ds_read_b64_tr_b16 v[184:185], v5 offset:128
    ds_read_b64_tr_b16 v[186:187], v5 offset:640
    ds_read_b64_tr_b16 v[188:189], v5 offset:2176
    ds_read_b64_tr_b16 v[190:191], v5 offset:2688
    ds_read_b64_tr_b16 a[80:81], v5 offset:192
    ds_read_b64_tr_b16 a[82:83], v5 offset:704
    ds_read_b64_tr_b16 a[84:85], v5 offset:2240
    ds_read_b64_tr_b16 a[86:87], v5 offset:2752
    s_waitcnt lgkmcnt(0)
    s_add_u32 m0, s72, 0
    s_mov_b32 s61, 131072
    buffer_load_dwordx4 v3, s[80:83], s61 offen  lds
    s_add_u32 m0, s72, 1024
    s_mov_b32 s61, 163840
    buffer_load_dwordx4 v3, s[80:83], s61 offen  lds
    s_add_u32 m0, s72, 2048
    s_mov_b32 s61, 1179648
    buffer_load_dwordx4 v3, s[80:83], s61 offen  lds
    s_add_u32 m0, s72, 3072
    s_mov_b32 s61, 1212416
    buffer_load_dwordx4 v3, s[80:83], s61 offen  lds
    s_add_u32 m0, s72, 4096
    s_mov_b32 s61, 262144
    buffer_load_dwordx4 v3, s[80:83], s61 offen  lds
    s_add_u32 m0, s72, 5120
    s_mov_b32 s61, 294912
    buffer_load_dwordx4 v3, s[80:83], s61 offen  lds
    s_add_u32 m0, s72, 6144
    s_mov_b32 s61, 1310720
    buffer_load_dwordx4 v3, s[80:83], s61 offen  lds
    s_add_u32 m0, s72, 7168
    s_mov_b32 s61, 1343488
    buffer_load_dwordx4 v3, s[80:83], s61 offen  lds
    ds_read_b64_tr_b16 v[144:145], v5 offset:8192
    ds_read_b64_tr_b16 v[146:147], v5 offset:8704
    ds_read_b64_tr_b16 v[148:149], v5 offset:10240
    ds_read_b64_tr_b16 v[150:151], v5 offset:10752
    ds_read_b64_tr_b16 v[168:169], v5 offset:8256
    ds_read_b64_tr_b16 v[170:171], v5 offset:8768
    ds_read_b64_tr_b16 v[172:173], v5 offset:10304
    ds_read_b64_tr_b16 v[174:175], v5 offset:10816
    s_waitcnt lgkmcnt(0)
    ds_read_b64_tr_b16 v[192:193], v5 offset:8320
    ds_read_b64_tr_b16 v[194:195], v5 offset:8832
    ds_read_b64_tr_b16 v[196:197], v5 offset:10368
    ds_read_b64_tr_b16 v[198:199], v5 offset:10880
    ds_read_b64_tr_b16 a[88:89], v5 offset:8384
    ds_read_b64_tr_b16 a[90:91], v5 offset:8896
    ds_read_b64_tr_b16 a[92:93], v5 offset:10432
    ds_read_b64_tr_b16 a[94:95], v5 offset:10944
    s_waitcnt lgkmcnt(0)
    s_add_u32 m0, s72, 8192
    s_mov_b32 s61, 393216
    buffer_load_dwordx4 v3, s[80:83], s61 offen  lds
    s_add_u32 m0, s72, 9216
    s_mov_b32 s61, 425984
    buffer_load_dwordx4 v3, s[80:83], s61 offen  lds
    s_add_u32 m0, s72, 10240
    s_mov_b32 s61, 1441792
    buffer_load_dwordx4 v3, s[80:83], s61 offen  lds
    s_add_u32 m0, s72, 11264
    s_mov_b32 s61, 1474560
    buffer_load_dwordx4 v3, s[80:83], s61 offen  lds
    s_waitcnt vmcnt(24)
    ds_read_b64_tr_b16 a[16:17], v5 offset:16384
    ds_read_b64_tr_b16 a[18:19], v5 offset:16896
    ds_read_b64_tr_b16 a[20:21], v5 offset:18432
    ds_read_b64_tr_b16 a[22:23], v5 offset:18944
    ds_read_b64_tr_b16 a[24:25], v5 offset:16448
    ds_read_b64_tr_b16 a[26:27], v5 offset:16960
    ds_read_b64_tr_b16 a[28:29], v5 offset:18496
    ds_read_b64_tr_b16 a[30:31], v5 offset:19008
    s_waitcnt lgkmcnt(0)
    ds_read_b64_tr_b16 a[48:49], v5 offset:16512
    ds_read_b64_tr_b16 a[50:51], v5 offset:17024
    ds_read_b64_tr_b16 a[52:53], v5 offset:18560
    ds_read_b64_tr_b16 a[54:55], v5 offset:19072
    ds_read_b64_tr_b16 a[56:57], v5 offset:16576
    ds_read_b64_tr_b16 a[58:59], v5 offset:17088
    ds_read_b64_tr_b16 a[60:61], v5 offset:18624
    ds_read_b64_tr_b16 a[62:63], v5 offset:19136
    s_waitcnt lgkmcnt(0)
    s_waitcnt vmcnt(16)
    ds_read_b64_tr_b16 v[128:129], v5 offset:24576
    ds_read_b64_tr_b16 v[130:131], v5 offset:25088
    ds_read_b64_tr_b16 v[132:133], v5 offset:26624
    ds_read_b64_tr_b16 v[134:135], v5 offset:27136
    ds_read_b64_tr_b16 v[152:153], v5 offset:24640
    ds_read_b64_tr_b16 v[154:155], v5 offset:25152
    ds_read_b64_tr_b16 v[156:157], v5 offset:26688
    ds_read_b64_tr_b16 v[158:159], v5 offset:27200
    s_waitcnt lgkmcnt(0)
    ds_read_b64_tr_b16 v[176:177], v5 offset:24704
    ds_read_b64_tr_b16 v[178:179], v5 offset:25216
    ds_read_b64_tr_b16 v[180:181], v5 offset:26752
    ds_read_b64_tr_b16 v[182:183], v5 offset:27264
    ds_read_b64_tr_b16 v[200:201], v5 offset:24768
    ds_read_b64_tr_b16 v[202:203], v5 offset:25280
    ds_read_b64_tr_b16 v[204:205], v5 offset:26816
    ds_read_b64_tr_b16 v[206:207], v5 offset:27328
    s_waitcnt lgkmcnt(0)
    v_add_u32 v4, 36864, v6
    v_add_u32 v5, 36864, v7
    s_waitcnt vmcnt(12)
    s_barrier
    ds_read_b64_tr_b16 v[208:209], v6 offset:32768
    ds_read_b64_tr_b16 v[210:211], v4 offset:32768
    ds_read_b64_tr_b16 v[212:213], v7 offset:32768
    ds_read_b64_tr_b16 v[214:215], v5 offset:32768
    ds_read_b64_tr_b16 v[216:217], v6 offset:32800
    ds_read_b64_tr_b16 v[218:219], v4 offset:32800
    ds_read_b64_tr_b16 v[220:221], v7 offset:32800
    ds_read_b64_tr_b16 v[222:223], v5 offset:32800
    ds_write_b128 v118, a[48:51] offset:28672
    ds_write_b128 v118, a[52:55] offset:29696
    ds_write_b128 v118, a[56:59] offset:30720
    ds_write_b128 v118, a[60:63] offset:31744
    s_add_u32 m0, s72, 20480
    s_mov_b32 s61, 524288
    buffer_load_dwordx4 v3, s[80:83], s61 offen  lds
    s_add_u32 m0, s72, 21504
    s_mov_b32 s61, 557056
    buffer_load_dwordx4 v3, s[80:83], s61 offen  lds
    s_add_u32 m0, s72, 22528
    s_mov_b32 s61, 1572864
    buffer_load_dwordx4 v3, s[80:83], s61 offen  lds
    s_add_u32 m0, s72, 23552
    s_mov_b32 s61, 1605632
    buffer_load_dwordx4 v3, s[80:83], s61 offen  lds
    s_waitcnt lgkmcnt(0)
    s_waitcnt vmcnt(12)
    s_barrier
    ds_read_b64_tr_b16 v[240:241], v6 offset:0
    ds_read_b64_tr_b16 v[242:243], v4 offset:0
    ds_read_b64_tr_b16 v[244:245], v7 offset:0
    ds_read_b64_tr_b16 v[246:247], v5 offset:0
    ds_read_b64_tr_b16 v[248:249], v6 offset:32
    ds_read_b64_tr_b16 v[250:251], v4 offset:32
    ds_read_b64_tr_b16 v[252:253], v7 offset:32
    ds_read_b64_tr_b16 v[254:255], v5 offset:32
    ds_write_b128 v118, a[80:83] offset:32768
    ds_write_b128 v118, a[84:87] offset:33792
    ds_write_b128 v118, a[88:91] offset:34816
    ds_write_b128 v118, a[92:95] offset:35840
    s_add_u32 m0, s72, 16384
    s_mov_b32 s61, 655360
    buffer_load_dwordx4 v3, s[80:83], s61 offen  lds
    s_add_u32 m0, s72, 17408
    s_mov_b32 s61, 688128
    buffer_load_dwordx4 v3, s[80:83], s61 offen  lds
    s_add_u32 m0, s72, 18432
    s_mov_b32 s61, 1703936
    buffer_load_dwordx4 v3, s[80:83], s61 offen  lds
    s_add_u32 m0, s72, 19456
    s_mov_b32 s61, 1736704
    buffer_load_dwordx4 v3, s[80:83], s61 offen  lds
    s_waitcnt lgkmcnt(0)
    s_waitcnt vmcnt(12)
    s_barrier
    ds_read_b64_tr_b16 v[8:9], v6 offset:4096
    ds_read_b64_tr_b16 v[10:11], v4 offset:4096
    ds_read_b64_tr_b16 v[12:13], v7 offset:4096
    ds_read_b64_tr_b16 v[14:15], v5 offset:4096
    ds_read_b64_tr_b16 v[16:17], v6 offset:4128
    ds_read_b64_tr_b16 v[18:19], v4 offset:4128
    ds_read_b64_tr_b16 v[20:21], v7 offset:4128
    ds_read_b64_tr_b16 v[22:23], v5 offset:4128
    ds_write_b128 v118, a[16:19] offset:24576
    ds_write_b128 v118, a[20:23] offset:25600
    ds_write_b128 v118, a[24:27] offset:26624
    ds_write_b128 v118, a[28:31] offset:27648
    s_add_u32 m0, s72, 12288
    s_mov_b32 s61, 786432
    buffer_load_dwordx4 v3, s[80:83], s61 offen  lds
    s_add_u32 m0, s72, 13312
    s_mov_b32 s61, 819200
    buffer_load_dwordx4 v3, s[80:83], s61 offen  lds
    s_add_u32 m0, s72, 14336
    s_mov_b32 s61, 1835008
    buffer_load_dwordx4 v3, s[80:83], s61 offen  lds
    s_add_u32 m0, s72, 15360
    s_mov_b32 s61, 1867776
    buffer_load_dwordx4 v3, s[80:83], s61 offen  lds
    s_waitcnt lgkmcnt(0)
    s_waitcnt vmcnt(12)
    s_barrier
    ds_read_b64_tr_b16 v[24:25], v6 offset:8192
    ds_read_b64_tr_b16 v[26:27], v4 offset:8192
    ds_read_b64_tr_b16 v[28:29], v7 offset:8192
    ds_read_b64_tr_b16 v[30:31], v5 offset:8192
    ds_read_b64_tr_b16 v[32:33], v6 offset:8224
    ds_read_b64_tr_b16 v[34:35], v4 offset:8224
    ds_read_b64_tr_b16 v[36:37], v7 offset:8224
    ds_read_b64_tr_b16 v[38:39], v5 offset:8224
    s_add_u32 m0, s72, 4096
    s_mov_b32 s61, 917504
    buffer_load_dwordx4 v3, s[80:83], s61 offen  lds
    s_add_u32 m0, s72, 5120
    s_mov_b32 s61, 950272
    buffer_load_dwordx4 v3, s[80:83], s61 offen  lds
    s_add_u32 m0, s72, 6144
    s_mov_b32 s61, 1966080
    buffer_load_dwordx4 v3, s[80:83], s61 offen  lds
    s_add_u32 m0, s72, 7168
    s_mov_b32 s61, 1998848
    buffer_load_dwordx4 v3, s[80:83], s61 offen  lds
    s_waitcnt lgkmcnt(0)
    s_waitcnt vmcnt(12)
    s_barrier
    ds_read_b64_tr_b16 v[224:225], v6 offset:20480
    ds_read_b64_tr_b16 v[226:227], v4 offset:20480
    ds_read_b64_tr_b16 v[228:229], v7 offset:20480
    ds_read_b64_tr_b16 v[230:231], v5 offset:20480
    ds_read_b64_tr_b16 v[232:233], v6 offset:20512
    ds_read_b64_tr_b16 v[234:235], v4 offset:20512
    ds_read_b64_tr_b16 v[236:237], v7 offset:20512
    ds_read_b64_tr_b16 v[238:239], v5 offset:20512
    s_add_u32 m0, s72, 8192
    s_mov_b32 s61, 0
    buffer_load_dwordx4 v3, s[84:87], s61 offen  lds
    s_add_u32 m0, s72, 9216
    s_mov_b32 s61, 32768
    buffer_load_dwordx4 v3, s[84:87], s61 offen  lds
    s_add_u32 m0, s72, 10240
    s_mov_b32 s61, 1048576
    buffer_load_dwordx4 v3, s[84:87], s61 offen  lds
    s_add_u32 m0, s72, 11264
    s_mov_b32 s61, 1081344
    buffer_load_dwordx4 v3, s[84:87], s61 offen  lds
    s_waitcnt lgkmcnt(0)
    s_waitcnt vmcnt(12)
    s_barrier
    ds_read_b64_tr_b16 a[224:225], v6 offset:16384
    ds_read_b64_tr_b16 a[226:227], v4 offset:16384
    ds_read_b64_tr_b16 a[228:229], v7 offset:16384
    ds_read_b64_tr_b16 a[230:231], v5 offset:16384
    ds_read_b64_tr_b16 a[232:233], v6 offset:16416
    ds_read_b64_tr_b16 a[234:235], v4 offset:16416
    ds_read_b64_tr_b16 a[236:237], v7 offset:16416
    ds_read_b64_tr_b16 a[238:239], v5 offset:16416
    s_add_u32 m0, s72, 20480
    s_mov_b32 s61, 131072
    buffer_load_dwordx4 v3, s[84:87], s61 offen  lds
    s_add_u32 m0, s72, 21504
    s_mov_b32 s61, 163840
    buffer_load_dwordx4 v3, s[84:87], s61 offen  lds
    s_add_u32 m0, s72, 22528
    s_mov_b32 s61, 1179648
    buffer_load_dwordx4 v3, s[84:87], s61 offen  lds
    s_add_u32 m0, s72, 23552
    s_mov_b32 s61, 1212416
    buffer_load_dwordx4 v3, s[84:87], s61 offen  lds
    s_waitcnt lgkmcnt(0)
    s_waitcnt vmcnt(12)
    s_barrier
    ds_read_b64_tr_b16 v[40:41], v6 offset:12288
    ds_read_b64_tr_b16 v[42:43], v4 offset:12288
    ds_read_b64_tr_b16 v[44:45], v7 offset:12288
    ds_read_b64_tr_b16 v[46:47], v5 offset:12288
    ds_read_b64_tr_b16 v[48:49], v6 offset:12320
    ds_read_b64_tr_b16 v[50:51], v4 offset:12320
    ds_read_b64_tr_b16 v[52:53], v7 offset:12320
    ds_read_b64_tr_b16 v[54:55], v5 offset:12320
    s_add_u32 m0, s72, 16384
    s_mov_b32 s61, 262144
    buffer_load_dwordx4 v3, s[84:87], s61 offen  lds
    s_add_u32 m0, s72, 17408
    s_mov_b32 s61, 294912
    buffer_load_dwordx4 v3, s[84:87], s61 offen  lds
    s_add_u32 m0, s72, 18432
    s_mov_b32 s61, 1310720
    buffer_load_dwordx4 v3, s[84:87], s61 offen  lds
    s_add_u32 m0, s72, 19456
    s_mov_b32 s61, 1343488
    buffer_load_dwordx4 v3, s[84:87], s61 offen  lds
    s_waitcnt lgkmcnt(0)
    s_waitcnt vmcnt(12)
    s_barrier
    ds_read_b64_tr_b16 v[56:57], v6 offset:4096
    ds_read_b64_tr_b16 v[58:59], v4 offset:4096
    ds_read_b64_tr_b16 v[60:61], v7 offset:4096
    ds_read_b64_tr_b16 v[62:63], v5 offset:4096
    ds_read_b64_tr_b16 v[64:65], v6 offset:4128
    ds_read_b64_tr_b16 v[66:67], v4 offset:4128
    ds_read_b64_tr_b16 v[68:69], v7 offset:4128
    ds_read_b64_tr_b16 v[70:71], v5 offset:4128
    s_add_u32 m0, s72, 12288
    s_mov_b32 s61, 393216
    buffer_load_dwordx4 v3, s[84:87], s61 offen  lds
    s_add_u32 m0, s72, 13312
    s_mov_b32 s61, 425984
    buffer_load_dwordx4 v3, s[84:87], s61 offen  lds
    s_add_u32 m0, s72, 14336
    s_mov_b32 s61, 1441792
    buffer_load_dwordx4 v3, s[84:87], s61 offen  lds
    s_add_u32 m0, s72, 15360
    s_mov_b32 s61, 1474560
    buffer_load_dwordx4 v3, s[84:87], s61 offen  lds
    s_waitcnt lgkmcnt(0)
    s_waitcnt vmcnt(12)
    s_barrier
    ds_read_b64_tr_b16 a[192:193], v6 offset:8192
    ds_read_b64_tr_b16 a[194:195], v4 offset:8192
    ds_read_b64_tr_b16 a[196:197], v7 offset:8192
    ds_read_b64_tr_b16 a[198:199], v5 offset:8192
    ds_read_b64_tr_b16 a[200:201], v6 offset:8224
    ds_read_b64_tr_b16 a[202:203], v4 offset:8224
    ds_read_b64_tr_b16 a[204:205], v7 offset:8224
    ds_read_b64_tr_b16 a[206:207], v5 offset:8224
    ds_write_b128 v118, v[8:11] offset:0
    ds_write_b128 v118, v[12:15] offset:1024
    ds_write_b128 v118, v[16:19] offset:2048
    ds_write_b128 v118, v[20:23] offset:3072
    s_add_u32 m0, s72, 4096
    s_mov_b32 s61, 524288
    buffer_load_dwordx4 v3, s[84:87], s61 offen  lds
    s_add_u32 m0, s72, 5120
    s_mov_b32 s61, 557056
    buffer_load_dwordx4 v3, s[84:87], s61 offen  lds
    s_add_u32 m0, s72, 6144
    s_mov_b32 s61, 1572864
    buffer_load_dwordx4 v3, s[84:87], s61 offen  lds
    s_add_u32 m0, s72, 7168
    s_mov_b32 s61, 1605632
    buffer_load_dwordx4 v3, s[84:87], s61 offen  lds
    s_waitcnt lgkmcnt(0)
    s_waitcnt vmcnt(12)
    s_barrier
    ds_read_b64_tr_b16 a[208:209], v6 offset:20480
    ds_read_b64_tr_b16 a[210:211], v4 offset:20480
    ds_read_b64_tr_b16 a[212:213], v7 offset:20480
    ds_read_b64_tr_b16 a[214:215], v5 offset:20480
    ds_read_b64_tr_b16 a[216:217], v6 offset:20512
    ds_read_b64_tr_b16 a[218:219], v4 offset:20512
    ds_read_b64_tr_b16 a[220:221], v7 offset:20512
    ds_read_b64_tr_b16 a[222:223], v5 offset:20512
    s_add_u32 m0, s72, 8192
    s_mov_b32 s61, 655360
    buffer_load_dwordx4 v3, s[84:87], s61 offen  lds
    s_add_u32 m0, s72, 9216
    s_mov_b32 s61, 688128
    buffer_load_dwordx4 v3, s[84:87], s61 offen  lds
    s_add_u32 m0, s72, 10240
    s_mov_b32 s61, 1703936
    buffer_load_dwordx4 v3, s[84:87], s61 offen  lds
    s_add_u32 m0, s72, 11264
    s_mov_b32 s61, 1736704
    buffer_load_dwordx4 v3, s[84:87], s61 offen  lds
    s_waitcnt lgkmcnt(0)
    s_waitcnt vmcnt(12)
    s_barrier
    ds_read_b64_tr_b16 a[128:129], v6 offset:16384
    ds_read_b64_tr_b16 a[130:131], v4 offset:16384
    ds_read_b64_tr_b16 a[132:133], v7 offset:16384
    ds_read_b64_tr_b16 a[134:135], v5 offset:16384
    ds_read_b64_tr_b16 a[136:137], v6 offset:16416
    ds_read_b64_tr_b16 a[138:139], v4 offset:16416
    ds_read_b64_tr_b16 a[140:141], v7 offset:16416
    ds_read_b64_tr_b16 a[142:143], v5 offset:16416
    s_add_u32 m0, s72, 20480
    s_mov_b32 s61, 786432
    buffer_load_dwordx4 v3, s[84:87], s61 offen  lds
    s_add_u32 m0, s72, 21504
    s_mov_b32 s61, 819200
    buffer_load_dwordx4 v3, s[84:87], s61 offen  lds
    s_add_u32 m0, s72, 22528
    s_mov_b32 s61, 1835008
    buffer_load_dwordx4 v3, s[84:87], s61 offen  lds
    s_add_u32 m0, s72, 23552
    s_mov_b32 s61, 1867776
    buffer_load_dwordx4 v3, s[84:87], s61 offen  lds
    s_waitcnt lgkmcnt(0)
    s_waitcnt vmcnt(12)
    s_barrier
    ds_read_b64_tr_b16 a[160:161], v6 offset:12288
    ds_read_b64_tr_b16 a[162:163], v4 offset:12288
    ds_read_b64_tr_b16 a[164:165], v7 offset:12288
    ds_read_b64_tr_b16 a[166:167], v5 offset:12288
    ds_read_b64_tr_b16 a[168:169], v6 offset:12320
    ds_read_b64_tr_b16 a[170:171], v4 offset:12320
    ds_read_b64_tr_b16 a[172:173], v7 offset:12320
    ds_read_b64_tr_b16 a[174:175], v5 offset:12320
    s_add_u32 m0, s72, 16384
    s_mov_b32 s61, 917504
    buffer_load_dwordx4 v3, s[84:87], s61 offen  lds
    s_add_u32 m0, s72, 17408
    s_mov_b32 s61, 950272
    buffer_load_dwordx4 v3, s[84:87], s61 offen  lds
    s_add_u32 m0, s72, 18432
    s_mov_b32 s61, 1966080
    buffer_load_dwordx4 v3, s[84:87], s61 offen  lds
    s_add_u32 m0, s72, 19456
    s_mov_b32 s61, 1998848
    buffer_load_dwordx4 v3, s[84:87], s61 offen  lds
    s_waitcnt lgkmcnt(0)
    s_waitcnt vmcnt(12)
    s_barrier
    ds_read_b64_tr_b16 v[72:73], v6 offset:4096
    ds_read_b64_tr_b16 v[74:75], v4 offset:4096
    ds_read_b64_tr_b16 v[76:77], v7 offset:4096
    ds_read_b64_tr_b16 v[78:79], v5 offset:4096
    ds_read_b64_tr_b16 v[80:81], v6 offset:4128
    ds_read_b64_tr_b16 v[82:83], v4 offset:4128
    ds_read_b64_tr_b16 v[84:85], v7 offset:4128
    ds_read_b64_tr_b16 v[86:87], v5 offset:4128
    s_add_u32 m0, s72, 12288
    s_mov_b32 s61, 0
    buffer_load_dwordx4 v3, s[76:79], s61 offen  lds
    s_add_u32 m0, s72, 13312
    s_mov_b32 s61, 32768
    buffer_load_dwordx4 v3, s[76:79], s61 offen  lds
    s_add_u32 m0, s72, 14336
    s_mov_b32 s61, 1048576
    buffer_load_dwordx4 v3, s[76:79], s61 offen  lds
    s_add_u32 m0, s72, 15360
    s_mov_b32 s61, 1081344
    buffer_load_dwordx4 v3, s[76:79], s61 offen  lds
    s_waitcnt lgkmcnt(0)
    s_waitcnt vmcnt(12)
    s_barrier
    ds_read_b64_tr_b16 v[88:89], v6 offset:8192
    ds_read_b64_tr_b16 v[90:91], v4 offset:8192
    ds_read_b64_tr_b16 v[92:93], v7 offset:8192
    ds_read_b64_tr_b16 v[94:95], v5 offset:8192
    ds_read_b64_tr_b16 v[96:97], v6 offset:8224
    ds_read_b64_tr_b16 v[98:99], v4 offset:8224
    ds_read_b64_tr_b16 v[100:101], v7 offset:8224
    ds_read_b64_tr_b16 v[102:103], v5 offset:8224
    s_add_u32 m0, s72, 4096
    s_mov_b32 s61, 131072
    buffer_load_dwordx4 v3, s[76:79], s61 offen  lds
    s_add_u32 m0, s72, 5120
    s_mov_b32 s61, 163840
    buffer_load_dwordx4 v3, s[76:79], s61 offen  lds
    s_add_u32 m0, s72, 6144
    s_mov_b32 s61, 1179648
    buffer_load_dwordx4 v3, s[76:79], s61 offen  lds
    s_add_u32 m0, s72, 7168
    s_mov_b32 s61, 1212416
    buffer_load_dwordx4 v3, s[76:79], s61 offen  lds
    s_waitcnt lgkmcnt(0)
    s_waitcnt vmcnt(12)
    s_barrier
    ds_read_b64_tr_b16 a[144:145], v6 offset:20480
    ds_read_b64_tr_b16 a[146:147], v4 offset:20480
    ds_read_b64_tr_b16 a[148:149], v7 offset:20480
    ds_read_b64_tr_b16 a[150:151], v5 offset:20480
    ds_read_b64_tr_b16 a[152:153], v6 offset:20512
    ds_read_b64_tr_b16 a[154:155], v4 offset:20512
    ds_read_b64_tr_b16 a[156:157], v7 offset:20512
    ds_read_b64_tr_b16 a[158:159], v5 offset:20512
    s_add_u32 m0, s72, 8192
    s_mov_b32 s61, 262144
    buffer_load_dwordx4 v3, s[76:79], s61 offen  lds
    s_add_u32 m0, s72, 9216
    s_mov_b32 s61, 294912
    buffer_load_dwordx4 v3, s[76:79], s61 offen  lds
    s_add_u32 m0, s72, 10240
    s_mov_b32 s61, 1310720
    buffer_load_dwordx4 v3, s[76:79], s61 offen  lds
    s_add_u32 m0, s72, 11264
    s_mov_b32 s61, 1343488
    buffer_load_dwordx4 v3, s[76:79], s61 offen  lds
    global_store_dword v113, v123, s[36:37] sc1
    v_mbcnt_lo_u32_b32 v1, -1, 0
    v_and_b32 v1, 15, v1
    v_lshlrev_b32 v1, 4, v1
    global_load_dword v2, v1, s[18:19] sc1
    s_waitcnt lgkmcnt(0)
    s_waitcnt vmcnt(14)
    s_barrier
    ds_read_b64_tr_b16 a[176:177], v6 offset:16384
    ds_read_b64_tr_b16 a[178:179], v4 offset:16384
    ds_read_b64_tr_b16 a[180:181], v7 offset:16384
    ds_read_b64_tr_b16 a[182:183], v5 offset:16384
    ds_read_b64_tr_b16 a[184:185], v6 offset:16416
    ds_read_b64_tr_b16 a[186:187], v4 offset:16416
    ds_read_b64_tr_b16 a[188:189], v7 offset:16416
    ds_read_b64_tr_b16 a[190:191], v5 offset:16416
    s_add_u32 m0, s72, 20480
    s_mov_b32 s61, 393216
    buffer_load_dwordx4 v3, s[76:79], s61 offen  lds
    s_add_u32 m0, s72, 21504
    s_mov_b32 s61, 425984
    buffer_load_dwordx4 v3, s[76:79], s61 offen  lds
    s_add_u32 m0, s72, 22528
    s_mov_b32 s61, 1441792
    buffer_load_dwordx4 v3, s[76:79], s61 offen  lds
    s_add_u32 m0, s72, 23552
    s_mov_b32 s61, 1474560
    buffer_load_dwordx4 v3, s[76:79], s61 offen  lds
    s_waitcnt lgkmcnt(0)
    s_waitcnt vmcnt(14)
    s_barrier
    ds_read_b64_tr_b16 a[64:65], v6 offset:12288
    ds_read_b64_tr_b16 a[66:67], v4 offset:12288
    ds_read_b64_tr_b16 a[68:69], v7 offset:12288
    ds_read_b64_tr_b16 a[70:71], v5 offset:12288
    ds_read_b64_tr_b16 a[72:73], v6 offset:12320
    ds_read_b64_tr_b16 a[74:75], v4 offset:12320
    ds_read_b64_tr_b16 a[76:77], v7 offset:12320
    ds_read_b64_tr_b16 a[78:79], v5 offset:12320
    s_add_u32 m0, s72, 16384
    s_mov_b32 s61, 524288
    buffer_load_dwordx4 v3, s[76:79], s61 offen  lds
    s_add_u32 m0, s72, 17408
    s_mov_b32 s61, 557056
    buffer_load_dwordx4 v3, s[76:79], s61 offen  lds
    s_add_u32 m0, s72, 18432
    s_mov_b32 s61, 1572864
    buffer_load_dwordx4 v3, s[76:79], s61 offen  lds
    s_add_u32 m0, s72, 19456
    s_mov_b32 s61, 1605632
    buffer_load_dwordx4 v3, s[76:79], s61 offen  lds
    s_waitcnt lgkmcnt(0)
    s_waitcnt vmcnt(14)
    s_barrier
    ds_read_b64_tr_b16 a[96:97], v6 offset:4096
    ds_read_b64_tr_b16 a[98:99], v4 offset:4096
    ds_read_b64_tr_b16 a[100:101], v7 offset:4096
    ds_read_b64_tr_b16 a[102:103], v5 offset:4096
    ds_read_b64_tr_b16 a[104:105], v6 offset:4128
    ds_read_b64_tr_b16 a[106:107], v4 offset:4128
    ds_read_b64_tr_b16 a[108:109], v7 offset:4128
    ds_read_b64_tr_b16 a[110:111], v5 offset:4128
    s_add_u32 m0, s72, 12288
    s_mov_b32 s61, 655360
    buffer_load_dwordx4 v3, s[76:79], s61 offen  lds
    s_add_u32 m0, s72, 13312
    s_mov_b32 s61, 688128
    buffer_load_dwordx4 v3, s[76:79], s61 offen  lds
    s_add_u32 m0, s72, 14336
    s_mov_b32 s61, 1703936
    buffer_load_dwordx4 v3, s[76:79], s61 offen  lds
    s_add_u32 m0, s72, 15360
    s_mov_b32 s61, 1736704
    buffer_load_dwordx4 v3, s[76:79], s61 offen  lds
    s_waitcnt lgkmcnt(0)
    s_waitcnt vmcnt(14)
    s_barrier
    ds_read_b64_tr_b16 a[0:1], v6 offset:8192
    ds_read_b64_tr_b16 a[2:3], v4 offset:8192
    ds_read_b64_tr_b16 a[4:5], v7 offset:8192
    ds_read_b64_tr_b16 a[6:7], v5 offset:8192
    ds_read_b64_tr_b16 a[8:9], v6 offset:8224
    ds_read_b64_tr_b16 a[10:11], v4 offset:8224
    ds_read_b64_tr_b16 a[12:13], v7 offset:8224
    ds_read_b64_tr_b16 a[14:15], v5 offset:8224
    s_add_u32 m0, s72, 4096
    s_mov_b32 s61, 786432
    buffer_load_dwordx4 v3, s[76:79], s61 offen  lds
    s_add_u32 m0, s72, 5120
    s_mov_b32 s61, 819200
    buffer_load_dwordx4 v3, s[76:79], s61 offen  lds
    s_add_u32 m0, s72, 6144
    s_mov_b32 s61, 1835008
    buffer_load_dwordx4 v3, s[76:79], s61 offen  lds
    s_add_u32 m0, s72, 7168
    s_mov_b32 s61, 1867776
    buffer_load_dwordx4 v3, s[76:79], s61 offen  lds
    s_waitcnt lgkmcnt(0)
    s_waitcnt vmcnt(12)
    s_barrier
    ds_read_b64_tr_b16 a[32:33], v6 offset:20480
    ds_read_b64_tr_b16 a[34:35], v4 offset:20480
    ds_read_b64_tr_b16 a[36:37], v7 offset:20480
    ds_read_b64_tr_b16 a[38:39], v5 offset:20480
    ds_read_b64_tr_b16 a[40:41], v6 offset:20512
    ds_read_b64_tr_b16 a[42:43], v4 offset:20512
    ds_read_b64_tr_b16 a[44:45], v7 offset:20512
    ds_read_b64_tr_b16 a[46:47], v5 offset:20512
    s_add_u32 m0, s72, 8192
    s_mov_b32 s61, 917504
    buffer_load_dwordx4 v3, s[76:79], s61 offen  lds
    s_add_u32 m0, s72, 9216
    s_mov_b32 s61, 950272
    buffer_load_dwordx4 v3, s[76:79], s61 offen  lds
    s_add_u32 m0, s72, 10240
    s_mov_b32 s61, 1966080
    buffer_load_dwordx4 v3, s[76:79], s61 offen  lds
    s_add_u32 m0, s72, 11264
    s_mov_b32 s61, 1998848
    buffer_load_dwordx4 v3, s[76:79], s61 offen  lds
    s_waitcnt lgkmcnt(0)
    s_waitcnt vmcnt(12)
    s_barrier
    ds_read_b64_tr_b16 a[80:81], v6 offset:16384
    ds_read_b64_tr_b16 a[82:83], v4 offset:16384
    ds_read_b64_tr_b16 a[84:85], v7 offset:16384
    ds_read_b64_tr_b16 a[86:87], v5 offset:16384
    ds_read_b64_tr_b16 a[88:89], v6 offset:16416
    ds_read_b64_tr_b16 a[90:91], v4 offset:16416
    ds_read_b64_tr_b16 a[92:93], v7 offset:16416
    ds_read_b64_tr_b16 a[94:95], v5 offset:16416
    ds_write_b128 v118, v[88:91] offset:20480
    ds_write_b128 v118, v[92:95] offset:21504
    ds_write_b128 v118, v[96:99] offset:22528
    ds_write_b128 v118, v[100:103] offset:23552
    global_load_dword v123, v122, s[96:97] sc1
    s_waitcnt lgkmcnt(0)
    s_waitcnt vmcnt(9)
    s_barrier
    ds_read_b64_tr_b16 a[112:113], v6 offset:12288
    ds_read_b64_tr_b16 a[114:115], v4 offset:12288
    ds_read_b64_tr_b16 a[116:117], v7 offset:12288
    ds_read_b64_tr_b16 a[118:119], v5 offset:12288
    ds_read_b64_tr_b16 a[120:121], v6 offset:12320
    ds_read_b64_tr_b16 a[122:123], v4 offset:12320
    ds_read_b64_tr_b16 a[124:125], v7 offset:12320
    ds_read_b64_tr_b16 a[126:127], v5 offset:12320
    ds_write_b128 v118, v[72:75] offset:16384
    ds_write_b128 v118, v[76:79] offset:17408
    ds_write_b128 v118, v[80:83] offset:18432
    ds_write_b128 v118, v[84:87] offset:19456
    s_waitcnt lgkmcnt(0)
    s_waitcnt vmcnt(5)
    s_barrier
    ds_read_b64_tr_b16 a[16:17], v6 offset:4096
    ds_read_b64_tr_b16 a[18:19], v4 offset:4096
    ds_read_b64_tr_b16 a[20:21], v7 offset:4096
    ds_read_b64_tr_b16 a[22:23], v5 offset:4096
    ds_read_b64_tr_b16 a[24:25], v6 offset:4128
    ds_read_b64_tr_b16 a[26:27], v4 offset:4128
    ds_read_b64_tr_b16 a[28:29], v7 offset:4128
    ds_read_b64_tr_b16 a[30:31], v5 offset:4128
    ds_write_b128 v118, v[56:59] offset:12288
    ds_write_b128 v118, v[60:63] offset:13312
    ds_write_b128 v118, v[64:67] offset:14336
    ds_write_b128 v118, v[68:71] offset:15360
    s_waitcnt lgkmcnt(0)
    s_waitcnt vmcnt(1)
    s_barrier
    ds_read_b64_tr_b16 a[48:49], v6 offset:8192
    ds_read_b64_tr_b16 a[50:51], v4 offset:8192
    ds_read_b64_tr_b16 a[52:53], v7 offset:8192
    ds_read_b64_tr_b16 a[54:55], v5 offset:8192
    ds_read_b64_tr_b16 a[56:57], v6 offset:8224
    ds_read_b64_tr_b16 a[58:59], v4 offset:8224
    ds_read_b64_tr_b16 a[60:61], v7 offset:8224
    ds_read_b64_tr_b16 a[62:63], v5 offset:8224
    ds_write_b128 v118, v[24:27] offset:4096
    ds_write_b128 v118, v[28:31] offset:5120
    ds_write_b128 v118, v[32:35] offset:6144
    ds_write_b128 v118, v[36:39] offset:7168
    s_waitcnt vmcnt(0)
    global_load_dwordx4 a[240:243], v105, s[42:43] offset:0 sc1
    global_load_dwordx4 a[244:247], v105, s[42:43] offset:1024 sc1
    global_load_dwordx4 a[248:251], v105, s[42:43] offset:2048 sc1
    global_load_dwordx4 a[252:255], v105, s[42:43] offset:3072 sc1
    s_waitcnt lgkmcnt(0)
    s_barrier
    ds_write_b128 v118, v[40:43] offset:8192
    ds_write_b128 v118, v[44:47] offset:9216
    ds_write_b128 v118, v[48:51] offset:10240
    ds_write_b128 v118, v[52:55] offset:11264
    s_branch L_cs_wdone
L_cs_wv3:
    ds_read_b64_tr_b16 v[144:145], v5 offset:0
    ds_read_b64_tr_b16 v[146:147], v5 offset:512
    ds_read_b64_tr_b16 v[148:149], v5 offset:2048
    ds_read_b64_tr_b16 v[150:151], v5 offset:2560
    ds_read_b64_tr_b16 v[168:169], v5 offset:64
    ds_read_b64_tr_b16 v[170:171], v5 offset:576
    ds_read_b64_tr_b16 v[172:173], v5 offset:2112
    ds_read_b64_tr_b16 v[174:175], v5 offset:2624
    s_waitcnt lgkmcnt(0)
    ds_read_b64_tr_b16 v[192:193], v5 offset:128
    ds_read_b64_tr_b16 v[194:195], v5 offset:640
    ds_read_b64_tr_b16 v[196:197], v5 offset:2176
    ds_read_b64_tr_b16 v[198:199], v5 offset:2688
    ds_read_b64_tr_b16 a[88:89], v5 offset:192
    ds_read_b64_tr_b16 a[90:91], v5 offset:704
    ds_read_b64_tr_b16 a[92:93], v5 offset:2240
    ds_read_b64_tr_b16 a[94:95], v5 offset:2752
    s_waitcnt lgkmcnt(0)
    s_add_u32 m0, s72, 0
    s_mov_b32 s61, 131072
    buffer_load_dwordx4 v3, s[80:83], s61 offen  lds
    s_add_u32 m0, s72, 1024
    s_mov_b32 s61, 163840
    buffer_load_dwordx4 v3, s[80:83], s61 offen  lds
    s_add_u32 m0, s72, 2048
    s_mov_b32 s61, 1179648
    buffer_load_dwordx4 v3, s[80:83], s61 offen  lds
    s_add_u32 m0, s72, 3072
    s_mov_b32 s61, 1212416
    buffer_load_dwordx4 v3, s[80:83], s61 offen  lds
    s_add_u32 m0, s72, 4096
    s_mov_b32 s61, 262144
    buffer_load_dwordx4 v3, s[80:83], s61 offen  lds
    s_add_u32 m0, s72, 5120
    s_mov_b32 s61, 294912
    buffer_load_dwordx4 v3, s[80:83], s61 offen  lds
    s_add_u32 m0, s72, 6144
    s_mov_b32 s61, 1310720
    buffer_load_dwordx4 v3, s[80:83], s61 offen  lds
    s_add_u32 m0, s72, 7168
    s_mov_b32 s61, 1343488
    buffer_load_dwordx4 v3, s[80:83], s61 offen  lds
    ds_read_b64_tr_b16 v[136:137], v5 offset:8192
    ds_read_b64_tr_b16 v[138:139], v5 offset:8704
    ds_read_b64_tr_b16 v[140:141], v5 offset:10240
    ds_read_b64_tr_b16 v[142:143], v5 offset:10752
    ds_read_b64_tr_b16 v[160:161], v5 offset:8256
    ds_read_b64_tr_b16 v[162:163], v5 offset:8768
    ds_read_b64_tr_b16 v[164:165], v5 offset:10304
    ds_read_b64_tr_b16 v[166:167], v5 offset:10816
    s_waitcnt lgkmcnt(0)
    ds_read_b64_tr_b16 v[184:185], v5 offset:8320
    ds_read_b64_tr_b16 v[186:187], v5 offset:8832
    ds_read_b64_tr_b16 v[188:189], v5 offset:10368
    ds_read_b64_tr_b16 v[190:191], v5 offset:10880
    ds_read_b64_tr_b16 a[80:81], v5 offset:8384
    ds_read_b64_tr_b16 a[82:83], v5 offset:8896
    ds_read_b64_tr_b16 a[84:85], v5 offset:10432
    ds_read_b64_tr_b16 a[86:87], v5 offset:10944
    s_waitcnt lgkmcnt(0)
    s_add_u32 m0, s72, 8192
    s_mov_b32 s61, 393216
    buffer_load_dwordx4 v3, s[80:83], s61 offen  lds
    s_add_u32 m0, s72, 9216
    s_mov_b32 s61, 425984
    buffer_load_dwordx4 v3, s[80:83], s61 offen  lds
    s_add_u32 m0, s72, 10240
    s_mov_b32 s61, 1441792
    buffer_load_dwordx4 v3, s[80:83], s61 offen  lds
    s_add_u32 m0, s72, 11264
    s_mov_b32 s61, 1474560
    buffer_load_dwordx4 v3, s[80:83], s61 offen  lds
    s_waitcnt vmcnt(24)
    ds_read_b64_tr_b16 v[128:129], v5 offset:16384
    ds_read_b64_tr_b16 v[130:131], v5 offset:16896
    ds_read_b64_tr_b16 v[132:133], v5 offset:18432
    ds_read_b64_tr_b16 v[134:135], v5 offset:18944
    ds_read_b64_tr_b16 v[152:153], v5 offset:16448
    ds_read_b64_tr_b16 v[154:155], v5 offset:16960
    ds_read_b64_tr_b16 v[156:157], v5 offset:18496
    ds_read_b64_tr_b16 v[158:159], v5 offset:19008
    s_waitcnt lgkmcnt(0)
    ds_read_b64_tr_b16 v[176:177], v5 offset:16512
    ds_read_b64_tr_b16 v[178:179], v5 offset:17024
    ds_read_b64_tr_b16 v[180:181], v5 offset:18560
    ds_read_b64_tr_b16 v[182:183], v5 offset:19072
    ds_read_b64_tr_b16 v[200:201], v5 offset:16576
    ds_read_b64_tr_b16 v[202:203], v5 offset:17088
    ds_read_b64_tr_b16 v[204:205], v5 offset:18624
    ds_read_b64_tr_b16 v[206:207], v5 offset:19136
    s_waitcnt lgkmcnt(0)
    s_waitcnt vmcnt(16)
    ds_read_b64_tr_b16 a[16:17], v5 offset:24576
    ds_read_b64_tr_b16 a[18:19], v5 offset:25088
    ds_read_b64_tr_b16 a[20:21], v5 offset:26624
    ds_read_b64_tr_b16 a[22:23], v5 offset:27136
    ds_read_b64_tr_b16 a[24:25], v5 offset:24640
    ds_read_b64_tr_b16 a[26:27], v5 offset:25152
    ds_read_b64_tr_b16 a[28:29], v5 offset:26688
    ds_read_b64_tr_b16 a[30:31], v5 offset:27200
    s_waitcnt lgkmcnt(0)
    ds_read_b64_tr_b16 a[48:49], v5 offset:24704
    ds_read_b64_tr_b16 a[50:51], v5 offset:25216
    ds_read_b64_tr_b16 a[52:53], v5 offset:26752
    ds_read_b64_tr_b16 a[54:55], v5 offset:27264
    ds_read_b64_tr_b16 a[56:57], v5 offset:24768
    ds_read_b64_tr_b16 a[58:59], v5 offset:25280
    ds_read_b64_tr_b16 a[60:61], v5 offset:26816
    ds_read_b64_tr_b16 a[62:63], v5 offset:27328
    s_waitcnt lgkmcnt(0)
    v_add_u32 v4, 36864, v6
    v_add_u32 v5, 36864, v7
    s_waitcnt vmcnt(12)
    s_barrier
    ds_read_b64_tr_b16 v[240:241], v6 offset:32768
    ds_read_b64_tr_b16 v[242:243], v4 offset:32768
    ds_read_b64_tr_b16 v[244:245], v7 offset:32768
    ds_read_b64_tr_b16 v[246:247], v5 offset:32768
    ds_read_b64_tr_b16 v[248:249], v6 offset:32800
    ds_read_b64_tr_b16 v[250:251], v4 offset:32800
    ds_read_b64_tr_b16 v[252:253], v7 offset:32800
    ds_read_b64_tr_b16 v[254:255], v5 offset:32800
    ds_write_b128 v118, a[48:51] offset:28672
    ds_write_b128 v118, a[52:55] offset:29696
    ds_write_b128 v118, a[56:59] offset:30720
    ds_write_b128 v118, a[60:63] offset:31744
    s_add_u32 m0, s72, 20480
    s_mov_b32 s61, 524288
    buffer_load_dwordx4 v3, s[80:83], s61 offen  lds
    s_add_u32 m0, s72, 21504
    s_mov_b32 s61, 557056
    buffer_load_dwordx4 v3, s[80:83], s61 offen  lds
    s_add_u32 m0, s72, 22528
    s_mov_b32 s61, 1572864
    buffer_load_dwordx4 v3, s[80:83], s61 offen  lds
    s_add_u32 m0, s72, 23552
    s_mov_b32 s61, 1605632
    buffer_load_dwordx4 v3, s[80:83], s61 offen  lds
    s_waitcnt lgkmcnt(0)
    s_waitcnt vmcnt(12)
    s_barrier
    ds_read_b64_tr_b16 v[208:209], v6 offset:0
    ds_read_b64_tr_b16 v[210:211], v4 offset:0
    ds_read_b64_tr_b16 v[212:213], v7 offset:0
    ds_read_b64_tr_b16 v[214:215], v5 offset:0
    ds_read_b64_tr_b16 v[216:217], v6 offset:32
    ds_read_b64_tr_b16 v[218:219], v4 offset:32
    ds_read_b64_tr_b16 v[220:221], v7 offset:32
    ds_read_b64_tr_b16 v[222:223], v5 offset:32
    ds_write_b128 v118, a[80:83] offset:32768
    ds_write_b128 v118, a[84:87] offset:33792
    ds_write_b128 v118, a[88:91] offset:34816
    ds_write_b128 v118, a[92:95] offset:35840
    s_add_u32 m0, s72, 16384
    s_mov_b32 s61, 655360
    buffer_load_dwordx4 v3, s[80:83], s61 offen  lds
    s_add_u32 m0, s72, 17408
    s_mov_b32 s61, 688128
    buffer_load_dwordx4 v3, s[80:83], s61 offen  lds
    s_add_u32 m0, s72, 18432
    s_mov_b32 s61, 1703936
    buffer_load_dwordx4 v3, s[80:83], s61 offen  lds
    s_add_u32 m0, s72, 19456
    s_mov_b32 s61, 1736704
    buffer_load_dwordx4 v3, s[80:83], s61 offen  lds
    s_waitcnt lgkmcnt(0)
    s_waitcnt vmcnt(12)
    s_barrier
    ds_read_b64_tr_b16 v[24:25], v6 offset:4096
    ds_read_b64_tr_b16 v[26:27], v4 offset:4096
    ds_read_b64_tr_b16 v[28:29], v7 offset:4096
    ds_read_b64_tr_b16 v[30:31], v5 offset:4096
    ds_read_b64_tr_b16 v[32:33], v6 offset:4128
    ds_read_b64_tr_b16 v[34:35], v4 offset:4128
    ds_read_b64_tr_b16 v[36:37], v7 offset:4128
    ds_read_b64_tr_b16 v[38:39], v5 offset:4128
    ds_write_b128 v118, a[16:19] offset:24576
    ds_write_b128 v118, a[20:23] offset:25600
    ds_write_b128 v118, a[24:27] offset:26624
    ds_write_b128 v118, a[28:31] offset:27648
    s_add_u32 m0, s72, 12288
    s_mov_b32 s61, 786432
    buffer_load_dwordx4 v3, s[80:83], s61 offen  lds
    s_add_u32 m0, s72, 13312
    s_mov_b32 s61, 819200
    buffer_load_dwordx4 v3, s[80:83], s61 offen  lds
    s_add_u32 m0, s72, 14336
    s_mov_b32 s61, 1835008
    buffer_load_dwordx4 v3, s[80:83], s61 offen  lds
    s_add_u32 m0, s72, 15360
    s_mov_b32 s61, 1867776
    buffer_load_dwordx4 v3, s[80:83], s61 offen  lds
    s_waitcnt lgkmcnt(0)
    s_waitcnt vmcnt(12)
    s_barrier
    ds_read_b64_tr_b16 v[8:9], v6 offset:8192
    ds_read_b64_tr_b16 v[10:11], v4 offset:8192
    ds_read_b64_tr_b16 v[12:13], v7 offset:8192
    ds_read_b64_tr_b16 v[14:15], v5 offset:8192
    ds_read_b64_tr_b16 v[16:17], v6 offset:8224
    ds_read_b64_tr_b16 v[18:19], v4 offset:8224
    ds_read_b64_tr_b16 v[20:21], v7 offset:8224
    ds_read_b64_tr_b16 v[22:23], v5 offset:8224
    s_add_u32 m0, s72, 4096
    s_mov_b32 s61, 917504
    buffer_load_dwordx4 v3, s[80:83], s61 offen  lds
    s_add_u32 m0, s72, 5120
    s_mov_b32 s61, 950272
    buffer_load_dwordx4 v3, s[80:83], s61 offen  lds
    s_add_u32 m0, s72, 6144
    s_mov_b32 s61, 1966080
    buffer_load_dwordx4 v3, s[80:83], s61 offen  lds
    s_add_u32 m0, s72, 7168
    s_mov_b32 s61, 1998848
    buffer_load_dwordx4 v3, s[80:83], s61 offen  lds
    s_waitcnt lgkmcnt(0)
    s_waitcnt vmcnt(12)
    s_barrier
    ds_read_b64_tr_b16 a[224:225], v6 offset:20480
    ds_read_b64_tr_b16 a[226:227], v4 offset:20480
    ds_read_b64_tr_b16 a[228:229], v7 offset:20480
    ds_read_b64_tr_b16 a[230:231], v5 offset:20480
    ds_read_b64_tr_b16 a[232:233], v6 offset:20512
    ds_read_b64_tr_b16 a[234:235], v4 offset:20512
    ds_read_b64_tr_b16 a[236:237], v7 offset:20512
    ds_read_b64_tr_b16 a[238:239], v5 offset:20512
    s_add_u32 m0, s72, 8192
    s_mov_b32 s61, 0
    buffer_load_dwordx4 v3, s[84:87], s61 offen  lds
    s_add_u32 m0, s72, 9216
    s_mov_b32 s61, 32768
    buffer_load_dwordx4 v3, s[84:87], s61 offen  lds
    s_add_u32 m0, s72, 10240
    s_mov_b32 s61, 1048576
    buffer_load_dwordx4 v3, s[84:87], s61 offen  lds
    s_add_u32 m0, s72, 11264
    s_mov_b32 s61, 1081344
    buffer_load_dwordx4 v3, s[84:87], s61 offen  lds
    s_waitcnt lgkmcnt(0)
    s_waitcnt vmcnt(12)
    s_barrier
    ds_read_b64_tr_b16 v[224:225], v6 offset:16384
    ds_read_b64_tr_b16 v[226:227], v4 offset:16384
    ds_read_b64_tr_b16 v[228:229], v7 offset:16384
    ds_read_b64_tr_b16 v[230:231], v5 offset:16384
    ds_read_b64_tr_b16 v[232:233], v6 offset:16416
    ds_read_b64_tr_b16 v[234:235], v4 offset:16416
    ds_read_b64_tr_b16 v[236:237], v7 offset:16416
    ds_read_b64_tr_b16 v[238:239], v5 offset:16416
    s_add_u32 m0, s72, 20480
    s_mov_b32 s61, 131072
    buffer_load_dwordx4 v3, s[84:87], s61 offen  lds
    s_add_u32 m0, s72, 21504
    s_mov_b32 s61, 163840
    buffer_load_dwordx4 v3, s[84:87], s61 offen  lds
    s_add_u32 m0, s72, 22528
    s_mov_b32 s61, 1179648
    buffer_load_dwordx4 v3, s[84:87], s61 offen  lds
    s_add_u32 m0, s72, 23552
    s_mov_b32 s61, 1212416
    buffer_load_dwordx4 v3, s[84:87], s61 offen  lds
    s_waitcnt lgkmcnt(0)
    s_waitcnt vmcnt(12)
    s_barrier
    ds_read_b64_tr_b16 v[56:57], v6 offset:12288
    ds_read_b64_tr_b16 v[58:59], v4 offset:12288
    ds_read_b64_tr_b16 v[60:61], v7 offset:12288
    ds_read_b64_tr_b16 v[62:63], v5 offset:12288
    ds_read_b64_tr_b16 v[64:65], v6 offset:12320
    ds_read_b64_tr_b16 v[66:67], v4 offset:12320
    ds_read_b64_tr_b16 v[68:69], v7 offset:12320
    ds_read_b64_tr_b16 v[70:71], v5 offset:12320
    s_add_u32 m0, s72, 16384
    s_mov_b32 s61, 262144
    buffer_load_dwordx4 v3, s[84:87], s61 offen  lds
    s_add_u32 m0, s72, 17408
    s_mov_b32 s61, 294912
    buffer_load_dwordx4 v3, s[84:87], s61 offen  lds
    s_add_u32 m0, s72, 18432
    s_mov_b32 s61, 1310720
    buffer_load_dwordx4 v3, s[84:87], s61 offen  lds
    s_add_u32 m0, s72, 19456
    s_mov_b32 s61, 1343488
    buffer_load_dwordx4 v3, s[84:87], s61 offen  lds
    s_waitcnt lgkmcnt(0)
    s_waitcnt vmcnt(12)
    s_barrier
    ds_read_b64_tr_b16 v[40:41], v6 offset:4096
    ds_read_b64_tr_b16 v[42:43], v4 offset:4096
    ds_read_b64_tr_b16 v[44:45], v7 offset:4096
    ds_read_b64_tr_b16 v[46:47], v5 offset:4096
    ds_read_b64_tr_b16 v[48:49], v6 offset:4128
    ds_read_b64_tr_b16 v[50:51], v4 offset:4128
    ds_read_b64_tr_b16 v[52:53], v7 offset:4128
    ds_read_b64_tr_b16 v[54:55], v5 offset:4128
    s_add_u32 m0, s72, 12288
    s_mov_b32 s61, 393216
    buffer_load_dwordx4 v3, s[84:87], s61 offen  lds
    s_add_u32 m0, s72, 13312
    s_mov_b32 s61, 425984
    buffer_load_dwordx4 v3, s[84:87], s61 offen  lds
    s_add_u32 m0, s72, 14336
    s_mov_b32 s61, 1441792
    buffer_load_dwordx4 v3, s[84:87], s61 offen  lds
    s_add_u32 m0, s72, 15360
    s_mov_b32 s61, 1474560
    buffer_load_dwordx4 v3, s[84:87], s61 offen  lds
    s_waitcnt lgkmcnt(0)
    s_waitcnt vmcnt(12)
    s_barrier
    ds_read_b64_tr_b16 a[208:209], v6 offset:8192
    ds_read_b64_tr_b16 a[210:211], v4 offset:8192
    ds_read_b64_tr_b16 a[212:213], v7 offset:8192
    ds_read_b64_tr_b16 a[214:215], v5 offset:8192
    ds_read_b64_tr_b16 a[216:217], v6 offset:8224
    ds_read_b64_tr_b16 a[218:219], v4 offset:8224
    ds_read_b64_tr_b16 a[220:221], v7 offset:8224
    ds_read_b64_tr_b16 a[222:223], v5 offset:8224
    ds_write_b128 v118, v[8:11] offset:0
    ds_write_b128 v118, v[12:15] offset:1024
    ds_write_b128 v118, v[16:19] offset:2048
    ds_write_b128 v118, v[20:23] offset:3072
    s_add_u32 m0, s72, 4096
    s_mov_b32 s61, 524288
    buffer_load_dwordx4 v3, s[84:87], s61 offen  lds
    s_add_u32 m0, s72, 5120
    s_mov_b32 s61, 557056
    buffer_load_dwordx4 v3, s[84:87], s61 offen  lds
    s_add_u32 m0, s72, 6144
    s_mov_b32 s61, 1572864
    buffer_load_dwordx4 v3, s[84:87], s61 offen  lds
    s_add_u32 m0, s72, 7168
    s_mov_b32 s61, 1605632
    buffer_load_dwordx4 v3, s[84:87], s61 offen  lds
    s_waitcnt lgkmcnt(0)
    s_waitcnt vmcnt(12)
    s_barrier
    ds_read_b64_tr_b16 a[192:193], v6 offset:20480
    ds_read_b64_tr_b16 a[194:195], v4 offset:20480
    ds_read_b64_tr_b16 a[196:197], v7 offset:20480
    ds_read_b64_tr_b16 a[198:199], v5 offset:20480
    ds_read_b64_tr_b16 a[200:201], v6 offset:20512
    ds_read_b64_tr_b16 a[202:203], v4 offset:20512
    ds_read_b64_tr_b16 a[204:205], v7 offset:20512
    ds_read_b64_tr_b16 a[206:207], v5 offset:20512
    s_add_u32 m0, s72, 8192
    s_mov_b32 s61, 655360
    buffer_load_dwordx4 v3, s[84:87], s61 offen  lds
    s_add_u32 m0, s72, 9216
    s_mov_b32 s61, 688128
    buffer_load_dwordx4 v3, s[84:87], s61 offen  lds
    s_add_u32 m0, s72, 10240
    s_mov_b32 s61, 1703936
    buffer_load_dwordx4 v3, s[84:87], s61 offen  lds
    s_add_u32 m0, s72, 11264
    s_mov_b32 s61, 1736704
    buffer_load_dwordx4 v3, s[84:87], s61 offen  lds
    s_waitcnt lgkmcnt(0)
    s_waitcnt vmcnt(12)
    s_barrier
    ds_read_b64_tr_b16 a[160:161], v6 offset:16384
    ds_read_b64_tr_b16 a[162:163], v4 offset:16384
    ds_read_b64_tr_b16 a[164:165], v7 offset:16384
    ds_read_b64_tr_b16 a[166:167], v5 offset:16384
    ds_read_b64_tr_b16 a[168:169], v6 offset:16416
    ds_read_b64_tr_b16 a[170:171], v4 offset:16416
    ds_read_b64_tr_b16 a[172:173], v7 offset:16416
    ds_read_b64_tr_b16 a[174:175], v5 offset:16416
    s_add_u32 m0, s72, 20480
    s_mov_b32 s61, 786432
    buffer_load_dwordx4 v3, s[84:87], s61 offen  lds
    s_add_u32 m0, s72, 21504
    s_mov_b32 s61, 819200
    buffer_load_dwordx4 v3, s[84:87], s61 offen  lds
    s_add_u32 m0, s72, 22528
    s_mov_b32 s61, 1835008
    buffer_load_dwordx4 v3, s[84:87], s61 offen  lds
    s_add_u32 m0, s72, 23552
    s_mov_b32 s61, 1867776
    buffer_load_dwordx4 v3, s[84:87], s61 offen  lds
    s_waitcnt lgkmcnt(0)
    s_waitcnt vmcnt(12)
    s_barrier
    ds_read_b64_tr_b16 a[128:129], v6 offset:12288
    ds_read_b64_tr_b16 a[130:131], v4 offset:12288
    ds_read_b64_tr_b16 a[132:133], v7 offset:12288
    ds_read_b64_tr_b16 a[134:135], v5 offset:12288
    ds_read_b64_tr_b16 a[136:137], v6 offset:12320
    ds_read_b64_tr_b16 a[138:139], v4 offset:12320
    ds_read_b64_tr_b16 a[140:141], v7 offset:12320
    ds_read_b64_tr_b16 a[142:143], v5 offset:12320
    s_add_u32 m0, s72, 16384
    s_mov_b32 s61, 917504
    buffer_load_dwordx4 v3, s[84:87], s61 offen  lds
    s_add_u32 m0, s72, 17408
    s_mov_b32 s61, 950272
    buffer_load_dwordx4 v3, s[84:87], s61 offen  lds
    s_add_u32 m0, s72, 18432
    s_mov_b32 s61, 1966080
    buffer_load_dwordx4 v3, s[84:87], s61 offen  lds
    s_add_u32 m0, s72, 19456
    s_mov_b32 s61, 1998848
    buffer_load_dwordx4 v3, s[84:87], s61 offen  lds
    s_waitcnt lgkmcnt(0)
    s_waitcnt vmcnt(12)
    s_barrier
    ds_read_b64_tr_b16 v[88:89], v6 offset:4096
    ds_read_b64_tr_b16 v[90:91], v4 offset:4096
    ds_read_b64_tr_b16 v[92:93], v7 offset:4096
    ds_read_b64_tr_b16 v[94:95], v5 offset:4096
    ds_read_b64_tr_b16 v[96:97], v6 offset:4128
    ds_read_b64_tr_b16 v[98:99], v4 offset:4128
    ds_read_b64_tr_b16 v[100:101], v7 offset:4128
    ds_read_b64_tr_b16 v[102:103], v5 offset:4128
    s_add_u32 m0, s72, 12288
    s_mov_b32 s61, 0
    buffer_load_dwordx4 v3, s[76:79], s61 offen  lds
    s_add_u32 m0, s72, 13312
    s_mov_b32 s61, 32768
    buffer_load_dwordx4 v3, s[76:79], s61 offen  lds
    s_add_u32 m0, s72, 14336
    s_mov_b32 s61, 1048576
    buffer_load_dwordx4 v3, s[76:79], s61 offen  lds
    s_add_u32 m0, s72, 15360
    s_mov_b32 s61, 1081344
    buffer_load_dwordx4 v3, s[76:79], s61 offen  lds
    s_waitcnt lgkmcnt(0)
    s_waitcnt vmcnt(12)
    s_barrier
    ds_read_b64_tr_b16 v[72:73], v6 offset:8192
    ds_read_b64_tr_b16 v[74:75], v4 offset:8192
    ds_read_b64_tr_b16 v[76:77], v7 offset:8192
    ds_read_b64_tr_b16 v[78:79], v5 offset:8192
    ds_read_b64_tr_b16 v[80:81], v6 offset:8224
    ds_read_b64_tr_b16 v[82:83], v4 offset:8224
    ds_read_b64_tr_b16 v[84:85], v7 offset:8224
    ds_read_b64_tr_b16 v[86:87], v5 offset:8224
    s_add_u32 m0, s72, 4096
    s_mov_b32 s61, 131072
    buffer_load_dwordx4 v3, s[76:79], s61 offen  lds
    s_add_u32 m0, s72, 5120
    s_mov_b32 s61, 163840
    buffer_load_dwordx4 v3, s[76:79], s61 offen  lds
    s_add_u32 m0, s72, 6144
    s_mov_b32 s61, 1179648
    buffer_load_dwordx4 v3, s[76:79], s61 offen  lds
    s_add_u32 m0, s72, 7168
    s_mov_b32 s61, 1212416
    buffer_load_dwordx4 v3, s[76:79], s61 offen  lds
    s_waitcnt lgkmcnt(0)
    s_waitcnt vmcnt(12)
    s_barrier
    ds_read_b64_tr_b16 a[176:177], v6 offset:20480
    ds_read_b64_tr_b16 a[178:179], v4 offset:20480
    ds_read_b64_tr_b16 a[180:181], v7 offset:20480
    ds_read_b64_tr_b16 a[182:183], v5 offset:20480
    ds_read_b64_tr_b16 a[184:185], v6 offset:20512
    ds_read_b64_tr_b16 a[186:187], v4 offset:20512
    ds_read_b64_tr_b16 a[188:189], v7 offset:20512
    ds_read_b64_tr_b16 a[190:191], v5 offset:20512
    s_add_u32 m0, s72, 8192
    s_mov_b32 s61, 262144
    buffer_load_dwordx4 v3, s[76:79], s61 offen  lds
    s_add_u32 m0, s72, 9216
    s_mov_b32 s61, 294912
    buffer_load_dwordx4 v3, s[76:79], s61 offen  lds
    s_add_u32 m0, s72, 10240
    s_mov_b32 s61, 1310720
    buffer_load_dwordx4 v3, s[76:79], s61 offen  lds
    s_add_u32 m0, s72, 11264
    s_mov_b32 s61, 1343488
    buffer_load_dwordx4 v3, s[76:79], s61 offen  lds
    global_store_dword v113, v123, s[36:37] sc1
    v_mbcnt_lo_u32_b32 v1, -1, 0
    v_and_b32 v1, 15, v1
    v_lshlrev_b32 v1, 4, v1
    global_load_dword v2, v1, s[18:19] sc1
    s_waitcnt lgkmcnt(0)
    s_waitcnt vmcnt(14)
    s_barrier
    ds_read_b64_tr_b16 a[144:145], v6 offset:16384
    ds_read_b64_tr_b16 a[146:147], v4 offset:16384
    ds_read_b64_tr_b16 a[148:149], v7 offset:16384
    ds_read_b64_tr_b16 a[150:151], v5 offset:16384
    ds_read_b64_tr_b16 a[152:153], v6 offset:16416
    ds_read_b64_tr_b16 a[154:155], v4 offset:16416
    ds_read_b64_tr_b16 a[156:157], v7 offset:16416
    ds_read_b64_tr_b16 a[158:159], v5 offset:16416
    s_add_u32 m0, s72, 20480
    s_mov_b32 s61, 393216
    buffer_load_dwordx4 v3, s[76:79], s61 offen  lds
    s_add_u32 m0, s72, 21504
    s_mov_b32 s61, 425984
    buffer_load_dwordx4 v3, s[76:79], s61 offen  lds
    s_add_u32 m0, s72, 22528
    s_mov_b32 s61, 1441792
    buffer_load_dwordx4 v3, s[76:79], s61 offen  lds
    s_add_u32 m0, s72, 23552
    s_mov_b32 s61, 1474560
    buffer_load_dwordx4 v3, s[76:79], s61 offen  lds
    s_waitcnt lgkmcnt(0)
    s_waitcnt vmcnt(14)
    s_barrier
    ds_read_b64_tr_b16 a[96:97], v6 offset:12288
    ds_read_b64_tr_b16 a[98:99], v4 offset:12288
    ds_read_b64_tr_b16 a[100:101], v7 offset:12288
    ds_read_b64_tr_b16 a[102:103], v5 offset:12288
    ds_read_b64_tr_b16 a[104:105], v6 offset:12320
    ds_read_b64_tr_b16 a[106:107], v4 offset:12320
    ds_read_b64_tr_b16 a[108:109], v7 offset:12320
    ds_read_b64_tr_b16 a[110:111], v5 offset:12320
    s_add_u32 m0, s72, 16384
    s_mov_b32 s61, 524288
    buffer_load_dwordx4 v3, s[76:79], s61 offen  lds
    s_add_u32 m0, s72, 17408
    s_mov_b32 s61, 557056
    buffer_load_dwordx4 v3, s[76:79], s61 offen  lds
    s_add_u32 m0, s72, 18432
    s_mov_b32 s61, 1572864
    buffer_load_dwordx4 v3, s[76:79], s61 offen  lds
    s_add_u32 m0, s72, 19456
    s_mov_b32 s61, 1605632
    buffer_load_dwordx4 v3, s[76:79], s61 offen  lds
    s_waitcnt lgkmcnt(0)
    s_waitcnt vmcnt(14)
    s_barrier
    ds_read_b64_tr_b16 a[64:65], v6 offset:4096
    ds_read_b64_tr_b16 a[66:67], v4 offset:4096
    ds_read_b64_tr_b16 a[68:69], v7 offset:4096
    ds_read_b64_tr_b16 a[70:71], v5 offset:4096
    ds_read_b64_tr_b16 a[72:73], v6 offset:4128
    ds_read_b64_tr_b16 a[74:75], v4 offset:4128
    ds_read_b64_tr_b16 a[76:77], v7 offset:4128
    ds_read_b64_tr_b16 a[78:79], v5 offset:4128
    s_add_u32 m0, s72, 12288
    s_mov_b32 s61, 655360
    buffer_load_dwordx4 v3, s[76:79], s61 offen  lds
    s_add_u32 m0, s72, 13312
    s_mov_b32 s61, 688128
    buffer_load_dwordx4 v3, s[76:79], s61 offen  lds
    s_add_u32 m0, s72, 14336
    s_mov_b32 s61, 1703936
    buffer_load_dwordx4 v3, s[76:79], s61 offen  lds
    s_add_u32 m0, s72, 15360
    s_mov_b32 s61, 1736704
    buffer_load_dwordx4 v3, s[76:79], s61 offen  lds
    s_waitcnt lgkmcnt(0)
    s_waitcnt vmcnt(14)
    s_barrier
    ds_read_b64_tr_b16 a[32:33], v6 offset:8192
    ds_read_b64_tr_b16 a[34:35], v4 offset:8192
    ds_read_b64_tr_b16 a[36:37], v7 offset:8192
    ds_read_b64_tr_b16 a[38:39], v5 offset:8192
    ds_read_b64_tr_b16 a[40:41], v6 offset:8224
    ds_read_b64_tr_b16 a[42:43], v4 offset:8224
    ds_read_b64_tr_b16 a[44:45], v7 offset:8224
    ds_read_b64_tr_b16 a[46:47], v5 offset:8224
    s_add_u32 m0, s72, 4096
    s_mov_b32 s61, 786432
    buffer_load_dwordx4 v3, s[76:79], s61 offen  lds
    s_add_u32 m0, s72, 5120
    s_mov_b32 s61, 819200
    buffer_load_dwordx4 v3, s[76:79], s61 offen  lds
    s_add_u32 m0, s72, 6144
    s_mov_b32 s61, 1835008
    buffer_load_dwordx4 v3, s[76:79], s61 offen  lds
    s_add_u32 m0, s72, 7168
    s_mov_b32 s61, 1867776
    buffer_load_dwordx4 v3, s[76:79], s61 offen  lds
    s_waitcnt lgkmcnt(0)
    s_waitcnt vmcnt(12)
    s_barrier
    ds_read_b64_tr_b16 a[0:1], v6 offset:20480
    ds_read_b64_tr_b16 a[2:3], v4 offset:20480
    ds_read_b64_tr_b16 a[4:5], v7 offset:20480
    ds_read_b64_tr_b16 a[6:7], v5 offset:20480
    ds_read_b64_tr_b16 a[8:9], v6 offset:20512
    ds_read_b64_tr_b16 a[10:11], v4 offset:20512
    ds_read_b64_tr_b16 a[12:13], v7 offset:20512
    ds_read_b64_tr_b16 a[14:15], v5 offset:20512
    s_add_u32 m0, s72, 8192
    s_mov_b32 s61, 917504
    buffer_load_dwordx4 v3, s[76:79], s61 offen  lds
    s_add_u32 m0, s72, 9216
    s_mov_b32 s61, 950272
    buffer_load_dwordx4 v3, s[76:79], s61 offen  lds
    s_add_u32 m0, s72, 10240
    s_mov_b32 s61, 1966080
    buffer_load_dwordx4 v3, s[76:79], s61 offen  lds
    s_add_u32 m0, s72, 11264
    s_mov_b32 s61, 1998848
    buffer_load_dwordx4 v3, s[76:79], s61 offen  lds
    s_waitcnt lgkmcnt(0)
    s_waitcnt vmcnt(12)
    s_barrier
    ds_read_b64_tr_b16 a[112:113], v6 offset:16384
    ds_read_b64_tr_b16 a[114:115], v4 offset:16384
    ds_read_b64_tr_b16 a[116:117], v7 offset:16384
    ds_read_b64_tr_b16 a[118:119], v5 offset:16384
    ds_read_b64_tr_b16 a[120:121], v6 offset:16416
    ds_read_b64_tr_b16 a[122:123], v4 offset:16416
    ds_read_b64_tr_b16 a[124:125], v7 offset:16416
    ds_read_b64_tr_b16 a[126:127], v5 offset:16416
    ds_write_b128 v118, v[88:91] offset:20480
    ds_write_b128 v118, v[92:95] offset:21504
    ds_write_b128 v118, v[96:99] offset:22528
    ds_write_b128 v118, v[100:103] offset:23552
    global_load_dword v123, v122, s[96:97] sc1
    s_waitcnt lgkmcnt(0)
    s_waitcnt vmcnt(9)
    s_barrier
    ds_read_b64_tr_b16 a[80:81], v6 offset:12288
    ds_read_b64_tr_b16 a[82:83], v4 offset:12288
    ds_read_b64_tr_b16 a[84:85], v7 offset:12288
    ds_read_b64_tr_b16 a[86:87], v5 offset:12288
    ds_read_b64_tr_b16 a[88:89], v6 offset:12320
    ds_read_b64_tr_b16 a[90:91], v4 offset:12320
    ds_read_b64_tr_b16 a[92:93], v7 offset:12320
    ds_read_b64_tr_b16 a[94:95], v5 offset:12320
    ds_write_b128 v118, v[72:75] offset:16384
    ds_write_b128 v118, v[76:79] offset:17408
    ds_write_b128 v118, v[80:83] offset:18432
    ds_write_b128 v118, v[84:87] offset:19456
    s_waitcnt lgkmcnt(0)
    s_waitcnt vmcnt(5)
    s_barrier
    ds_read_b64_tr_b16 a[48:49], v6 offset:4096
    ds_read_b64_tr_b16 a[50:51], v4 offset:4096
    ds_read_b64_tr_b16 a[52:53], v7 offset:4096
    ds_read_b64_tr_b16 a[54:55], v5 offset:4096
    ds_read_b64_tr_b16 a[56:57], v6 offset:4128
    ds_read_b64_tr_b16 a[58:59], v4 offset:4128
    ds_read_b64_tr_b16 a[60:61], v7 offset:4128
    ds_read_b64_tr_b16 a[62:63], v5 offset:4128
    ds_write_b128 v118, v[56:59] offset:12288
    ds_write_b128 v118, v[60:63] offset:13312
    ds_write_b128 v118, v[64:67] offset:14336
    ds_write_b128 v118, v[68:71] offset:15360
    s_waitcnt lgkmcnt(0)
    s_waitcnt vmcnt(1)
    s_barrier
    ds_read_b64_tr_b16 a[16:17], v6 offset:8192
    ds_read_b64_tr_b16 a[18:19], v4 offset:8192
    ds_read_b64_tr_b16 a[20:21], v7 offset:8192
    ds_read_b64_tr_b16 a[22:23], v5 offset:8192
    ds_read_b64_tr_b16 a[24:25], v6 offset:8224
    ds_read_b64_tr_b16 a[26:27], v4 offset:8224
    ds_read_b64_tr_b16 a[28:29], v7 offset:8224
    ds_read_b64_tr_b16 a[30:31], v5 offset:8224
    ds_write_b128 v118, v[24:27] offset:4096
    ds_write_b128 v118, v[28:31] offset:5120
    ds_write_b128 v118, v[32:35] offset:6144
    ds_write_b128 v118, v[36:39] offset:7168
    s_waitcnt vmcnt(0)
    global_load_dwordx4 a[240:243], v105, s[42:43] offset:0 sc1
    global_load_dwordx4 a[244:247], v105, s[42:43] offset:1024 sc1
    global_load_dwordx4 a[248:251], v105, s[42:43] offset:2048 sc1
    global_load_dwordx4 a[252:255], v105, s[42:43] offset:3072 sc1
    s_waitcnt lgkmcnt(0)
    s_barrier
    ds_write_b128 v118, v[40:43] offset:8192
    ds_write_b128 v118, v[44:47] offset:9216
    ds_write_b128 v118, v[48:51] offset:10240
    ds_write_b128 v118, v[52:55] offset:11264
L_cs_wdone:
    s_mov_b32 s26, 0
    s_lshl_b32 s59, s3, 1
    s_add_u32 s59, s59, 13
    v_readlane_b32 s60, v2, s59
    s_lshl_b32 s59, s3, 1
    s_add_u32 s59, s59, 13
    s_branch L_cs_w0
L_cs_wa:
    global_load_dword v2, v1, s[18:19] sc1
    s_waitcnt vmcnt(0)
L_cs_w0:
    v_readlane_b32 s58, v2, s59
    s_cmp_ge_u32 s58, 256
    s_cbranch_scc1 L_cs_wb
    s_sleep 16
    s_sub_u32 s27, s27, 1
    s_cbranch_scc0 L_cs_wa
    s_branch L_end
L_cs_wb:
    s_cmp_eq_u32 s3, 1
    s_cbranch_scc1 L_cs_wc
    v_cmp_ne_u32 vcc, 32, v2
    s_and_b32 s58, vcc_lo, 0x5555
    s_cbranch_scc0 L_cs_wc
    global_load_dword v2, v1, s[18:19] sc1
    s_waitcnt vmcnt(0)
    v_cmp_ne_u32 vcc, 32, v2
    s_and_b32 s58, vcc_lo, 0x5555
    s_cbranch_scc1 L_safe
L_cs_wc:
    s_mov_b32 s59, 1
    v_cmp_ge_u32 vcc, s59, v123
    s_cmp_ge_u32 s60, 256
    s_cbranch_scc0 L_cs_fl0
    s_cbranch_vccz L_cs_kvok
L_cs_fl0:
    global_load_dword v123, v122, s[96:97] sc1
    s_waitcnt vmcnt(0)
    v_cmp_ge_u32 vcc, s59, v123
    s_cbranch_vccz L_cs_fl0ok
    s_sleep 1
    s_sub_u32 s27, s27, 1
    s_cbranch_scc0 L_cs_fl0
    s_branch L_end
L_cs_fl0ok:
    global_load_dwordx4 a[240:243], v105, s[42:43] offset:0 sc1
    global_load_dwordx4 a[244:247], v105, s[42:43] offset:1024 sc1
    global_load_dwordx4 a[248:251], v105, s[42:43] offset:2048 sc1
    global_load_dwordx4 a[252:255], v105, s[42:43] offset:3072 sc1
L_cs_kvok:
    s_add_u32 s42, s42, 524288
    s_addc_u32 s43, s43, 0
    s_waitcnt lgkmcnt(0)
    s_mov_b32 s30, 0x40000
    s_mov_b32 s31, 0x20000
    s_mov_b32 s12, 0x3f803f80
    s_mov_b32 s13, 0x3f803f80
    s_add_u32 s62, s28, 0x40000
    s_addc_u32 s63, s29, 0
    s_xor_b64 s[62:63], s[62:63], s[28:29]
    s_xor_b64 s[6:7], s[34:35], s[46:47]
    s_xor_b64 s[16:17], s[36:37], s[38:39]
    s_add_u32 s68, s40, 0x2000
    s_addc_u32 s69, s41, 0
    s_xor_b64 s[68:69], s[68:69], s[40:41]
    s_xor_b64 s[28:29], s[28:29], s[62:63]
    s_mov_b64 s[34:35], s[46:47]
    s_sub_u32 s44, s44, 131072
    s_subb_u32 s45, s45, 0
    s_mov_b32 s8, s4
    s_mov_b32 s9, s5
    s_cmp_eq_u32 s23, 0
    s_cselect_b32 s10, 4, 0
    s_mov_b32 s11, 0x20000
    v_mov_b64 v[64:65], 0
    v_mov_b64 v[66:67], 0
    v_mov_b64 v[68:69], 0
    v_mov_b64 v[70:71], 0
    v_mov_b64 v[72:73], 0
    v_mov_b64 v[74:75], 0
    v_mov_b64 v[76:77], 0
    v_mov_b64 v[78:79], 0
    v_mov_b64 v[80:81], 0
    v_mov_b64 v[82:83], 0
    v_mov_b64 v[84:85], 0
    v_mov_b64 v[86:87], 0
    ds_read_b128 v[32:35], v118 offset:0
    ds_read_b128 v[36:39], v118 offset:1024
    ds_read_b128 v[40:43], v118 offset:2048
    ds_read_b128 v[44:47], v118 offset:3072
    ds_read_b128 v[48:51], v118 offset:4096
    ds_read_b128 v[52:55], v118 offset:5120
    ds_read_b128 v[56:59], v118 offset:6144
    ds_read_b128 v[60:63], v118 offset:7168
    global_load_dwordx4 v[0:3], v105, s[40:41] offset:-2048 sc1
    v_mov_b32 v121, 1
    s_mov_b64 s[14:15], -1
    s_waitcnt vmcnt(0) lgkmcnt(0)
    v_accvgpr_read_b32 v88, a240
    v_accvgpr_read_b32 v89, a241
    v_accvgpr_read_b32 v90, a242
    v_accvgpr_read_b32 v91, a243
    v_accvgpr_read_b32 v92, a244
    v_accvgpr_read_b32 v93, a245
    v_accvgpr_read_b32 v94, a246
    v_accvgpr_read_b32 v95, a247
    v_accvgpr_read_b32 v100, a252
    v_accvgpr_read_b32 v101, a253
    v_accvgpr_read_b32 v102, a254
    v_accvgpr_read_b32 v103, a255
    s_branch L_cs_chk
.p2align 6
    s_nop 0
L_cs_mefail:
    s_mov_b64 exec, vcc
L_cs_mestart:
    global_load_dwordx4 v[0:3], v105, s[40:41] offset:-2048 sc1
    s_mov_b64 exec, -1
L_cs_mewait:
    v_max3_u32 v28, v0, v1, v2
    v_max_u32 v28, v28, v3
    v_cmp_le_u32 vcc, s71, v28
    s_cbranch_vccz L_cs_go
    s_sub_u32 s27, s27, 1
    s_cbranch_scc1 L_end
L_cs_chk:
    v_max3_u32 v28, v0, v1, v2
    v_max_u32 v28, v28, v3
    v_cmp_le_u32 vcc, s71, v28
    s_cbranch_vccnz L_cs_mefail
L_cs_go:
    ds_write_b128 v114, v[0:3] offset:0
    v_smfmac_f32_16x16x64_bf16 v[64:67], v[0:3], a[0:7], v104
    global_store_dword v113, v124, s[38:39] sc1
    v_smfmac_f32_16x16x64_bf16 v[68:71], v[0:3], a[8:15], v104
    global_load_dwordx4 v[4:7], v105, s[40:41] offset:2048 sc1
    v_smfmac_f32_16x16x64_bf16 v[72:75], v[0:3], v[32:39], v104
    v_smfmac_f32_16x16x64_bf16 v[76:79], v[0:3], v[40:47], v104
    s_waitcnt lgkmcnt(0)
    s_barrier
    ds_read_b128 v[8:11], v115 offset:0
    v_smfmac_f32_16x16x64_bf16 v[80:83], v[0:3], a[128:135], v104
    ds_read_b128 v[16:19], v116 offset:0
    v_smfmac_f32_16x16x64_bf16 v[84:87], v[0:3], a[136:143], v104
    ds_read_b128 v[24:27], v117 offset:0
    s_waitcnt lgkmcnt(2)
    v_smfmac_f32_16x16x64_bf16 v[64:67], v[8:11], a[32:39], v104
    ds_read_b128 v[32:35], v118 offset:8192
    v_smfmac_f32_16x16x64_bf16 v[68:71], v[8:11], a[40:47], v104
    ds_read_b128 v[36:39], v118 offset:9216
    v_smfmac_f32_16x16x64_bf16 v[72:75], v[8:11], v[48:55], v104
    ds_read_b128 v[40:43], v118 offset:10240
    v_smfmac_f32_16x16x64_bf16 v[76:79], v[8:11], v[56:63], v104
    ds_read_b128 v[44:47], v118 offset:11264
    s_waitcnt lgkmcnt(4)
    v_smfmac_f32_16x16x64_bf16 v[64:67], v[16:19], a[64:71], v104
    global_load_dwordx4 v[4:7], v105, s[40:41] offset:2048 sc1
    v_smfmac_f32_16x16x64_bf16 v[68:71], v[16:19], a[72:79], v104
    ds_read_b128 v[48:51], v118 offset:12288
    v_smfmac_f32_16x16x64_bf16 v[72:75], v[16:19], v[208:215], v104
    ds_read_b128 v[52:55], v118 offset:13312
    v_smfmac_f32_16x16x64_bf16 v[76:79], v[16:19], v[216:223], v104
    global_load_dwordx4 a[240:243], v105, s[42:43] offset:0 sc1
    v_smfmac_f32_16x16x64_bf16 v[64:67], v[24:27], a[96:103], v104
    ds_read_b128 v[56:59], v118 offset:14336
    v_smfmac_f32_16x16x64_bf16 v[68:71], v[24:27], a[104:111], v104
    s_waitcnt vmcnt(2)
    v_max3_u32 v28, v4, v5, v6
    v_smfmac_f32_16x16x64_bf16 v[72:75], v[24:27], v[240:247], v104
    v_max_u32 v28, v28, v7
    ds_write_b128 v114, v[4:7] offset:1024
    v_smfmac_f32_16x16x64_bf16 v[76:79], v[24:27], v[248:255], v104
    global_store_dwordx4 v105, v[96:99], s[44:45] sc1
    global_load_dwordx4 a[244:247], v105, s[42:43] offset:1024 sc1
    v_cmp_le_u32 vcc, s71, v28
    v_smfmac_f32_16x16x64_bf16 v[80:83], v[8:11], a[160:167], v104
    buffer_store_dword v121, v105, s[8:11], 0 offen sc1
    v_accvgpr_read_b32 v96, a248
    v_smfmac_f32_16x16x64_bf16 v[84:87], v[8:11], a[168:175], v104
    s_cbranch_vccnz L_cs_mlfail2
L_cs_mlok:
    s_waitcnt lgkmcnt(0)
    s_barrier
    ds_read_b128 v[12:15], v115 offset:1024
    v_smfmac_f32_16x16x64_bf16 v[64:67], v[4:7], a[16:23], v104
    ds_read_b128 v[20:23], v116 offset:1024
    v_accvgpr_read_b32 v97, a249
    v_smfmac_f32_16x16x64_bf16 v[68:71], v[4:7], a[24:31], v104
    ds_read_b128 v[28:31], v117 offset:1024
    v_accvgpr_read_b32 v98, a250
    v_smfmac_f32_16x16x64_bf16 v[72:75], v[4:7], v[32:39], v104
    global_load_dwordx4 a[252:255], v105, s[42:43] offset:3072 sc1
    v_accvgpr_read_b32 v99, a251
    v_smfmac_f32_16x16x64_bf16 v[76:79], v[4:7], v[40:47], v104
    ds_read_b128 v[60:63], v118 offset:15360
    s_waitcnt lgkmcnt(3)
    v_smfmac_f32_16x16x64_bf16 v[64:67], v[12:15], a[48:55], v104
    ds_read_b128 v[32:35], v118 offset:16384
    v_smfmac_f32_16x16x64_bf16 v[72:75], v[12:15], v[48:55], v104
    global_load_dwordx4 a[248:251], v105, s[42:43] offset:2048 sc1
    s_waitcnt lgkmcnt(2)
    v_smfmac_f32_16x16x64_bf16 v[64:67], v[20:23], a[80:87], v104
    ds_read_b128 v[36:39], v118 offset:17408
    v_mov_b32 v1, 0
    v_smfmac_f32_16x16x64_bf16 v[72:75], v[20:23], v[224:231], v104
    ds_read_b128 v[40:43], v118 offset:18432
    v_mov_b32 v2, 0
    v_smfmac_f32_16x16x64_bf16 v[64:67], v[28:31], a[112:119], v104
    ds_read_b128 v[44:47], v118 offset:19456
    v_mov_b64 v[8:9], s[12:13]
    v_smfmac_f32_16x16x64_bf16 v[72:75], v[28:31], a[224:231], v104
    ds_read_b128 v[48:51], v118 offset:20480
    v_mov_b64 v[10:11], s[12:13]
    v_smfmac_f32_16x16x64_bf16 v[68:71], v[12:15], a[56:63], v104
    ds_read_b128 v[52:55], v118 offset:21504
    v_add_f32 v64, v64, v66
    s_waitcnt lgkmcnt(6)
    v_smfmac_f32_16x16x64_bf16 v[76:79], v[12:15], v[56:63], v104
    ds_read_b128 v[56:59], v118 offset:22528
    v_add_f32 v65, v65, v67
    v_smfmac_f32_16x16x64_bf16 v[68:71], v[20:23], a[88:95], v104
    ds_read_b128 v[60:63], v118 offset:23552
    v_cvt_pk_bf16_f32 v66, v64, v65
    v_smfmac_f32_16x16x64_bf16 v[68:71], v[28:31], a[120:127], v104
    v_add_f32 v72, v72, v74
    v_smfmac_f32_16x16x64_bf16 v[76:79], v[20:23], v[232:239], v104
    s_mov_b64 vcc, s[48:49]
    v_add_f32 v73, v73, v75
    v_smfmac_f32_16x16x64_bf16 v[76:79], v[28:31], a[232:239], v104
    v_cvt_pk_bf16_f32 v67, v72, v73
    v_add_f32 v68, v68, v70
    v_add_f32 v69, v69, v71
    v_mfma_f32_16x16x16_bf16 v[72:75], v[66:67], v[106:107], 0
    v_cvt_pk_bf16_f32 v70, v68, v69
    s_nop 0
    v_add_f32 v76, v76, v78
    v_add_f32 v77, v77, v79
    v_cvt_pk_bf16_f32 v71, v76, v77
    s_xor_b64 s[36:37], s[36:37], s[16:17]
    s_xor_b64 s[38:39], s[38:39], s[16:17]
    v_mfma_f32_16x16x16_bf16 v[76:79], v[70:71], v[106:107], 0
    global_store_dwordx4 v105, v[124:127], s[34:35] offset:1024 sc1
    v_cvt_pk_bf16_f32 v64, v72, v73
    v_cvt_pk_bf16_f32 v65, v74, v75
    s_nop 4
    v_cvt_pk_bf16_f32 v66, v76, v77
    v_cvt_pk_bf16_f32 v67, v78, v79
    s_xor_b64 s[40:41], s[40:41], s[68:69]
    s_xor_b64 s[28:29], s[28:29], s[62:63]
    v_mfma_f32_16x16x32_bf16 v[72:75], v[88:91], v[64:67], 0
    s_mov_b64 exec, s[14:15]
    global_load_dword v123, v122, s[96:97] sc1
    s_mov_b64 exec, -1
    v_mfma_f32_16x16x32_bf16 v[76:79], v[92:95], v[64:67], 0
    s_add_u32 s42, s42, 524288
    s_addc_u32 s43, s43, 0
    v_mfma_f32_16x16x32_bf16 v[68:71], v[64:67], v[64:67], 0
    s_add_u32 s44, s44, 131072
    s_addc_u32 s45, s45, 0
    s_nop 1
    v_cndmask_b32_dpp v72, v76, v72, vcc quad_perm:[2,3,2,3] row_mask:0xf bank_mask:0xf
    v_cndmask_b32_dpp v73, v77, v73, vcc quad_perm:[2,3,2,3] row_mask:0xf bank_mask:0xf
    v_cndmask_b32_dpp v74, v78, v74, vcc quad_perm:[2,3,2,3] row_mask:0xf bank_mask:0xf
    v_cndmask_b32_dpp v75, v79, v75, vcc quad_perm:[2,3,2,3] row_mask:0xf bank_mask:0xf
    v_cndmask_b32_dpp v68, v69, v68, vcc quad_perm:[2,3,2,3] row_mask:0xf bank_mask:0xf
    ds_write_b128 v114, v[72:75] offset:8192
    ds_write_b32 v119, v68 offset:9216
    global_store_dwordx4 v105, v[124:127], s[34:35] offset:0 sc1
    s_waitcnt lgkmcnt(8)
    v_smfmac_f32_16x16x64_bf16 v[80:83], v[20:23], v[32:39], v104
    ds_read_b128 v[32:35], v118 offset:24576
    s_waitcnt lgkmcnt(7)
    v_smfmac_f32_16x16x64_bf16 v[84:87], v[20:23], v[40:47], v104
    v_mov_b64 v[20:21], 0
    s_waitcnt lgkmcnt(5)
    v_smfmac_f32_16x16x64_bf16 v[80:83], v[28:31], v[48:55], v104
    v_mov_b64 v[22:23], 0
    s_waitcnt vmcnt(9) lgkmcnt(1)
    s_barrier
    ds_read_b128 v[76:79], v115 offset:8192
    v_smfmac_f32_16x16x64_bf16 v[84:87], v[28:31], v[56:63], v104
    ds_read_b128 v[88:91], v116 offset:8192
    ds_read_b128 v[92:95], v117 offset:8192
    ds_read_b128 v[68:71], v105 offset:9216
    v_smfmac_f32_16x16x64_bf16 v[80:83], v[16:19], a[192:199], v104
    ds_read_b128 v[36:39], v118 offset:25600
    v_mov_b64 v[28:29], 0
    v_smfmac_f32_16x16x64_bf16 v[84:87], v[16:19], a[200:207], v104
    ds_read_b128 v[40:43], v118 offset:26624
    v_mov_b64 v[30:31], 0
    v_smfmac_f32_16x16x64_bf16 v[80:83], v[24:27], a[208:215], v104
    ds_read_b128 v[44:47], v118 offset:27648
    v_mov_b64 v[16:17], 0
    v_smfmac_f32_16x16x64_bf16 v[84:87], v[24:27], a[216:223], v104
    s_not_b64 vcc, vcc
    s_cmp_ge_u32 s26, 63
    v_mov_b64 v[18:19], 0
    v_smfmac_f32_16x16x64_bf16 v[80:83], v[4:7], a[144:151], v104
    s_cbranch_scc1 L_cs_done
    s_waitcnt lgkmcnt(6)
    v_add_f32 v72, v72, v76
    v_add_f32 v73, v73, v77
    v_add_f32 v74, v74, v78
    v_add_f32 v75, v75, v79
    s_waitcnt lgkmcnt(3)
    v_pk_add_f32 v[88:89], v[88:89], v[92:93]
    v_pk_add_f32 v[90:91], v[90:91], v[94:95]
    v_pk_add_f32 v[68:69], v[68:69], v[70:71]
    v_pk_add_f32 v[72:73], v[72:73], v[88:89]
    v_pk_add_f32 v[74:75], v[74:75], v[90:91]
    v_add_f32 v68, v68, v69
    v_max3_f32 v69, v72, v73, v74
    v_max3_f32 v69, v69, v75, v68
    v_smfmac_f32_16x16x64_bf16 v[84:87], v[4:7], a[152:159], v104
    ds_read_b128 v[48:51], v118 offset:28672
    v_max_f32_dpp v69, v69, v69 quad_perm:[2,3,0,1] row_mask:0xf bank_mask:0xf
    v_mov_b32 v70, v69
    v_smfmac_f32_16x16x64_bf16 v[80:83], v[12:15], a[176:183], v104
    ds_read_b128 v[52:55], v118 offset:29696
    v_permlane16_swap_b32 v69, v70
    v_max_f32 v69, v69, v70
    v_mov_b32 v70, v69
    v_smfmac_f32_16x16x64_bf16 v[84:87], v[12:15], a[184:191], v104
    ds_read_b128 v[56:59], v118 offset:30720
    v_permlane32_swap_b32 v69, v70
    v_max_f32 v70, v69, v70
    v_sub_f32 v68, v68, v70
    v_pk_add_f32 v[72:73], v[72:73], v[70:71] op_sel_hi:[1,0] neg_lo:[0,1] neg_hi:[0,1]
    v_pk_add_f32 v[74:75], v[74:75], v[70:71] op_sel_hi:[1,0] neg_lo:[0,1] neg_hi:[0,1]
    v_pk_mul_f32 v[72:73], v[72:73], s[98:99]
    v_pk_mul_f32 v[74:75], v[74:75], s[98:99]
    v_mul_f32 v68, s98, v68
    v_exp_f32 v72, v72
    v_exp_f32 v73, v73
    v_exp_f32 v74, v74
    v_cvt_pk_bf16_f32 v72, v72, v73
    v_exp_f32 v75, v75
    v_exp_f32 v68, v68
    v_cvt_pk_bf16_f32 v74, v74, v75
    v_mov_b32_dpp v88, v72 quad_perm:[2,3,2,3] row_mask:0xf bank_mask:0xf
    v_mov_b32_dpp v90, v72 quad_perm:[0,1,0,1] row_mask:0xf bank_mask:0xf
    v_mov_b32_dpp v89, v74 quad_perm:[2,3,2,3] row_mask:0xf bank_mask:0xf
    v_mov_b32_dpp v91, v74 quad_perm:[0,1,0,1] row_mask:0xf bank_mask:0xf
    v_mov_b32_dpp v69, v68 quad_perm:[2,3,2,3] row_mask:0xf bank_mask:0xf
    v_mov_b32_dpp v70, v68 quad_perm:[0,1,0,1] row_mask:0xf bank_mask:0xf
    v_mfma_f32_16x16x32_bf16 v[92:95], v[8:11], v[88:91], 0
    v_cvt_pk_bf16_f32 v0, v69, v70
    v_cvt_pk_bf16_f32 v3, v69, v70
    v_mfma_f32_16x16x32_bf16 v[76:79], v[100:103], v[88:91], 0
    v_add_f32 v80, v80, v82
    v_add_f32 v81, v81, v83
    v_mfma_f32_16x16x32_bf16 v[72:75], v[96:99], v[88:91], 0
    v_add_f32 v84, v84, v86
    v_add_f32 v85, v85, v87
    v_cvt_pk_bf16_f32 v82, v80, v81
    v_mfma_f32_16x16x16_bf16 v[92:95], v[8:9], v[0:1], v[92:95]
    v_cvt_pk_bf16_f32 v83, v84, v85
    ds_read_b128 v[60:63], v118 offset:31744
    s_nop 0
    v_mfma_f32_16x16x16_bf16 v[76:79], v[82:83], v[2:3], v[76:79]
    v_mov_b64 v[24:25], 0
    v_mov_b64 v[26:27], 0
    v_mfma_f32_16x16x16_bf16 v[72:75], v[82:83], v[0:1], v[72:75]
    v_rcp_f32 v68, v92
    s_waitcnt lgkmcnt(4)
    s_nop 0
    v_mul_f32 v76, v76, v68
    v_mul_f32 v77, v77, v68
    v_pk_mul_f32 v[78:79], v[78:79], v[68:69] op_sel_hi:[1,0]
    v_cvt_pk_bf16_f32 v86, v76, v77
    v_cvt_pk_bf16_f32 v87, v78, v79
    v_pk_mul_f32 v[72:73], v[72:73], v[68:69] op_sel_hi:[1,0]
    v_pk_mul_f32 v[74:75], v[74:75], v[68:69] op_sel_hi:[1,0]
    v_cvt_pk_bf16_f32 v84, v72, v73
    v_cvt_pk_bf16_f32 v85, v74, v75
    ds_write_b128 v114, v[84:87] offset:0
    s_nop 0
    v_smfmac_f32_16x16x64_bf16 v[20:23], v[84:87], v[32:39], v104
    s_add_u32 s26, s26, 1
    s_xor_b64 s[34:35], s[34:35], s[6:7]
    v_cndmask_b32 v96, v82, v64, vcc
    v_smfmac_f32_16x16x64_bf16 v[28:31], v[84:87], v[40:47], v104
    s_add_u32 s59, s26, 1
    s_min_u32 s59, s59, 63
    v_cndmask_b32 v97, v83, v65, vcc
    s_waitcnt lgkmcnt(0)
    s_barrier
    ds_read_b128 v[68:71], v115 offset:0
    v_smfmac_f32_16x16x64_bf16 v[16:19], v[84:87], v[48:55], v104
    ds_read_b128 v[72:75], v116 offset:0
    ds_read_b128 v[76:79], v117 offset:0
    s_cmp_eq_u32 s32, 1
    v_smfmac_f32_16x16x64_bf16 v[24:27], v[84:87], v[56:63], v104
    s_waitcnt lgkmcnt(2)
    v_smfmac_f32_16x16x64_bf16 v[20:23], v[68:71], v[128:135], v104
    s_waitcnt lgkmcnt(0)
    v_smfmac_f32_16x16x64_bf16 v[20:23], v[72:75], v[136:143], v104
    ds_read_b128 v[32:35], v118 offset:32768
    v_cndmask_b32_dpp v98, v82, v66, vcc quad_perm:[2,3,0,1] row_mask:0xf bank_mask:0xf
    v_smfmac_f32_16x16x64_bf16 v[20:23], v[76:79], v[144:151], v104
    ds_read_b128 v[36:39], v118 offset:33792
    v_cndmask_b32_dpp v99, v83, v67, vcc quad_perm:[2,3,0,1] row_mask:0xf bank_mask:0xf
    v_smfmac_f32_16x16x64_bf16 v[28:31], v[68:71], v[152:159], v104
    ds_read_b128 v[40:43], v118 offset:34816
    v_mov_b64 v[0:1], v[124:125]
    v_smfmac_f32_16x16x64_bf16 v[28:31], v[72:75], v[160:167], v104
    ds_read_b128 v[44:47], v118 offset:35840
    v_cvt_pk_bf16_f32 v20, v20, v21
    v_smfmac_f32_16x16x64_bf16 v[28:31], v[76:79], v[168:175], v104
    buffer_store_dword v20, v112, s[28:31], s50 offen sc1
    v_cvt_pk_bf16_f32 v22, v22, v23
    v_smfmac_f32_16x16x64_bf16 v[16:19], v[68:71], v[176:183], v104
    buffer_store_dword v22, v112, s[28:31], s51 offen sc1
    v_mov_b64 v[2:3], v[124:125]
    v_smfmac_f32_16x16x64_bf16 v[16:19], v[72:75], v[184:191], v104
    v_cvt_pk_bf16_f32 v28, v28, v29
    v_smfmac_f32_16x16x64_bf16 v[16:19], v[76:79], v[192:199], v104
    buffer_store_dword v28, v112, s[28:31], s52 offen sc1
    v_cvt_pk_bf16_f32 v30, v30, v31
    v_smfmac_f32_16x16x64_bf16 v[24:27], v[68:71], v[200:207], v104
    buffer_store_dword v30, v112, s[28:31], s53 offen sc1
    s_waitcnt lgkmcnt(0)
    v_smfmac_f32_16x16x64_bf16 v[24:27], v[72:75], v[32:39], v104
    v_cvt_pk_bf16_f32 v16, v16, v17
    v_smfmac_f32_16x16x64_bf16 v[24:27], v[76:79], v[40:47], v104
    buffer_store_dword v16, v112, s[28:31], s54 offen sc1
    v_cvt_pk_bf16_f32 v18, v18, v19
    buffer_store_dword v18, v112, s[28:31], s55 offen sc1
    s_nop 3
    v_cvt_pk_bf16_f32 v24, v24, v25
    v_cvt_pk_bf16_f32 v26, v26, v27
    buffer_store_dword v24, v112, s[28:31], s56 offen sc1
    buffer_store_dword v26, v112, s[28:31], s57 offen sc1
    s_cbranch_scc1 L_cs_late
    ds_read_b128 v[32:35], v118 offset:0
    v_mov_b64 v[64:65], 0
    ds_read_b128 v[36:39], v118 offset:1024
    v_mov_b64 v[66:67], 0
    ds_read_b128 v[40:43], v118 offset:2048
    v_mov_b64 v[68:69], 0
    ds_read_b128 v[44:47], v118 offset:3072
    v_mov_b64 v[70:71], 0
    s_waitcnt vmcnt(4)
    global_load_dwordx4 v[4:7], v105, s[34:35] sc1
    global_load_dwordx4 v[12:15], v105, s[34:35] offset:1024 sc1
    ds_read_b128 v[48:51], v118 offset:4096
    ds_read_b128 v[52:55], v118 offset:5120
    ds_read_b128 v[56:59], v118 offset:6144
    ds_read_b128 v[60:63], v118 offset:7168
    s_waitcnt vmcnt(1)
    v_mfma_f32_16x16x32_bf16 v[8:11], v[108:111], v[4:7], 0
    s_waitcnt vmcnt(0)
    v_mfma_f32_16x16x32_bf16 v[8:11], v[108:111], v[12:15], v[8:11]
    s_nop 7
    v_add_f32_dpp v8, v8, v8 row_ror:4 row_mask:0xf bank_mask:0xf
    v_add_f32_dpp v9, v9, v9 row_ror:4 row_mask:0xf bank_mask:0xf
    v_cmp_u_f32 vcc, v10, v10
    v_add_f32_dpp v8, v8, v8 row_ror:8 row_mask:0xf bank_mask:0xf
    v_add_f32_dpp v9, v9, v9 row_ror:8 row_mask:0xf bank_mask:0xf
    v_cvt_pk_bf16_f32 v8, v8, v9
    global_store_dword v113, v8, s[36:37] sc1
    s_cbranch_vccnz L_cs_eret
L_cs_eok:
    s_waitcnt vmcnt(1)
    v_cmp_ge_u32 vcc, s59, v123
    v_accvgpr_read_b32 v88, a240
    v_accvgpr_read_b32 v89, a241
    v_accvgpr_read_b32 v90, a242
    v_accvgpr_read_b32 v91, a243
    v_accvgpr_read_b32 v92, a244
    v_accvgpr_read_b32 v93, a245
    v_accvgpr_read_b32 v94, a246
    v_accvgpr_read_b32 v95, a247
    v_accvgpr_read_b32 v100, a252
    v_accvgpr_read_b32 v101, a253
    v_accvgpr_read_b32 v102, a254
    v_accvgpr_read_b32 v103, a255
    s_cbranch_vccnz L_cs_fle
L_cs_floke:
    v_mov_b32 v121, s26
    s_add_u32 s59, s59, 4
    s_min_u32 s59, s59, 63
    v_cmp_ge_u32 vcc, s59, v123
    s_cmp_lg_u64 vcc, 0
    s_cselect_b64 s[14:15], -1, 0
    v_mov_b64 v[72:73], 0
    v_mov_b64 v[74:75], 0
    v_mov_b64 v[76:77], 0
    v_mov_b64 v[78:79], 0
    v_mov_b64 v[80:81], 0
    v_mov_b64 v[82:83], 0
    v_mov_b64 v[84:85], 0
    v_mov_b64 v[86:87], 0
    s_waitcnt lgkmcnt(0)
    s_branch L_cs_mestart
.p2align 5
L_cs_late:
    ds_read_b128 v[32:35], v118 offset:0
    v_mov_b64 v[64:65], 0
    ds_read_b128 v[36:39], v118 offset:1024
    v_mov_b64 v[66:67], 0
    ds_read_b128 v[40:43], v118 offset:2048
    v_mov_b64 v[68:69], 0
    ds_read_b128 v[44:47], v118 offset:3072
    v_mov_b64 v[70:71], 0
    ds_read_b128 v[48:51], v118 offset:4096
    v_mov_b64 v[72:73], 0
    ds_read_b128 v[52:55], v118 offset:5120
    v_mov_b64 v[74:75], 0
    ds_read_b128 v[56:59], v118 offset:6144
    v_mov_b64 v[76:77], 0
    ds_read_b128 v[60:63], v118 offset:7168
    v_mov_b64 v[78:79], 0
    v_mov_b64 v[80:81], 0
    v_mov_b64 v[82:83], 0
    v_mov_b64 v[84:85], 0
    v_mov_b64 v[86:87], 0
    s_waitcnt vmcnt(8)
    v_cmp_ge_u32 vcc, s59, v123
    v_accvgpr_read_b32 v88, a240
    v_accvgpr_read_b32 v89, a241
    v_accvgpr_read_b32 v90, a242
    v_accvgpr_read_b32 v91, a243
    v_accvgpr_read_b32 v92, a244
    v_accvgpr_read_b32 v93, a245
    v_accvgpr_read_b32 v94, a246
    v_accvgpr_read_b32 v95, a247
    v_accvgpr_read_b32 v100, a252
    v_accvgpr_read_b32 v101, a253
    v_accvgpr_read_b32 v102, a254
    v_accvgpr_read_b32 v103, a255
    s_cbranch_vccnz L_cs_fll
L_cs_flokl:
    v_mov_b32 v121, s26
    s_add_u32 s59, s59, 4
    s_min_u32 s59, s59, 63
    v_cmp_ge_u32 vcc, s59, v123
    s_cmp_lg_u64 vcc, 0
    s_cselect_b64 s[14:15], -1, 0
    s_waitcnt vmcnt(0)
    global_load_dwordx4 v[4:7], v105, s[34:35] sc1
    global_load_dwordx4 v[12:15], v105, s[34:35] offset:1024 sc1
    s_waitcnt vmcnt(1)
    v_mfma_f32_16x16x32_bf16 v[8:11], v[108:111], v[4:7], 0
    s_waitcnt vmcnt(0)
    v_mfma_f32_16x16x32_bf16 v[8:11], v[108:111], v[12:15], v[8:11]
    s_nop 7
    v_add_f32_dpp v8, v8, v8 row_ror:4 row_mask:0xf bank_mask:0xf
    v_add_f32_dpp v9, v9, v9 row_ror:4 row_mask:0xf bank_mask:0xf
    v_cmp_u_f32 vcc, v10, v10
    v_add_f32_dpp v8, v8, v8 row_ror:8 row_mask:0xf bank_mask:0xf
    v_add_f32_dpp v9, v9, v9 row_ror:8 row_mask:0xf bank_mask:0xf
    v_cvt_pk_bf16_f32 v8, v8, v9
    global_load_dwordx4 v[0:3], v105, s[40:41] offset:-2048 sc1
    global_store_dword v113, v8, s[36:37] sc1
    s_cbranch_vccnz L_cs_lret
L_cs_lok:
    s_waitcnt lgkmcnt(0)
    s_branch L_cs_chk
L_cs_eret:
    global_load_dwordx4 v[4:7], v105, s[34:35] sc1
    global_load_dwordx4 v[12:15], v105, s[34:35] offset:1024 sc1
    s_waitcnt vmcnt(1)
    v_mfma_f32_16x16x32_bf16 v[8:11], v[108:111], v[4:7], 0
    s_waitcnt vmcnt(0)
    v_mfma_f32_16x16x32_bf16 v[8:11], v[108:111], v[12:15], v[8:11]
    s_nop 7
    v_add_f32_dpp v8, v8, v8 row_ror:4 row_mask:0xf bank_mask:0xf
    v_add_f32_dpp v9, v9, v9 row_ror:4 row_mask:0xf bank_mask:0xf
    v_cmp_u_f32 vcc, v10, v10
    v_add_f32_dpp v8, v8, v8 row_ror:8 row_mask:0xf bank_mask:0xf
    v_add_f32_dpp v9, v9, v9 row_ror:8 row_mask:0xf bank_mask:0xf
    v_cvt_pk_bf16_f32 v8, v8, v9
    global_store_dword v113, v8, s[36:37] sc1
    s_cbranch_vccz L_cs_eok
    s_sub_u32 s27, s27, 1
    s_cbranch_scc0 L_cs_eret
    s_branch L_end
L_cs_lret:
    global_load_dwordx4 v[4:7], v105, s[34:35] sc1
    global_load_dwordx4 v[12:15], v105, s[34:35] offset:1024 sc1
    s_waitcnt vmcnt(1)
    v_mfma_f32_16x16x32_bf16 v[8:11], v[108:111], v[4:7], 0
    s_waitcnt vmcnt(0)
    v_mfma_f32_16x16x32_bf16 v[8:11], v[108:111], v[12:15], v[8:11]
    s_nop 7
    v_add_f32_dpp v8, v8, v8 row_ror:4 row_mask:0xf bank_mask:0xf
    v_add_f32_dpp v9, v9, v9 row_ror:4 row_mask:0xf bank_mask:0xf
    v_cmp_u_f32 vcc, v10, v10
    v_add_f32_dpp v8, v8, v8 row_ror:8 row_mask:0xf bank_mask:0xf
    v_add_f32_dpp v9, v9, v9 row_ror:8 row_mask:0xf bank_mask:0xf
    v_cvt_pk_bf16_f32 v8, v8, v9
    global_store_dword v113, v8, s[36:37] sc1
    s_cbranch_vccz L_cs_lok
    s_sub_u32 s27, s27, 1
    s_cbranch_scc0 L_cs_lret
    s_branch L_end
L_cs_mlfail2:
    s_waitcnt vmcnt(4) lgkmcnt(0)
    v_max3_u32 v28, v4, v5, v6
    v_max_u32 v28, v28, v7
    v_cmp_le_u32 vcc, s71, v28
    ds_write_b128 v114, v[4:7] offset:1024
    s_cbranch_vccz L_cs_mlok
L_cs_mlfail:
    global_load_dwordx4 v[4:7], v105, s[40:41] offset:2048 sc1
    s_waitcnt vmcnt(0) lgkmcnt(0)
    v_max3_u32 v28, v4, v5, v6
    v_max_u32 v28, v28, v7
    v_cmp_le_u32 vcc, s71, v28
    ds_write_b128 v114, v[4:7] offset:1024
    s_cbranch_vccz L_cs_mlok
    s_sub_u32 s27, s27, 1
    s_cbranch_scc0 L_cs_mlfail
    s_branch L_end
L_cs_fle:
    global_load_dword v123, v122, s[96:97] sc1
    s_waitcnt vmcnt(0)
    v_cmp_ge_u32 vcc, s59, v123
    s_cbranch_vccz L_cs_floke
    s_sleep 1
    s_sub_u32 s27, s27, 1
    s_cbranch_scc0 L_cs_fle
    s_branch L_end
L_cs_fll:
    global_load_dword v123, v122, s[96:97] sc1
    s_waitcnt vmcnt(0)
    v_cmp_ge_u32 vcc, s59, v123
    s_cbranch_vccz L_cs_flokl
    s_sleep 1
    s_sub_u32 s27, s27, 1
    s_cbranch_scc0 L_cs_fll
    s_branch L_end
L_cs_done:
    v_smfmac_f32_16x16x64_bf16 v[84:87], v[4:7], a[152:159], v104
    v_smfmac_f32_16x16x64_bf16 v[80:83], v[12:15], a[176:183], v104
    v_smfmac_f32_16x16x64_bf16 v[84:87], v[12:15], a[184:191], v104
    s_nop 6
    v_pk_add_f32 v[80:81], v[80:81], v[82:83]
    v_pk_add_f32 v[84:85], v[84:85], v[86:87]
    v_cvt_pk_bf16_f32 v82, v80, v81
    v_cvt_pk_bf16_f32 v83, v84, v85
    v_cndmask_b32 v96, v82, v64, vcc
    v_cndmask_b32 v97, v83, v65, vcc
    v_cndmask_b32_dpp v98, v82, v66, vcc quad_perm:[2,3,0,1] row_mask:0xf bank_mask:0xf
    v_cndmask_b32_dpp v99, v83, v67, vcc quad_perm:[2,3,0,1] row_mask:0xf bank_mask:0xf
    global_store_dwordx4 v105, v[96:99], s[44:45] sc1
    s_waitcnt lgkmcnt(0)
    v_mov_b32 v29, 65
    s_waitcnt vmcnt(0)
    s_barrier
    s_mov_b64 exec, 1
    global_store_dword v105, v29, s[4:5] sc1
    s_mov_b64 exec, -1
    s_endpgm
L_cs_cend:
L_end:
L_end2:
    s_endpgm
.section .rodata,"a"
.p2align 6
.amdhsa_kernel concat_heads__memory_aug_recurrent_mem_tr__memory_aug_recurrent_mem_tr__prompt_kernel
  .amdhsa_next_free_vgpr 512
  .amdhsa_next_free_sgpr 102
  .amdhsa_accum_offset 256
  .amdhsa_group_segment_fixed_size 0
  .amdhsa_kernarg_size 136
  .amdhsa_user_sgpr_count 2
  .amdhsa_user_sgpr_kernarg_segment_ptr 1
  .amdhsa_system_sgpr_workgroup_id_x 1
  .amdhsa_float_denorm_mode_32 3
.end_amdhsa_kernel
```
